```python
import torch

def _softmax(x, axis=-1):
    return torch.softmax(x, dim=axis)
def _gelu(x):
    return torch.nn.functional.gelu(x, approximate="tanh")
def _silu(x):
    return torch.nn.functional.silu(x)
def _sigmoid(x):
    return torch.sigmoid(x)
def _layernorm(x, axis=-1, eps=1e-5):
    m = x.mean(dim=axis, keepdim=True)
    v = x.var(dim=axis, keepdim=True, unbiased=False)
    return (x - m) / torch.sqrt(v + eps)
def _scatter_add(tgt, idx, src, axis=0):
    return tgt.clone().index_add_(axis, idx, src)
def _segment_sum(src, seg, n):
    out = torch.zeros((n,) + src.shape[1:], dtype=src.dtype)
    return out.index_add_(0, seg, src)
def _pad(x, pw):
    flat = tuple(v for pair in reversed(pw) for v in pair)
    return torch.nn.functional.pad(x, flat)

kernel_name = 'interleave_layers__linear_kernel_hedgehog__mixer_s_mlp__prompt'

def setup_inputs():

    _w = (lambda a: (lambda t: t.to(torch.bfloat16) if t.is_floating_point() else t)(torch.as_tensor(a)))
    def _A_setup():
        B, S, D, H = 1, 2048, 640, 32
        Dh = D // H
        return {
            "x": _w((lambda *s: torch.randn(*s, dtype=torch.bfloat16) * 0.05)(B, S, D)),
            "wqkv": _w((lambda *s: torch.randn(*s, dtype=torch.bfloat16) * 0.4)(D, 3 * D)),
            "w_phi": _w((lambda *s: torch.randn(*s, dtype=torch.bfloat16) * 0.4)(H, Dh, Dh) * (Dh ** -0.5)),
            "wo": _w((lambda *s: torch.randn(*s, dtype=torch.bfloat16) * 0.05)(D, D)),
        }
    _A_in = _A_setup()

    def _B_setup():
        B, S, D, F = 1, 2048, 640, 1536
        return {
            "x":  _w((lambda *s: torch.randn(*s, dtype=torch.bfloat16) * 0.05)(B, S, D)),
            "w1": _w((lambda *s: torch.randn(*s, dtype=torch.bfloat16) * 3.2)(D, D) * (D ** -0.5)),
            "w2": _w((lambda *s: torch.randn(*s, dtype=torch.bfloat16) * 3.2)(D, D) * (D ** -0.5)),
            "w3": _w((lambda *s: torch.randn(*s, dtype=torch.bfloat16) * 3.2)(D, F) * (D ** -0.5)),
            "w4": _w((lambda *s: torch.randn(*s, dtype=torch.bfloat16) * 3.2)(F, D) * (F ** -0.5)),
        }
    _B_in = _B_setup()

    return {
        "A_x": _A_in["x"],
        "A_wqkv": _A_in["wqkv"],
        "A_w_phi": _A_in["w_phi"],
        "A_wo": _A_in["wo"],
        "B_x": _B_in["x"],
        "B_w1": _B_in["w1"],
        "B_w2": _B_in["w2"],
        "B_w3": _B_in["w3"],
        "B_w4": _B_in["w4"],
    }

def reference(A_x, A_wqkv, A_w_phi, A_wo, B_x, B_w1, B_w2, B_w3, B_w4):
    def _A_ref(x, wqkv, w_phi, wo):
        B, S, D = x.shape
        H = 32; Dh = D // H
        qkv = (lambda x, *d: x.permute(*d))((x @ wqkv).reshape(B, S, 3, H, Dh), 2, 0, 3, 1, 4)
        q, k, v = qkv[0], qkv[1], qkv[2]
        pq = torch.einsum("bhsd,hdf->bhsf", q, w_phi)
        pk = torch.einsum("bhsd,hdf->bhsf", k, w_phi)
        phi_q = torch.concatenate([_softmax(pq, axis=-1), _softmax(-pq, axis=-1)], axis=-1)
        phi_k = torch.concatenate([_softmax(pk, axis=-1), _softmax(-pk, axis=-1)], axis=-1)
        kv = torch.einsum("bhsf,bhsd->bhfd", phi_k, v)
        z  = torch.einsum("bhsf->bhf", phi_k)
        num = torch.einsum("bhqf,bhfd->bhqd", phi_q, kv)
        den = torch.einsum("bhqf,bhf->bhq", phi_q, z)[..., None] + 1e-6
        o = num / den
        return (lambda x, *d: x.permute(*d))(o, 0, 2, 1, 3).reshape(B, S, D) @ wo

    def _B_ref(x, w1, w2, w3, w4):
        B, S, D = x.shape
        h = _gelu(_layernorm(x, axis=-1) @ w1)
        c = D // 4
        g0 = _pad(h[:, :, 0*c:1*c], ((0, 0), (1, 0), (0, 0)))[:, :S, :]
        g1 = _pad(h[:, :, 1*c:2*c], ((0, 0), (0, 1), (0, 0)))[:, 1:, :]
        g2 = _pad(h[:, :, 2*c:3*c], ((0, 0), (2, 0), (0, 0)))[:, :S, :]
        g3 = _pad(h[:, :, 3*c:   ], ((0, 0), (0, 2), (0, 0)))[:, 2:, :]
        hs = torch.concatenate([g0, g1, g2, g3], axis=-1) @ w2
        x1 = x + hs
        h2 = _gelu(_layernorm(x1, axis=-1) @ w3) @ w4
        return x1 + h2

    x = A_x
    x = x + _A_ref(_layernorm(x, axis=-1), A_wqkv, A_w_phi, A_wo)
    x = x + _B_ref(_layernorm(x, axis=-1), B_w1, B_w2, B_w3, B_w4)
    x = x + _A_ref(_layernorm(x, axis=-1), A_wqkv, A_w_phi, A_wo)
    x = x + _B_ref(_layernorm(x, axis=-1), B_w1, B_w2, B_w3, B_w4)
    return x
```

```asm
; @launch grid=(256,1,1) block=(256,1,1) lds=163840
.amdgcn_target "amdgcn-amd-amdhsa--gfx950"
.text
.globl interleave_layers__linear_kernel_hedgehog__mixer_s_mlp__prompt_kernel
.p2align 8
.type interleave_layers__linear_kernel_hedgehog__mixer_s_mlp__prompt_kernel,@function
interleave_layers__linear_kernel_hedgehog__mixer_s_mlp__prompt_kernel:
KSTART:
    s_cmp_ge_u32 s2, 256
    s_cbranch_scc1 KEND
    s_load_dwordx16 s[20:35], s[0:1], 0
    s_load_dwordx8 s[36:43], s[0:1], 64
    s_getpc_b64 s[4:5]
PCL0:
    s_lshr_b32 s45, s2, 3
    s_lshl_b32 s82, s45, 12
    v_lshl_add_u32 v26, v0, 4, s82
    v_min_u32 v26, CODE_END-PCL0-16, v26
    global_load_dword a253, v26, s[4:5]
    v_lshrrev_b32 v7, 6, v0
    v_mov_b32 v25, v0
    v_readfirstlane_b32 s49, v7
    v_and_b32 v0, 63, v0
    s_and_b32 s44, s2, 7
    s_lshr_b32 s46, s45, 3
    s_and_b32 s47, s45, 7
    s_lshl_b32 s48, s44, 2
    s_add_u32 s48, s48, s46
    s_lshl_b32 s51, s48, 2
    s_add_u32 s51, s51, s49
    s_mul_i32 s82, s47, 5
    s_add_u32 s82, s82, 1
    s_lshr_b32 s82, s82, 1
    s_lshl_b32 s52, s82, 10
    s_mul_i32 s53, s47, 2560
    s_bitcmp0_b32 s47, 0
    s_cselect_b32 s85, 2048, 0
    s_add_u32 s53, s53, s85
    s_mul_i32 s58, s51, 20480
    s_lshr_b32 s64, s52, 4
    s_lshr_b32 s65, s53, 4
    s_add_u32 s64, s64, s58
    s_add_u32 s65, s65, s58
    v_and_b32 v20, 15, v0
    v_lshrrev_b32 v21, 4, v0
    v_mul_u32_u24 v26, 1280, v20
    v_lshl_add_u32 v36, v21, 4, v26
    v_lshl_add_u32 v37, v21, 3, v26
    s_lshr_b32 s83, s2, 1
    s_and_b32 s82, s2, 1
    s_mul_i32 s87, s83, 30720
    s_mul_i32 s84, s82, 640
    s_add_u32 s87, s87, s84
    s_cmp_lt_u32 s2, 160
    s_cselect_b32 s6, 0, 2147483648
    s_cselect_b32 s87, s87, 0
    v_add_u32 v26, 0, v25
    v_mul_u32_u24 v27, 13108, v26
    v_lshrrev_b32 v27, 19, v27
    v_mul_u32_u24 v28, 40, v27
    v_sub_u32 v28, v26, v28
    v_and_b32 v29, 7, v27
    v_mul_u32_u24 v29, 3840, v29
    v_lshl_add_u32 v29, v28, 4, v29
    v_lshrrev_b32 v27, 3, v27
    v_mul_u32_u24 v28, 1280, v27
    v_add3_u32 v40, v29, v28, s6
    v_add_u32 v26, 256, v25
    v_mul_u32_u24 v27, 13108, v26
    v_lshrrev_b32 v27, 19, v27
    v_mul_u32_u24 v28, 40, v27
    v_sub_u32 v28, v26, v28
    v_and_b32 v29, 7, v27
    v_mul_u32_u24 v29, 3840, v29
    v_lshl_add_u32 v29, v28, 4, v29
    v_lshrrev_b32 v27, 3, v27
    v_mul_u32_u24 v28, 1280, v27
    v_add3_u32 v41, v29, v28, s6
    v_add_u32 v26, 512, v25
    v_mul_u32_u24 v27, 13108, v26
    v_lshrrev_b32 v27, 19, v27
    v_mul_u32_u24 v28, 40, v27
    v_sub_u32 v28, v26, v28
    v_and_b32 v29, 7, v27
    v_mul_u32_u24 v29, 3840, v29
    v_lshl_add_u32 v29, v28, 4, v29
    v_lshrrev_b32 v27, 3, v27
    v_mul_u32_u24 v28, 1280, v27
    v_add3_u32 v42, v29, v28, s6
    v_add_u32 v26, 768, v25
    v_mul_u32_u24 v27, 13108, v26
    v_lshrrev_b32 v27, 19, v27
    v_mul_u32_u24 v28, 40, v27
    v_sub_u32 v28, v26, v28
    v_and_b32 v29, 7, v27
    v_mul_u32_u24 v29, 3840, v29
    v_lshl_add_u32 v29, v28, 4, v29
    v_lshrrev_b32 v27, 3, v27
    v_mul_u32_u24 v28, 1280, v27
    v_add3_u32 v43, v29, v28, s6
    v_cmp_gt_u32 vcc, 3, v27
    v_mov_b32 v28, 2147483648
    s_nop 0
    v_cndmask_b32 v43, v28, v43, vcc
    s_lshl_b32 s79, s49, 10
    s_mov_b32 s15, 0x20000
    s_mov_b32 s11, 0x20000
    s_mov_b32 s19, 0x20000
    s_mov_b32 s10, 0x10000000
    s_mov_b32 s18, 2621440
    s_lshl_b32 s90, s2, 2
    s_add_u32 s90, s90, s49
    s_memrealtime s[94:95]
    s_waitcnt lgkmcnt(0)
    s_mov_b32 s8, s42
    s_and_b32 s9, s43, 0xffff
    s_cmp_lg_u32 s90, 3
    s_cbranch_scc1 NOTAG
    s_lshl_b32 s95, s95, 4
    s_or_b32 s95, s95, 0x80000000
    v_mov_b32 v26, s94
    v_mov_b32 v27, s95
    v_mov_b32 v28, 0
    s_mov_b64 exec, 1
    global_store_dwordx2 v28, v[26:27], s[40:41] sc1
    s_mov_b64 exec, -1
NOTAG:
    s_mov_b32 s12, s22
    s_and_b32 s13, s23, 0xffff
    s_mov_b32 s14, 2457600
    s_add_u32 m0, s79, 0
    s_nop 0
    buffer_load_dwordx4 v40, s[12:15], s87 offen nt lds
    s_add_u32 m0, s79, 4096
    s_nop 0
    buffer_load_dwordx4 v41, s[12:15], s87 offen nt lds
    s_add_u32 m0, s79, 8192
    s_nop 0
    buffer_load_dwordx4 v42, s[12:15], s87 offen nt lds
    s_add_u32 m0, s79, 12288
    s_nop 0
    buffer_load_dwordx4 v43, s[12:15], s87 offen nt lds
    s_mov_b32 s12, s20
    s_and_b32 s13, s21, 0xffff
    s_mov_b32 s14, 2621440
    buffer_load_dwordx4 v[8:11], v36, s[12:15], s64 offen nt
    buffer_load_dwordx4 v[12:15], v36, s[12:15], s64 offen offset:64 nt
    buffer_load_dwordx2 v[16:17], v37, s[12:15], s65 offen nt
    s_mov_b32 s16, s38
    s_and_b32 s17, s39, 0xffff
    s_mul_i32 s93, s82, 1310720
    s_mul_i32 s84, s49, 327680
    s_add_u32 s93, s93, s84
    s_lshr_b32 s84, s83, 2
    s_lshl_b32 s84, s84, 12
    s_add_u32 s93, s93, s84
    s_and_b32 s84, s83, 3
    s_lshl_b32 s84, s84, 8
    s_add_u32 s93, s93, s84
    s_mov_b32 s4, s6
    s_add_u32 s90, s90, 384
    s_and_b32 s90, s90, 1023
    s_mov_b32 s12, s26
    s_mov_b32 s13, s27
    s_mov_b32 s14, 819200
    s_mov_b32 s88, 3145728
    s_mov_b32 s89, 102400
    s_mov_b32 s82, s90
    s_sub_u32 s83, s90, 160
    s_cmp_ge_u32 s90, 160
    s_cselect_b32 s12, s30, s12
    s_cselect_b32 s13, s31, s13
    s_cselect_b32 s88, 4194304, s88
    s_cselect_b32 s82, s83, s82
    s_sub_u32 s83, s90, 320
    s_cmp_ge_u32 s90, 320
    s_cselect_b32 s12, s32, s12
    s_cselect_b32 s13, s33, s13
    s_cselect_b32 s88, 5242880, s88
    s_cselect_b32 s82, s83, s82
    s_sub_u32 s83, s90, 480
    s_cmp_ge_u32 s90, 480
    s_cselect_b32 s12, s36, s12
    s_cselect_b32 s13, s37, s13
    s_cselect_b32 s88, 8388608, s88
    s_cselect_b32 s82, s83, s82
    s_cselect_b32 s89, 245760, s89
    s_cselect_b32 s14, 1966080, s14
    s_and_b32 s13, s13, 0xffff
    s_cmp_lt_u32 s90, 864
    s_cselect_b32 s6, s4, 2147483648
    s_cselect_b32 s82, s82, 0
    s_xor_b32 s5, s4, 2147483648
    s_lshr_b32 s83, s82, 1
    s_and_b32 s82, s82, 1
    s_lshl_b32 s87, s83, 3
    s_mov_b32 s86, 0
    s_cmp_ge_u32 s90, 160
    s_cbranch_scc1 PREP_RB
    s_lshr_b32 s84, s83, 1
    s_mul_i32 s84, s84, 20
    s_and_b32 s87, s83, 1
    s_lshl_b32 s87, s87, 3
    s_add_u32 s87, s87, s84
    s_cmp_lt_u32 s83, 64
    s_cbranch_scc1 PREP_RB
    s_sub_u32 s84, s83, 64
    s_mul_i32 s87, s84, 40
    s_add_u32 s87, s87, 16
    s_mov_b32 s86, 20480
PREP_RB:
    s_mul_i32 s87, s87, 1280
    s_mul_i32 s84, s82, 640
    s_add_u32 s87, s87, s84
    s_lshl_b32 s79, s49, 13
    s_add_u32 s79, s79, 32768
    v_add_u32 v26, 0, v0
    v_mul_u32_u24 v27, 1639, v26
    v_lshrrev_b32 v27, 16, v27
    v_mul_u32_u24 v28, 40, v27
    v_sub_u32 v28, v26, v28
    v_mul_u32_u24 v29, 1280, v27
    v_lshl_add_u32 v29, v28, 4, v29
    v_lshrrev_b32 v27, 2, v27
    v_mad_u32_u24 v29, v27, s86, v29
    v_or_b32 v200, s6, v29
    v_or_b32 v29, s5, v29
    s_add_u32 m0, s79, 0
    s_nop 0
    buffer_load_dwordx4 v29, s[12:15], s87 offen nt lds
    v_add_u32 v26, 64, v0
    v_mul_u32_u24 v27, 1639, v26
    v_lshrrev_b32 v27, 16, v27
    v_mul_u32_u24 v28, 40, v27
    v_sub_u32 v28, v26, v28
    v_mul_u32_u24 v29, 1280, v27
    v_lshl_add_u32 v29, v28, 4, v29
    v_lshrrev_b32 v27, 2, v27
    v_mad_u32_u24 v29, v27, s86, v29
    v_or_b32 v201, s6, v29
    v_or_b32 v29, s5, v29
    s_add_u32 m0, s79, 1024
    s_nop 0
    buffer_load_dwordx4 v29, s[12:15], s87 offen nt lds
    v_add_u32 v26, 128, v0
    v_mul_u32_u24 v27, 1639, v26
    v_lshrrev_b32 v27, 16, v27
    v_mul_u32_u24 v28, 40, v27
    v_sub_u32 v28, v26, v28
    v_mul_u32_u24 v29, 1280, v27
    v_lshl_add_u32 v29, v28, 4, v29
    v_lshrrev_b32 v27, 2, v27
    v_mad_u32_u24 v29, v27, s86, v29
    v_or_b32 v202, s6, v29
    v_or_b32 v29, s5, v29
    s_add_u32 m0, s79, 2048
    s_nop 0
    buffer_load_dwordx4 v29, s[12:15], s87 offen nt lds
    v_add_u32 v26, 192, v0
    v_mul_u32_u24 v27, 1639, v26
    v_lshrrev_b32 v27, 16, v27
    v_mul_u32_u24 v28, 40, v27
    v_sub_u32 v28, v26, v28
    v_mul_u32_u24 v29, 1280, v27
    v_lshl_add_u32 v29, v28, 4, v29
    v_lshrrev_b32 v27, 2, v27
    v_mad_u32_u24 v29, v27, s86, v29
    v_or_b32 v203, s6, v29
    v_or_b32 v29, s5, v29
    s_add_u32 m0, s79, 3072
    s_nop 0
    buffer_load_dwordx4 v29, s[12:15], s87 offen nt lds
    v_add_u32 v26, 256, v0
    v_mul_u32_u24 v27, 1639, v26
    v_lshrrev_b32 v27, 16, v27
    v_mul_u32_u24 v28, 40, v27
    v_sub_u32 v28, v26, v28
    v_mul_u32_u24 v29, 1280, v27
    v_lshl_add_u32 v29, v28, 4, v29
    v_lshrrev_b32 v27, 2, v27
    v_mad_u32_u24 v29, v27, s86, v29
    v_or_b32 v204, s6, v29
    v_or_b32 v29, s5, v29
    s_add_u32 m0, s79, 4096
    s_nop 0
    buffer_load_dwordx4 v29, s[12:15], s87 offen nt lds
    s_mul_i32 s84, s82, s89
    s_lshl_b32 s84, s84, 2
    s_add_u32 s88, s88, s84
    s_lshr_b32 s84, s83, 2
    s_mul_i32 s84, s84, 5120
    s_add_u32 s88, s88, s84
    s_and_b32 s84, s83, 3
    s_lshl_b32 s84, s84, 8
    s_add_u32 s88, s88, s84
    s_add_u32 s82, s90, 160
    s_and_b32 s82, s82, 1023
    s_cmp_lt_u32 s82, 640
    s_cselect_b32 s7, 0, 2147483648
    s_cselect_b32 s82, s82, 0
    s_lshr_b32 s83, s82, 3
    s_and_b32 s82, s82, 7
    s_mul_i32 s3, s83, 24576
    s_mul_i32 s84, s82, 384
    s_add_u32 s3, s3, s84
    s_mul_i32 s85, s82, 245760
    s_lshl_b32 s84, s83, 8
    s_add_u32 s85, s85, s84
    s_add_u32 s85, s85, 6291456
    s_mov_b32 s67, 400000
    s_mov_b32 s50, 0
    s_mul_i32 s55, s51, 21504
    s_mul_i32 s59, s51, 49152
    s_add_u32 s56, s58, s52
    s_add_u32 s57, s58, s53
    s_add_u32 s52, s55, s52
    s_add_u32 s53, s55, s53
    s_lshr_b32 s82, s47, 1
    s_lshl_b32 s82, s82, 8
    s_and_b32 s83, s47, 1
    s_lshl_b32 s83, s83, 3
    s_add_u32 s54, s55, s82
    s_add_u32 s54, s54, s83
    s_add_u32 s54, s54, 20480
    s_mul_i32 s63, s49, 5120
    s_mul_i32 s60, s47, 102400
    s_add_u32 s60, s60, s63
    s_mul_i32 s61, s47, 245760
    s_add_u32 s61, s61, s63
    s_mul_i32 s62, s45, 81920
    s_add_u32 s62, s62, s63
    s_lshl_b32 s78, s45, 2
    s_add_u32 s78, s78, s49
    s_lshl_b32 s82, s44, 2
    s_add_u32 s82, s82, s49
    s_mul_i32 s68, s82, 86016
    s_mul_i32 s83, s82, 81920
    s_lshl_b32 s84, s45, 9
    s_add_u32 s69, s83, s84
    s_lshr_b32 s84, s45, 1
    s_lshl_b32 s84, s84, 8
    s_add_u32 s70, s83, s84
    s_and_b32 s84, s45, 1
    s_lshl_b32 s84, s84, 3
    s_add_u32 s70, s70, s84
    s_add_u32 s70, s70, 16384
    s_lshl_b32 s84, s82, 7
    s_lshl_b32 s77, s45, 2
    s_add_u32 s77, s84, s77
    s_add_u32 s77, s77, 13639680
    s_lshl_b32 s72, s45, 16
    s_lshl_b32 s84, s49, 10
    s_add_u32 s72, s72, s84
    s_add_u32 s72, s72, 14680064
    s_lshl_b32 s84, s44, 13
    s_add_u32 s71, s72, s84
    s_lshl_b32 s82, s47, 2
    s_add_u32 s82, s82, s49
    s_mul_i32 s81, s82, 61440
    s_mul_i32 s83, s82, 3
    s_add_u32 s83, s83, 1
    s_lshr_b32 s83, s83, 1
    s_lshl_b32 s73, s83, 10
    s_mul_i32 s74, s82, 1536
    s_bitcmp0_b32 s82, 0
    s_cselect_b32 s84, 1024, 0
    s_add_u32 s74, s74, s84
    s_mul_i32 s84, s48, 196608
    s_add_u32 s73, s84, s73
    s_add_u32 s74, s84, s74
    s_mul_i32 s75, s48, 86016
    s_lshl_b32 s76, s51, 5
    s_lshl_b32 s84, s47, 2
    s_add_u32 s76, s76, s84
    s_add_u32 s76, s76, 13635584
    s_and_b32 s82, s51, 15
    s_mov_b32 s66, 2147483648
    s_cmp_eq_u32 s82, 0
    s_cselect_b32 s66, 0, s66
    s_cmp_eq_u32 s82, 15
    s_cselect_b32 s66, 0, s66
    s_cselect_b32 s80, 1, 0
    s_cmp_eq_u32 s51, 0
    s_cselect_b32 s66, 2147483648, s66
    s_cmp_eq_u32 s51, 127
    s_cselect_b32 s66, 2147483648, s66
    v_lshlrev_b32 v1, 4, v0
    v_add_u32 v2, 0x10000, v1
    v_add_u32 v3, 0x20000, v1
    v_lshrrev_b32 v22, 5, v0
    v_and_b32 v23, 1, v21
    v_lshlrev_b32 v24, 4, v20
    v_lshl_add_u32 v4, v22, 8, v24
    v_lshl_add_u32 v4, v23, 3, v4
    v_lshl_add_u32 v5, v22, 2, v24
    v_and_b32 v6, 31, v0
    v_lshlrev_b32 v6, 2, v6
    v_lshrrev_b32 v26, 2, v20
    v_and_b32 v27, 3, v20
    s_mul_i32 s84, s49, 160
    v_mul_u32_u24 v29, 640, v26
    v_add_u32 v29, s84, v29
    v_mul_u32_u24 v28, 40, v21
    v_add_u32 v29, v29, v28
    v_lshl_add_u32 v30, v27, 3, v29
    v_lshlrev_b32 v28, 3, v27
    v_add_u32 v31, 10232, v28
    v_mov_b32 v33, 5152
    v_cmp_eq_u32 vcc, 0, v27
    s_nop 1
    v_cndmask_b32 v31, v31, v33, vcc
    v_add_u32 v31, v31, v29
    v_min_u32 v28, 2, v27
    v_lshlrev_b32 v28, 3, v28
    v_add_u32 v33, 10256, v28
    v_mov_b32 v34, 32
    v_cndmask_b32 v33, v33, v34, vcc
    v_add_u32 v33, v33, v29
    s_mov_b32 s84, 81920
    v_mul_lo_u32 v32, v21, s84
    v_add3_u32 v32, v32, v24, s4
    v_add_u32 v26, 0, v0
    v_mul_u32_u24 v27, 2731, v26
    v_lshrrev_b32 v27, 16, v27
    v_mul_u32_u24 v28, 24, v27
    v_sub_u32 v28, v26, v28
    v_mul_u32_u24 v29, 3072, v27
    v_lshl_add_u32 v29, v28, 4, v29
    v_or_b32 v205, s7, v29
    v_add_u32 v26, 64, v0
    v_mul_u32_u24 v27, 2731, v26
    v_lshrrev_b32 v27, 16, v27
    v_mul_u32_u24 v28, 24, v27
    v_sub_u32 v28, v26, v28
    v_mul_u32_u24 v29, 3072, v27
    v_lshl_add_u32 v29, v28, 4, v29
    v_or_b32 v206, s7, v29
    v_add_u32 v26, 128, v0
    v_mul_u32_u24 v27, 2731, v26
    v_lshrrev_b32 v27, 16, v27
    v_mul_u32_u24 v28, 24, v27
    v_sub_u32 v28, v26, v28
    v_mul_u32_u24 v29, 3072, v27
    v_lshl_add_u32 v29, v28, 4, v29
    v_or_b32 v207, s7, v29
    v_lshrrev_b32 v26, 2, v20
    v_and_b32 v27, 3, v20
    v_mul_u32_u24 v28, 5, v21
    v_add_u32 v28, 1, v28
    v_lshrrev_b32 v28, 1, v28
    v_mul_u32_u24 v29, 640, v26
    v_add_u32 v29, s79, v29
    v_lshl_add_u32 v210, v28, 6, v29
    v_lshl_add_u32 v210, v27, 4, v210
    v_mul_u32_u24 v211, 160, v21
    v_xor_b32 v28, 1, v23
    v_lshl_add_u32 v211, v28, 7, v211
    v_add_u32 v211, v211, v29
    v_lshl_add_u32 v211, v27, 3, v211
    v_mul_lo_u32 v212, v21, s89
    v_add3_u32 v216, v212, v24, s5
    v_add3_u32 v212, v212, v24, s6
    v_mul_u32_u24 v29, 384, v26
    v_add_u32 v29, s79, v29
    v_mul_u32_u24 v28, 96, v21
    v_add_u32 v29, v29, v28
    v_lshl_add_u32 v213, v23, 5, v29
    v_lshl_add_u32 v213, v27, 4, v213
    v_xor_b32 v28, 1, v23
    v_lshl_add_u32 v214, v28, 6, v29
    v_lshl_add_u32 v214, v27, 3, v214
    v_mul_u32_u24 v215, 61440, v21
    v_add3_u32 v215, v215, v24, s7
    s_getreg_b32 s90, hwreg(HW_REG_XCC_ID)
    s_and_b32 s90, s90, 15
    v_mov_b32 v132, -1
    v_mov_b32 v133, -1
    v_mov_b32 v134, -1
    v_mov_b32 v135, -1
    v_mov_b32 v136, -1
    v_mov_b32 v137, -1
    v_mov_b32 v138, -1
    v_mov_b32 v139, -1
    v_mov_b32 v140, -1
    v_mov_b32 v141, -1
    v_mov_b32 v128, 0
    s_waitcnt vmcnt(0)
    v_mov_b32 v26, 0
    global_load_dwordx2 v[208:209], v26, s[40:41] sc1
    s_add_u32 s82, s52, 18874368
    s_add_u32 s83, s53, 18874368
    buffer_store_dwordx4 v[8:11], v1, s[8:11], s82 offen sc1
    buffer_store_dwordx4 v[12:15], v1, s[8:11], s82 offen offset:1024 sc1
    buffer_store_dwordx2 v[16:17], v4, s[8:11], s83 offen sc1
    ds_read_b64_tr_b16 v[64:65], v210 offset:0
    ds_read_b64_tr_b16 v[66:67], v210 offset:2560
    ds_read_b64_tr_b16 v[68:69], v210 offset:8
    ds_read_b64_tr_b16 v[70:71], v210 offset:2568
    ds_read_b64_tr_b16 v[72:73], v210 offset:64
    ds_read_b64_tr_b16 v[74:75], v210 offset:2624
    ds_read_b64_tr_b16 v[76:77], v210 offset:72
    ds_read_b64_tr_b16 v[78:79], v210 offset:2632
    ds_read_b64_tr_b16 v[80:81], v211 offset:0
    ds_read_b64_tr_b16 v[82:83], v211 offset:2560
    s_barrier
    s_waitcnt lgkmcnt(0)
    ds_read_b64_tr_b16 v[48:49], v30 offset:5120
    ds_read_b64_tr_b16 v[50:51], v30 offset:7680
    ds_read_b64_tr_b16 v[52:53], v31 offset:0
    ds_read_b64_tr_b16 v[54:55], v31 offset:2560
    ds_read_b64_tr_b16 v[56:57], v30 offset:0
    ds_read_b64_tr_b16 v[58:59], v30 offset:2560
    ds_read_b64_tr_b16 v[60:61], v33 offset:0
    ds_read_b64_tr_b16 v[62:63], v33 offset:2560
    buffer_store_dwordx4 v[64:67], v216, s[8:11], s88 offen offset:0 sc1
    buffer_store_dwordx4 v[68:71], v216, s[8:11], s88 offen offset:1024 sc1
    buffer_store_dwordx4 v[72:75], v216, s[8:11], s88 offen offset:2048 sc1
    buffer_store_dwordx4 v[76:79], v216, s[8:11], s88 offen offset:3072 sc1
    s_add_u32 s82, s88, 4096
    buffer_store_dwordx4 v[80:83], v216, s[8:11], s82 offen sc1
    s_waitcnt lgkmcnt(0)
    buffer_store_dwordx4 v[48:51], v32, s[8:11], s93 offen offset:0 sc1
    buffer_store_dwordx4 v[52:55], v32, s[8:11], s93 offen offset:1024 sc1
    buffer_store_dwordx4 v[56:59], v32, s[8:11], s93 offen offset:2048 sc1
    buffer_store_dwordx4 v[60:63], v32, s[8:11], s93 offen offset:3072 sc1
    v_lshlrev_b32 v144, 16, v8
    v_and_b32 v145, 0xffff0000, v8
    v_lshlrev_b32 v146, 16, v9
    v_and_b32 v147, 0xffff0000, v9
    v_lshlrev_b32 v148, 16, v10
    v_and_b32 v149, 0xffff0000, v10
    v_lshlrev_b32 v150, 16, v11
    v_and_b32 v151, 0xffff0000, v11
    v_lshlrev_b32 v152, 16, v12
    v_and_b32 v153, 0xffff0000, v12
    v_lshlrev_b32 v154, 16, v13
    v_and_b32 v155, 0xffff0000, v13
    v_lshlrev_b32 v156, 16, v14
    v_and_b32 v157, 0xffff0000, v14
    v_lshlrev_b32 v158, 16, v15
    v_and_b32 v159, 0xffff0000, v15
    v_lshlrev_b32 v160, 16, v16
    v_and_b32 v161, 0xffff0000, v16
    v_lshlrev_b32 v162, 16, v17
    v_and_b32 v163, 0xffff0000, v17
    v_pk_add_f32 v[164:165], v[144:145], v[146:147]
    v_pk_mul_f32 v[166:167], v[144:145], v[144:145]
    v_pk_fma_f32 v[166:167], v[146:147], v[146:147], v[166:167]
    v_pk_add_f32 v[164:165], v[164:165], v[148:149]
    v_pk_fma_f32 v[166:167], v[148:149], v[148:149], v[166:167]
    v_pk_add_f32 v[164:165], v[164:165], v[150:151]
    v_pk_fma_f32 v[166:167], v[150:151], v[150:151], v[166:167]
    v_pk_add_f32 v[164:165], v[164:165], v[152:153]
    v_pk_fma_f32 v[166:167], v[152:153], v[152:153], v[166:167]
    v_pk_add_f32 v[164:165], v[164:165], v[154:155]
    v_pk_fma_f32 v[166:167], v[154:155], v[154:155], v[166:167]
    v_pk_add_f32 v[164:165], v[164:165], v[156:157]
    v_pk_fma_f32 v[166:167], v[156:157], v[156:157], v[166:167]
    v_pk_add_f32 v[164:165], v[164:165], v[158:159]
    v_pk_fma_f32 v[166:167], v[158:159], v[158:159], v[166:167]
    v_pk_add_f32 v[164:165], v[164:165], v[160:161]
    v_pk_fma_f32 v[166:167], v[160:161], v[160:161], v[166:167]
    v_pk_add_f32 v[164:165], v[164:165], v[162:163]
    v_pk_fma_f32 v[166:167], v[162:163], v[162:163], v[166:167]
    v_add_f32 v164, v164, v165
    v_add_f32 v166, v166, v167
    s_nop 1
    v_permlane32_swap_b32 v164, v166
    v_add_f32 v164, v164, v166
    v_mov_b32 v165, v164
    s_nop 1
    v_permlane16_swap_b32 v164, v165
    v_add_f32 v164, v164, v165
    v_and_or_b32 v164, v164, -4, 1
    s_add_u32 s82, s54, 18874368
    buffer_store_dword v164, v5, s[8:11], s82 offen sc1
    buffer_store_dwordx4 v[132:135], v1, s[8:11], s71 offen sc1
    s_lshl_b32 s82, s2, 7
    s_add_u32 s82, s82, 13635584
    s_cmp_eq_u32 s49, 1
    s_cselect_b32 s83, 0, 2147483648
    s_cmp_lt_u32 s2, 64
    s_cselect_b32 s83, s83, 2147483648
    v_or_b32 v26, s83, v6
    buffer_store_dword v128, v26, s[8:11], s82 offen sc1
    s_add_u32 m0, s79, 0
    s_nop 0
    buffer_load_dwordx4 v200, s[12:15], s87 offen nt lds
    s_add_u32 m0, s79, 1024
    s_nop 0
    buffer_load_dwordx4 v201, s[12:15], s87 offen nt lds
    s_add_u32 m0, s79, 2048
    s_nop 0
    buffer_load_dwordx4 v202, s[12:15], s87 offen nt lds
    s_add_u32 m0, s79, 3072
    s_nop 0
    buffer_load_dwordx4 v203, s[12:15], s87 offen nt lds
    s_add_u32 m0, s79, 4096
    s_nop 0
    buffer_load_dwordx4 v204, s[12:15], s87 offen nt lds
    s_mov_b32 s12, s34
    s_and_b32 s13, s35, 0xffff
    s_mov_b32 s14, 1966080
    s_add_u32 m0, s79, 5120
    s_nop 0
    buffer_load_dwordx4 v205, s[12:15], s3 offen nt lds
    s_add_u32 m0, s79, 6144
    s_nop 0
    buffer_load_dwordx4 v206, s[12:15], s3 offen nt lds
    s_add_u32 m0, s79, 7168
    s_nop 0
    buffer_load_dwordx4 v207, s[12:15], s3 offen nt lds
    s_mov_b32 s12, s24
    s_and_b32 s13, s25, 0xffff
    s_mov_b32 s14, 25600
    v_and_b32 v26, 3, v0
    v_lshlrev_b32 v26, 1, v26
    s_mul_i32 s82, s45, 800
    v_mul_u32_u24 v27, 160, v21
    v_add3_u32 v27, v27, v26, s82
    v_add_u32 v28, s82, v26
    v_add_u32 v28, 640, v28
    v_mov_b32 v29, 2147483648
    v_cmp_eq_u32 vcc, 0, v21
    s_nop 1
    v_cndmask_b32 v28, v29, v28, vcc
    s_lshl_b32 s82, s49, 3
    buffer_load_ushort v120, v27, s[12:15], s82 offen offset:0
    buffer_load_ushort v180, v27, s[12:15], s82 offen offset:40
    buffer_load_ushort v121, v27, s[12:15], s82 offen offset:80
    buffer_load_ushort v181, v27, s[12:15], s82 offen offset:120
    buffer_load_ushort v122, v28, s[12:15], s82 offen offset:0
    buffer_load_ushort v182, v28, s[12:15], s82 offen offset:40
    buffer_load_ushort v123, v28, s[12:15], s82 offen offset:80
    buffer_load_ushort v183, v28, s[12:15], s82 offen offset:120
    buffer_load_ushort v124, v27, s[12:15], 32 offen offset:0
    buffer_load_ushort v184, v27, s[12:15], 32 offen offset:40
    buffer_load_ushort v125, v27, s[12:15], 32 offen offset:80
    buffer_load_ushort v185, v27, s[12:15], 32 offen offset:120
    buffer_load_ushort v126, v28, s[12:15], 32 offen offset:0
    buffer_load_ushort v186, v28, s[12:15], 32 offen offset:40
    buffer_load_ushort v127, v28, s[12:15], 32 offen offset:80
    buffer_load_ushort v187, v28, s[12:15], 32 offen offset:120
    v_mov_b32 v26, 0
    s_waitcnt vmcnt(24)
    s_mov_b32 s92, s67
GB_P0:
    v_cmp_ne_u32 vcc, 0, v209
    s_nop 0
    s_cmp_eq_u64 vcc, -1
    s_cbranch_scc1 GB_P0D
    global_load_dwordx2 v[208:209], v26, s[40:41] sc1
    s_waitcnt vmcnt(0)
    s_sub_u32 s92, s92, 1
    s_cbranch_scc0 GB_P0
GB_P0D:
    v_readfirstlane_b32 s0, v208
    v_readfirstlane_b32 s1, v209
    s_barrier
    s_cmp_eq_u32 s49, 0
    s_cselect_b32 s82, 0, 2147483648
    s_add_u32 s83, s1, s90
    v_mov_b32 v208, s0
    v_mov_b32 v209, s83
    v_lshlrev_b32 v7, 3, v0
    v_or_b32 v7, s82, v7
    s_lshl_b32 s83, s2, 7
    s_add_u32 s83, s83, 13697024
    s_mov_b64 exec, 0xffff
    buffer_store_dwordx2 v[208:209], v7, s[8:11], s83 offen sc1
    s_mov_b64 exec, -1
    s_waitcnt vmcnt(0)
    ds_read_b64_tr_b16 a[0:1], v210 offset:0
    ds_read_b64_tr_b16 a[2:3], v210 offset:2560
    ds_read_b64_tr_b16 a[4:5], v210 offset:8
    ds_read_b64_tr_b16 a[6:7], v210 offset:2568
    ds_read_b64_tr_b16 a[8:9], v210 offset:64
    ds_read_b64_tr_b16 a[10:11], v210 offset:2624
    ds_read_b64_tr_b16 a[12:13], v210 offset:72
    ds_read_b64_tr_b16 a[14:15], v210 offset:2632
    ds_read_b64_tr_b16 a[16:17], v211 offset:0
    ds_read_b64_tr_b16 a[18:19], v211 offset:2560
    s_waitcnt lgkmcnt(0)
    ds_read_b64_tr_b16 a[20:21], v213 offset:5120
    ds_read_b64_tr_b16 a[22:23], v213 offset:6656
    ds_read_b64_tr_b16 a[24:25], v213 offset:5128
    ds_read_b64_tr_b16 a[26:27], v213 offset:6664
    ds_read_b64_tr_b16 a[28:29], v214 offset:5120
    ds_read_b64_tr_b16 a[30:31], v214 offset:6656
    v_accvgpr_write_b32 a32, -1
    v_accvgpr_write_b32 a33, -1
    v_accvgpr_write_b32 a34, -1
    v_accvgpr_write_b32 a35, -1
    s_mov_b32 s4, s88
    s_mov_b32 s5, s85
    v_accvgpr_write_b32 a38, v212
    v_accvgpr_write_b32 a39, v215
    v_bfe_u32 v26, v0, 2, 1
    s_mov_b32 s82, 0x80008000
    v_mul_lo_u32 v26, v26, s82
    v_lshl_or_b32 v120, v180, 16, v120
    v_lshl_or_b32 v121, v181, 16, v121
    v_lshl_or_b32 v122, v182, 16, v122
    v_lshl_or_b32 v123, v183, 16, v123
    v_lshl_or_b32 v124, v184, 16, v124
    v_lshl_or_b32 v125, v185, 16, v125
    v_lshl_or_b32 v126, v186, 16, v126
    v_lshl_or_b32 v127, v187, 16, v127
    v_xor_b32 v120, v120, v26
    v_xor_b32 v121, v121, v26
    v_xor_b32 v122, v122, v26
    v_xor_b32 v123, v123, v26
    v_xor_b32 v124, v124, v26
    v_xor_b32 v125, v125, v26
    v_xor_b32 v126, v126, v26
    v_xor_b32 v127, v127, v26
    v_accvgpr_write_b32 a240, v120
    v_accvgpr_write_b32 a241, v121
    v_accvgpr_write_b32 a242, v122
    v_accvgpr_write_b32 a243, v123
    v_accvgpr_write_b32 a244, v124
    v_accvgpr_write_b32 a245, v125
    v_accvgpr_write_b32 a246, v126
    v_accvgpr_write_b32 a247, v127
    s_add_u32 s36, s45, s44
    s_mul_i32 s37, s36, 52429
    s_lshr_b32 s37, s37, 18
    s_mul_i32 s37, s37, 5
    s_sub_u32 s36, s36, s37
    s_lshl_b32 s36, s36, 12
    s_add_u32 s37, s36, 4096
    s_cmp_eq_u32 s37, 20480
    s_cselect_b32 s37, 0, s37
    s_add_u32 s38, s37, 4096
    s_cmp_eq_u32 s38, 20480
    s_cselect_b32 s38, 0, s38
    s_add_u32 s39, s38, 4096
    s_cmp_eq_u32 s39, 20480
    s_cselect_b32 s39, 0, s39
    s_add_u32 s40, s39, 4096
    s_cmp_eq_u32 s40, 20480
    s_cselect_b32 s40, 0, s40
    v_add_u32 v44, 21504, v1
    v_add_u32 v45, 43008, v1
    v_add_u32 v46, 64512, v1
    s_lshl_b32 s85, s49, 10
    v_mov_b32 v20, 0x3f803f80
    v_mov_b32 v21, 0x3f803f80
    v_mov_b32 v22, 0x3f803f80
    v_mov_b32 v23, 0x3f803f80
    v_add_u32 v47, s85, v1
    v_add_u32 v48, s85, v2
    v_add_u32 v49, s85, v3
    v_accvgpr_read_b32 v76, a240
    v_accvgpr_read_b32 v77, a241
    v_accvgpr_read_b32 v78, a242
    v_accvgpr_read_b32 v79, a243
    v_accvgpr_read_b32 v80, a244
    v_accvgpr_read_b32 v81, a245
    v_accvgpr_read_b32 v82, a246
    v_accvgpr_read_b32 v83, a247
    v_bfe_u32 v64, v0, 3, 1
    v_add_u32 v64, -1, v64
    v_not_b32 v65, v64
    v_and_b32 v84, v76, v64
    v_and_b32 v85, v77, v64
    v_and_b32 v86, v78, v64
    v_and_b32 v87, v79, v64
    v_and_b32 v88, v80, v64
    v_and_b32 v89, v81, v64
    v_and_b32 v90, v82, v64
    v_and_b32 v91, v83, v64
    v_and_b32 v92, v76, v65
    v_and_b32 v93, v77, v65
    v_and_b32 v94, v78, v65
    v_and_b32 v95, v79, v65
    v_and_b32 v96, v80, v65
    v_and_b32 v97, v81, v65
    v_and_b32 v98, v82, v65
    v_and_b32 v99, v83, v65
    v_add_u32 v64, 81920, v1
    v_add_u32 v65, s85, v64
    ds_write_b128 v65, v[84:87]
    ds_write_b128 v64, v[88:91] offset:4096
    ds_write_b128 v65, v[92:95] offset:5120
    ds_write_b128 v64, v[96:99] offset:9216
    v_mov_b32 v72, 0
    v_mov_b32 v73, 0
    v_mov_b32 v74, 0
    v_mov_b32 v75, 0
    v_min_u32 v64, 560, v1
    v_add_u32 v64, 97248, v64
    ds_write_b128 v64, v[72:75]
    s_mov_b32 s79, 122880
    s_cmp_lt_u32 s49, 2
    s_cselect_b32 s79, 102400, s79
    s_and_b32 s85, s49, 1
    s_mul_i32 s85, s85, 10240
    s_add_u32 s79, s79, s85
    v_and_b32 v68, 15, v0
    v_lshrrev_b32 v69, 4, v0
    s_lshl_b32 s85, s49, 6
    s_add_u32 s85, s85, 94208
    v_lshlrev_b32 v64, 4, v69
    v_add_u32 v63, s85, v64
    v_add_u32 v62, 94208, v64
    v_lshrrev_b32 v64, 5, v0
    v_lshl_add_u32 v64, v64, 4, v68
    v_mul_u32_u24 v50, 80, v64
    v_and_b32 v64, 1, v69
    v_mul_u32_u24 v64, 40, v64
    v_add3_u32 v50, v50, v64, s79
    v_mul_u32_u24 v64, 72, v68
    v_add_u32 v64, s79, v64
    v_add_u32 v64, 5120, v64
    v_lshlrev_b32 v65, 3, v69
    v_add_u32 v51, -8, v65
    v_add_u32 v52, 16, v65
    v_cmp_eq_u32 vcc, 0, v69
    s_nop 1
    v_cndmask_b32 v51, v51, 48, vcc
    v_cndmask_b32 v52, v52, 56, vcc
    v_add_u32 v51, v51, v64
    v_add_u32 v52, v52, v64
    v_lshrrev_b32 v64, 2, v68
    v_lshl_add_u32 v64, v69, 3, v64
    v_and_b32 v65, 3, v0
    v_lshlrev_b32 v65, 3, v65
    v_add_u32 v65, s79, v65
    v_mad_u32_u24 v53, v64, 20, v65
    v_mad_u32_u24 v53, v64, 60, v53
    v_mad_u32_u24 v54, v64, 12, v65
    v_mad_u32_u24 v54, v64, 60, v54
    v_add_u32 v54, 5120, v54
    v_min_u32 v64, 59, v0
    v_mul_u32_u24 v65, 3277, v64
    v_lshrrev_b32 v65, 16, v65
    v_mul_u32_u24 v66, 20, v65
    v_sub_u32 v64, v64, v66
    v_mul_u32_u24 v66, 13108, v64
    v_lshrrev_b32 v66, 16, v66
    v_mul_u32_u24 v67, 5, v66
    v_sub_u32 v64, v64, v67
    s_cmp_eq_u32 s49, 3
    s_cselect_b64 vcc, -1, 0
    v_mov_b32 v67, s49
    v_cndmask_b32 v65, v67, v65, vcc
    v_cndmask_b32 v66, v69, v66, vcc
    v_cndmask_b32 v64, v68, v64, vcc
    v_cndmask_b32 v67, 0, 1, vcc
    v_lshlrev_b32 v55, 10, v65
    s_movk_i32 s86, 3072
    v_mad_u32_u24 v55, v67, s86, v55
    v_lshl_add_u32 v55, v66, 8, v55
    v_lshl_add_u32 v55, v64, 4, v55
    v_lshl_add_u32 v65, v65, 2, v66
    v_lshl_add_u32 v64, v67, 4, v64
    v_mul_u32_u24 v56, 96, v64
    v_lshl_add_u32 v56, v65, 3, v56
    v_cmp_le_u32 vcc, 5, v65
    s_nop 1
    v_cndmask_b32 v64, 0, 8, vcc
    v_add_u32 v56, v56, v64
    v_add_u32 v56, 95232, v56
    v_cmp_gt_u32 vcc, 10, v65
    v_mov_b32 v64, 98112
    s_nop 0
    v_cndmask_b32 v56, v64, v56, vcc
    v_mov_b32 v64, 2147483648
    v_lshlrev_b32 v57, 3, v0
    v_cndmask_b32 v57, v64, v57, vcc
    v_bfe_u32 v64, v0, 2, 1
    v_and_b32 v65, 3, v0
    v_lshl_add_u32 v66, v64, 3, v65
    v_lshl_add_u32 v67, v64, 1, v65
    v_add_u32 v67, 16, v67
    v_cmp_le_u32 vcc, 2, v65
    s_nop 1
    v_cndmask_b32 v67, v67, 20, vcc
    v_bfe_u32 v64, v0, 3, 1
    v_lshrrev_b32 v65, 5, v0
    v_cmp_eq_u32 vcc, v64, v65
    s_nop 1
    v_cndmask_b32 v66, 21, v66, vcc
    v_cndmask_b32 v67, 21, v67, vcc
    v_and_b32 v64, 1, v69
    v_mul_u32_u24 v64, 48, v64
    v_add_u32 v64, 95232, v64
    s_movk_i32 s85, 96
    v_mad_u32_u24 v58, v66, s85, v64
    v_mad_u32_u24 v59, v67, s85, v64
    v_mul_u32_u24 v60, 20480, v65
    v_lshl_add_u32 v60, v68, 4, v60
    v_and_b32 v64, 1, v69
    v_lshl_add_u32 v61, v64, 2, v60
    v_lshl_add_u32 v60, v64, 8, v60
    s_cmp_lg_u32 s49, 0
    s_cbranch_scc1 GB_WAIT
    s_lshr_b32 s82, s45, 4
    v_lshlrev_b32 v201, 1, v0
    v_add_u32 v201, s82, v201
    v_and_b32 v203, 15, v0
    v_lshlrev_b32 v203, 1, v203
    v_add_u32 v203, s82, v203
    v_add_u32 v203, 128, v203
    v_and_b32 v204, 31, v0
    v_lshlrev_b32 v204, 3, v204
    v_add_u32 v204, s44, v204
    v_cmp_gt_u32 vcc, 32, v0
    s_nop 1
    v_cndmask_b32 v203, v203, v204, vcc
    v_lshlrev_b32 v201, 7, v201
    v_lshlrev_b32 v203, 7, v203
    s_mov_b32 s83, 13697024
    s_mov_b32 s92, s67
GB_P1:
    buffer_load_dwordx2 v[206:207], v201, s[8:11], s83 offen sc1
    buffer_load_dwordx2 v[208:209], v203, s[8:11], s83 offen sc1
    s_waitcnt vmcnt(0)
    v_and_b32 v207, -16, v207
    v_and_b32 v202, 15, v209
    v_and_b32 v209, -16, v209
    v_cmp_eq_u64 vcc, s[0:1], v[206:207]
    v_cmp_eq_u64 s[6:7], s[0:1], v[208:209]
    s_nop 0
    s_and_b64 vcc, vcc, s[6:7]
    s_cmp_eq_u64 vcc, -1
    s_cbranch_scc1 GB_P1D
    s_sub_u32 s92, s92, 1
    s_cbranch_scc0 GB_P1
GB_P1D:
    v_cmp_eq_u32 vcc, s90, v202
    s_nop 0
    s_cmp_eq_u32 vcc_lo, -1
    s_cselect_b32 s82, 1, 0
    v_mov_b32 v200, s82
    v_mov_b32 v201, 143360
    ds_write_b32 v201, v200
GB_WAIT:
    s_waitcnt lgkmcnt(0)
    s_barrier
    v_mov_b32 v201, 143360
    ds_read_b32 v7, v201
    s_mul_i32 s6, s78, 2688
    s_add_u32 s6, s6, 18874368
    s_mul_i32 s7, s44, 344064
    s_add_u32 s6, s6, s7
    v_min_u32 v19, 20, v0
    v_lshlrev_b32 v19, 7, v19
    buffer_load_dword a252, v19, s[8:11], s6 offen sc1
    s_lshl_b32 s3, s49, 10
    s_mul_i32 s88, s45, 81920
    s_add_u32 s88, s88, s3
    s_lshl_b32 s93, s36, 2
    s_add_u32 s93, s93, s88
    s_add_u32 s93, s93, 0
    s_add_u32 m0, s3, 0
    s_nop 0
    buffer_load_dwordx4 v1, s[8:11], s93 offen  lds
    s_lshl_b32 s93, s36, 2
    s_add_u32 s93, s93, s88
    s_add_u32 s93, s93, 4096
    s_add_u32 m0, s3, 4096
    s_nop 0
    buffer_load_dwordx4 v1, s[8:11], s93 offen  lds
    s_lshl_b32 s93, s36, 2
    s_add_u32 s93, s93, s88
    s_add_u32 s93, s93, 8192
    s_add_u32 m0, s3, 8192
    s_nop 0
    buffer_load_dwordx4 v1, s[8:11], s93 offen  lds
    s_add_u32 s84, s68, s36
    s_add_u32 s84, s84, 18874368
    buffer_load_dwordx4 v[128:131], v1, s[8:11], s84 offen offset:0 sc1
    buffer_load_dwordx4 v[132:135], v44, s[8:11], s84 offen offset:0 sc1
    s_lshl_b32 s93, s36, 2
    s_add_u32 s93, s93, s88
    s_add_u32 s93, s93, 12288
    s_add_u32 m0, s3, 12288
    s_nop 0
    buffer_load_dwordx4 v1, s[8:11], s93 offen  lds
    buffer_load_dwordx4 v[136:139], v45, s[8:11], s84 offen offset:0 sc1
    buffer_load_dwordx4 v[140:143], v46, s[8:11], s84 offen offset:0 sc1
    s_lshl_b32 s93, s37, 2
    s_add_u32 s93, s93, s88
    s_add_u32 s93, s93, 0
    s_add_u32 m0, s3, 16384
    s_nop 0
    buffer_load_dwordx4 v1, s[8:11], s93 offen  lds
    buffer_load_dwordx4 v[144:147], v1, s[8:11], s84 offen offset:1024 sc1
    buffer_load_dwordx4 v[148:151], v44, s[8:11], s84 offen offset:1024 sc1
    s_lshl_b32 s93, s37, 2
    s_add_u32 s93, s93, s88
    s_add_u32 s93, s93, 4096
    s_add_u32 m0, s3, 20480
    s_nop 0
    buffer_load_dwordx4 v1, s[8:11], s93 offen  lds
    buffer_load_dwordx4 v[152:155], v45, s[8:11], s84 offen offset:1024 sc1
    buffer_load_dwordx4 v[156:159], v46, s[8:11], s84 offen offset:1024 sc1
    s_lshl_b32 s93, s37, 2
    s_add_u32 s93, s93, s88
    s_add_u32 s93, s93, 8192
    s_add_u32 m0, s3, 24576
    s_nop 0
    buffer_load_dwordx4 v1, s[8:11], s93 offen  lds
    buffer_load_dwordx4 v[160:163], v1, s[8:11], s84 offen offset:2048 sc1
    buffer_load_dwordx4 v[164:167], v44, s[8:11], s84 offen offset:2048 sc1
    s_lshl_b32 s93, s37, 2
    s_add_u32 s93, s93, s88
    s_add_u32 s93, s93, 12288
    s_add_u32 m0, s3, 28672
    s_nop 0
    buffer_load_dwordx4 v1, s[8:11], s93 offen  lds
    buffer_load_dwordx4 v[168:171], v45, s[8:11], s84 offen offset:2048 sc1
    buffer_load_dwordx4 v[172:175], v46, s[8:11], s84 offen offset:2048 sc1
    s_waitcnt lgkmcnt(0)
    v_readfirstlane_b32 s50, v7
    s_waitcnt vmcnt(18)
    s_barrier
    ds_read_b128 v[104:107], v1 offset:0
    ds_read_b128 v[108:111], v1 offset:1024
    ds_read_b128 v[112:115], v1 offset:2048
    ds_read_b128 v[116:119], v1 offset:3072
    ds_read_b128 v[120:123], v1 offset:4096
    ds_read_b128 v[24:27], v47 offset:0
    s_waitcnt vmcnt(16) lgkmcnt(5)
    v_mfma_f32_16x16x32_bf16 v[192:195], v[104:107], v[128:131], 0
    s_barrier
    ds_read_b128 v[124:127], v1 offset:5120
    s_waitcnt vmcnt(15)
    v_mfma_f32_16x16x32_bf16 v[208:211], v[104:107], v[132:135], 0
    buffer_load_dwordx4 v[176:179], v1, s[8:11], s84 offen offset:3072 sc1
    s_waitcnt vmcnt(14)
    v_mfma_f32_16x16x32_bf16 v[224:227], v[104:107], v[136:139], 0
    ds_read_b128 v[28:31], v47 offset:4096
    s_waitcnt vmcnt(13)
    v_mfma_f32_16x16x32_bf16 v[240:243], v[104:107], v[140:143], 0
    s_waitcnt lgkmcnt(6)
    v_mfma_f32_16x16x32_bf16 v[196:199], v[108:111], v[128:131], 0
    ds_read_b128 v[104:107], v1 offset:6144
    v_mfma_f32_16x16x32_bf16 v[212:215], v[108:111], v[132:135], 0
    buffer_load_dwordx4 v[180:183], v44, s[8:11], s84 offen offset:3072 sc1
    v_mfma_f32_16x16x32_bf16 v[228:231], v[108:111], v[136:139], 0
    v_mfma_f32_16x16x32_bf16 v[244:247], v[108:111], v[140:143], 0
    s_waitcnt lgkmcnt(6)
    v_mfma_f32_16x16x32_bf16 v[200:203], v[112:115], v[128:131], 0
    ds_read_b128 v[108:111], v1 offset:7168
    v_mfma_f32_16x16x32_bf16 v[216:219], v[112:115], v[132:135], 0
    buffer_load_dwordx4 v[184:187], v45, s[8:11], s84 offen offset:3072 sc1
    v_mfma_f32_16x16x32_bf16 v[232:235], v[112:115], v[136:139], 0
    v_mfma_f32_16x16x32_bf16 v[248:251], v[112:115], v[140:143], 0
    s_waitcnt lgkmcnt(6)
    v_mfma_f32_16x16x32_bf16 v[204:207], v[116:119], v[128:131], 0
    ds_read_b128 v[112:115], v1 offset:8192
    v_mfma_f32_16x16x32_bf16 v[220:223], v[116:119], v[132:135], 0
    buffer_load_dwordx4 v[188:191], v46, s[8:11], s84 offen offset:3072 sc1
    v_mfma_f32_16x16x32_bf16 v[236:239], v[116:119], v[136:139], 0
    v_mfma_f32_16x16x32_bf16 v[252:255], v[116:119], v[140:143], 0
    s_lshl_b32 s93, s38, 2
    s_add_u32 s93, s93, s88
    s_add_u32 s93, s93, 0
    s_add_u32 m0, s3, 32768
    s_nop 0
    buffer_load_dwordx4 v1, s[8:11], s93 offen  lds
    s_waitcnt lgkmcnt(5)
    v_mfma_f32_16x16x32_bf16 v[32:35], v[24:27], v[20:23], 0
    s_waitcnt vmcnt(15)
    v_mfma_f32_16x16x32_bf16 v[192:195], v[120:123], v[144:147], v[192:195]
    s_barrier
    ds_read_b128 v[116:119], v1 offset:9216
    s_waitcnt vmcnt(14)
    v_mfma_f32_16x16x32_bf16 v[208:211], v[120:123], v[148:151], v[208:211]
    s_add_u32 s84, s68, s37
    s_add_u32 s84, s84, 18874368
    buffer_load_dwordx4 v[128:131], v1, s[8:11], s84 offen offset:0 sc1
    s_waitcnt vmcnt(13)
    v_mfma_f32_16x16x32_bf16 v[224:227], v[120:123], v[152:155], v[224:227]
    ds_read_b128 v[24:27], v47 offset:8192
    s_waitcnt vmcnt(12)
    v_mfma_f32_16x16x32_bf16 v[240:243], v[120:123], v[156:159], v[240:243]
    s_waitcnt lgkmcnt(6)
    v_mfma_f32_16x16x32_bf16 v[196:199], v[124:127], v[144:147], v[196:199]
    ds_read_b128 v[120:123], v1 offset:10240
    v_mfma_f32_16x16x32_bf16 v[212:215], v[124:127], v[148:151], v[212:215]
    buffer_load_dwordx4 v[132:135], v44, s[8:11], s84 offen offset:0 sc1
    v_mfma_f32_16x16x32_bf16 v[228:231], v[124:127], v[152:155], v[228:231]
    v_mfma_f32_16x16x32_bf16 v[244:247], v[124:127], v[156:159], v[244:247]
    s_waitcnt lgkmcnt(5)
    v_mfma_f32_16x16x32_bf16 v[200:203], v[104:107], v[144:147], v[200:203]
    ds_read_b128 v[124:127], v1 offset:11264
    v_mfma_f32_16x16x32_bf16 v[216:219], v[104:107], v[148:151], v[216:219]
    buffer_load_dwordx4 v[136:139], v45, s[8:11], s84 offen offset:0 sc1
    v_mfma_f32_16x16x32_bf16 v[232:235], v[104:107], v[152:155], v[232:235]
    v_mfma_f32_16x16x32_bf16 v[248:251], v[104:107], v[156:159], v[248:251]
    s_waitcnt lgkmcnt(5)
    v_mfma_f32_16x16x32_bf16 v[204:207], v[108:111], v[144:147], v[204:207]
    ds_read_b128 v[104:107], v1 offset:12288
    v_mfma_f32_16x16x32_bf16 v[220:223], v[108:111], v[148:151], v[220:223]
    buffer_load_dwordx4 v[140:143], v46, s[8:11], s84 offen offset:0 sc1
    v_mfma_f32_16x16x32_bf16 v[236:239], v[108:111], v[152:155], v[236:239]
    v_mfma_f32_16x16x32_bf16 v[252:255], v[108:111], v[156:159], v[252:255]
    s_lshl_b32 s93, s38, 2
    s_add_u32 s93, s93, s88
    s_add_u32 s93, s93, 4096
    s_add_u32 m0, s3, 36864
    s_nop 0
    buffer_load_dwordx4 v1, s[8:11], s93 offen  lds
    v_mfma_f32_16x16x32_bf16 v[32:35], v[28:31], v[20:23], v[32:35]
    s_waitcnt vmcnt(14) lgkmcnt(5)
    v_mfma_f32_16x16x32_bf16 v[192:195], v[112:115], v[160:163], v[192:195]
    s_barrier
    ds_read_b128 v[108:111], v1 offset:13312
    s_waitcnt vmcnt(13)
    v_mfma_f32_16x16x32_bf16 v[208:211], v[112:115], v[164:167], v[208:211]
    buffer_load_dwordx4 v[144:147], v1, s[8:11], s84 offen offset:1024 sc1
    s_waitcnt vmcnt(12)
    v_mfma_f32_16x16x32_bf16 v[224:227], v[112:115], v[168:171], v[224:227]
    ds_read_b128 v[28:31], v47 offset:12288
    s_waitcnt vmcnt(11)
    v_mfma_f32_16x16x32_bf16 v[240:243], v[112:115], v[172:175], v[240:243]
    s_waitcnt lgkmcnt(6)
    v_mfma_f32_16x16x32_bf16 v[196:199], v[116:119], v[160:163], v[196:199]
    ds_read_b128 v[112:115], v1 offset:14336
    v_mfma_f32_16x16x32_bf16 v[212:215], v[116:119], v[164:167], v[212:215]
    buffer_load_dwordx4 v[148:151], v44, s[8:11], s84 offen offset:1024 sc1
    v_mfma_f32_16x16x32_bf16 v[228:231], v[116:119], v[168:171], v[228:231]
    v_mfma_f32_16x16x32_bf16 v[244:247], v[116:119], v[172:175], v[244:247]
    s_waitcnt lgkmcnt(5)
    v_mfma_f32_16x16x32_bf16 v[200:203], v[120:123], v[160:163], v[200:203]
    ds_read_b128 v[116:119], v1 offset:15360
    v_mfma_f32_16x16x32_bf16 v[216:219], v[120:123], v[164:167], v[216:219]
    buffer_load_dwordx4 v[152:155], v45, s[8:11], s84 offen offset:1024 sc1
    v_mfma_f32_16x16x32_bf16 v[232:235], v[120:123], v[168:171], v[232:235]
    v_mfma_f32_16x16x32_bf16 v[248:251], v[120:123], v[172:175], v[248:251]
    s_waitcnt lgkmcnt(5)
    v_mfma_f32_16x16x32_bf16 v[204:207], v[124:127], v[160:163], v[204:207]
    ds_read_b128 v[120:123], v1 offset:16384
    v_mfma_f32_16x16x32_bf16 v[220:223], v[124:127], v[164:167], v[220:223]
    buffer_load_dwordx4 v[156:159], v46, s[8:11], s84 offen offset:1024 sc1
    v_mfma_f32_16x16x32_bf16 v[236:239], v[124:127], v[168:171], v[236:239]
    v_mfma_f32_16x16x32_bf16 v[252:255], v[124:127], v[172:175], v[252:255]
    s_lshl_b32 s93, s38, 2
    s_add_u32 s93, s93, s88
    s_add_u32 s93, s93, 8192
    s_add_u32 m0, s3, 40960
    s_nop 0
    buffer_load_dwordx4 v1, s[8:11], s93 offen  lds
    v_mfma_f32_16x16x32_bf16 v[32:35], v[24:27], v[20:23], v[32:35]
    s_waitcnt vmcnt(14) lgkmcnt(5)
    v_mfma_f32_16x16x32_bf16 v[192:195], v[104:107], v[176:179], v[192:195]
    ds_read_b128 v[124:127], v1 offset:17408
    s_waitcnt vmcnt(13)
    v_mfma_f32_16x16x32_bf16 v[208:211], v[104:107], v[180:183], v[208:211]
    buffer_load_dwordx4 v[160:163], v1, s[8:11], s84 offen offset:2048 sc1
    s_waitcnt vmcnt(13)
    v_mfma_f32_16x16x32_bf16 v[224:227], v[104:107], v[184:187], v[224:227]
    ds_read_b128 v[24:27], v47 offset:16384
    s_waitcnt vmcnt(12)
    v_mfma_f32_16x16x32_bf16 v[240:243], v[104:107], v[188:191], v[240:243]
    s_waitcnt lgkmcnt(6)
    v_mfma_f32_16x16x32_bf16 v[196:199], v[108:111], v[176:179], v[196:199]
    ds_read_b128 v[104:107], v1 offset:18432
    v_mfma_f32_16x16x32_bf16 v[212:215], v[108:111], v[180:183], v[212:215]
    buffer_load_dwordx4 v[164:167], v44, s[8:11], s84 offen offset:2048 sc1
    v_mfma_f32_16x16x32_bf16 v[228:231], v[108:111], v[184:187], v[228:231]
    v_mfma_f32_16x16x32_bf16 v[244:247], v[108:111], v[188:191], v[244:247]
    s_waitcnt lgkmcnt(5)
    v_mfma_f32_16x16x32_bf16 v[200:203], v[112:115], v[176:179], v[200:203]
    ds_read_b128 v[108:111], v1 offset:19456
    v_mfma_f32_16x16x32_bf16 v[216:219], v[112:115], v[180:183], v[216:219]
    buffer_load_dwordx4 v[168:171], v45, s[8:11], s84 offen offset:2048 sc1
    v_mfma_f32_16x16x32_bf16 v[232:235], v[112:115], v[184:187], v[232:235]
    v_mfma_f32_16x16x32_bf16 v[248:251], v[112:115], v[188:191], v[248:251]
    s_waitcnt lgkmcnt(5)
    v_mfma_f32_16x16x32_bf16 v[204:207], v[116:119], v[176:179], v[204:207]
    ds_read_b128 v[112:115], v1 offset:20480
    v_mfma_f32_16x16x32_bf16 v[220:223], v[116:119], v[180:183], v[220:223]
    buffer_load_dwordx4 v[172:175], v46, s[8:11], s84 offen offset:2048 sc1
    v_mfma_f32_16x16x32_bf16 v[236:239], v[116:119], v[184:187], v[236:239]
    v_mfma_f32_16x16x32_bf16 v[252:255], v[116:119], v[188:191], v[252:255]
    s_lshl_b32 s93, s38, 2
    s_add_u32 s93, s93, s88
    s_add_u32 s93, s93, 12288
    s_add_u32 m0, s3, 45056
    s_nop 0
    buffer_load_dwordx4 v1, s[8:11], s93 offen  lds
    v_mfma_f32_16x16x32_bf16 v[32:35], v[28:31], v[20:23], v[32:35]
    s_waitcnt vmcnt(14) lgkmcnt(5)
    v_mfma_f32_16x16x32_bf16 v[192:195], v[120:123], v[128:131], v[192:195]
    ds_read_b128 v[116:119], v1 offset:21504
    s_waitcnt vmcnt(13)
    v_mfma_f32_16x16x32_bf16 v[208:211], v[120:123], v[132:135], v[208:211]
    buffer_load_dwordx4 v[176:179], v1, s[8:11], s84 offen offset:3072 sc1
    s_waitcnt vmcnt(13)
    v_mfma_f32_16x16x32_bf16 v[224:227], v[120:123], v[136:139], v[224:227]
    ds_read_b128 v[28:31], v47 offset:20480
    s_waitcnt vmcnt(12)
    v_mfma_f32_16x16x32_bf16 v[240:243], v[120:123], v[140:143], v[240:243]
    s_waitcnt lgkmcnt(6)
    v_mfma_f32_16x16x32_bf16 v[196:199], v[124:127], v[128:131], v[196:199]
    ds_read_b128 v[120:123], v1 offset:22528
    v_mfma_f32_16x16x32_bf16 v[212:215], v[124:127], v[132:135], v[212:215]
    buffer_load_dwordx4 v[180:183], v44, s[8:11], s84 offen offset:3072 sc1
    v_mfma_f32_16x16x32_bf16 v[228:231], v[124:127], v[136:139], v[228:231]
    v_mfma_f32_16x16x32_bf16 v[244:247], v[124:127], v[140:143], v[244:247]
    s_waitcnt lgkmcnt(5)
    v_mfma_f32_16x16x32_bf16 v[200:203], v[104:107], v[128:131], v[200:203]
    ds_read_b128 v[124:127], v1 offset:23552
    v_mfma_f32_16x16x32_bf16 v[216:219], v[104:107], v[132:135], v[216:219]
    buffer_load_dwordx4 v[184:187], v45, s[8:11], s84 offen offset:3072 sc1
    v_mfma_f32_16x16x32_bf16 v[232:235], v[104:107], v[136:139], v[232:235]
    v_mfma_f32_16x16x32_bf16 v[248:251], v[104:107], v[140:143], v[248:251]
    s_waitcnt lgkmcnt(5)
    v_mfma_f32_16x16x32_bf16 v[204:207], v[108:111], v[128:131], v[204:207]
    ds_read_b128 v[104:107], v1 offset:24576
    v_mfma_f32_16x16x32_bf16 v[220:223], v[108:111], v[132:135], v[220:223]
    buffer_load_dwordx4 v[188:191], v46, s[8:11], s84 offen offset:3072 sc1
    v_mfma_f32_16x16x32_bf16 v[236:239], v[108:111], v[136:139], v[236:239]
    v_mfma_f32_16x16x32_bf16 v[252:255], v[108:111], v[140:143], v[252:255]
    s_lshl_b32 s93, s39, 2
    s_add_u32 s93, s93, s88
    s_add_u32 s93, s93, 0
    s_add_u32 m0, s3, 49152
    s_nop 0
    buffer_load_dwordx4 v1, s[8:11], s93 offen  lds
    v_mfma_f32_16x16x32_bf16 v[32:35], v[24:27], v[20:23], v[32:35]
    s_waitcnt vmcnt(14) lgkmcnt(5)
    v_mfma_f32_16x16x32_bf16 v[192:195], v[112:115], v[144:147], v[192:195]
    s_barrier
    ds_read_b128 v[108:111], v1 offset:25600
    s_waitcnt vmcnt(13)
    v_mfma_f32_16x16x32_bf16 v[208:211], v[112:115], v[148:151], v[208:211]
    s_add_u32 s84, s68, s38
    s_add_u32 s84, s84, 18874368
    buffer_load_dwordx4 v[128:131], v1, s[8:11], s84 offen offset:0 sc1
    s_waitcnt vmcnt(13)
    v_mfma_f32_16x16x32_bf16 v[224:227], v[112:115], v[152:155], v[224:227]
    ds_read_b128 v[24:27], v47 offset:24576
    s_waitcnt vmcnt(12)
    v_mfma_f32_16x16x32_bf16 v[240:243], v[112:115], v[156:159], v[240:243]
    s_waitcnt lgkmcnt(6)
    v_mfma_f32_16x16x32_bf16 v[196:199], v[116:119], v[144:147], v[196:199]
    ds_read_b128 v[112:115], v1 offset:26624
    v_mfma_f32_16x16x32_bf16 v[212:215], v[116:119], v[148:151], v[212:215]
    buffer_load_dwordx4 v[132:135], v44, s[8:11], s84 offen offset:0 sc1
    v_mfma_f32_16x16x32_bf16 v[228:231], v[116:119], v[152:155], v[228:231]
    v_mfma_f32_16x16x32_bf16 v[244:247], v[116:119], v[156:159], v[244:247]
    s_waitcnt lgkmcnt(5)
    v_mfma_f32_16x16x32_bf16 v[200:203], v[120:123], v[144:147], v[200:203]
    ds_read_b128 v[116:119], v1 offset:27648
    v_mfma_f32_16x16x32_bf16 v[216:219], v[120:123], v[148:151], v[216:219]
    buffer_load_dwordx4 v[136:139], v45, s[8:11], s84 offen offset:0 sc1
    v_mfma_f32_16x16x32_bf16 v[232:235], v[120:123], v[152:155], v[232:235]
    v_mfma_f32_16x16x32_bf16 v[248:251], v[120:123], v[156:159], v[248:251]
    s_waitcnt lgkmcnt(5)
    v_mfma_f32_16x16x32_bf16 v[204:207], v[124:127], v[144:147], v[204:207]
    ds_read_b128 v[120:123], v1 offset:28672
    v_mfma_f32_16x16x32_bf16 v[220:223], v[124:127], v[148:151], v[220:223]
    buffer_load_dwordx4 v[140:143], v46, s[8:11], s84 offen offset:0 sc1
    v_mfma_f32_16x16x32_bf16 v[236:239], v[124:127], v[152:155], v[236:239]
    v_mfma_f32_16x16x32_bf16 v[252:255], v[124:127], v[156:159], v[252:255]
    s_lshl_b32 s93, s39, 2
    s_add_u32 s93, s93, s88
    s_add_u32 s93, s93, 4096
    s_add_u32 m0, s3, 53248
    s_nop 0
    buffer_load_dwordx4 v1, s[8:11], s93 offen  lds
    v_mfma_f32_16x16x32_bf16 v[32:35], v[28:31], v[20:23], v[32:35]
    s_waitcnt vmcnt(14) lgkmcnt(5)
    v_mfma_f32_16x16x32_bf16 v[192:195], v[104:107], v[160:163], v[192:195]
    ds_read_b128 v[124:127], v1 offset:29696
    s_waitcnt vmcnt(13)
    v_mfma_f32_16x16x32_bf16 v[208:211], v[104:107], v[164:167], v[208:211]
    buffer_load_dwordx4 v[144:147], v1, s[8:11], s84 offen offset:1024 sc1
    s_waitcnt vmcnt(13)
    v_mfma_f32_16x16x32_bf16 v[224:227], v[104:107], v[168:171], v[224:227]
    ds_read_b128 v[28:31], v47 offset:28672
    s_waitcnt vmcnt(12)
    v_mfma_f32_16x16x32_bf16 v[240:243], v[104:107], v[172:175], v[240:243]
    s_waitcnt lgkmcnt(6)
    v_mfma_f32_16x16x32_bf16 v[196:199], v[108:111], v[160:163], v[196:199]
    ds_read_b128 v[104:107], v1 offset:30720
    v_mfma_f32_16x16x32_bf16 v[212:215], v[108:111], v[164:167], v[212:215]
    buffer_load_dwordx4 v[148:151], v44, s[8:11], s84 offen offset:1024 sc1
    v_mfma_f32_16x16x32_bf16 v[228:231], v[108:111], v[168:171], v[228:231]
    v_mfma_f32_16x16x32_bf16 v[244:247], v[108:111], v[172:175], v[244:247]
    s_waitcnt lgkmcnt(5)
    v_mfma_f32_16x16x32_bf16 v[200:203], v[112:115], v[160:163], v[200:203]
    ds_read_b128 v[108:111], v1 offset:31744
    v_mfma_f32_16x16x32_bf16 v[216:219], v[112:115], v[164:167], v[216:219]
    buffer_load_dwordx4 v[152:155], v45, s[8:11], s84 offen offset:1024 sc1
    v_mfma_f32_16x16x32_bf16 v[232:235], v[112:115], v[168:171], v[232:235]
    v_mfma_f32_16x16x32_bf16 v[248:251], v[112:115], v[172:175], v[248:251]
    s_waitcnt lgkmcnt(5)
    v_mfma_f32_16x16x32_bf16 v[204:207], v[116:119], v[160:163], v[204:207]
    ds_read_b128 v[112:115], v1 offset:32768
    v_mfma_f32_16x16x32_bf16 v[220:223], v[116:119], v[164:167], v[220:223]
    buffer_load_dwordx4 v[156:159], v46, s[8:11], s84 offen offset:1024 sc1
    v_mfma_f32_16x16x32_bf16 v[236:239], v[116:119], v[168:171], v[236:239]
    v_mfma_f32_16x16x32_bf16 v[252:255], v[116:119], v[172:175], v[252:255]
    s_lshl_b32 s93, s39, 2
    s_add_u32 s93, s93, s88
    s_add_u32 s93, s93, 8192
    s_add_u32 m0, s3, 57344
    s_nop 0
    buffer_load_dwordx4 v1, s[8:11], s93 offen  lds
    v_mfma_f32_16x16x32_bf16 v[32:35], v[24:27], v[20:23], v[32:35]
    s_waitcnt vmcnt(14) lgkmcnt(5)
    v_mfma_f32_16x16x32_bf16 v[192:195], v[120:123], v[176:179], v[192:195]
    ds_read_b128 v[116:119], v1 offset:33792
    s_waitcnt vmcnt(13)
    v_mfma_f32_16x16x32_bf16 v[208:211], v[120:123], v[180:183], v[208:211]
    buffer_load_dwordx4 v[160:163], v1, s[8:11], s84 offen offset:2048 sc1
    s_waitcnt vmcnt(13)
    v_mfma_f32_16x16x32_bf16 v[224:227], v[120:123], v[184:187], v[224:227]
    ds_read_b128 v[24:27], v47 offset:32768
    s_waitcnt vmcnt(12)
    v_mfma_f32_16x16x32_bf16 v[240:243], v[120:123], v[188:191], v[240:243]
    s_waitcnt lgkmcnt(6)
    v_mfma_f32_16x16x32_bf16 v[196:199], v[124:127], v[176:179], v[196:199]
    ds_read_b128 v[120:123], v1 offset:34816
    v_mfma_f32_16x16x32_bf16 v[212:215], v[124:127], v[180:183], v[212:215]
    buffer_load_dwordx4 v[164:167], v44, s[8:11], s84 offen offset:2048 sc1
    v_mfma_f32_16x16x32_bf16 v[228:231], v[124:127], v[184:187], v[228:231]
    v_mfma_f32_16x16x32_bf16 v[244:247], v[124:127], v[188:191], v[244:247]
    s_waitcnt lgkmcnt(5)
    v_mfma_f32_16x16x32_bf16 v[200:203], v[104:107], v[176:179], v[200:203]
    ds_read_b128 v[124:127], v1 offset:35840
    v_mfma_f32_16x16x32_bf16 v[216:219], v[104:107], v[180:183], v[216:219]
    buffer_load_dwordx4 v[168:171], v45, s[8:11], s84 offen offset:2048 sc1
    v_mfma_f32_16x16x32_bf16 v[232:235], v[104:107], v[184:187], v[232:235]
    v_mfma_f32_16x16x32_bf16 v[248:251], v[104:107], v[188:191], v[248:251]
    s_waitcnt lgkmcnt(5)
    v_mfma_f32_16x16x32_bf16 v[204:207], v[108:111], v[176:179], v[204:207]
    ds_read_b128 v[104:107], v1 offset:36864
    v_mfma_f32_16x16x32_bf16 v[220:223], v[108:111], v[180:183], v[220:223]
    buffer_load_dwordx4 v[172:175], v46, s[8:11], s84 offen offset:2048 sc1
    v_mfma_f32_16x16x32_bf16 v[236:239], v[108:111], v[184:187], v[236:239]
    v_mfma_f32_16x16x32_bf16 v[252:255], v[108:111], v[188:191], v[252:255]
    s_lshl_b32 s93, s39, 2
    s_add_u32 s93, s93, s88
    s_add_u32 s93, s93, 12288
    s_add_u32 m0, s3, 61440
    s_nop 0
    buffer_load_dwordx4 v1, s[8:11], s93 offen  lds
    v_mfma_f32_16x16x32_bf16 v[32:35], v[28:31], v[20:23], v[32:35]
    s_waitcnt vmcnt(14) lgkmcnt(5)
    v_mfma_f32_16x16x32_bf16 v[192:195], v[112:115], v[128:131], v[192:195]
    s_barrier
    ds_read_b128 v[108:111], v1 offset:37888
    s_waitcnt vmcnt(13)
    v_mfma_f32_16x16x32_bf16 v[208:211], v[112:115], v[132:135], v[208:211]
    buffer_load_dwordx4 v[176:179], v1, s[8:11], s84 offen offset:3072 sc1
    s_waitcnt vmcnt(13)
    v_mfma_f32_16x16x32_bf16 v[224:227], v[112:115], v[136:139], v[224:227]
    ds_read_b128 v[28:31], v47 offset:36864
    s_waitcnt vmcnt(12)
    v_mfma_f32_16x16x32_bf16 v[240:243], v[112:115], v[140:143], v[240:243]
    s_waitcnt lgkmcnt(6)
    v_mfma_f32_16x16x32_bf16 v[196:199], v[116:119], v[128:131], v[196:199]
    ds_read_b128 v[112:115], v1 offset:38912
    v_mfma_f32_16x16x32_bf16 v[212:215], v[116:119], v[132:135], v[212:215]
    buffer_load_dwordx4 v[180:183], v44, s[8:11], s84 offen offset:3072 sc1
    v_mfma_f32_16x16x32_bf16 v[228:231], v[116:119], v[136:139], v[228:231]
    v_mfma_f32_16x16x32_bf16 v[244:247], v[116:119], v[140:143], v[244:247]
    s_waitcnt lgkmcnt(5)
    v_mfma_f32_16x16x32_bf16 v[200:203], v[120:123], v[128:131], v[200:203]
    ds_read_b128 v[116:119], v1 offset:39936
    v_mfma_f32_16x16x32_bf16 v[216:219], v[120:123], v[132:135], v[216:219]
    buffer_load_dwordx4 v[184:187], v45, s[8:11], s84 offen offset:3072 sc1
    v_mfma_f32_16x16x32_bf16 v[232:235], v[120:123], v[136:139], v[232:235]
    v_mfma_f32_16x16x32_bf16 v[248:251], v[120:123], v[140:143], v[248:251]
    s_waitcnt lgkmcnt(5)
    v_mfma_f32_16x16x32_bf16 v[204:207], v[124:127], v[128:131], v[204:207]
    ds_read_b128 v[120:123], v1 offset:40960
    v_mfma_f32_16x16x32_bf16 v[220:223], v[124:127], v[132:135], v[220:223]
    buffer_load_dwordx4 v[188:191], v46, s[8:11], s84 offen offset:3072 sc1
    v_mfma_f32_16x16x32_bf16 v[236:239], v[124:127], v[136:139], v[236:239]
    v_mfma_f32_16x16x32_bf16 v[252:255], v[124:127], v[140:143], v[252:255]
    s_lshl_b32 s93, s40, 2
    s_add_u32 s93, s93, s88
    s_add_u32 s93, s93, 0
    s_add_u32 m0, s3, 65536
    s_nop 0
    buffer_load_dwordx4 v1, s[8:11], s93 offen  lds
    v_mfma_f32_16x16x32_bf16 v[32:35], v[24:27], v[20:23], v[32:35]
    s_waitcnt vmcnt(14) lgkmcnt(5)
    v_mfma_f32_16x16x32_bf16 v[192:195], v[104:107], v[144:147], v[192:195]
    ds_read_b128 v[124:127], v1 offset:41984
    s_waitcnt vmcnt(13)
    v_mfma_f32_16x16x32_bf16 v[208:211], v[104:107], v[148:151], v[208:211]
    s_add_u32 s84, s68, s39
    s_add_u32 s84, s84, 18874368
    buffer_load_dwordx4 v[128:131], v1, s[8:11], s84 offen offset:0 sc1
    s_waitcnt vmcnt(13)
    v_mfma_f32_16x16x32_bf16 v[224:227], v[104:107], v[152:155], v[224:227]
    ds_read_b128 v[24:27], v47 offset:40960
    s_waitcnt vmcnt(12)
    v_mfma_f32_16x16x32_bf16 v[240:243], v[104:107], v[156:159], v[240:243]
    s_waitcnt lgkmcnt(6)
    v_mfma_f32_16x16x32_bf16 v[196:199], v[108:111], v[144:147], v[196:199]
    ds_read_b128 v[104:107], v1 offset:43008
    v_mfma_f32_16x16x32_bf16 v[212:215], v[108:111], v[148:151], v[212:215]
    buffer_load_dwordx4 v[132:135], v44, s[8:11], s84 offen offset:0 sc1
    v_mfma_f32_16x16x32_bf16 v[228:231], v[108:111], v[152:155], v[228:231]
    v_mfma_f32_16x16x32_bf16 v[244:247], v[108:111], v[156:159], v[244:247]
    s_waitcnt lgkmcnt(5)
    v_mfma_f32_16x16x32_bf16 v[200:203], v[112:115], v[144:147], v[200:203]
    ds_read_b128 v[108:111], v1 offset:44032
    v_mfma_f32_16x16x32_bf16 v[216:219], v[112:115], v[148:151], v[216:219]
    buffer_load_dwordx4 v[136:139], v45, s[8:11], s84 offen offset:0 sc1
    v_mfma_f32_16x16x32_bf16 v[232:235], v[112:115], v[152:155], v[232:235]
    v_mfma_f32_16x16x32_bf16 v[248:251], v[112:115], v[156:159], v[248:251]
    s_waitcnt lgkmcnt(5)
    v_mfma_f32_16x16x32_bf16 v[204:207], v[116:119], v[144:147], v[204:207]
    ds_read_b128 v[112:115], v1 offset:45056
    v_mfma_f32_16x16x32_bf16 v[220:223], v[116:119], v[148:151], v[220:223]
    buffer_load_dwordx4 v[140:143], v46, s[8:11], s84 offen offset:0 sc1
    v_mfma_f32_16x16x32_bf16 v[236:239], v[116:119], v[152:155], v[236:239]
    v_mfma_f32_16x16x32_bf16 v[252:255], v[116:119], v[156:159], v[252:255]
    s_lshl_b32 s93, s40, 2
    s_add_u32 s93, s93, s88
    s_add_u32 s93, s93, 4096
    s_add_u32 m0, s3, 69632
    s_nop 0
    buffer_load_dwordx4 v1, s[8:11], s93 offen  lds
    v_mfma_f32_16x16x32_bf16 v[32:35], v[28:31], v[20:23], v[32:35]
    s_waitcnt vmcnt(14) lgkmcnt(5)
    v_mfma_f32_16x16x32_bf16 v[192:195], v[120:123], v[160:163], v[192:195]
    ds_read_b128 v[116:119], v1 offset:46080
    s_waitcnt vmcnt(13)
    v_mfma_f32_16x16x32_bf16 v[208:211], v[120:123], v[164:167], v[208:211]
    buffer_load_dwordx4 v[144:147], v1, s[8:11], s84 offen offset:1024 sc1
    s_waitcnt vmcnt(13)
    v_mfma_f32_16x16x32_bf16 v[224:227], v[120:123], v[168:171], v[224:227]
    ds_read_b128 v[28:31], v47 offset:45056
    s_waitcnt vmcnt(12)
    v_mfma_f32_16x16x32_bf16 v[240:243], v[120:123], v[172:175], v[240:243]
    s_waitcnt lgkmcnt(6)
    v_mfma_f32_16x16x32_bf16 v[196:199], v[124:127], v[160:163], v[196:199]
    ds_read_b128 v[120:123], v1 offset:47104
    v_mfma_f32_16x16x32_bf16 v[212:215], v[124:127], v[164:167], v[212:215]
    buffer_load_dwordx4 v[148:151], v44, s[8:11], s84 offen offset:1024 sc1
    v_mfma_f32_16x16x32_bf16 v[228:231], v[124:127], v[168:171], v[228:231]
    v_mfma_f32_16x16x32_bf16 v[244:247], v[124:127], v[172:175], v[244:247]
    s_waitcnt lgkmcnt(5)
    v_mfma_f32_16x16x32_bf16 v[200:203], v[104:107], v[160:163], v[200:203]
    ds_read_b128 v[124:127], v1 offset:48128
    v_mfma_f32_16x16x32_bf16 v[216:219], v[104:107], v[164:167], v[216:219]
    buffer_load_dwordx4 v[152:155], v45, s[8:11], s84 offen offset:1024 sc1
    v_mfma_f32_16x16x32_bf16 v[232:235], v[104:107], v[168:171], v[232:235]
    v_mfma_f32_16x16x32_bf16 v[248:251], v[104:107], v[172:175], v[248:251]
    s_waitcnt lgkmcnt(5)
    v_mfma_f32_16x16x32_bf16 v[204:207], v[108:111], v[160:163], v[204:207]
    ds_read_b128 v[104:107], v1 offset:49152
    v_mfma_f32_16x16x32_bf16 v[220:223], v[108:111], v[164:167], v[220:223]
    buffer_load_dwordx4 v[156:159], v46, s[8:11], s84 offen offset:1024 sc1
    v_mfma_f32_16x16x32_bf16 v[236:239], v[108:111], v[168:171], v[236:239]
    v_mfma_f32_16x16x32_bf16 v[252:255], v[108:111], v[172:175], v[252:255]
    s_lshl_b32 s93, s40, 2
    s_add_u32 s93, s93, s88
    s_add_u32 s93, s93, 8192
    s_add_u32 m0, s3, 73728
    s_nop 0
    buffer_load_dwordx4 v1, s[8:11], s93 offen  lds
    v_mfma_f32_16x16x32_bf16 v[32:35], v[24:27], v[20:23], v[32:35]
    s_waitcnt vmcnt(14) lgkmcnt(5)
    v_mfma_f32_16x16x32_bf16 v[192:195], v[112:115], v[176:179], v[192:195]
    s_barrier
    ds_read_b128 v[108:111], v1 offset:50176
    s_waitcnt vmcnt(13)
    v_mfma_f32_16x16x32_bf16 v[208:211], v[112:115], v[180:183], v[208:211]
    buffer_load_dwordx4 v[160:163], v1, s[8:11], s84 offen offset:2048 sc1
    s_waitcnt vmcnt(13)
    v_mfma_f32_16x16x32_bf16 v[224:227], v[112:115], v[184:187], v[224:227]
    ds_read_b128 v[24:27], v47 offset:49152
    s_waitcnt vmcnt(12)
    v_mfma_f32_16x16x32_bf16 v[240:243], v[112:115], v[188:191], v[240:243]
    s_waitcnt lgkmcnt(6)
    v_mfma_f32_16x16x32_bf16 v[196:199], v[116:119], v[176:179], v[196:199]
    ds_read_b128 v[112:115], v1 offset:51200
    v_mfma_f32_16x16x32_bf16 v[212:215], v[116:119], v[180:183], v[212:215]
    buffer_load_dwordx4 v[164:167], v44, s[8:11], s84 offen offset:2048 sc1
    v_mfma_f32_16x16x32_bf16 v[228:231], v[116:119], v[184:187], v[228:231]
    v_mfma_f32_16x16x32_bf16 v[244:247], v[116:119], v[188:191], v[244:247]
    s_waitcnt lgkmcnt(5)
    v_mfma_f32_16x16x32_bf16 v[200:203], v[120:123], v[176:179], v[200:203]
    ds_read_b128 v[116:119], v1 offset:52224
    v_mfma_f32_16x16x32_bf16 v[216:219], v[120:123], v[180:183], v[216:219]
    buffer_load_dwordx4 v[168:171], v45, s[8:11], s84 offen offset:2048 sc1
    v_mfma_f32_16x16x32_bf16 v[232:235], v[120:123], v[184:187], v[232:235]
    v_mfma_f32_16x16x32_bf16 v[248:251], v[120:123], v[188:191], v[248:251]
    s_waitcnt lgkmcnt(5)
    v_mfma_f32_16x16x32_bf16 v[204:207], v[124:127], v[176:179], v[204:207]
    ds_read_b128 v[120:123], v1 offset:53248
    v_mfma_f32_16x16x32_bf16 v[220:223], v[124:127], v[180:183], v[220:223]
    buffer_load_dwordx4 v[172:175], v46, s[8:11], s84 offen offset:2048 sc1
    v_mfma_f32_16x16x32_bf16 v[236:239], v[124:127], v[184:187], v[236:239]
    v_mfma_f32_16x16x32_bf16 v[252:255], v[124:127], v[188:191], v[252:255]
    s_lshl_b32 s93, s40, 2
    s_add_u32 s93, s93, s88
    s_add_u32 s93, s93, 12288
    s_add_u32 m0, s3, 77824
    s_nop 0
    buffer_load_dwordx4 v1, s[8:11], s93 offen  lds
    v_mfma_f32_16x16x32_bf16 v[32:35], v[28:31], v[20:23], v[32:35]
    s_waitcnt vmcnt(14) lgkmcnt(5)
    v_mfma_f32_16x16x32_bf16 v[192:195], v[104:107], v[128:131], v[192:195]
    ds_read_b128 v[124:127], v1 offset:54272
    s_waitcnt vmcnt(13)
    v_mfma_f32_16x16x32_bf16 v[208:211], v[104:107], v[132:135], v[208:211]
    buffer_load_dwordx4 v[176:179], v1, s[8:11], s84 offen offset:3072 sc1
    s_waitcnt vmcnt(13)
    v_mfma_f32_16x16x32_bf16 v[224:227], v[104:107], v[136:139], v[224:227]
    ds_read_b128 v[28:31], v47 offset:53248
    s_waitcnt vmcnt(12)
    v_mfma_f32_16x16x32_bf16 v[240:243], v[104:107], v[140:143], v[240:243]
    s_waitcnt lgkmcnt(6)
    v_mfma_f32_16x16x32_bf16 v[196:199], v[108:111], v[128:131], v[196:199]
    ds_read_b128 v[104:107], v1 offset:55296
    v_mfma_f32_16x16x32_bf16 v[212:215], v[108:111], v[132:135], v[212:215]
    buffer_load_dwordx4 v[180:183], v44, s[8:11], s84 offen offset:3072 sc1
    v_mfma_f32_16x16x32_bf16 v[228:231], v[108:111], v[136:139], v[228:231]
    v_mfma_f32_16x16x32_bf16 v[244:247], v[108:111], v[140:143], v[244:247]
    s_waitcnt lgkmcnt(5)
    v_mfma_f32_16x16x32_bf16 v[200:203], v[112:115], v[128:131], v[200:203]
    ds_read_b128 v[108:111], v1 offset:56320
    v_mfma_f32_16x16x32_bf16 v[216:219], v[112:115], v[132:135], v[216:219]
    buffer_load_dwordx4 v[184:187], v45, s[8:11], s84 offen offset:3072 sc1
    v_mfma_f32_16x16x32_bf16 v[232:235], v[112:115], v[136:139], v[232:235]
    v_mfma_f32_16x16x32_bf16 v[248:251], v[112:115], v[140:143], v[248:251]
    s_waitcnt lgkmcnt(5)
    v_mfma_f32_16x16x32_bf16 v[204:207], v[116:119], v[128:131], v[204:207]
    ds_read_b128 v[112:115], v1 offset:57344
    v_mfma_f32_16x16x32_bf16 v[220:223], v[116:119], v[132:135], v[220:223]
    buffer_load_dwordx4 v[188:191], v46, s[8:11], s84 offen offset:3072 sc1
    v_mfma_f32_16x16x32_bf16 v[236:239], v[116:119], v[136:139], v[236:239]
    v_mfma_f32_16x16x32_bf16 v[252:255], v[116:119], v[140:143], v[252:255]
    v_mfma_f32_16x16x32_bf16 v[32:35], v[24:27], v[20:23], v[32:35]
    s_waitcnt vmcnt(13) lgkmcnt(5)
    v_mfma_f32_16x16x32_bf16 v[192:195], v[120:123], v[144:147], v[192:195]
    ds_read_b128 v[116:119], v1 offset:58368
    s_waitcnt vmcnt(12)
    v_mfma_f32_16x16x32_bf16 v[208:211], v[120:123], v[148:151], v[208:211]
    s_add_u32 s84, s68, s40
    s_add_u32 s84, s84, 18874368
    buffer_load_dwordx4 v[128:131], v1, s[8:11], s84 offen offset:0 sc1
    s_waitcnt vmcnt(12)
    v_mfma_f32_16x16x32_bf16 v[224:227], v[120:123], v[152:155], v[224:227]
    ds_read_b128 v[24:27], v47 offset:57344
    s_waitcnt vmcnt(11)
    v_mfma_f32_16x16x32_bf16 v[240:243], v[120:123], v[156:159], v[240:243]
    s_waitcnt lgkmcnt(6)
    v_mfma_f32_16x16x32_bf16 v[196:199], v[124:127], v[144:147], v[196:199]
    ds_read_b128 v[120:123], v1 offset:59392
    v_mfma_f32_16x16x32_bf16 v[212:215], v[124:127], v[148:151], v[212:215]
    buffer_load_dwordx4 v[132:135], v44, s[8:11], s84 offen offset:0 sc1
    v_mfma_f32_16x16x32_bf16 v[228:231], v[124:127], v[152:155], v[228:231]
    v_mfma_f32_16x16x32_bf16 v[244:247], v[124:127], v[156:159], v[244:247]
    s_waitcnt lgkmcnt(5)
    v_mfma_f32_16x16x32_bf16 v[200:203], v[104:107], v[144:147], v[200:203]
    ds_read_b128 v[124:127], v1 offset:60416
    v_mfma_f32_16x16x32_bf16 v[216:219], v[104:107], v[148:151], v[216:219]
    buffer_load_dwordx4 v[136:139], v45, s[8:11], s84 offen offset:0 sc1
    v_mfma_f32_16x16x32_bf16 v[232:235], v[104:107], v[152:155], v[232:235]
    v_mfma_f32_16x16x32_bf16 v[248:251], v[104:107], v[156:159], v[248:251]
    s_waitcnt lgkmcnt(5)
    v_mfma_f32_16x16x32_bf16 v[204:207], v[108:111], v[144:147], v[204:207]
    ds_read_b128 v[104:107], v1 offset:61440
    v_mfma_f32_16x16x32_bf16 v[220:223], v[108:111], v[148:151], v[220:223]
    buffer_load_dwordx4 v[140:143], v46, s[8:11], s84 offen offset:0 sc1
    v_mfma_f32_16x16x32_bf16 v[236:239], v[108:111], v[152:155], v[236:239]
    v_mfma_f32_16x16x32_bf16 v[252:255], v[108:111], v[156:159], v[252:255]
    v_mfma_f32_16x16x32_bf16 v[32:35], v[28:31], v[20:23], v[32:35]
    s_waitcnt vmcnt(12) lgkmcnt(5)
    v_mfma_f32_16x16x32_bf16 v[192:195], v[112:115], v[160:163], v[192:195]
    s_barrier
    ds_read_b128 v[108:111], v1 offset:62464
    s_waitcnt vmcnt(11)
    v_mfma_f32_16x16x32_bf16 v[208:211], v[112:115], v[164:167], v[208:211]
    buffer_load_dwordx4 v[144:147], v1, s[8:11], s84 offen offset:1024 sc1
    s_waitcnt vmcnt(11)
    v_mfma_f32_16x16x32_bf16 v[224:227], v[112:115], v[168:171], v[224:227]
    ds_read_b128 v[28:31], v47 offset:61440
    ds_read_b128 v[64:67], v2 offset:16384
    s_waitcnt vmcnt(10)
    v_mfma_f32_16x16x32_bf16 v[240:243], v[112:115], v[172:175], v[240:243]
    s_waitcnt lgkmcnt(7)
    v_mfma_f32_16x16x32_bf16 v[196:199], v[116:119], v[160:163], v[196:199]
    ds_read_b128 v[112:115], v1 offset:63488
    v_mfma_f32_16x16x32_bf16 v[212:215], v[116:119], v[164:167], v[212:215]
    buffer_load_dwordx4 v[148:151], v44, s[8:11], s84 offen offset:1024 sc1
    v_mfma_f32_16x16x32_bf16 v[228:231], v[116:119], v[168:171], v[228:231]
    ds_read_b128 v[68:71], v2 offset:17408
    v_mfma_f32_16x16x32_bf16 v[244:247], v[116:119], v[172:175], v[244:247]
    s_waitcnt lgkmcnt(7)
    v_mfma_f32_16x16x32_bf16 v[200:203], v[120:123], v[160:163], v[200:203]
    ds_read_b128 v[116:119], v1 offset:64512
    v_mfma_f32_16x16x32_bf16 v[216:219], v[120:123], v[164:167], v[216:219]
    buffer_load_dwordx4 v[152:155], v45, s[8:11], s84 offen offset:1024 sc1
    v_mfma_f32_16x16x32_bf16 v[232:235], v[120:123], v[168:171], v[232:235]
    ds_read_b128 v[72:75], v2 offset:18432
    v_mfma_f32_16x16x32_bf16 v[248:251], v[120:123], v[172:175], v[248:251]
    s_waitcnt lgkmcnt(8)
    v_mfma_f32_16x16x32_bf16 v[204:207], v[124:127], v[160:163], v[204:207]
    ds_read_b128 v[120:123], v2 offset:0
    v_mfma_f32_16x16x32_bf16 v[220:223], v[124:127], v[164:167], v[220:223]
    buffer_load_dwordx4 v[156:159], v46, s[8:11], s84 offen offset:1024 sc1
    v_mfma_f32_16x16x32_bf16 v[236:239], v[124:127], v[168:171], v[236:239]
    ds_read_b128 v[76:79], v2 offset:19456
    v_mfma_f32_16x16x32_bf16 v[252:255], v[124:127], v[172:175], v[252:255]
    v_mfma_f32_16x16x32_bf16 v[32:35], v[24:27], v[20:23], v[32:35]
    s_waitcnt vmcnt(11) lgkmcnt(9)
    v_mfma_f32_16x16x32_bf16 v[192:195], v[104:107], v[176:179], v[192:195]
    ds_read_b128 v[124:127], v2 offset:1024
    s_waitcnt vmcnt(10)
    v_mfma_f32_16x16x32_bf16 v[208:211], v[104:107], v[180:183], v[208:211]
    buffer_load_dwordx4 v[160:163], v1, s[8:11], s84 offen offset:2048 sc1
    s_waitcnt vmcnt(10)
    v_mfma_f32_16x16x32_bf16 v[224:227], v[104:107], v[184:187], v[224:227]
    ds_read_b128 v[24:27], v48 offset:0
    ds_read_b128 v[80:83], v2 offset:20480
    s_waitcnt vmcnt(9)
    v_mfma_f32_16x16x32_bf16 v[240:243], v[104:107], v[188:191], v[240:243]
    s_waitcnt lgkmcnt(11)
    v_mfma_f32_16x16x32_bf16 v[196:199], v[108:111], v[176:179], v[196:199]
    ds_read_b128 v[104:107], v2 offset:2048
    v_mfma_f32_16x16x32_bf16 v[212:215], v[108:111], v[180:183], v[212:215]
    buffer_load_dwordx4 v[164:167], v44, s[8:11], s84 offen offset:2048 sc1
    v_mfma_f32_16x16x32_bf16 v[228:231], v[108:111], v[184:187], v[228:231]
    ds_read_b128 v[84:87], v2 offset:21504
    v_mfma_f32_16x16x32_bf16 v[244:247], v[108:111], v[188:191], v[244:247]
    s_waitcnt lgkmcnt(10)
    v_mfma_f32_16x16x32_bf16 v[200:203], v[112:115], v[176:179], v[200:203]
    ds_read_b128 v[108:111], v2 offset:3072
    v_mfma_f32_16x16x32_bf16 v[216:219], v[112:115], v[180:183], v[216:219]
    buffer_load_dwordx4 v[168:171], v45, s[8:11], s84 offen offset:2048 sc1
    v_mfma_f32_16x16x32_bf16 v[232:235], v[112:115], v[184:187], v[232:235]
    ds_read_b128 v[88:91], v2 offset:22528
    v_mfma_f32_16x16x32_bf16 v[248:251], v[112:115], v[188:191], v[248:251]
    s_waitcnt lgkmcnt(10)
    v_mfma_f32_16x16x32_bf16 v[204:207], v[116:119], v[176:179], v[204:207]
    ds_read_b128 v[112:115], v2 offset:4096
    v_mfma_f32_16x16x32_bf16 v[220:223], v[116:119], v[180:183], v[220:223]
    buffer_load_dwordx4 v[172:175], v46, s[8:11], s84 offen offset:2048 sc1
    v_mfma_f32_16x16x32_bf16 v[236:239], v[116:119], v[184:187], v[236:239]
    ds_read_b128 v[92:95], v2 offset:23552
    v_mfma_f32_16x16x32_bf16 v[252:255], v[116:119], v[188:191], v[252:255]
    v_mfma_f32_16x16x32_bf16 v[32:35], v[28:31], v[20:23], v[32:35]
    s_waitcnt vmcnt(11) lgkmcnt(10)
    v_mfma_f32_16x16x32_bf16 v[192:195], v[120:123], v[128:131], v[192:195]
    ds_read_b128 v[116:119], v2 offset:5120
    s_waitcnt vmcnt(10)
    v_mfma_f32_16x16x32_bf16 v[208:211], v[120:123], v[132:135], v[208:211]
    buffer_load_dwordx4 v[176:179], v1, s[8:11], s84 offen offset:3072 sc1
    s_waitcnt vmcnt(10)
    v_mfma_f32_16x16x32_bf16 v[224:227], v[120:123], v[136:139], v[224:227]
    ds_read_b128 v[28:31], v48 offset:4096
    ds_read_b128 v[96:99], v2 offset:24576
    s_waitcnt vmcnt(9)
    v_mfma_f32_16x16x32_bf16 v[240:243], v[120:123], v[140:143], v[240:243]
    s_waitcnt lgkmcnt(11)
    v_mfma_f32_16x16x32_bf16 v[196:199], v[124:127], v[128:131], v[196:199]
    ds_read_b128 v[120:123], v2 offset:6144
    v_mfma_f32_16x16x32_bf16 v[212:215], v[124:127], v[132:135], v[212:215]
    buffer_load_dwordx4 v[180:183], v44, s[8:11], s84 offen offset:3072 sc1
    v_mfma_f32_16x16x32_bf16 v[228:231], v[124:127], v[136:139], v[228:231]
    ds_read_b128 v[100:103], v2 offset:25600
    v_mfma_f32_16x16x32_bf16 v[244:247], v[124:127], v[140:143], v[244:247]
    s_waitcnt lgkmcnt(10)
    v_mfma_f32_16x16x32_bf16 v[200:203], v[104:107], v[128:131], v[200:203]
    ds_read_b128 v[124:127], v2 offset:7168
    v_mfma_f32_16x16x32_bf16 v[216:219], v[104:107], v[132:135], v[216:219]
    buffer_load_dwordx4 v[184:187], v45, s[8:11], s84 offen offset:3072 sc1
    v_mfma_f32_16x16x32_bf16 v[232:235], v[104:107], v[136:139], v[232:235]
    v_mfma_f32_16x16x32_bf16 v[248:251], v[104:107], v[140:143], v[248:251]
    s_waitcnt lgkmcnt(9)
    v_mfma_f32_16x16x32_bf16 v[204:207], v[108:111], v[128:131], v[204:207]
    ds_read_b128 v[104:107], v2 offset:8192
    v_mfma_f32_16x16x32_bf16 v[220:223], v[108:111], v[132:135], v[220:223]
    buffer_load_dwordx4 v[188:191], v46, s[8:11], s84 offen offset:3072 sc1
    v_mfma_f32_16x16x32_bf16 v[236:239], v[108:111], v[136:139], v[236:239]
    v_mfma_f32_16x16x32_bf16 v[252:255], v[108:111], v[140:143], v[252:255]
    v_mfma_f32_16x16x32_bf16 v[32:35], v[24:27], v[20:23], v[32:35]
    s_waitcnt vmcnt(11) lgkmcnt(8)
    v_mfma_f32_16x16x32_bf16 v[192:195], v[112:115], v[144:147], v[192:195]
    s_barrier
    ds_read_b128 v[108:111], v2 offset:9216
    s_waitcnt vmcnt(10)
    v_mfma_f32_16x16x32_bf16 v[208:211], v[112:115], v[148:151], v[208:211]
    s_add_u32 s84, s68, 18894848
    buffer_load_dwordx4 v[128:131], v1, s[8:11], s84 offen offset:0 sc1
    s_waitcnt vmcnt(10)
    v_mfma_f32_16x16x32_bf16 v[224:227], v[112:115], v[152:155], v[224:227]
    ds_read_b128 v[24:27], v48 offset:8192
    s_waitcnt vmcnt(9)
    v_mfma_f32_16x16x32_bf16 v[240:243], v[112:115], v[156:159], v[240:243]
    s_waitcnt lgkmcnt(8)
    v_mfma_f32_16x16x32_bf16 v[196:199], v[116:119], v[144:147], v[196:199]
    ds_read_b128 v[112:115], v2 offset:10240
    v_mfma_f32_16x16x32_bf16 v[212:215], v[116:119], v[148:151], v[212:215]
    buffer_load_dwordx4 v[132:135], v44, s[8:11], s84 offen offset:0 sc1
    v_mfma_f32_16x16x32_bf16 v[228:231], v[116:119], v[152:155], v[228:231]
    v_mfma_f32_16x16x32_bf16 v[244:247], v[116:119], v[156:159], v[244:247]
    s_waitcnt lgkmcnt(6)
    v_mfma_f32_16x16x32_bf16 v[200:203], v[120:123], v[144:147], v[200:203]
    ds_read_b128 v[116:119], v2 offset:11264
    v_mfma_f32_16x16x32_bf16 v[216:219], v[120:123], v[148:151], v[216:219]
    buffer_load_dwordx4 v[136:139], v45, s[8:11], s84 offen offset:0 sc1
    v_mfma_f32_16x16x32_bf16 v[232:235], v[120:123], v[152:155], v[232:235]
    v_mfma_f32_16x16x32_bf16 v[248:251], v[120:123], v[156:159], v[248:251]
    s_waitcnt lgkmcnt(5)
    v_mfma_f32_16x16x32_bf16 v[204:207], v[124:127], v[144:147], v[204:207]
    ds_read_b128 v[120:123], v2 offset:12288
    v_mfma_f32_16x16x32_bf16 v[220:223], v[124:127], v[148:151], v[220:223]
    buffer_load_dwordx4 v[140:143], v46, s[8:11], s84 offen offset:0 sc1
    v_mfma_f32_16x16x32_bf16 v[236:239], v[124:127], v[152:155], v[236:239]
    v_mfma_f32_16x16x32_bf16 v[252:255], v[124:127], v[156:159], v[252:255]
    v_mfma_f32_16x16x32_bf16 v[32:35], v[28:31], v[20:23], v[32:35]
    s_waitcnt vmcnt(11) lgkmcnt(5)
    v_mfma_f32_16x16x32_bf16 v[192:195], v[104:107], v[160:163], v[192:195]
    ds_read_b128 v[124:127], v2 offset:13312
    s_waitcnt vmcnt(10)
    v_mfma_f32_16x16x32_bf16 v[208:211], v[104:107], v[164:167], v[208:211]
    v_lshlrev_b32 v146, 7, v0
    s_lshl_b32 s87, s49, 13
    s_add_u32 s87, s87, 13697024
    buffer_load_dwordx2 v[144:145], v146, s[8:11], s87 offen sc1
    s_waitcnt vmcnt(10)
    v_mfma_f32_16x16x32_bf16 v[224:227], v[104:107], v[168:171], v[224:227]
    ds_read_b128 v[28:31], v48 offset:12288
    s_waitcnt vmcnt(9)
    v_mfma_f32_16x16x32_bf16 v[240:243], v[104:107], v[172:175], v[240:243]
    s_waitcnt lgkmcnt(6)
    v_mfma_f32_16x16x32_bf16 v[196:199], v[108:111], v[160:163], v[196:199]
    ds_read_b128 v[104:107], v2 offset:14336
    v_mfma_f32_16x16x32_bf16 v[212:215], v[108:111], v[164:167], v[212:215]
    v_mfma_f32_16x16x32_bf16 v[228:231], v[108:111], v[168:171], v[228:231]
    v_mfma_f32_16x16x32_bf16 v[244:247], v[108:111], v[172:175], v[244:247]
    s_waitcnt lgkmcnt(5)
    v_mfma_f32_16x16x32_bf16 v[200:203], v[112:115], v[160:163], v[200:203]
    ds_read_b128 v[108:111], v2 offset:15360
    v_mfma_f32_16x16x32_bf16 v[216:219], v[112:115], v[164:167], v[216:219]
    v_mfma_f32_16x16x32_bf16 v[232:235], v[112:115], v[168:171], v[232:235]
    v_mfma_f32_16x16x32_bf16 v[248:251], v[112:115], v[172:175], v[248:251]
    s_waitcnt lgkmcnt(5)
    v_mfma_f32_16x16x32_bf16 v[204:207], v[116:119], v[160:163], v[204:207]
    v_mfma_f32_16x16x32_bf16 v[220:223], v[116:119], v[164:167], v[220:223]
    v_mfma_f32_16x16x32_bf16 v[236:239], v[116:119], v[168:171], v[236:239]
    v_mfma_f32_16x16x32_bf16 v[252:255], v[116:119], v[172:175], v[252:255]
    v_mfma_f32_16x16x32_bf16 v[32:35], v[24:27], v[20:23], v[32:35]
    s_waitcnt vmcnt(8) lgkmcnt(4)
    v_mfma_f32_16x16x32_bf16 v[192:195], v[120:123], v[176:179], v[192:195]
    s_waitcnt vmcnt(7)
    v_mfma_f32_16x16x32_bf16 v[208:211], v[120:123], v[180:183], v[208:211]
    s_waitcnt vmcnt(6)
    v_mfma_f32_16x16x32_bf16 v[224:227], v[120:123], v[184:187], v[224:227]
    s_waitcnt vmcnt(5)
    v_mfma_f32_16x16x32_bf16 v[240:243], v[120:123], v[188:191], v[240:243]
    s_waitcnt lgkmcnt(3)
    v_mfma_f32_16x16x32_bf16 v[196:199], v[124:127], v[176:179], v[196:199]
    v_mfma_f32_16x16x32_bf16 v[212:215], v[124:127], v[180:183], v[212:215]
    v_mfma_f32_16x16x32_bf16 v[228:231], v[124:127], v[184:187], v[228:231]
    v_mfma_f32_16x16x32_bf16 v[244:247], v[124:127], v[188:191], v[244:247]
    s_waitcnt lgkmcnt(1)
    v_mfma_f32_16x16x32_bf16 v[200:203], v[104:107], v[176:179], v[200:203]
    v_mfma_f32_16x16x32_bf16 v[216:219], v[104:107], v[180:183], v[216:219]
    s_waitcnt vmcnt(1)
    v_add_f32 v128, v128, v130
    v_add_f32 v132, v132, v134
    v_mfma_f32_16x16x32_bf16 v[232:235], v[104:107], v[184:187], v[232:235]
    v_add_f32 v136, v136, v138
    v_add_f32 v140, v140, v142
    v_mfma_f32_16x16x32_bf16 v[248:251], v[104:107], v[188:191], v[248:251]
    s_waitcnt lgkmcnt(0)
    v_add_f32 v129, v129, v131
    v_add_f32 v133, v133, v135
    v_mfma_f32_16x16x32_bf16 v[204:207], v[108:111], v[176:179], v[204:207]
    v_add_f32 v137, v137, v139
    v_add_f32 v141, v141, v143
    v_mfma_f32_16x16x32_bf16 v[220:223], v[108:111], v[180:183], v[220:223]
    v_permlane32_swap_b32 v128, v129
    v_permlane32_swap_b32 v132, v133
    v_mfma_f32_16x16x32_bf16 v[236:239], v[108:111], v[184:187], v[236:239]
    v_permlane32_swap_b32 v136, v137
    v_permlane32_swap_b32 v140, v141
    v_mfma_f32_16x16x32_bf16 v[252:255], v[108:111], v[188:191], v[252:255]
    v_add_f32 v128, v128, v129
    v_add_f32 v132, v132, v133
    v_mfma_f32_16x16x32_bf16 v[32:35], v[28:31], v[20:23], v[32:35]
    v_add_f32 v136, v136, v137
    v_add_f32 v140, v140, v141
    s_mul_i32 s6, s78, 2560
    s_add_u32 s6, s6, 22020096
    s_mul_i32 s7, s44, 327680
    s_add_u32 s6, s6, s7
    v_min_u32 v19, 19, v0
    v_lshlrev_b32 v19, 7, v19
    buffer_load_dword a252, v19, s[8:11], s6 offen sc1
    ds_write_b128 v63, v[32:35]
    v_mov_b32 v129, v128
    v_mov_b32 v133, v132
    v_mov_b32 v137, v136
    v_mov_b32 v141, v140
    v_permlane16_swap_b32 v128, v129
    v_permlane16_swap_b32 v132, v133
    v_permlane16_swap_b32 v136, v137
    v_permlane16_swap_b32 v140, v141
    v_add_f32 v128, v128, v129
    v_add_f32 v132, v132, v133
    v_add_f32 v136, v136, v137
    v_add_f32 v140, v140, v141
    v_mov_b32 v129, v128
    v_mov_b32 v133, v132
    v_mov_b32 v137, v136
    v_mov_b32 v141, v140
    v_permlane32_swap_b32 v128, v129
    v_permlane32_swap_b32 v132, v133
    v_permlane32_swap_b32 v136, v137
    v_permlane32_swap_b32 v140, v141
    v_mul_f32 v36, 0xbacccccd, v128
    v_mul_f32 v38, 0xbacccccd, v132
    v_mul_f32 v40, 0xbacccccd, v136
    v_mul_f32 v42, 0xbacccccd, v140
    v_mul_f32 v129, 0x3acccccd, v129
    v_mul_f32 v133, 0x3acccccd, v133
    v_mul_f32 v137, 0x3acccccd, v137
    v_mul_f32 v141, 0x3acccccd, v141
    v_fma_f32 v129, -v36, v36, v129
    v_fma_f32 v133, -v38, v38, v133
    v_fma_f32 v137, -v40, v40, v137
    v_fma_f32 v141, -v42, v42, v141
    v_max_f32 v129, 0, v129
    v_max_f32 v133, 0, v133
    v_max_f32 v137, 0, v137
    v_max_f32 v141, 0, v141
    v_add_f32 v130, 0x3727c5ac, v129
    v_add_f32 v134, 0x3727c5ac, v133
    v_add_f32 v138, 0x3727c5ac, v137
    v_add_f32 v142, 0x3727c5ac, v141
    v_rsq_f32 v37, v130
    v_rsq_f32 v39, v134
    v_rsq_f32 v41, v138
    v_rsq_f32 v43, v142
    v_accvgpr_read_b32 v48, a38
    v_accvgpr_read_b32 v49, a39
    s_waitcnt vmcnt(1)
    s_mov_b32 s92, s67
ACP_1:
    v_and_b32 v145, -16, v145
    v_cmp_eq_u64 vcc, s[0:1], v[144:145]
    s_nop 0
    s_cmp_eq_u64 vcc, -1
    s_cbranch_scc1 ACD_2
    buffer_load_dwordx2 v[144:145], v146, s[8:11], s87 offen sc1
    s_waitcnt vmcnt(0)
    s_sub_u32 s92, s92, 1
    s_cbranch_scc0 ACP_1
    s_mov_b32 s67, 0
ACD_2:
    s_waitcnt lgkmcnt(0)
    s_barrier
    s_mul_i32 s6, s78, 6400
    s_add_u32 s6, s6, 3145728
    v_min_u32 v19, 49, v0
    v_lshlrev_b32 v19, 7, v19
    buffer_load_dword a252, v19, s[8:11], s6 offen sc1
    ds_read_b128 v[20:23], v62 offset:0
    ds_read_b128 v[24:27], v62 offset:64
    ds_read_b128 v[28:31], v62 offset:128
    ds_read_b128 v[32:35], v62 offset:192
    v_and_b32 v46, 15, v0
    v_lshrrev_b32 v47, 2, v46
    v_and_b32 v46, 3, v46
    v_lshl_add_u32 v47, v47, 6, v62
    v_lshl_add_u32 v47, v46, 2, v47
    ds_read_b32 v46, v47
    s_waitcnt lgkmcnt(0)
    v_accvgpr_write_b32 a248, v46
    v_pk_fma_f32 v[192:193], v[20:21], v[36:37], v[192:193] op_sel_hi:[1,0,1]
    v_pk_fma_f32 v[194:195], v[22:23], v[36:37], v[194:195] op_sel_hi:[1,0,1]
    v_pk_fma_f32 v[196:197], v[24:25], v[36:37], v[196:197] op_sel_hi:[1,0,1]
    v_pk_fma_f32 v[198:199], v[26:27], v[36:37], v[198:199] op_sel_hi:[1,0,1]
    v_pk_fma_f32 v[204:205], v[32:33], v[36:37], v[204:205] op_sel_hi:[1,0,1]
    v_pk_fma_f32 v[206:207], v[34:35], v[36:37], v[206:207] op_sel_hi:[1,0,1]
    v_pk_mul_f32 v[192:193], v[192:193], v[36:37] op_sel:[0,1] op_sel_hi:[1,1]
    v_pk_mul_f32 v[194:195], v[194:195], v[36:37] op_sel:[0,1] op_sel_hi:[1,1]
    v_pk_mul_f32 v[196:197], v[196:197], v[36:37] op_sel:[0,1] op_sel_hi:[1,1]
    v_pk_mul_f32 v[198:199], v[198:199], v[36:37] op_sel:[0,1] op_sel_hi:[1,1]
    v_pk_mul_f32 v[204:205], v[204:205], v[36:37] op_sel:[0,1] op_sel_hi:[1,1]
    v_pk_mul_f32 v[206:207], v[206:207], v[36:37] op_sel:[0,1] op_sel_hi:[1,1]
    v_pk_fma_f32 v[208:209], v[20:21], v[38:39], v[208:209] op_sel_hi:[1,0,1]
    v_pk_fma_f32 v[210:211], v[22:23], v[38:39], v[210:211] op_sel_hi:[1,0,1]
    v_pk_fma_f32 v[212:213], v[24:25], v[38:39], v[212:213] op_sel_hi:[1,0,1]
    v_pk_fma_f32 v[214:215], v[26:27], v[38:39], v[214:215] op_sel_hi:[1,0,1]
    v_pk_fma_f32 v[220:221], v[32:33], v[38:39], v[220:221] op_sel_hi:[1,0,1]
    v_pk_fma_f32 v[222:223], v[34:35], v[38:39], v[222:223] op_sel_hi:[1,0,1]
    v_pk_mul_f32 v[208:209], v[208:209], v[38:39] op_sel:[0,1] op_sel_hi:[1,1]
    v_pk_mul_f32 v[210:211], v[210:211], v[38:39] op_sel:[0,1] op_sel_hi:[1,1]
    v_pk_mul_f32 v[212:213], v[212:213], v[38:39] op_sel:[0,1] op_sel_hi:[1,1]
    v_pk_mul_f32 v[214:215], v[214:215], v[38:39] op_sel:[0,1] op_sel_hi:[1,1]
    v_pk_mul_f32 v[220:221], v[220:221], v[38:39] op_sel:[0,1] op_sel_hi:[1,1]
    v_pk_mul_f32 v[222:223], v[222:223], v[38:39] op_sel:[0,1] op_sel_hi:[1,1]
    v_pk_fma_f32 v[224:225], v[20:21], v[40:41], v[224:225] op_sel_hi:[1,0,1]
    v_pk_fma_f32 v[226:227], v[22:23], v[40:41], v[226:227] op_sel_hi:[1,0,1]
    v_pk_fma_f32 v[228:229], v[24:25], v[40:41], v[228:229] op_sel_hi:[1,0,1]
    v_pk_fma_f32 v[230:231], v[26:27], v[40:41], v[230:231] op_sel_hi:[1,0,1]
    v_pk_fma_f32 v[236:237], v[32:33], v[40:41], v[236:237] op_sel_hi:[1,0,1]
    v_pk_fma_f32 v[238:239], v[34:35], v[40:41], v[238:239] op_sel_hi:[1,0,1]
    v_pk_mul_f32 v[224:225], v[224:225], v[40:41] op_sel:[0,1] op_sel_hi:[1,1]
    v_pk_mul_f32 v[226:227], v[226:227], v[40:41] op_sel:[0,1] op_sel_hi:[1,1]
    v_pk_mul_f32 v[228:229], v[228:229], v[40:41] op_sel:[0,1] op_sel_hi:[1,1]
    v_pk_mul_f32 v[230:231], v[230:231], v[40:41] op_sel:[0,1] op_sel_hi:[1,1]
    v_pk_mul_f32 v[236:237], v[236:237], v[40:41] op_sel:[0,1] op_sel_hi:[1,1]
    v_pk_mul_f32 v[238:239], v[238:239], v[40:41] op_sel:[0,1] op_sel_hi:[1,1]
    v_pk_fma_f32 v[240:241], v[20:21], v[42:43], v[240:241] op_sel_hi:[1,0,1]
    v_pk_fma_f32 v[242:243], v[22:23], v[42:43], v[242:243] op_sel_hi:[1,0,1]
    v_pk_fma_f32 v[244:245], v[24:25], v[42:43], v[244:245] op_sel_hi:[1,0,1]
    v_pk_fma_f32 v[246:247], v[26:27], v[42:43], v[246:247] op_sel_hi:[1,0,1]
    v_pk_fma_f32 v[252:253], v[32:33], v[42:43], v[252:253] op_sel_hi:[1,0,1]
    v_pk_fma_f32 v[254:255], v[34:35], v[42:43], v[254:255] op_sel_hi:[1,0,1]
    v_pk_mul_f32 v[240:241], v[240:241], v[42:43] op_sel:[0,1] op_sel_hi:[1,1]
    v_pk_mul_f32 v[242:243], v[242:243], v[42:43] op_sel:[0,1] op_sel_hi:[1,1]
    v_pk_mul_f32 v[244:245], v[244:245], v[42:43] op_sel:[0,1] op_sel_hi:[1,1]
    v_pk_mul_f32 v[246:247], v[246:247], v[42:43] op_sel:[0,1] op_sel_hi:[1,1]
    v_pk_mul_f32 v[252:253], v[252:253], v[42:43] op_sel:[0,1] op_sel_hi:[1,1]
    v_pk_mul_f32 v[254:255], v[254:255], v[42:43] op_sel:[0,1] op_sel_hi:[1,1]
    v_pk_fma_f32 v[176:177], v[28:29], v[36:37], v[200:201] op_sel_hi:[1,0,1]
    v_pk_fma_f32 v[178:179], v[30:31], v[36:37], v[202:203] op_sel_hi:[1,0,1]
    v_pk_fma_f32 v[180:181], v[28:29], v[38:39], v[216:217] op_sel_hi:[1,0,1]
    v_pk_fma_f32 v[182:183], v[30:31], v[38:39], v[218:219] op_sel_hi:[1,0,1]
    v_pk_fma_f32 v[184:185], v[28:29], v[40:41], v[232:233] op_sel_hi:[1,0,1]
    v_pk_fma_f32 v[186:187], v[30:31], v[40:41], v[234:235] op_sel_hi:[1,0,1]
    v_pk_fma_f32 v[188:189], v[28:29], v[42:43], v[248:249] op_sel_hi:[1,0,1]
    v_pk_fma_f32 v[190:191], v[30:31], v[42:43], v[250:251] op_sel_hi:[1,0,1]
    v_cvt_pk_bf16_f32 v144, v192, v193
    v_cvt_pk_bf16_f32 v145, v194, v195
    v_cvt_pk_bf16_f32 v146, v196, v197
    v_cvt_pk_bf16_f32 v147, v198, v199
    v_cvt_pk_bf16_f32 v152, v208, v209
    v_cvt_pk_bf16_f32 v153, v210, v211
    v_cvt_pk_bf16_f32 v154, v212, v213
    v_cvt_pk_bf16_f32 v155, v214, v215
    v_lshrrev_b32 v24, 4, v0
    v_cmp_eq_u32 vcc, 3, v24
    v_mov_b32 v24, 0x3f80
    v_mov_b32 v44, 0x3fb8aa3b
    v_mfma_f32_16x16x32_bf16 v[104:107], v[64:67], v[144:147], 0
    v_cvt_pk_bf16_f32 v160, v224, v225
    v_cvt_pk_bf16_f32 v161, v226, v227
    v_mfma_f32_16x16x32_bf16 v[108:111], v[68:71], v[144:147], 0
    v_cvt_pk_bf16_f32 v162, v228, v229
    v_cvt_pk_bf16_f32 v163, v230, v231
    v_mfma_f32_16x16x32_bf16 v[112:115], v[72:75], v[144:147], 0
    v_cvt_pk_bf16_f32 v168, v240, v241
    v_cvt_pk_bf16_f32 v169, v242, v243
    v_mfma_f32_16x16x32_bf16 v[116:119], v[76:79], v[144:147], 0
    v_cvt_pk_bf16_f32 v170, v244, v245
    v_cvt_pk_bf16_f32 v171, v246, v247
    v_mfma_f32_16x16x32_bf16 v[120:123], v[80:83], v[144:147], 0
    v_cvt_pk_bf16_f32 v150, v204, v205
    v_cvt_pk_bf16_f32 v151, v206, v207
    v_mfma_f32_16x16x32_bf16 v[104:107], v[84:87], v[152:155], v[104:107]
    v_cndmask_b32 v150, v150, v24, vcc
    v_cndmask_b32 v151, v151, 0, vcc
    v_mfma_f32_16x16x32_bf16 v[108:111], v[88:91], v[152:155], v[108:111]
    ds_write_b64 v51, v[146:147] offset:0
    ds_write_b64 v52, v[150:151] offset:0
    v_cvt_pk_bf16_f32 v158, v220, v221
    v_mfma_f32_16x16x32_bf16 v[112:115], v[92:95], v[152:155], v[112:115]
    v_cvt_pk_bf16_f32 v159, v222, v223
    v_cndmask_b32 v158, v158, v24, vcc
    v_mfma_f32_16x16x32_bf16 v[116:119], v[96:99], v[152:155], v[116:119]
    v_cndmask_b32 v159, v159, 0, vcc
    v_mfma_f32_16x16x32_bf16 v[120:123], v[100:103], v[152:155], v[120:123]
    ds_write_b64 v51, v[154:155] offset:1152
    ds_write_b64 v52, v[158:159] offset:1152
    v_cvt_pk_bf16_f32 v166, v236, v237
    v_mfma_f32_16x16x32_bf16 v[124:127], v[64:67], v[160:163], 0
    v_cvt_pk_bf16_f32 v167, v238, v239
    v_cndmask_b32 v166, v166, v24, vcc
    v_mfma_f32_16x16x32_bf16 v[128:131], v[68:71], v[160:163], 0
    v_cndmask_b32 v167, v167, 0, vcc
    v_mfma_f32_16x16x32_bf16 v[132:135], v[72:75], v[160:163], 0
    ds_write_b64 v51, v[162:163] offset:2304
    ds_write_b64 v52, v[166:167] offset:2304
    v_cvt_pk_bf16_f32 v174, v252, v253
    v_mfma_f32_16x16x32_bf16 v[136:139], v[76:79], v[160:163], 0
    v_cvt_pk_bf16_f32 v175, v254, v255
    v_cndmask_b32 v174, v174, v24, vcc
    v_mfma_f32_16x16x32_bf16 v[140:143], v[80:83], v[160:163], 0
    v_cndmask_b32 v175, v175, 0, vcc
    v_mfma_f32_16x16x32_bf16 v[124:127], v[84:87], v[168:171], v[124:127]
    ds_write_b64 v51, v[170:171] offset:3456
    ds_write_b64 v52, v[174:175] offset:3456
    v_mfma_f32_16x16x32_bf16 v[128:131], v[88:91], v[168:171], v[128:131]
    v_mfma_f32_16x16x32_bf16 v[132:135], v[92:95], v[168:171], v[132:135]
    v_mfma_f32_16x16x32_bf16 v[136:139], v[96:99], v[168:171], v[136:139]
    v_mfma_f32_16x16x32_bf16 v[140:143], v[100:103], v[168:171], v[140:143]
    v_max3_f32 v46, v104, v105, v106
    v_max3_f32 v47, v107, v108, v109
    v_max3_f32 v46, v46, v110, v111
    ds_read_b64_tr_b16 v[204:205], v54 offset:0
    v_max3_f32 v47, v47, v112, v113
    v_max3_f32 v46, v46, v114, v115
    v_max3_f32 v47, v47, v116, v117
    v_max3_f32 v46, v46, v118, v119
    v_max3_f32 v47, v47, v120, v121
    v_max3_f32 v46, v46, v122, v123
    v_max_f32 v46, v46, v47
    ds_read_b64_tr_b16 v[206:207], v54 offset:288
    v_mul_f32 v46, 0xbfb8aa3b, v46
    v_pk_fma_f32 v[104:105], v[104:105], v[44:45], v[46:47] op_sel_hi:[1,0,0]
    v_pk_fma_f32 v[106:107], v[106:107], v[44:45], v[46:47] op_sel_hi:[1,0,0]
    v_pk_fma_f32 v[108:109], v[108:109], v[44:45], v[46:47] op_sel_hi:[1,0,0]
    v_pk_fma_f32 v[110:111], v[110:111], v[44:45], v[46:47] op_sel_hi:[1,0,0]
    v_pk_fma_f32 v[112:113], v[112:113], v[44:45], v[46:47] op_sel_hi:[1,0,0]
    v_pk_fma_f32 v[114:115], v[114:115], v[44:45], v[46:47] op_sel_hi:[1,0,0]
    ds_read_b64_tr_b16 v[208:209], v54 offset:32
    v_pk_fma_f32 v[116:117], v[116:117], v[44:45], v[46:47] op_sel_hi:[1,0,0]
    v_pk_fma_f32 v[118:119], v[118:119], v[44:45], v[46:47] op_sel_hi:[1,0,0]
    v_pk_fma_f32 v[120:121], v[120:121], v[44:45], v[46:47] op_sel_hi:[1,0,0]
    v_pk_fma_f32 v[122:123], v[122:123], v[44:45], v[46:47] op_sel_hi:[1,0,0]
    v_exp_f32 v104, v104
    v_exp_f32 v105, v105
    ds_read_b64_tr_b16 v[210:211], v54 offset:320
    v_exp_f32 v106, v106
    v_exp_f32 v107, v107
    v_exp_f32 v108, v108
    v_exp_f32 v109, v109
    ds_read_b64_tr_b16 v[224:225], v54 offset:2304
    v_exp_f32 v110, v110
    v_exp_f32 v111, v111
    v_exp_f32 v112, v112
    v_exp_f32 v113, v113
    ds_read_b64_tr_b16 v[226:227], v54 offset:2592
    v_exp_f32 v114, v114
    v_exp_f32 v115, v115
    v_exp_f32 v116, v116
    v_exp_f32 v117, v117
    ds_read_b64_tr_b16 v[228:229], v54 offset:2336
    v_exp_f32 v118, v118
    v_exp_f32 v119, v119
    v_exp_f32 v120, v120
    v_exp_f32 v121, v121
    ds_read_b64_tr_b16 v[230:231], v54 offset:2624
    v_exp_f32 v122, v122
    v_exp_f32 v123, v123
    v_pk_add_f32 v[46:47], v[104:105], v[106:107]
    v_pk_add_f32 v[46:47], v[46:47], v[108:109]
    v_pk_add_f32 v[46:47], v[46:47], v[110:111]
    v_pk_add_f32 v[46:47], v[46:47], v[112:113]
    v_pk_add_f32 v[46:47], v[46:47], v[114:115]
    v_pk_add_f32 v[46:47], v[46:47], v[116:117]
    v_pk_add_f32 v[46:47], v[46:47], v[118:119]
    v_pk_add_f32 v[46:47], v[46:47], v[120:121]
    v_pk_add_f32 v[46:47], v[46:47], v[122:123]
    v_add_f32 v46, v46, v47
    v_rcp_f32 v46, v46
    s_nop 0
    v_pk_mul_f32 v[104:105], v[104:105], v[46:47] op_sel_hi:[1,0]
    v_pk_mul_f32 v[106:107], v[106:107], v[46:47] op_sel_hi:[1,0]
    v_cvt_pk_bf16_f32 v104, v104, v105
    v_cvt_pk_bf16_f32 v105, v106, v107
    ds_write_b64 v50, v[104:105] offset:0
    v_pk_mul_f32 v[108:109], v[108:109], v[46:47] op_sel_hi:[1,0]
    v_pk_mul_f32 v[110:111], v[110:111], v[46:47] op_sel_hi:[1,0]
    v_cvt_pk_bf16_f32 v106, v108, v109
    v_cvt_pk_bf16_f32 v107, v110, v111
    ds_write_b64 v50, v[106:107] offset:8
    v_pk_mul_f32 v[112:113], v[112:113], v[46:47] op_sel_hi:[1,0]
    v_pk_mul_f32 v[114:115], v[114:115], v[46:47] op_sel_hi:[1,0]
    v_cvt_pk_bf16_f32 v108, v112, v113
    v_cvt_pk_bf16_f32 v109, v114, v115
    ds_write_b64 v50, v[108:109] offset:16
    v_pk_mul_f32 v[116:117], v[116:117], v[46:47] op_sel_hi:[1,0]
    v_pk_mul_f32 v[118:119], v[118:119], v[46:47] op_sel_hi:[1,0]
    v_cvt_pk_bf16_f32 v110, v116, v117
    v_cvt_pk_bf16_f32 v111, v118, v119
    ds_write_b64 v50, v[110:111] offset:24
    v_pk_mul_f32 v[120:121], v[120:121], v[46:47] op_sel_hi:[1,0]
    v_pk_mul_f32 v[122:123], v[122:123], v[46:47] op_sel_hi:[1,0]
    v_cvt_pk_bf16_f32 v112, v120, v121
    v_cvt_pk_bf16_f32 v113, v122, v123
    ds_write_b64 v50, v[112:113] offset:32
    v_max3_f32 v46, v124, v125, v126
    v_max3_f32 v47, v127, v128, v129
    v_max3_f32 v46, v46, v130, v131
    ds_read_b64_tr_b16 v[192:193], v53 offset:0
    v_max3_f32 v47, v47, v132, v133
    v_max3_f32 v46, v46, v134, v135
    v_max3_f32 v47, v47, v136, v137
    v_max3_f32 v46, v46, v138, v139
    v_max3_f32 v47, v47, v140, v141
    v_max3_f32 v46, v46, v142, v143
    v_max_f32 v46, v46, v47
    ds_read_b64_tr_b16 v[194:195], v53 offset:320
    v_mul_f32 v46, 0xbfb8aa3b, v46
    v_pk_fma_f32 v[124:125], v[124:125], v[44:45], v[46:47] op_sel_hi:[1,0,0]
    v_pk_fma_f32 v[126:127], v[126:127], v[44:45], v[46:47] op_sel_hi:[1,0,0]
    v_pk_fma_f32 v[128:129], v[128:129], v[44:45], v[46:47] op_sel_hi:[1,0,0]
    v_pk_fma_f32 v[130:131], v[130:131], v[44:45], v[46:47] op_sel_hi:[1,0,0]
    v_pk_fma_f32 v[132:133], v[132:133], v[44:45], v[46:47] op_sel_hi:[1,0,0]
    v_pk_fma_f32 v[134:135], v[134:135], v[44:45], v[46:47] op_sel_hi:[1,0,0]
    ds_read_b64_tr_b16 v[196:197], v53 offset:32
    v_pk_fma_f32 v[136:137], v[136:137], v[44:45], v[46:47] op_sel_hi:[1,0,0]
    v_pk_fma_f32 v[138:139], v[138:139], v[44:45], v[46:47] op_sel_hi:[1,0,0]
    v_pk_fma_f32 v[140:141], v[140:141], v[44:45], v[46:47] op_sel_hi:[1,0,0]
    v_pk_fma_f32 v[142:143], v[142:143], v[44:45], v[46:47] op_sel_hi:[1,0,0]
    v_exp_f32 v124, v124
    v_exp_f32 v125, v125
    ds_read_b64_tr_b16 v[198:199], v53 offset:352
    v_exp_f32 v126, v126
    v_exp_f32 v127, v127
    v_exp_f32 v128, v128
    v_exp_f32 v129, v129
    ds_read_b64_tr_b16 v[200:201], v53 offset:64
    v_exp_f32 v130, v130
    v_exp_f32 v131, v131
    v_exp_f32 v132, v132
    v_exp_f32 v133, v133
    ds_read_b64_tr_b16 v[202:203], v53 offset:384
    v_exp_f32 v134, v134
    v_exp_f32 v135, v135
    v_exp_f32 v136, v136
    v_exp_f32 v137, v137
    v_exp_f32 v138, v138
    v_exp_f32 v139, v139
    v_exp_f32 v140, v140
    v_exp_f32 v141, v141
    v_exp_f32 v142, v142
    v_exp_f32 v143, v143
    v_pk_add_f32 v[46:47], v[124:125], v[126:127]
    v_pk_add_f32 v[46:47], v[46:47], v[128:129]
    v_pk_add_f32 v[46:47], v[46:47], v[130:131]
    v_pk_add_f32 v[46:47], v[46:47], v[132:133]
    v_pk_add_f32 v[46:47], v[46:47], v[134:135]
    v_pk_add_f32 v[46:47], v[46:47], v[136:137]
    v_pk_add_f32 v[46:47], v[46:47], v[138:139]
    v_pk_add_f32 v[46:47], v[46:47], v[140:141]
    v_pk_add_f32 v[46:47], v[46:47], v[142:143]
    v_add_f32 v46, v46, v47
    v_rcp_f32 v46, v46
    s_nop 0
    v_pk_mul_f32 v[124:125], v[124:125], v[46:47] op_sel_hi:[1,0]
    v_pk_mul_f32 v[126:127], v[126:127], v[46:47] op_sel_hi:[1,0]
    v_cvt_pk_bf16_f32 v124, v124, v125
    v_cvt_pk_bf16_f32 v125, v126, v127
    ds_write_b64 v50, v[124:125] offset:2560
    v_pk_mul_f32 v[128:129], v[128:129], v[46:47] op_sel_hi:[1,0]
    v_pk_mul_f32 v[130:131], v[130:131], v[46:47] op_sel_hi:[1,0]
    v_cvt_pk_bf16_f32 v126, v128, v129
    v_cvt_pk_bf16_f32 v127, v130, v131
    ds_write_b64 v50, v[126:127] offset:2568
    v_pk_mul_f32 v[132:133], v[132:133], v[46:47] op_sel_hi:[1,0]
    v_pk_mul_f32 v[134:135], v[134:135], v[46:47] op_sel_hi:[1,0]
    v_cvt_pk_bf16_f32 v128, v132, v133
    v_cvt_pk_bf16_f32 v129, v134, v135
    ds_write_b64 v50, v[128:129] offset:2576
    v_pk_mul_f32 v[136:137], v[136:137], v[46:47] op_sel_hi:[1,0]
    v_pk_mul_f32 v[138:139], v[138:139], v[46:47] op_sel_hi:[1,0]
    v_cvt_pk_bf16_f32 v130, v136, v137
    v_cvt_pk_bf16_f32 v131, v138, v139
    ds_write_b64 v50, v[130:131] offset:2584
    v_pk_mul_f32 v[140:141], v[140:141], v[46:47] op_sel_hi:[1,0]
    v_pk_mul_f32 v[142:143], v[142:143], v[46:47] op_sel_hi:[1,0]
    v_cvt_pk_bf16_f32 v132, v140, v141
    v_cvt_pk_bf16_f32 v133, v142, v143
    ds_write_b64 v50, v[132:133] offset:2592
    ds_read_b64_tr_b16 v[212:213], v53 offset:2560
    ds_read_b64_tr_b16 v[214:215], v53 offset:2880
    ds_read_b64_tr_b16 v[216:217], v53 offset:2592
    ds_read_b64_tr_b16 v[218:219], v53 offset:2912
    ds_read_b64_tr_b16 v[220:221], v53 offset:2624
    ds_read_b64_tr_b16 v[222:223], v53 offset:2944
    v_add_u32 v24, s79, v1
    s_waitcnt lgkmcnt(11)
    v_mfma_f32_16x16x32_bf16 v[232:235], v[192:195], v[204:207], 0
    v_mfma_f32_16x16x32_bf16 v[236:239], v[196:199], v[204:207], 0
    v_mfma_f32_16x16x32_bf16 v[240:243], v[200:203], v[204:207], 0
    v_mfma_f32_16x16x32_bf16 v[244:247], v[192:195], v[208:211], 0
    v_mfma_f32_16x16x32_bf16 v[248:251], v[196:199], v[208:211], 0
    v_mfma_f32_16x16x32_bf16 v[252:255], v[200:203], v[208:211], 0
    s_waitcnt lgkmcnt(0)
    v_mfma_f32_16x16x32_bf16 v[232:235], v[212:215], v[224:227], v[232:235]
    v_mfma_f32_16x16x32_bf16 v[236:239], v[216:219], v[224:227], v[236:239]
    v_mfma_f32_16x16x32_bf16 v[240:243], v[220:223], v[224:227], v[240:243]
    v_mfma_f32_16x16x32_bf16 v[244:247], v[212:215], v[228:231], v[244:247]
    v_mfma_f32_16x16x32_bf16 v[248:251], v[216:219], v[228:231], v[248:251]
    v_mfma_f32_16x16x32_bf16 v[252:255], v[220:223], v[228:231], v[252:255]
    v_add_u32 v25, 102400, v55
    v_add_u32 v26, 112640, v55
    v_add_u32 v27, 122880, v55
    v_add_u32 v28, 133120, v55
    s_add_u32 s85, s71, 0
    ds_write_b128 v24, v[232:235] offset:0
    ds_write_b128 v24, v[236:239] offset:1024
    ds_write_b128 v24, v[240:243] offset:2048
    ds_write_b128 v24, v[244:247] offset:3072
    ds_write_b128 v24, v[248:251] offset:4096
    ds_write_b128 v24, v[252:255] offset:5120
    s_waitcnt lgkmcnt(0)
    s_barrier
    ds_read_b128 v[192:195], v25
    ds_read_b128 v[196:199], v26
    ds_read_b128 v[200:203], v27
    ds_read_b128 v[204:207], v28
    v_pk_mul_f32 v[176:177], v[176:177], v[36:37] op_sel:[0,1] op_sel_hi:[1,1]
    v_pk_mul_f32 v[178:179], v[178:179], v[36:37] op_sel:[0,1] op_sel_hi:[1,1]
    v_pk_mul_f32 v[180:181], v[180:181], v[38:39] op_sel:[0,1] op_sel_hi:[1,1]
    v_pk_mul_f32 v[182:183], v[182:183], v[38:39] op_sel:[0,1] op_sel_hi:[1,1]
    v_pk_mul_f32 v[184:185], v[184:185], v[40:41] op_sel:[0,1] op_sel_hi:[1,1]
    v_pk_mul_f32 v[186:187], v[186:187], v[40:41] op_sel:[0,1] op_sel_hi:[1,1]
    v_pk_mul_f32 v[188:189], v[188:189], v[42:43] op_sel:[0,1] op_sel_hi:[1,1]
    v_pk_mul_f32 v[190:191], v[190:191], v[42:43] op_sel:[0,1] op_sel_hi:[1,1]
    v_cvt_pk_bf16_f32 v148, v176, v177
    v_cvt_pk_bf16_f32 v149, v178, v179
    v_cvt_pk_bf16_f32 v156, v180, v181
    v_cvt_pk_bf16_f32 v157, v182, v183
    v_cvt_pk_bf16_f32 v164, v184, v185
    v_cvt_pk_bf16_f32 v165, v186, v187
    v_cvt_pk_bf16_f32 v172, v188, v189
    v_cvt_pk_bf16_f32 v173, v190, v191
    s_waitcnt lgkmcnt(0)
    v_pk_add_f32 v[192:193], v[192:193], v[196:197]
    v_pk_add_f32 v[200:201], v[200:201], v[204:205]
    v_pk_add_f32 v[194:195], v[194:195], v[198:199]
    v_pk_add_f32 v[202:203], v[202:203], v[206:207]
    v_pk_add_f32 v[192:193], v[192:193], v[200:201]
    v_pk_add_f32 v[194:195], v[194:195], v[202:203]
    v_cvt_pk_bf16_f32 v192, v192, v193
    v_cvt_pk_bf16_f32 v193, v194, v195
    buffer_store_dwordx2 v[192:193], v57, s[8:11], s85 offen sc1
    v_add_u32 v24, s63, v1
    v_add_u32 v25, s63, v2
    v_add_u32 v26, s63, v3
    v_mfma_f32_16x16x32_bf16 v[104:107], v[64:67], v[148:151], 0
    ds_read_b128 v[176:179], v24 offset:0
    v_mfma_f32_16x16x32_bf16 v[108:111], v[68:71], v[148:151], 0
    ds_read_b128 v[180:183], v24 offset:1024
    v_mfma_f32_16x16x32_bf16 v[112:115], v[72:75], v[148:151], 0
    ds_read_b128 v[184:187], v24 offset:2048
    v_mfma_f32_16x16x32_bf16 v[116:119], v[76:79], v[148:151], 0
    ds_read_b128 v[188:191], v24 offset:3072
    v_mfma_f32_16x16x32_bf16 v[120:123], v[80:83], v[148:151], 0
    ds_read_b128 v[192:195], v24 offset:4096
    v_mfma_f32_16x16x32_bf16 v[104:107], v[84:87], v[156:159], v[104:107]
    ds_read_b128 v[196:199], v24 offset:20480
    v_mfma_f32_16x16x32_bf16 v[108:111], v[88:91], v[156:159], v[108:111]
    ds_read_b128 v[200:203], v24 offset:21504
    v_mfma_f32_16x16x32_bf16 v[112:115], v[92:95], v[156:159], v[112:115]
    ds_read_b128 v[204:207], v24 offset:22528
    v_mfma_f32_16x16x32_bf16 v[116:119], v[96:99], v[156:159], v[116:119]
    ds_read_b128 v[208:211], v24 offset:23552
    v_mfma_f32_16x16x32_bf16 v[120:123], v[100:103], v[156:159], v[120:123]
    ds_read_b128 v[212:215], v24 offset:24576
    v_mfma_f32_16x16x32_bf16 v[124:127], v[64:67], v[164:167], 0
    ds_read_b128 v[216:219], v24 offset:40960
    v_mfma_f32_16x16x32_bf16 v[128:131], v[68:71], v[164:167], 0
    ds_read_b128 v[220:223], v24 offset:41984
    v_mfma_f32_16x16x32_bf16 v[132:135], v[72:75], v[164:167], 0
    ds_read_b128 v[224:227], v24 offset:43008
    v_mfma_f32_16x16x32_bf16 v[136:139], v[76:79], v[164:167], 0
    ds_read_b128 v[228:231], v24 offset:44032
    v_mfma_f32_16x16x32_bf16 v[140:143], v[80:83], v[164:167], 0
    ds_read_b128 v[232:235], v24 offset:45056
    v_mfma_f32_16x16x32_bf16 v[124:127], v[84:87], v[172:175], v[124:127]
    ds_read_b128 v[236:239], v24 offset:61440
    v_mfma_f32_16x16x32_bf16 v[128:131], v[88:91], v[172:175], v[128:131]
    ds_read_b128 v[240:243], v24 offset:62464
    v_mfma_f32_16x16x32_bf16 v[132:135], v[92:95], v[172:175], v[132:135]
    ds_read_b128 v[244:247], v24 offset:63488
    v_mfma_f32_16x16x32_bf16 v[136:139], v[96:99], v[172:175], v[136:139]
    ds_read_b128 v[248:251], v24 offset:64512
    v_mfma_f32_16x16x32_bf16 v[140:143], v[100:103], v[172:175], v[140:143]
    ds_read_b128 v[252:255], v25 offset:0
    s_waitcnt lgkmcnt(0)
    v_max3_f32 v46, v104, v105, v106
    s_add_u32 m0, s63, 143360
    s_add_u32 s93, s60, 3145728
    buffer_load_dwordx4 v1, s[8:11], s93 offen offset:0  lds
    v_max3_f32 v47, v107, v108, v109
    v_max3_f32 v46, v46, v110, v111
    v_max3_f32 v47, v47, v112, v113
    v_max3_f32 v46, v46, v114, v115
    v_max3_f32 v47, v47, v116, v117
    v_max3_f32 v46, v46, v118, v119
    v_max3_f32 v47, v47, v120, v121
    v_max3_f32 v46, v46, v122, v123
    v_max_f32 v46, v46, v47
    v_mul_f32 v46, 0xbfb8aa3b, v46
    v_pk_fma_f32 v[104:105], v[104:105], v[44:45], v[46:47] op_sel_hi:[1,0,0]
    buffer_load_dwordx4 v1, s[8:11], s93 offen offset:1024  lds
    v_pk_fma_f32 v[106:107], v[106:107], v[44:45], v[46:47] op_sel_hi:[1,0,0]
    v_pk_fma_f32 v[108:109], v[108:109], v[44:45], v[46:47] op_sel_hi:[1,0,0]
    v_pk_fma_f32 v[110:111], v[110:111], v[44:45], v[46:47] op_sel_hi:[1,0,0]
    v_pk_fma_f32 v[112:113], v[112:113], v[44:45], v[46:47] op_sel_hi:[1,0,0]
    v_pk_fma_f32 v[114:115], v[114:115], v[44:45], v[46:47] op_sel_hi:[1,0,0]
    v_pk_fma_f32 v[116:117], v[116:117], v[44:45], v[46:47] op_sel_hi:[1,0,0]
    v_pk_fma_f32 v[118:119], v[118:119], v[44:45], v[46:47] op_sel_hi:[1,0,0]
    v_pk_fma_f32 v[120:121], v[120:121], v[44:45], v[46:47] op_sel_hi:[1,0,0]
    v_pk_fma_f32 v[122:123], v[122:123], v[44:45], v[46:47] op_sel_hi:[1,0,0]
    v_exp_f32 v104, v104
    buffer_load_dwordx4 v1, s[8:11], s93 offen offset:2048  lds
    v_exp_f32 v105, v105
    v_exp_f32 v106, v106
    v_exp_f32 v107, v107
    v_exp_f32 v108, v108
    v_exp_f32 v109, v109
    v_exp_f32 v110, v110
    buffer_load_dwordx4 v1, s[8:11], s93 offen offset:3072  lds
    v_exp_f32 v111, v111
    v_exp_f32 v112, v112
    v_exp_f32 v113, v113
    v_exp_f32 v114, v114
    v_exp_f32 v115, v115
    v_exp_f32 v116, v116
    s_add_u32 m0, m0, 4096
    s_add_u32 s93, s93, 4096
    buffer_load_dwordx4 v1, s[8:11], s93 offen offset:0  lds
    v_exp_f32 v117, v117
    v_exp_f32 v118, v118
    v_exp_f32 v119, v119
    v_exp_f32 v120, v120
    v_exp_f32 v121, v121
    v_exp_f32 v122, v122
    s_add_u32 m0, s63, 0
    s_add_u32 s93, s60, 3166208
    buffer_load_dwordx4 v1, s[8:11], s93 offen offset:0  lds
    v_exp_f32 v123, v123
    v_pk_add_f32 v[46:47], v[104:105], v[106:107]
    v_pk_add_f32 v[46:47], v[46:47], v[108:109]
    v_pk_add_f32 v[46:47], v[46:47], v[110:111]
    v_pk_add_f32 v[46:47], v[46:47], v[112:113]
    v_pk_add_f32 v[46:47], v[46:47], v[114:115]
    v_pk_add_f32 v[46:47], v[46:47], v[116:117]
    v_pk_add_f32 v[46:47], v[46:47], v[118:119]
    v_pk_add_f32 v[46:47], v[46:47], v[120:121]
    v_pk_add_f32 v[46:47], v[46:47], v[122:123]
    buffer_load_dwordx4 v1, s[8:11], s93 offen offset:1024  lds
    v_add_f32 v46, v46, v47
    v_rcp_f32 v46, v46
    s_nop 0
    v_pk_mul_f32 v[104:105], v[104:105], v[46:47] op_sel_hi:[1,0]
    v_pk_mul_f32 v[106:107], v[106:107], v[46:47] op_sel_hi:[1,0]
    v_pk_mul_f32 v[108:109], v[108:109], v[46:47] op_sel_hi:[1,0]
    v_pk_mul_f32 v[110:111], v[110:111], v[46:47] op_sel_hi:[1,0]
    v_pk_mul_f32 v[112:113], v[112:113], v[46:47] op_sel_hi:[1,0]
    v_pk_mul_f32 v[114:115], v[114:115], v[46:47] op_sel_hi:[1,0]
    v_pk_mul_f32 v[116:117], v[116:117], v[46:47] op_sel_hi:[1,0]
    v_pk_mul_f32 v[118:119], v[118:119], v[46:47] op_sel_hi:[1,0]
    buffer_load_dwordx4 v1, s[8:11], s93 offen offset:2048  lds
    v_pk_mul_f32 v[120:121], v[120:121], v[46:47] op_sel_hi:[1,0]
    v_pk_mul_f32 v[122:123], v[122:123], v[46:47] op_sel_hi:[1,0]
    v_cvt_pk_bf16_f32 v104, v104, v105
    v_cvt_pk_bf16_f32 v105, v106, v107
    v_cvt_pk_bf16_f32 v106, v108, v109
    v_cvt_pk_bf16_f32 v107, v110, v111
    v_cvt_pk_bf16_f32 v108, v112, v113
    v_cvt_pk_bf16_f32 v109, v114, v115
    v_cvt_pk_bf16_f32 v110, v116, v117
    v_cvt_pk_bf16_f32 v111, v118, v119
    v_cvt_pk_bf16_f32 v112, v120, v121
    v_cvt_pk_bf16_f32 v113, v122, v123
    v_max3_f32 v46, v124, v125, v126
    buffer_load_dwordx4 v1, s[8:11], s93 offen offset:3072  lds
    v_max3_f32 v47, v127, v128, v129
    v_max3_f32 v46, v46, v130, v131
    v_max3_f32 v47, v47, v132, v133
    v_max3_f32 v46, v46, v134, v135
    v_max3_f32 v47, v47, v136, v137
    v_max3_f32 v46, v46, v138, v139
    v_max3_f32 v47, v47, v140, v141
    v_max3_f32 v46, v46, v142, v143
    v_max_f32 v46, v46, v47
    v_mul_f32 v46, 0xbfb8aa3b, v46
    v_pk_fma_f32 v[124:125], v[124:125], v[44:45], v[46:47] op_sel_hi:[1,0,0]
    s_add_u32 m0, m0, 4096
    s_add_u32 s93, s93, 4096
    buffer_load_dwordx4 v1, s[8:11], s93 offen offset:0  lds
    v_pk_fma_f32 v[126:127], v[126:127], v[44:45], v[46:47] op_sel_hi:[1,0,0]
    v_pk_fma_f32 v[128:129], v[128:129], v[44:45], v[46:47] op_sel_hi:[1,0,0]
    v_pk_fma_f32 v[130:131], v[130:131], v[44:45], v[46:47] op_sel_hi:[1,0,0]
    v_pk_fma_f32 v[132:133], v[132:133], v[44:45], v[46:47] op_sel_hi:[1,0,0]
    v_pk_fma_f32 v[134:135], v[134:135], v[44:45], v[46:47] op_sel_hi:[1,0,0]
    v_pk_fma_f32 v[136:137], v[136:137], v[44:45], v[46:47] op_sel_hi:[1,0,0]
    v_pk_fma_f32 v[138:139], v[138:139], v[44:45], v[46:47] op_sel_hi:[1,0,0]
    v_pk_fma_f32 v[140:141], v[140:141], v[44:45], v[46:47] op_sel_hi:[1,0,0]
    v_pk_fma_f32 v[142:143], v[142:143], v[44:45], v[46:47] op_sel_hi:[1,0,0]
    v_exp_f32 v124, v124
    s_add_u32 m0, s63, 20480
    s_add_u32 s93, s60, 3186688
    buffer_load_dwordx4 v1, s[8:11], s93 offen offset:0  lds
    v_exp_f32 v125, v125
    v_exp_f32 v126, v126
    v_exp_f32 v127, v127
    v_exp_f32 v128, v128
    v_exp_f32 v129, v129
    v_exp_f32 v130, v130
    buffer_load_dwordx4 v1, s[8:11], s93 offen offset:1024  lds
    v_exp_f32 v131, v131
    v_exp_f32 v132, v132
    v_exp_f32 v133, v133
    v_exp_f32 v134, v134
    v_exp_f32 v135, v135
    v_exp_f32 v136, v136
    buffer_load_dwordx4 v1, s[8:11], s93 offen offset:2048  lds
    v_exp_f32 v137, v137
    v_exp_f32 v138, v138
    v_exp_f32 v139, v139
    v_exp_f32 v140, v140
    v_exp_f32 v141, v141
    v_exp_f32 v142, v142
    buffer_load_dwordx4 v1, s[8:11], s93 offen offset:3072  lds
    v_exp_f32 v143, v143
    v_pk_add_f32 v[46:47], v[124:125], v[126:127]
    v_pk_add_f32 v[46:47], v[46:47], v[128:129]
    v_pk_add_f32 v[46:47], v[46:47], v[130:131]
    v_pk_add_f32 v[46:47], v[46:47], v[132:133]
    v_pk_add_f32 v[46:47], v[46:47], v[134:135]
    v_pk_add_f32 v[46:47], v[46:47], v[136:137]
    v_pk_add_f32 v[46:47], v[46:47], v[138:139]
    v_pk_add_f32 v[46:47], v[46:47], v[140:141]
    v_pk_add_f32 v[46:47], v[46:47], v[142:143]
    s_add_u32 m0, m0, 4096
    s_add_u32 s93, s93, 4096
    buffer_load_dwordx4 v1, s[8:11], s93 offen offset:0  lds
    v_add_f32 v46, v46, v47
    v_rcp_f32 v46, v46
    s_nop 0
    v_pk_mul_f32 v[124:125], v[124:125], v[46:47] op_sel_hi:[1,0]
    v_pk_mul_f32 v[126:127], v[126:127], v[46:47] op_sel_hi:[1,0]
    v_pk_mul_f32 v[128:129], v[128:129], v[46:47] op_sel_hi:[1,0]
    v_pk_mul_f32 v[130:131], v[130:131], v[46:47] op_sel_hi:[1,0]
    v_pk_mul_f32 v[132:133], v[132:133], v[46:47] op_sel_hi:[1,0]
    v_pk_mul_f32 v[134:135], v[134:135], v[46:47] op_sel_hi:[1,0]
    v_pk_mul_f32 v[136:137], v[136:137], v[46:47] op_sel_hi:[1,0]
    v_pk_mul_f32 v[138:139], v[138:139], v[46:47] op_sel_hi:[1,0]
    s_add_u32 m0, s63, 40960
    s_add_u32 s93, s60, 3207168
    buffer_load_dwordx4 v1, s[8:11], s93 offen offset:0  lds
    v_pk_mul_f32 v[140:141], v[140:141], v[46:47] op_sel_hi:[1,0]
    v_pk_mul_f32 v[142:143], v[142:143], v[46:47] op_sel_hi:[1,0]
    v_cvt_pk_bf16_f32 v124, v124, v125
    v_cvt_pk_bf16_f32 v125, v126, v127
    v_cvt_pk_bf16_f32 v126, v128, v129
    v_cvt_pk_bf16_f32 v127, v130, v131
    v_cvt_pk_bf16_f32 v128, v132, v133
    v_cvt_pk_bf16_f32 v129, v134, v135
    v_cvt_pk_bf16_f32 v130, v136, v137
    v_cvt_pk_bf16_f32 v131, v138, v139
    v_cvt_pk_bf16_f32 v132, v140, v141
    v_cvt_pk_bf16_f32 v133, v142, v143
    s_mov_b32 s92, s67
    s_add_u32 s85, s72, 0
    buffer_load_dwordx2 v[64:65], v57, s[8:11], s85 offen sc1
    s_add_u32 s85, s72, 8192
    buffer_load_dwordx2 v[66:67], v57, s[8:11], s85 offen sc1
    s_add_u32 s85, s72, 16384
    buffer_load_dwordx2 v[68:69], v57, s[8:11], s85 offen sc1
    s_add_u32 s85, s72, 24576
    buffer_load_dwordx2 v[70:71], v57, s[8:11], s85 offen sc1
    s_add_u32 s85, s72, 32768
    buffer_load_dwordx2 v[72:73], v57, s[8:11], s85 offen sc1
    s_add_u32 s85, s72, 40960
    buffer_load_dwordx2 v[74:75], v57, s[8:11], s85 offen sc1
    s_add_u32 s85, s72, 49152
    buffer_load_dwordx2 v[76:77], v57, s[8:11], s85 offen sc1
    s_add_u32 s85, s72, 57344
    buffer_load_dwordx2 v[78:79], v57, s[8:11], s85 offen sc1
    buffer_load_dwordx4 v1, s[8:11], s93 offen offset:1024  lds
    buffer_load_dwordx4 v1, s[8:11], s93 offen offset:2048  lds
    buffer_load_dwordx4 v1, s[8:11], s93 offen offset:3072  lds
    s_add_u32 m0, m0, 4096
    s_add_u32 s93, s93, 4096
    buffer_load_dwordx4 v1, s[8:11], s93 offen offset:0  lds
    s_add_u32 m0, s63, 61440
    s_add_u32 s93, s60, 3227648
    buffer_load_dwordx4 v1, s[8:11], s93 offen offset:0  lds
    buffer_load_dwordx4 v1, s[8:11], s93 offen offset:1024  lds
    buffer_load_dwordx4 v1, s[8:11], s93 offen offset:2048  lds
    buffer_load_dwordx4 v1, s[8:11], s93 offen offset:3072  lds
    s_add_u32 m0, m0, 4096
    s_add_u32 s93, s93, 4096
    buffer_load_dwordx4 v1, s[8:11], s93 offen offset:0  lds
    buffer_store_dwordx4 a[0:3], v48, s[8:11], s4 offen offset:0 sc1
    buffer_store_dwordx4 a[4:7], v48, s[8:11], s4 offen offset:1024 sc1
    buffer_store_dwordx4 a[8:11], v48, s[8:11], s4 offen offset:2048 sc1
    buffer_store_dwordx4 a[12:15], v48, s[8:11], s4 offen offset:3072 sc1
    s_add_u32 s4, s4, 4096
    buffer_store_dwordx4 a[16:19], v48, s[8:11], s4 offen sc1
    buffer_store_dwordx4 a[20:23], v49, s[8:11], s5 offen sc1
    s_add_u32 s5, s5, 20480
    buffer_store_dwordx4 a[24:27], v49, s[8:11], s5 offen sc1
    s_add_u32 s5, s5, 20480
    buffer_store_dwordx4 a[28:31], v49, s[8:11], s5 offen sc1
    s_add_u32 s5, s5, 20480
    s_add_u32 s4, s71, 2097152
    buffer_store_dwordx4 a[32:35], v1, s[8:11], s4 offen sc1
    v_or_b32 v48, s66, v1
    v_or_b32 v49, s66, v4
    s_add_u32 s4, s56, 31457280
    buffer_store_dwordx4 a[32:35], v48, s[8:11], s4 offen sc1
    buffer_store_dwordx4 a[32:35], v48, s[8:11], s4 offen offset:1024 sc1
    s_add_u32 s4, s57, 31457280
    buffer_store_dwordx2 a[32:33], v49, s[8:11], s4 offen sc1
    s_add_u32 s4, s56, 34603008
    buffer_store_dwordx4 a[32:35], v48, s[8:11], s4 offen sc1
    buffer_store_dwordx4 a[32:35], v48, s[8:11], s4 offen offset:1024 sc1
    s_add_u32 s4, s57, 34603008
    buffer_store_dwordx2 a[32:33], v49, s[8:11], s4 offen sc1
    v_mov_b32 v26, 0x3f80
    v_mov_b32 v27, 0x3f800000
    v_mov_b32 v80, 0
    v_mov_b32 v81, 0
    v_mov_b32 v82, 0
    v_mov_b32 v83, 0
    s_waitcnt vmcnt(24)
KVCHK_5:
    v_max3_u32 v24, v64, v65, v66
    v_max3_u32 v25, v67, v68, v69
    v_max3_u32 v24, v24, v70, v71
    v_max3_u32 v25, v25, v72, v73
    v_max3_u32 v24, v24, v74, v75
    v_max3_u32 v25, v25, v76, v77
    v_max3_u32 v24, v24, v78, v79
    v_max_u32 v24, v24, v25
    v_cmp_eq_u32 vcc, -1, v24
    s_nop 0
    s_cmp_lg_u64 vcc, 0
    s_cbranch_scc1 KVPOLL_3
KVDONE_4:
    v_dot2c_f32_bf16 v80, v64, v26
    v_dot2c_f32_bf16 v81, v64, v27
    v_dot2c_f32_bf16 v82, v65, v26
    v_dot2c_f32_bf16 v83, v65, v27
    v_dot2c_f32_bf16 v80, v66, v26
    v_dot2c_f32_bf16 v81, v66, v27
    v_dot2c_f32_bf16 v82, v67, v26
    v_dot2c_f32_bf16 v83, v67, v27
    v_dot2c_f32_bf16 v80, v68, v26
    v_dot2c_f32_bf16 v81, v68, v27
    v_dot2c_f32_bf16 v82, v69, v26
    v_dot2c_f32_bf16 v83, v69, v27
    v_dot2c_f32_bf16 v80, v70, v26
    v_dot2c_f32_bf16 v81, v70, v27
    v_dot2c_f32_bf16 v82, v71, v26
    v_dot2c_f32_bf16 v83, v71, v27
    v_dot2c_f32_bf16 v80, v72, v26
    v_dot2c_f32_bf16 v81, v72, v27
    v_dot2c_f32_bf16 v82, v73, v26
    v_dot2c_f32_bf16 v83, v73, v27
    v_dot2c_f32_bf16 v80, v74, v26
    v_dot2c_f32_bf16 v81, v74, v27
    v_dot2c_f32_bf16 v82, v75, v26
    v_dot2c_f32_bf16 v83, v75, v27
    v_dot2c_f32_bf16 v80, v76, v26
    v_dot2c_f32_bf16 v81, v76, v27
    v_dot2c_f32_bf16 v82, v77, v26
    v_dot2c_f32_bf16 v83, v77, v27
    v_dot2c_f32_bf16 v80, v78, v26
    v_dot2c_f32_bf16 v81, v78, v27
    v_dot2c_f32_bf16 v82, v79, v26
    v_dot2c_f32_bf16 v83, v79, v27
    s_nop 2
    v_cvt_pk_bf16_f32 v64, v80, v81
    v_cvt_pk_bf16_f32 v65, v82, v83
    ds_write_b64 v56, v[64:65]
    s_add_u32 s86, s69, 22020096
    s_add_u32 s87, s70, 22020096
    s_add_u32 s88, s69, 22061056
    s_add_u32 s89, s70, 22061056
    s_waitcnt lgkmcnt(0)
    s_barrier
    ds_read_b128 v[136:139], v58 offset:0
    ds_read_b128 v[148:151], v58 offset:384
    ds_read_b128 v[160:163], v59 offset:0
    ds_read_b128 v[140:143], v58 offset:16
    ds_read_b128 v[152:155], v58 offset:400
    ds_read_b128 v[164:167], v59 offset:16
    ds_read_b64 v[144:145], v58 offset:32
    ds_read_b64 v[156:157], v58 offset:416
    ds_read_b64 v[168:169], v59 offset:32
    s_waitcnt lgkmcnt(6)
    v_mfma_f32_16x16x32_bf16 v[64:67], v[136:139], v[104:107], 0
    v_mfma_f32_16x16x32_bf16 v[68:71], v[148:151], v[104:107], 0
    v_mfma_f32_16x16x32_bf16 v[72:75], v[160:163], v[104:107], 0
    s_waitcnt lgkmcnt(3)
    v_mfma_f32_16x16x32_bf16 v[64:67], v[140:143], v[108:111], v[64:67]
    v_mfma_f32_16x16x32_bf16 v[68:71], v[152:155], v[108:111], v[68:71]
    v_mfma_f32_16x16x32_bf16 v[72:75], v[164:167], v[108:111], v[72:75]
    s_waitcnt lgkmcnt(0)
    v_mfma_f32_16x16x16_bf16 v[64:67], v[144:145], v[112:113], v[64:67]
    v_mfma_f32_16x16x16_bf16 v[68:71], v[156:157], v[112:113], v[68:71]
    v_mfma_f32_16x16x16_bf16 v[72:75], v[168:169], v[112:113], v[72:75]
    v_mfma_f32_16x16x32_bf16 v[80:83], v[136:139], v[124:127], 0
    v_mfma_f32_16x16x32_bf16 v[84:87], v[148:151], v[124:127], 0
    v_mfma_f32_16x16x32_bf16 v[88:91], v[160:163], v[124:127], 0
    s_nop 4
    v_add_f32 v74, 0x358637bd, v74
    v_mfma_f32_16x16x32_bf16 v[80:83], v[140:143], v[128:131], v[80:83]
    v_rcp_f32 v74, v74
    v_mfma_f32_16x16x32_bf16 v[84:87], v[152:155], v[128:131], v[84:87]
    v_mul_f32 v64, v64, v74
    v_mul_f32 v65, v65, v74
    v_mfma_f32_16x16x32_bf16 v[88:91], v[164:167], v[128:131], v[88:91]
    v_mul_f32 v66, v66, v74
    v_mul_f32 v67, v67, v74
    v_mfma_f32_16x16x16_bf16 v[80:83], v[144:145], v[132:133], v[80:83]
    v_mul_f32 v68, v68, v74
    v_mul_f32 v69, v69, v74
    v_mfma_f32_16x16x16_bf16 v[84:87], v[156:157], v[132:133], v[84:87]
    v_mul_f32 v70, v70, v74
    v_mul_f32 v71, v71, v74
    v_mfma_f32_16x16x16_bf16 v[88:91], v[168:169], v[132:133], v[88:91]
    v_mul_f32 v72, v72, v74
    v_mul_f32 v73, v73, v74
    v_cvt_pk_bf16_f32 v64, v64, v65
    v_cvt_pk_bf16_f32 v65, v66, v67
    v_cvt_pk_bf16_f32 v66, v68, v69
    v_cvt_pk_bf16_f32 v67, v70, v71
    v_cvt_pk_bf16_f32 v68, v72, v73
    s_cmp_eq_u32 s50, 0
    s_cbranch_scc1 SLOW_1
    buffer_store_dwordx4 v[64:67], v60, s[8:11], s86 offen
    buffer_store_dword v68, v61, s[8:11], s87 offen
BACK_1:
    v_add_f32 v90, 0x358637bd, v90
    v_rcp_f32 v90, v90
    s_nop 0
    v_pk_mul_f32 v[80:81], v[80:81], v[90:91] op_sel_hi:[1,0]
    v_pk_mul_f32 v[82:83], v[82:83], v[90:91] op_sel_hi:[1,0]
    v_pk_mul_f32 v[84:85], v[84:85], v[90:91] op_sel_hi:[1,0]
    v_pk_mul_f32 v[86:87], v[86:87], v[90:91] op_sel_hi:[1,0]
    v_pk_mul_f32 v[88:89], v[88:89], v[90:91] op_sel_hi:[1,0]
    v_cvt_pk_bf16_f32 v80, v80, v81
    v_cvt_pk_bf16_f32 v81, v82, v83
    v_cvt_pk_bf16_f32 v82, v84, v85
    v_cvt_pk_bf16_f32 v83, v86, v87
    v_cvt_pk_bf16_f32 v84, v88, v89
    s_cmp_eq_u32 s50, 0
    s_cbranch_scc1 SLOW_2
    buffer_store_dwordx4 v[80:83], v60, s[8:11], s88 offen
    buffer_store_dword v84, v61, s[8:11], s89 offen
BACK_2:
    s_add_u32 m0, s63, 102400
    s_add_u32 s93, s60, 4194304
    buffer_load_dwordx4 v1, s[8:11], s93 offen offset:0  lds
    buffer_load_dwordx4 v1, s[8:11], s93 offen offset:1024  lds
    buffer_load_dwordx4 v1, s[8:11], s93 offen offset:2048  lds
    buffer_load_dwordx4 v1, s[8:11], s93 offen offset:3072  lds
    s_add_u32 m0, m0, 4096
    s_add_u32 s93, s93, 4096
    buffer_load_dwordx4 v1, s[8:11], s93 offen offset:0  lds
    s_waitcnt vmcnt(5)
    v_mov_b32 v7, 1
    v_mov_b32 v18, 0
    s_mov_b64 exec, 1
    s_cmp_eq_u32 s50, 0
    s_cbranch_scc1 SLOW_3
    buffer_store_dword v7, v18, s[8:11], s77 offen
BACK_3:
    s_mov_b64 exec, -1
    s_barrier
    s_cmp_eq_u32 s49, 0
    s_cselect_b32 s82, 0, 2147483648
    s_add_u32 s83, s1, 0
    v_mov_b32 v32, s0
    v_mov_b32 v33, s83
    v_lshlrev_b32 v7, 3, v0
    v_or_b32 v7, s82, v7
    s_lshl_b32 s83, s2, 7
    s_add_u32 s83, s83, 13729792
    s_mov_b64 exec, 0xffff
    buffer_store_dwordx2 v[32:33], v7, s[8:11], s83 offen sc1
    s_mov_b64 exec, -1
    ds_read_b128 v[128:131], v3 offset:12288
    ds_read_b128 v[132:135], v3 offset:13312
    ds_read_b128 v[136:139], v3 offset:14336
    ds_read_b128 v[140:143], v3 offset:15360
    ds_read_b128 v[144:147], v3 offset:16384
    ds_read_b128 v[148:151], v3 offset:17408
    ds_read_b128 v[152:155], v3 offset:18432
    ds_read_b128 v[156:159], v3 offset:19456
    v_lshlrev_b32 v20, 16, v8
    v_and_b32 v21, 0xffff0000, v8
    v_lshlrev_b32 v22, 16, v9
    v_and_b32 v23, 0xffff0000, v9
    v_lshlrev_b32 v24, 16, v10
    v_and_b32 v25, 0xffff0000, v10
    v_lshlrev_b32 v26, 16, v11
    v_and_b32 v27, 0xffff0000, v11
    v_lshlrev_b32 v28, 16, v12
    v_and_b32 v29, 0xffff0000, v12
    v_lshlrev_b32 v30, 16, v13
    v_and_b32 v31, 0xffff0000, v13
    v_lshlrev_b32 v32, 16, v14
    v_and_b32 v33, 0xffff0000, v14
    v_lshlrev_b32 v34, 16, v15
    v_and_b32 v35, 0xffff0000, v15
    v_lshlrev_b32 v36, 16, v16
    v_and_b32 v37, 0xffff0000, v16
    v_lshlrev_b32 v38, 16, v17
    v_and_b32 v39, 0xffff0000, v17
    s_lshl_b32 s85, s48, 7
    s_add_u32 s85, s85, 13639680
    buffer_load_dword v7, v6, s[8:11], s85 offen sc1
    s_add_u32 m0, s63, 122880
    s_add_u32 s93, s60, 4214784
    buffer_load_dwordx4 v1, s[8:11], s93 offen offset:0  lds
    buffer_load_dwordx4 v1, s[8:11], s93 offen offset:1024  lds
    buffer_load_dwordx4 v1, s[8:11], s93 offen offset:2048  lds
    buffer_load_dwordx4 v1, s[8:11], s93 offen offset:3072  lds
    s_add_u32 m0, m0, 4096
    s_add_u32 s93, s93, 4096
    buffer_load_dwordx4 v1, s[8:11], s93 offen offset:0  lds
    s_waitcnt vmcnt(5)
    v_cmp_le_u32 vcc, 1, v7
    s_nop 0
    s_cmp_lg_u64 vcc, -1
    s_cbranch_scc1 POLL_6
PDONE_7:
    s_add_u32 s84, s58, 22020096
    buffer_load_dwordx4 v[80:83], v1, s[8:11], s84 offen offset:0 sc1
    buffer_load_dwordx4 v[84:87], v1, s[8:11], s84 offen offset:1024 sc1
    buffer_load_dwordx4 v[88:91], v1, s[8:11], s84 offen offset:2048 sc1
    buffer_load_dwordx4 v[92:95], v1, s[8:11], s84 offen offset:3072 sc1
    s_add_u32 s84, s58, 22024192
    buffer_load_dwordx4 v[96:99], v1, s[8:11], s84 offen offset:0 sc1
    buffer_load_dwordx4 v[100:103], v1, s[8:11], s84 offen offset:1024 sc1
    buffer_load_dwordx4 v[104:107], v1, s[8:11], s84 offen offset:2048 sc1
    buffer_load_dwordx4 v[108:111], v1, s[8:11], s84 offen offset:3072 sc1
    s_waitcnt vmcnt(7) lgkmcnt(6)
    v_mfma_f32_16x16x32_bf16 v[20:23], v[128:131], v[80:83], v[20:23]
    ds_read_b128 v[160:163], v3 offset:20480
    s_add_u32 s84, s58, 22028288
    buffer_load_dwordx4 v[112:115], v1, s[8:11], s84 offen offset:0 sc1
    v_mfma_f32_16x16x32_bf16 v[24:27], v[132:135], v[80:83], v[24:27]
    ds_read_b128 v[164:167], v3 offset:21504
    s_waitcnt lgkmcnt(6)
    v_mfma_f32_16x16x32_bf16 v[28:31], v[136:139], v[80:83], v[28:31]
    ds_read_b128 v[128:131], v3 offset:22528
    v_mfma_f32_16x16x32_bf16 v[32:35], v[140:143], v[80:83], v[32:35]
    ds_read_b128 v[132:135], v3 offset:23552
    s_waitcnt lgkmcnt(6)
    v_mfma_f32_16x16x32_bf16 v[36:39], v[144:147], v[80:83], v[36:39]
    ds_read_b128 v[136:139], v3 offset:24576
    buffer_load_dwordx4 v[116:119], v1, s[8:11], s84 offen offset:1024 sc1
    s_waitcnt vmcnt(8)
    v_mfma_f32_16x16x32_bf16 v[20:23], v[148:151], v[84:87], v[20:23]
    ds_read_b128 v[140:143], v3 offset:25600
    s_waitcnt lgkmcnt(6)
    v_mfma_f32_16x16x32_bf16 v[24:27], v[152:155], v[84:87], v[24:27]
    ds_read_b128 v[144:147], v3 offset:26624
    v_mfma_f32_16x16x32_bf16 v[28:31], v[156:159], v[84:87], v[28:31]
    ds_read_b128 v[148:151], v3 offset:27648
    s_waitcnt lgkmcnt(6)
    v_mfma_f32_16x16x32_bf16 v[32:35], v[160:163], v[84:87], v[32:35]
    ds_read_b128 v[152:155], v3 offset:28672
    buffer_load_dwordx4 v[120:123], v1, s[8:11], s84 offen offset:2048 sc1
    v_mfma_f32_16x16x32_bf16 v[36:39], v[164:167], v[84:87], v[36:39]
    ds_read_b128 v[156:159], v3 offset:29696
    s_waitcnt vmcnt(8) lgkmcnt(6)
    v_mfma_f32_16x16x32_bf16 v[20:23], v[128:131], v[88:91], v[20:23]
    ds_read_b128 v[160:163], v3 offset:30720
    v_mfma_f32_16x16x32_bf16 v[24:27], v[132:135], v[88:91], v[24:27]
    ds_read_b128 v[164:167], v3 offset:31744
    s_waitcnt lgkmcnt(6)
    v_mfma_f32_16x16x32_bf16 v[28:31], v[136:139], v[88:91], v[28:31]
    ds_read_b128 v[128:131], v1 offset:0
    buffer_load_dwordx4 v[124:127], v1, s[8:11], s84 offen offset:3072 sc1
    v_mfma_f32_16x16x32_bf16 v[32:35], v[140:143], v[88:91], v[32:35]
    ds_read_b128 v[132:135], v1 offset:1024
    s_waitcnt lgkmcnt(6)
    v_mfma_f32_16x16x32_bf16 v[36:39], v[144:147], v[88:91], v[36:39]
    ds_read_b128 v[136:139], v1 offset:2048
    s_waitcnt vmcnt(8)
    v_mfma_f32_16x16x32_bf16 v[20:23], v[148:151], v[92:95], v[20:23]
    ds_read_b128 v[140:143], v1 offset:3072
    s_waitcnt lgkmcnt(6)
    v_mfma_f32_16x16x32_bf16 v[24:27], v[152:155], v[92:95], v[24:27]
    ds_read_b128 v[144:147], v1 offset:4096
    s_add_u32 s84, s58, 22032384
    buffer_load_dwordx4 v[80:83], v1, s[8:11], s84 offen offset:0 sc1
    v_mfma_f32_16x16x32_bf16 v[28:31], v[156:159], v[92:95], v[28:31]
    ds_read_b128 v[148:151], v1 offset:5120
    s_waitcnt lgkmcnt(6)
    v_mfma_f32_16x16x32_bf16 v[32:35], v[160:163], v[92:95], v[32:35]
    ds_read_b128 v[152:155], v1 offset:6144
    v_mfma_f32_16x16x32_bf16 v[36:39], v[164:167], v[92:95], v[36:39]
    ds_read_b128 v[156:159], v1 offset:7168
    s_waitcnt vmcnt(8) lgkmcnt(6)
    v_mfma_f32_16x16x32_bf16 v[20:23], v[128:131], v[96:99], v[20:23]
    ds_read_b128 v[160:163], v1 offset:8192
    buffer_load_dwordx4 v[84:87], v1, s[8:11], s84 offen offset:1024 sc1
    v_mfma_f32_16x16x32_bf16 v[24:27], v[132:135], v[96:99], v[24:27]
    ds_read_b128 v[164:167], v1 offset:9216
    s_waitcnt lgkmcnt(6)
    v_mfma_f32_16x16x32_bf16 v[28:31], v[136:139], v[96:99], v[28:31]
    ds_read_b128 v[128:131], v1 offset:10240
    v_mfma_f32_16x16x32_bf16 v[32:35], v[140:143], v[96:99], v[32:35]
    ds_read_b128 v[132:135], v1 offset:11264
    s_waitcnt lgkmcnt(6)
    v_mfma_f32_16x16x32_bf16 v[36:39], v[144:147], v[96:99], v[36:39]
    ds_read_b128 v[136:139], v1 offset:12288
    buffer_load_dwordx4 v[88:91], v1, s[8:11], s84 offen offset:2048 sc1
    s_waitcnt vmcnt(9)
    v_mfma_f32_16x16x32_bf16 v[20:23], v[148:151], v[100:103], v[20:23]
    ds_read_b128 v[140:143], v1 offset:13312
    s_waitcnt lgkmcnt(6)
    v_mfma_f32_16x16x32_bf16 v[24:27], v[152:155], v[100:103], v[24:27]
    ds_read_b128 v[144:147], v1 offset:14336
    v_mfma_f32_16x16x32_bf16 v[28:31], v[156:159], v[100:103], v[28:31]
    ds_read_b128 v[148:151], v1 offset:15360
    s_waitcnt lgkmcnt(6)
    v_mfma_f32_16x16x32_bf16 v[32:35], v[160:163], v[100:103], v[32:35]
    ds_read_b128 v[152:155], v1 offset:16384
    buffer_load_dwordx4 v[92:95], v1, s[8:11], s84 offen offset:3072 sc1
    v_mfma_f32_16x16x32_bf16 v[36:39], v[164:167], v[100:103], v[36:39]
    ds_read_b128 v[156:159], v1 offset:17408
    s_waitcnt vmcnt(9) lgkmcnt(6)
    v_mfma_f32_16x16x32_bf16 v[20:23], v[128:131], v[104:107], v[20:23]
    ds_read_b128 v[160:163], v1 offset:18432
    v_mfma_f32_16x16x32_bf16 v[24:27], v[132:135], v[104:107], v[24:27]
    ds_read_b128 v[164:167], v1 offset:19456
    s_waitcnt lgkmcnt(6)
    v_mfma_f32_16x16x32_bf16 v[28:31], v[136:139], v[104:107], v[28:31]
    ds_read_b128 v[128:131], v1 offset:20480
    s_add_u32 s84, s58, 22036480
    buffer_load_dwordx4 v[96:99], v1, s[8:11], s84 offen offset:0 sc1
    v_mfma_f32_16x16x32_bf16 v[32:35], v[140:143], v[104:107], v[32:35]
    ds_read_b128 v[132:135], v1 offset:21504
    s_waitcnt lgkmcnt(6)
    v_mfma_f32_16x16x32_bf16 v[36:39], v[144:147], v[104:107], v[36:39]
    ds_read_b128 v[136:139], v1 offset:22528
    s_waitcnt vmcnt(9)
    v_mfma_f32_16x16x32_bf16 v[20:23], v[148:151], v[108:111], v[20:23]
    ds_read_b128 v[140:143], v1 offset:23552
    s_waitcnt lgkmcnt(6)
    v_mfma_f32_16x16x32_bf16 v[24:27], v[152:155], v[108:111], v[24:27]
    ds_read_b128 v[144:147], v1 offset:24576
    buffer_load_dwordx4 v[100:103], v1, s[8:11], s84 offen offset:1024 sc1
    v_mfma_f32_16x16x32_bf16 v[28:31], v[156:159], v[108:111], v[28:31]
    ds_read_b128 v[148:151], v1 offset:25600
    s_waitcnt lgkmcnt(6)
    v_mfma_f32_16x16x32_bf16 v[32:35], v[160:163], v[108:111], v[32:35]
    ds_read_b128 v[152:155], v1 offset:26624
    v_mfma_f32_16x16x32_bf16 v[36:39], v[164:167], v[108:111], v[36:39]
    ds_read_b128 v[156:159], v1 offset:27648
    s_waitcnt vmcnt(9) lgkmcnt(6)
    v_mfma_f32_16x16x32_bf16 v[20:23], v[128:131], v[112:115], v[20:23]
    ds_read_b128 v[160:163], v1 offset:28672
    buffer_load_dwordx4 v[104:107], v1, s[8:11], s84 offen offset:2048 sc1
    v_mfma_f32_16x16x32_bf16 v[24:27], v[132:135], v[112:115], v[24:27]
    ds_read_b128 v[164:167], v1 offset:29696
    s_waitcnt lgkmcnt(6)
    v_mfma_f32_16x16x32_bf16 v[28:31], v[136:139], v[112:115], v[28:31]
    ds_read_b128 v[128:131], v1 offset:30720
    v_mfma_f32_16x16x32_bf16 v[32:35], v[140:143], v[112:115], v[32:35]
    ds_read_b128 v[132:135], v1 offset:31744
    s_waitcnt lgkmcnt(6)
    v_mfma_f32_16x16x32_bf16 v[36:39], v[144:147], v[112:115], v[36:39]
    s_barrier
    ds_read_b128 v[136:139], v1 offset:32768
    buffer_load_dwordx4 v[108:111], v1, s[8:11], s84 offen offset:3072 sc1
    s_waitcnt vmcnt(10)
    v_mfma_f32_16x16x32_bf16 v[20:23], v[148:151], v[116:119], v[20:23]
    ds_read_b128 v[140:143], v1 offset:33792
    s_waitcnt lgkmcnt(6)
    v_mfma_f32_16x16x32_bf16 v[24:27], v[152:155], v[116:119], v[24:27]
    ds_read_b128 v[144:147], v1 offset:34816
    v_mfma_f32_16x16x32_bf16 v[28:31], v[156:159], v[116:119], v[28:31]
    ds_read_b128 v[148:151], v1 offset:35840
    s_waitcnt lgkmcnt(6)
    v_mfma_f32_16x16x32_bf16 v[32:35], v[160:163], v[116:119], v[32:35]
    ds_read_b128 v[152:155], v1 offset:36864
    v_mfma_f32_16x16x32_bf16 v[36:39], v[164:167], v[116:119], v[36:39]
    ds_read_b128 v[156:159], v1 offset:37888
    s_waitcnt vmcnt(9) lgkmcnt(6)
    v_mfma_f32_16x16x32_bf16 v[20:23], v[128:131], v[120:123], v[20:23]
    ds_read_b128 v[160:163], v1 offset:38912
    s_getpc_b64 s[4:5]
PCL_8:
    s_lshl_b32 s6, s45, 2
    s_add_u32 s6, s6, s49
    s_and_b32 s6, s6, 31
    s_lshl_b32 s6, s6, 10
    v_add_u32 v19, s6, v1
    v_min_u32 v19, CODE_END-PCL_8-16, v19
    global_load_dword a253, v19, s[4:5]
    v_mfma_f32_16x16x32_bf16 v[24:27], v[132:135], v[120:123], v[24:27]
    ds_read_b128 v[164:167], v1 offset:39936
    s_waitcnt lgkmcnt(6)
    v_mfma_f32_16x16x32_bf16 v[28:31], v[136:139], v[120:123], v[28:31]
    ds_read_b128 v[128:131], v1 offset:40960
    s_add_u32 m0, s63, 81920
    s_add_u32 s93, s60, 4235264
    buffer_load_dwordx4 v1, s[8:11], s93 offen offset:0  lds
    v_mfma_f32_16x16x32_bf16 v[32:35], v[140:143], v[120:123], v[32:35]
    ds_read_b128 v[132:135], v1 offset:41984
    s_waitcnt lgkmcnt(6)
    v_mfma_f32_16x16x32_bf16 v[36:39], v[144:147], v[120:123], v[36:39]
    ds_read_b128 v[136:139], v1 offset:43008
    s_waitcnt vmcnt(10)
    v_mfma_f32_16x16x32_bf16 v[20:23], v[148:151], v[124:127], v[20:23]
    ds_read_b128 v[140:143], v1 offset:44032
    buffer_load_dwordx4 v1, s[8:11], s93 offen offset:1024  lds
    s_waitcnt lgkmcnt(6)
    v_mfma_f32_16x16x32_bf16 v[24:27], v[152:155], v[124:127], v[24:27]
    ds_read_b128 v[144:147], v1 offset:45056
    v_mfma_f32_16x16x32_bf16 v[28:31], v[156:159], v[124:127], v[28:31]
    ds_read_b128 v[148:151], v1 offset:46080
    s_waitcnt lgkmcnt(6)
    v_mfma_f32_16x16x32_bf16 v[32:35], v[160:163], v[124:127], v[32:35]
    ds_read_b128 v[152:155], v1 offset:47104
    buffer_load_dwordx4 v1, s[8:11], s93 offen offset:2048  lds
    v_mfma_f32_16x16x32_bf16 v[36:39], v[164:167], v[124:127], v[36:39]
    ds_read_b128 v[156:159], v1 offset:48128
    s_waitcnt vmcnt(11) lgkmcnt(6)
    v_mfma_f32_16x16x32_bf16 v[20:23], v[128:131], v[80:83], v[20:23]
    ds_read_b128 v[160:163], v1 offset:49152
    v_mfma_f32_16x16x32_bf16 v[24:27], v[132:135], v[80:83], v[24:27]
    ds_read_b128 v[164:167], v1 offset:50176
    buffer_load_dwordx4 v1, s[8:11], s93 offen offset:3072  lds
    s_waitcnt lgkmcnt(6)
    v_mfma_f32_16x16x32_bf16 v[28:31], v[136:139], v[80:83], v[28:31]
    ds_read_b128 v[128:131], v1 offset:51200
    v_mfma_f32_16x16x32_bf16 v[32:35], v[140:143], v[80:83], v[32:35]
    ds_read_b128 v[132:135], v1 offset:52224
    s_add_u32 m0, m0, 4096
    s_add_u32 s93, s93, 4096
    buffer_load_dwordx4 v1, s[8:11], s93 offen offset:0  lds
    s_waitcnt lgkmcnt(6)
    v_mfma_f32_16x16x32_bf16 v[36:39], v[144:147], v[80:83], v[36:39]
    ds_read_b128 v[136:139], v1 offset:53248
    s_waitcnt vmcnt(12)
    v_mfma_f32_16x16x32_bf16 v[20:23], v[148:151], v[84:87], v[20:23]
    ds_read_b128 v[140:143], v1 offset:54272
    s_waitcnt lgkmcnt(6)
    v_mfma_f32_16x16x32_bf16 v[24:27], v[152:155], v[84:87], v[24:27]
    ds_read_b128 v[144:147], v1 offset:55296
    s_add_u32 m0, s63, 143360
    s_add_u32 s93, s60, 4255744
    buffer_load_dwordx4 v1, s[8:11], s93 offen offset:0  lds
    v_mfma_f32_16x16x32_bf16 v[28:31], v[156:159], v[84:87], v[28:31]
    ds_read_b128 v[148:151], v1 offset:56320
    s_waitcnt lgkmcnt(6)
    v_mfma_f32_16x16x32_bf16 v[32:35], v[160:163], v[84:87], v[32:35]
    ds_read_b128 v[152:155], v1 offset:57344
    v_mfma_f32_16x16x32_bf16 v[36:39], v[164:167], v[84:87], v[36:39]
    ds_read_b128 v[156:159], v1 offset:58368
    buffer_load_dwordx4 v1, s[8:11], s93 offen offset:1024  lds
    s_waitcnt vmcnt(13) lgkmcnt(6)
    v_mfma_f32_16x16x32_bf16 v[20:23], v[128:131], v[88:91], v[20:23]
    ds_read_b128 v[160:163], v1 offset:59392
    v_mfma_f32_16x16x32_bf16 v[24:27], v[132:135], v[88:91], v[24:27]
    ds_read_b128 v[164:167], v1 offset:60416
    s_waitcnt lgkmcnt(6)
    v_mfma_f32_16x16x32_bf16 v[28:31], v[136:139], v[88:91], v[28:31]
    ds_read_b128 v[128:131], v1 offset:61440
    buffer_load_dwordx4 v1, s[8:11], s93 offen offset:2048  lds
    v_mfma_f32_16x16x32_bf16 v[32:35], v[140:143], v[88:91], v[32:35]
    ds_read_b128 v[132:135], v1 offset:62464
    s_waitcnt lgkmcnt(6)
    v_mfma_f32_16x16x32_bf16 v[36:39], v[144:147], v[88:91], v[36:39]
    ds_read_b128 v[136:139], v1 offset:63488
    buffer_load_dwordx4 v1, s[8:11], s93 offen offset:3072  lds
    s_waitcnt vmcnt(14)
    v_mfma_f32_16x16x32_bf16 v[20:23], v[148:151], v[92:95], v[20:23]
    ds_read_b128 v[140:143], v1 offset:64512
    s_waitcnt lgkmcnt(6)
    v_mfma_f32_16x16x32_bf16 v[24:27], v[152:155], v[92:95], v[24:27]
    ds_read_b128 v[144:147], v2 offset:0
    v_mfma_f32_16x16x32_bf16 v[28:31], v[156:159], v[92:95], v[28:31]
    ds_read_b128 v[148:151], v2 offset:1024
    s_add_u32 m0, m0, 4096
    s_add_u32 s93, s93, 4096
    buffer_load_dwordx4 v1, s[8:11], s93 offen offset:0  lds
    s_waitcnt lgkmcnt(6)
    v_mfma_f32_16x16x32_bf16 v[32:35], v[160:163], v[92:95], v[32:35]
    ds_read_b128 v[152:155], v2 offset:2048
    v_mfma_f32_16x16x32_bf16 v[36:39], v[164:167], v[92:95], v[36:39]
    ds_read_b128 v[156:159], v2 offset:3072
    s_waitcnt vmcnt(14) lgkmcnt(6)
    v_mfma_f32_16x16x32_bf16 v[20:23], v[128:131], v[96:99], v[20:23]
    ds_read_b128 v[160:163], v2 offset:4096
    s_add_u32 m0, s63, 0
    s_add_u32 s93, s60, 4276224
    buffer_load_dwordx4 v1, s[8:11], s93 offen offset:0  lds
    v_mfma_f32_16x16x32_bf16 v[24:27], v[132:135], v[96:99], v[24:27]
    ds_read_b128 v[164:167], v2 offset:5120
    s_waitcnt lgkmcnt(6)
    v_mfma_f32_16x16x32_bf16 v[28:31], v[136:139], v[96:99], v[28:31]
    ds_read_b128 v[128:131], v2 offset:6144
    v_mfma_f32_16x16x32_bf16 v[32:35], v[140:143], v[96:99], v[32:35]
    ds_read_b128 v[132:135], v2 offset:7168
    buffer_load_dwordx4 v1, s[8:11], s93 offen offset:1024  lds
    s_waitcnt lgkmcnt(6)
    v_mfma_f32_16x16x32_bf16 v[36:39], v[144:147], v[96:99], v[36:39]
    ds_read_b128 v[136:139], v2 offset:8192
    s_waitcnt vmcnt(15)
    v_mfma_f32_16x16x32_bf16 v[20:23], v[148:151], v[100:103], v[20:23]
    ds_read_b128 v[140:143], v2 offset:9216
    buffer_load_dwordx4 v1, s[8:11], s93 offen offset:2048  lds
    s_waitcnt lgkmcnt(6)
    v_mfma_f32_16x16x32_bf16 v[24:27], v[152:155], v[100:103], v[24:27]
    ds_read_b128 v[144:147], v2 offset:10240
    v_mfma_f32_16x16x32_bf16 v[28:31], v[156:159], v[100:103], v[28:31]
    ds_read_b128 v[148:151], v2 offset:11264
    s_waitcnt lgkmcnt(6)
    v_mfma_f32_16x16x32_bf16 v[32:35], v[160:163], v[100:103], v[32:35]
    ds_read_b128 v[152:155], v2 offset:12288
    buffer_load_dwordx4 v1, s[8:11], s93 offen offset:3072  lds
    v_mfma_f32_16x16x32_bf16 v[36:39], v[164:167], v[100:103], v[36:39]
    ds_read_b128 v[156:159], v2 offset:13312
    s_waitcnt vmcnt(16) lgkmcnt(6)
    v_mfma_f32_16x16x32_bf16 v[20:23], v[128:131], v[104:107], v[20:23]
    ds_read_b128 v[160:163], v2 offset:14336
    v_mfma_f32_16x16x32_bf16 v[24:27], v[132:135], v[104:107], v[24:27]
    ds_read_b128 v[164:167], v2 offset:15360
    s_add_u32 m0, m0, 4096
    s_add_u32 s93, s93, 4096
    buffer_load_dwordx4 v1, s[8:11], s93 offen offset:0  lds
    s_waitcnt lgkmcnt(6)
    v_mfma_f32_16x16x32_bf16 v[28:31], v[136:139], v[104:107], v[28:31]
    v_mfma_f32_16x16x32_bf16 v[32:35], v[140:143], v[104:107], v[32:35]
    s_waitcnt lgkmcnt(4)
    v_mfma_f32_16x16x32_bf16 v[36:39], v[144:147], v[104:107], v[36:39]
    s_waitcnt vmcnt(16)
    v_mfma_f32_16x16x32_bf16 v[20:23], v[148:151], v[108:111], v[20:23]
    s_waitcnt lgkmcnt(2)
    v_mfma_f32_16x16x32_bf16 v[24:27], v[152:155], v[108:111], v[24:27]
    v_mfma_f32_16x16x32_bf16 v[28:31], v[156:159], v[108:111], v[28:31]
    s_waitcnt lgkmcnt(0)
    v_mfma_f32_16x16x32_bf16 v[32:35], v[160:163], v[108:111], v[32:35]
    v_mfma_f32_16x16x32_bf16 v[36:39], v[164:167], v[108:111], v[36:39]
    s_nop 1
    v_cvt_pk_bf16_f32 v60, v20, v21
    v_cvt_pk_bf16_f32 v61, v22, v23
    v_cvt_pk_bf16_f32 v62, v24, v25
    v_cvt_pk_bf16_f32 v63, v26, v27
    v_cvt_pk_bf16_f32 v64, v28, v29
    v_cvt_pk_bf16_f32 v65, v30, v31
    v_cvt_pk_bf16_f32 v66, v32, v33
    v_cvt_pk_bf16_f32 v67, v34, v35
    v_cvt_pk_bf16_f32 v68, v36, v37
    v_cvt_pk_bf16_f32 v69, v38, v39
    s_add_u32 s82, s52, 18874368
    s_add_u32 s83, s53, 18874368
    s_cmp_eq_u32 s50, 0
    s_cbranch_scc1 SLOW_4
    buffer_store_dwordx4 v[60:63], v1, s[8:11], s82 offen
    buffer_store_dwordx4 v[64:67], v1, s[8:11], s82 offen offset:1024
    buffer_store_dwordx2 v[68:69], v4, s[8:11], s83 offen
BACK_4:
    v_pk_add_f32 v[72:73], v[20:21], v[22:23]
    v_pk_mul_f32 v[74:75], v[20:21], v[20:21]
    v_pk_fma_f32 v[74:75], v[22:23], v[22:23], v[74:75]
    v_pk_add_f32 v[72:73], v[72:73], v[24:25]
    v_pk_fma_f32 v[74:75], v[24:25], v[24:25], v[74:75]
    v_pk_add_f32 v[72:73], v[72:73], v[26:27]
    v_pk_fma_f32 v[74:75], v[26:27], v[26:27], v[74:75]
    v_pk_add_f32 v[72:73], v[72:73], v[28:29]
    v_pk_fma_f32 v[74:75], v[28:29], v[28:29], v[74:75]
    v_pk_add_f32 v[72:73], v[72:73], v[30:31]
    v_pk_fma_f32 v[74:75], v[30:31], v[30:31], v[74:75]
    v_pk_add_f32 v[72:73], v[72:73], v[32:33]
    v_pk_fma_f32 v[74:75], v[32:33], v[32:33], v[74:75]
    v_pk_add_f32 v[72:73], v[72:73], v[34:35]
    v_pk_fma_f32 v[74:75], v[34:35], v[34:35], v[74:75]
    v_pk_add_f32 v[72:73], v[72:73], v[36:37]
    v_pk_fma_f32 v[74:75], v[36:37], v[36:37], v[74:75]
    v_pk_add_f32 v[72:73], v[72:73], v[38:39]
    v_pk_fma_f32 v[74:75], v[38:39], v[38:39], v[74:75]
    v_add_f32 v72, v72, v73
    v_add_f32 v74, v74, v75
    s_nop 1
    v_permlane32_swap_b32 v72, v74
    v_add_f32 v72, v72, v74
    v_mov_b32 v73, v72
    s_nop 1
    v_permlane16_swap_b32 v72, v73
    v_add_f32 v72, v72, v73
    v_and_or_b32 v72, v72, -4, 2
    s_add_u32 s82, s54, 18874368
    s_cmp_eq_u32 s50, 0
    s_cbranch_scc1 SLOW_5
    buffer_store_dword v72, v5, s[8:11], s82 offen
BACK_5:
    v_lshlrev_b32 v170, 7, v0
    s_lshl_b32 s87, s49, 13
    s_add_u32 s87, s87, 13729792
    buffer_load_dwordx2 v[168:169], v170, s[8:11], s87 offen sc1
    v_mov_b32 v40, v20
    v_mov_b32 v41, v21
    v_mov_b32 v42, v22
    v_mov_b32 v43, v23
    v_mov_b32 v44, v24
    v_mov_b32 v45, v25
    v_mov_b32 v46, v26
    v_mov_b32 v47, v27
    v_mov_b32 v48, v28
    v_mov_b32 v49, v29
    v_mov_b32 v50, v30
    v_mov_b32 v51, v31
    v_mov_b32 v52, v32
    v_mov_b32 v53, v33
    v_mov_b32 v54, v34
    v_mov_b32 v55, v35
    v_mov_b32 v56, v36
    v_mov_b32 v57, v37
    v_mov_b32 v58, v38
    v_mov_b32 v59, v39
    s_waitcnt vmcnt(2)
    v_mov_b32 v7, 1
    v_mov_b32 v18, 0
    s_mov_b64 exec, 1
    s_cmp_eq_u32 s50, 0
    s_cbranch_scc1 SLOW_6
    buffer_store_dword v7, v18, s[8:11], s76 offen
BACK_6:
    s_mov_b64 exec, -1
    s_barrier
    v_add_u32 v60, s63, v1
    v_add_u32 v61, s63, v2
    v_add_u32 v62, s63, v3
    v_mov_b32 v72, 0x3f803f80
    v_mov_b32 v73, 0x3f803f80
    v_mov_b32 v74, 0x3f803f80
    v_mov_b32 v75, 0x3f803f80
    ds_read_b128 v[80:83], v61 offset:36864
    ds_read_b128 v[84:87], v61 offset:37888
    ds_read_b128 v[88:91], v61 offset:38912
    ds_read_b128 v[92:95], v61 offset:39936
    ds_read_b128 v[96:99], v61 offset:40960
    ds_read_b128 v[100:103], v61 offset:57344
    ds_read_b128 v[104:107], v61 offset:58368
    ds_read_b128 v[108:111], v61 offset:59392
    ds_read_b128 v[112:115], v61 offset:60416
    ds_read_b128 v[116:119], v61 offset:61440
    s_waitcnt lgkmcnt(9)
    v_mfma_f32_16x16x32_bf16 v[20:23], v[80:83], v[72:75], 0
    ds_read_b128 v[120:123], v61 offset:16384
    s_waitcnt lgkmcnt(9)
    v_mfma_f32_16x16x32_bf16 v[24:27], v[84:87], v[72:75], 0
    ds_read_b128 v[124:127], v61 offset:17408
    s_waitcnt lgkmcnt(9)
    v_mfma_f32_16x16x32_bf16 v[28:31], v[88:91], v[72:75], 0
    ds_read_b128 v[80:83], v61 offset:18432
    s_waitcnt lgkmcnt(9)
    v_mfma_f32_16x16x32_bf16 v[32:35], v[92:95], v[72:75], 0
    ds_read_b128 v[84:87], v61 offset:19456
    s_waitcnt lgkmcnt(9)
    v_mfma_f32_16x16x32_bf16 v[36:39], v[96:99], v[72:75], 0
    ds_read_b128 v[88:91], v61 offset:20480
    s_waitcnt lgkmcnt(9)
    v_mfma_f32_16x16x32_bf16 v[20:23], v[100:103], v[72:75], v[20:23]
    ds_read_b128 v[92:95], v62 offset:12288
    s_waitcnt lgkmcnt(9)
    v_mfma_f32_16x16x32_bf16 v[24:27], v[104:107], v[72:75], v[24:27]
    ds_read_b128 v[96:99], v62 offset:13312
    s_waitcnt lgkmcnt(9)
    v_mfma_f32_16x16x32_bf16 v[28:31], v[108:111], v[72:75], v[28:31]
    ds_read_b128 v[100:103], v62 offset:14336
    s_waitcnt lgkmcnt(9)
    v_mfma_f32_16x16x32_bf16 v[32:35], v[112:115], v[72:75], v[32:35]
    ds_read_b128 v[104:107], v62 offset:15360
    s_waitcnt lgkmcnt(9)
    v_mfma_f32_16x16x32_bf16 v[36:39], v[116:119], v[72:75], v[36:39]
    ds_read_b128 v[108:111], v62 offset:16384
    s_waitcnt lgkmcnt(9)
    v_mfma_f32_16x16x32_bf16 v[20:23], v[120:123], v[72:75], v[20:23]
    ds_read_b128 v[112:115], v60 offset:0
    s_waitcnt lgkmcnt(9)
    v_mfma_f32_16x16x32_bf16 v[24:27], v[124:127], v[72:75], v[24:27]
    ds_read_b128 v[116:119], v60 offset:1024
    s_waitcnt lgkmcnt(9)
    v_mfma_f32_16x16x32_bf16 v[28:31], v[80:83], v[72:75], v[28:31]
    ds_read_b128 v[120:123], v60 offset:2048
    s_waitcnt lgkmcnt(9)
    v_mfma_f32_16x16x32_bf16 v[32:35], v[84:87], v[72:75], v[32:35]
    ds_read_b128 v[124:127], v60 offset:3072
    s_waitcnt lgkmcnt(9)
    v_mfma_f32_16x16x32_bf16 v[36:39], v[88:91], v[72:75], v[36:39]
    ds_read_b128 v[80:83], v60 offset:4096
    s_waitcnt lgkmcnt(9)
    v_mfma_f32_16x16x32_bf16 v[20:23], v[92:95], v[72:75], v[20:23]
    s_waitcnt lgkmcnt(8)
    v_mfma_f32_16x16x32_bf16 v[24:27], v[96:99], v[72:75], v[24:27]
    s_waitcnt lgkmcnt(7)
    v_mfma_f32_16x16x32_bf16 v[28:31], v[100:103], v[72:75], v[28:31]
    s_waitcnt lgkmcnt(6)
    v_mfma_f32_16x16x32_bf16 v[32:35], v[104:107], v[72:75], v[32:35]
    s_waitcnt lgkmcnt(5)
    v_mfma_f32_16x16x32_bf16 v[36:39], v[108:111], v[72:75], v[36:39]
    s_waitcnt lgkmcnt(4)
    v_mfma_f32_16x16x32_bf16 v[20:23], v[112:115], v[72:75], v[20:23]
    s_waitcnt lgkmcnt(3)
    v_mfma_f32_16x16x32_bf16 v[24:27], v[116:119], v[72:75], v[24:27]
    s_waitcnt lgkmcnt(2)
    v_mfma_f32_16x16x32_bf16 v[28:31], v[120:123], v[72:75], v[28:31]
    s_waitcnt lgkmcnt(1)
    v_mfma_f32_16x16x32_bf16 v[32:35], v[124:127], v[72:75], v[32:35]
    s_waitcnt lgkmcnt(0)
    v_mfma_f32_16x16x32_bf16 v[36:39], v[80:83], v[72:75], v[36:39]
    v_lshrrev_b32 v70, 4, v0
    v_lshlrev_b32 v70, 4, v70
    v_add_u32 v70, 61440, v70
    s_mul_i32 s85, s49, 320
    v_add_u32 v63, s85, v70
    v_bfe_u32 v71, v0, 2, 2
    v_and_b32 v64, 3, v0
    v_lshl_add_u32 v70, v64, 2, v70
    v_lshl_add_u32 v71, v71, 6, v70
    ds_write_b128 v63, v[20:23] offset:0
    ds_write_b128 v63, v[24:27] offset:64
    ds_write_b128 v63, v[28:31] offset:128
    ds_write_b128 v63, v[32:35] offset:192
    ds_write_b128 v63, v[36:39] offset:256
    ds_read_b128 v[128:131], v2 offset:36864
    ds_read_b128 v[132:135], v2 offset:37888
    ds_read_b128 v[136:139], v2 offset:38912
    ds_read_b128 v[140:143], v2 offset:39936
    ds_read_b128 v[144:147], v2 offset:40960
    ds_read_b128 v[148:151], v2 offset:41984
    ds_read_b128 v[152:155], v2 offset:43008
    ds_read_b128 v[156:159], v2 offset:44032
    s_waitcnt vmcnt(1)
    s_mov_b32 s92, s67
ACP_9:
    v_and_b32 v169, -16, v169
    v_cmp_eq_u64 vcc, s[0:1], v[168:169]
    s_nop 0
    s_cmp_eq_u64 vcc, -1
    s_cbranch_scc1 ACD_10
    buffer_load_dwordx2 v[168:169], v170, s[8:11], s87 offen sc1
    s_waitcnt vmcnt(0)
    s_sub_u32 s92, s92, 1
    s_cbranch_scc0 ACP_9
    s_mov_b32 s67, 0
ACD_10:
    v_and_b32 v168, 7, v0
    v_lshlrev_b32 v168, 2, v168
    s_lshl_b32 s85, s51, 5
    s_add_u32 s85, s85, 13635584
    s_waitcnt lgkmcnt(8)
    buffer_load_dword v7, v168, s[8:11], s85 offen sc1
    s_waitcnt vmcnt(0)
    v_cmp_le_u32 vcc, 1, v7
    s_nop 0
    s_cmp_lg_u64 vcc, -1
    s_cbranch_scc1 POLL_11
PDONE_12:
    s_add_u32 s84, s55, 18874368
    buffer_load_dwordx4 v[80:83], v1, s[8:11], s84 offen offset:0 sc1
    buffer_load_dwordx4 v[84:87], v1, s[8:11], s84 offen offset:1024 sc1
    buffer_load_dwordx4 v[88:91], v1, s[8:11], s84 offen offset:2048 sc1
    buffer_load_dwordx4 v[92:95], v1, s[8:11], s84 offen offset:3072 sc1
    s_add_u32 s84, s55, 18878464
    buffer_load_dwordx4 v[96:99], v1, s[8:11], s84 offen offset:0 sc1
    buffer_load_dwordx4 v[100:103], v1, s[8:11], s84 offen offset:1024 sc1
    buffer_load_dwordx4 v[104:107], v1, s[8:11], s84 offen offset:2048 sc1
    buffer_load_dwordx4 v[108:111], v1, s[8:11], s84 offen offset:3072 sc1
    s_waitcnt vmcnt(7) lgkmcnt(6)
    v_mfma_f32_16x16x32_bf16 v[20:23], v[128:131], v[80:83], 0
    ds_read_b128 v[160:163], v2 offset:45056
    s_add_u32 s84, s55, 18882560
    buffer_load_dwordx4 v[112:115], v1, s[8:11], s84 offen offset:0 sc1
    v_mfma_f32_16x16x32_bf16 v[24:27], v[132:135], v[80:83], 0
    ds_read_b128 v[164:167], v2 offset:46080
    s_waitcnt lgkmcnt(6)
    v_mfma_f32_16x16x32_bf16 v[28:31], v[136:139], v[80:83], 0
    ds_read_b128 v[128:131], v2 offset:47104
    v_mfma_f32_16x16x32_bf16 v[32:35], v[140:143], v[80:83], 0
    ds_read_b128 v[132:135], v2 offset:48128
    s_waitcnt lgkmcnt(6)
    v_mfma_f32_16x16x32_bf16 v[36:39], v[144:147], v[80:83], 0
    ds_read_b128 v[136:139], v2 offset:49152
    buffer_load_dwordx4 v[116:119], v1, s[8:11], s84 offen offset:1024 sc1
    s_waitcnt vmcnt(8)
    v_mfma_f32_16x16x32_bf16 v[20:23], v[148:151], v[84:87], v[20:23]
    ds_read_b128 v[140:143], v2 offset:50176
    s_waitcnt lgkmcnt(6)
    v_mfma_f32_16x16x32_bf16 v[24:27], v[152:155], v[84:87], v[24:27]
    ds_read_b128 v[144:147], v2 offset:51200
    v_mfma_f32_16x16x32_bf16 v[28:31], v[156:159], v[84:87], v[28:31]
    ds_read_b128 v[148:151], v2 offset:52224
    s_waitcnt lgkmcnt(6)
    v_mfma_f32_16x16x32_bf16 v[32:35], v[160:163], v[84:87], v[32:35]
    ds_read_b128 v[152:155], v2 offset:53248
    buffer_load_dwordx4 v[120:123], v1, s[8:11], s84 offen offset:2048 sc1
    v_mfma_f32_16x16x32_bf16 v[36:39], v[164:167], v[84:87], v[36:39]
    ds_read_b128 v[156:159], v2 offset:54272
    s_waitcnt vmcnt(8) lgkmcnt(6)
    v_mfma_f32_16x16x32_bf16 v[20:23], v[128:131], v[88:91], v[20:23]
    ds_read_b128 v[160:163], v2 offset:55296
    v_mfma_f32_16x16x32_bf16 v[24:27], v[132:135], v[88:91], v[24:27]
    ds_read_b128 v[164:167], v2 offset:56320
    s_waitcnt lgkmcnt(6)
    v_mfma_f32_16x16x32_bf16 v[28:31], v[136:139], v[88:91], v[28:31]
    ds_read_b128 v[128:131], v2 offset:57344
    buffer_load_dwordx4 v[124:127], v1, s[8:11], s84 offen offset:3072 sc1
    v_mfma_f32_16x16x32_bf16 v[32:35], v[140:143], v[88:91], v[32:35]
    ds_read_b128 v[132:135], v2 offset:58368
    s_waitcnt lgkmcnt(6)
    v_mfma_f32_16x16x32_bf16 v[36:39], v[144:147], v[88:91], v[36:39]
    ds_read_b128 v[136:139], v2 offset:59392
    s_waitcnt vmcnt(8)
    v_mfma_f32_16x16x32_bf16 v[20:23], v[148:151], v[92:95], v[20:23]
    ds_read_b128 v[140:143], v2 offset:60416
    s_waitcnt lgkmcnt(6)
    v_mfma_f32_16x16x32_bf16 v[24:27], v[152:155], v[92:95], v[24:27]
    ds_read_b128 v[144:147], v2 offset:61440
    s_add_u32 s84, s55, 18886656
    buffer_load_dwordx4 v[80:83], v1, s[8:11], s84 offen offset:0 sc1
    v_mfma_f32_16x16x32_bf16 v[28:31], v[156:159], v[92:95], v[28:31]
    ds_read_b128 v[148:151], v2 offset:62464
    s_waitcnt lgkmcnt(6)
    v_mfma_f32_16x16x32_bf16 v[32:35], v[160:163], v[92:95], v[32:35]
    ds_read_b128 v[152:155], v2 offset:63488
    v_mfma_f32_16x16x32_bf16 v[36:39], v[164:167], v[92:95], v[36:39]
    ds_read_b128 v[156:159], v2 offset:64512
    s_waitcnt vmcnt(8) lgkmcnt(6)
    v_mfma_f32_16x16x32_bf16 v[20:23], v[128:131], v[96:99], v[20:23]
    ds_read_b128 v[160:163], v3 offset:0
    buffer_load_dwordx4 v[84:87], v1, s[8:11], s84 offen offset:1024 sc1
    v_mfma_f32_16x16x32_bf16 v[24:27], v[132:135], v[96:99], v[24:27]
    ds_read_b128 v[164:167], v3 offset:1024
    s_waitcnt lgkmcnt(6)
    v_mfma_f32_16x16x32_bf16 v[28:31], v[136:139], v[96:99], v[28:31]
    ds_read_b128 v[128:131], v3 offset:2048
    v_mfma_f32_16x16x32_bf16 v[32:35], v[140:143], v[96:99], v[32:35]
    ds_read_b128 v[132:135], v3 offset:3072
    s_waitcnt lgkmcnt(6)
    v_mfma_f32_16x16x32_bf16 v[36:39], v[144:147], v[96:99], v[36:39]
    ds_read_b128 v[136:139], v3 offset:4096
    buffer_load_dwordx4 v[88:91], v1, s[8:11], s84 offen offset:2048 sc1
    s_waitcnt vmcnt(9)
    v_mfma_f32_16x16x32_bf16 v[20:23], v[148:151], v[100:103], v[20:23]
    ds_read_b128 v[140:143], v3 offset:5120
    s_waitcnt lgkmcnt(6)
    v_mfma_f32_16x16x32_bf16 v[24:27], v[152:155], v[100:103], v[24:27]
    ds_read_b128 v[144:147], v3 offset:6144
    v_mfma_f32_16x16x32_bf16 v[28:31], v[156:159], v[100:103], v[28:31]
    ds_read_b128 v[148:151], v3 offset:7168
    s_waitcnt lgkmcnt(6)
    v_mfma_f32_16x16x32_bf16 v[32:35], v[160:163], v[100:103], v[32:35]
    ds_read_b128 v[152:155], v3 offset:8192
    buffer_load_dwordx4 v[92:95], v1, s[8:11], s84 offen offset:3072 sc1
    v_mfma_f32_16x16x32_bf16 v[36:39], v[164:167], v[100:103], v[36:39]
    ds_read_b128 v[156:159], v3 offset:9216
    s_waitcnt vmcnt(9) lgkmcnt(6)
    v_mfma_f32_16x16x32_bf16 v[20:23], v[128:131], v[104:107], v[20:23]
    ds_read_b128 v[160:163], v3 offset:10240
    v_mfma_f32_16x16x32_bf16 v[24:27], v[132:135], v[104:107], v[24:27]
    ds_read_b128 v[164:167], v3 offset:11264
    s_waitcnt lgkmcnt(6)
    v_mfma_f32_16x16x32_bf16 v[28:31], v[136:139], v[104:107], v[28:31]
    ds_read_b128 v[128:131], v2 offset:16384
    s_add_u32 s84, s55, 18890752
    buffer_load_dwordx4 v[96:99], v1, s[8:11], s84 offen offset:0 sc1
    v_mfma_f32_16x16x32_bf16 v[32:35], v[140:143], v[104:107], v[32:35]
    ds_read_b128 v[132:135], v2 offset:17408
    s_waitcnt lgkmcnt(6)
    v_mfma_f32_16x16x32_bf16 v[36:39], v[144:147], v[104:107], v[36:39]
    ds_read_b128 v[136:139], v2 offset:18432
    s_waitcnt vmcnt(9)
    v_mfma_f32_16x16x32_bf16 v[20:23], v[148:151], v[108:111], v[20:23]
    ds_read_b128 v[140:143], v2 offset:19456
    s_waitcnt lgkmcnt(6)
    v_mfma_f32_16x16x32_bf16 v[24:27], v[152:155], v[108:111], v[24:27]
    ds_read_b128 v[144:147], v2 offset:20480
    buffer_load_dwordx4 v[100:103], v1, s[8:11], s84 offen offset:1024 sc1
    v_mfma_f32_16x16x32_bf16 v[28:31], v[156:159], v[108:111], v[28:31]
    ds_read_b128 v[148:151], v2 offset:21504
    s_waitcnt lgkmcnt(6)
    v_mfma_f32_16x16x32_bf16 v[32:35], v[160:163], v[108:111], v[32:35]
    ds_read_b128 v[152:155], v2 offset:22528
    v_mfma_f32_16x16x32_bf16 v[36:39], v[164:167], v[108:111], v[36:39]
    ds_read_b128 v[156:159], v2 offset:23552
    s_waitcnt vmcnt(9) lgkmcnt(6)
    v_mfma_f32_16x16x32_bf16 v[20:23], v[128:131], v[112:115], v[20:23]
    ds_read_b128 v[160:163], v2 offset:24576
    buffer_load_dwordx4 v[104:107], v1, s[8:11], s84 offen offset:2048 sc1
    v_mfma_f32_16x16x32_bf16 v[24:27], v[132:135], v[112:115], v[24:27]
    ds_read_b128 v[164:167], v2 offset:25600
    s_waitcnt lgkmcnt(6)
    v_mfma_f32_16x16x32_bf16 v[28:31], v[136:139], v[112:115], v[28:31]
    ds_read_b128 v[128:131], v2 offset:26624
    v_mfma_f32_16x16x32_bf16 v[32:35], v[140:143], v[112:115], v[32:35]
    ds_read_b128 v[132:135], v2 offset:27648
    s_waitcnt lgkmcnt(6)
    v_mfma_f32_16x16x32_bf16 v[36:39], v[144:147], v[112:115], v[36:39]
    s_barrier
    ds_read_b128 v[136:139], v2 offset:28672
    buffer_load_dwordx4 v[108:111], v1, s[8:11], s84 offen offset:3072 sc1
    s_waitcnt vmcnt(10)
    v_mfma_f32_16x16x32_bf16 v[20:23], v[148:151], v[116:119], v[20:23]
    ds_read_b128 v[140:143], v2 offset:29696
    s_waitcnt lgkmcnt(6)
    v_mfma_f32_16x16x32_bf16 v[24:27], v[152:155], v[116:119], v[24:27]
    ds_read_b128 v[144:147], v2 offset:30720
    ds_read_b32 v60, v71 offset:0
    v_mfma_f32_16x16x32_bf16 v[28:31], v[156:159], v[116:119], v[28:31]
    ds_read_b128 v[148:151], v2 offset:31744
    s_waitcnt lgkmcnt(7)
    v_mfma_f32_16x16x32_bf16 v[32:35], v[160:163], v[116:119], v[32:35]
    ds_read_b128 v[152:155], v2 offset:32768
    ds_read_b32 v64, v70 offset:256
    v_mfma_f32_16x16x32_bf16 v[36:39], v[164:167], v[116:119], v[36:39]
    ds_read_b128 v[156:159], v2 offset:33792
    s_waitcnt vmcnt(9) lgkmcnt(8)
    v_mfma_f32_16x16x32_bf16 v[20:23], v[128:131], v[120:123], v[20:23]
    ds_read_b128 v[160:163], v2 offset:34816
    s_getpc_b64 s[4:5]
PCL_15:
    s_lshl_b32 s6, s45, 2
    s_add_u32 s6, s6, s49
    s_and_b32 s6, s6, 31
    s_lshl_b32 s6, s6, 10
    v_add_u32 v19, s6, v1
    v_min_u32 v19, CODE_END-PCL_15-16, v19
    global_load_dword a253, v19, s[4:5]
    v_mfma_f32_16x16x32_bf16 v[24:27], v[132:135], v[120:123], v[24:27]
    ds_read_b128 v[164:167], v2 offset:35840
    s_waitcnt lgkmcnt(8)
    v_mfma_f32_16x16x32_bf16 v[28:31], v[136:139], v[120:123], v[28:31]
    ds_read_b128 v[128:131], v3 offset:12288
    s_add_u32 s84, s55, 18894848
    buffer_load_dwordx4 v[172:175], v1, s[8:11], s84 offen offset:0 sc1
    v_mfma_f32_16x16x32_bf16 v[32:35], v[140:143], v[120:123], v[32:35]
    ds_read_b128 v[132:135], v3 offset:13312
    s_waitcnt lgkmcnt(7)
    v_mfma_f32_16x16x32_bf16 v[36:39], v[144:147], v[120:123], v[36:39]
    ds_read_b128 v[136:139], v3 offset:14336
    s_waitcnt vmcnt(10)
    v_mfma_f32_16x16x32_bf16 v[20:23], v[148:151], v[124:127], v[20:23]
    ds_read_b128 v[140:143], v3 offset:15360
    s_add_u32 m0, s63, 20480
    s_add_u32 s93, s60, 5242880
    buffer_load_dwordx4 v1, s[8:11], s93 offen offset:0  lds
    s_waitcnt lgkmcnt(6)
    v_mfma_f32_16x16x32_bf16 v[24:27], v[152:155], v[124:127], v[24:27]
    ds_read_b128 v[144:147], v3 offset:16384
    ds_read_b32 v61, v71 offset:320
    v_mfma_f32_16x16x32_bf16 v[28:31], v[156:159], v[124:127], v[28:31]
    ds_read_b128 v[148:151], v3 offset:17408
    buffer_load_dwordx4 v1, s[8:11], s93 offen offset:1024  lds
    s_waitcnt lgkmcnt(7)
    v_mfma_f32_16x16x32_bf16 v[32:35], v[160:163], v[124:127], v[32:35]
    ds_read_b128 v[152:155], v3 offset:18432
    ds_read_b32 v65, v70 offset:576
    v_mfma_f32_16x16x32_bf16 v[36:39], v[164:167], v[124:127], v[36:39]
    ds_read_b128 v[156:159], v3 offset:19456
    s_waitcnt vmcnt(11) lgkmcnt(8)
    v_mfma_f32_16x16x32_bf16 v[20:23], v[128:131], v[80:83], v[20:23]
    ds_read_b128 v[160:163], v3 offset:20480
    buffer_load_dwordx4 v1, s[8:11], s93 offen offset:2048  lds
    v_mfma_f32_16x16x32_bf16 v[24:27], v[132:135], v[80:83], v[24:27]
    ds_read_b128 v[164:167], v3 offset:21504
    s_waitcnt lgkmcnt(8)
    v_mfma_f32_16x16x32_bf16 v[28:31], v[136:139], v[80:83], v[28:31]
    ds_read_b128 v[128:131], v3 offset:22528
    buffer_load_dwordx4 v1, s[8:11], s93 offen offset:3072  lds
    v_mfma_f32_16x16x32_bf16 v[32:35], v[140:143], v[80:83], v[32:35]
    ds_read_b128 v[132:135], v3 offset:23552
    s_waitcnt lgkmcnt(7)
    v_mfma_f32_16x16x32_bf16 v[36:39], v[144:147], v[80:83], v[36:39]
    ds_read_b128 v[136:139], v3 offset:24576
    s_waitcnt vmcnt(12)
    v_mfma_f32_16x16x32_bf16 v[20:23], v[148:151], v[84:87], v[20:23]
    ds_read_b128 v[140:143], v3 offset:25600
    s_add_u32 m0, m0, 4096
    s_add_u32 s93, s93, 4096
    buffer_load_dwordx4 v1, s[8:11], s93 offen offset:0  lds
    s_waitcnt lgkmcnt(6)
    v_mfma_f32_16x16x32_bf16 v[24:27], v[152:155], v[84:87], v[24:27]
    ds_read_b128 v[144:147], v3 offset:26624
    ds_read_b32 v62, v71 offset:640
    v_mfma_f32_16x16x32_bf16 v[28:31], v[156:159], v[84:87], v[28:31]
    ds_read_b128 v[148:151], v3 offset:27648
    s_waitcnt lgkmcnt(7)
    v_mfma_f32_16x16x32_bf16 v[32:35], v[160:163], v[84:87], v[32:35]
    ds_read_b128 v[152:155], v3 offset:28672
    s_add_u32 m0, s63, 40960
    s_add_u32 s93, s60, 5263360
    buffer_load_dwordx4 v1, s[8:11], s93 offen offset:0  lds
    v_mfma_f32_16x16x32_bf16 v[36:39], v[164:167], v[84:87], v[36:39]
    ds_read_b128 v[156:159], v3 offset:29696
    s_waitcnt vmcnt(13) lgkmcnt(7)
    v_mfma_f32_16x16x32_bf16 v[20:23], v[128:131], v[88:91], v[20:23]
    ds_read_b128 v[160:163], v3 offset:30720
    buffer_load_dwordx4 v1, s[8:11], s93 offen offset:1024  lds
    v_mfma_f32_16x16x32_bf16 v[24:27], v[132:135], v[88:91], v[24:27]
    ds_read_b128 v[164:167], v3 offset:31744
    s_waitcnt lgkmcnt(7)
    v_mfma_f32_16x16x32_bf16 v[28:31], v[136:139], v[88:91], v[28:31]
    ds_read_b128 v[128:131], v1 offset:0
    ds_read_b32 v66, v70 offset:896
    v_mfma_f32_16x16x32_bf16 v[32:35], v[140:143], v[88:91], v[32:35]
    ds_read_b128 v[132:135], v1 offset:1024
    buffer_load_dwordx4 v1, s[8:11], s93 offen offset:2048  lds
    s_waitcnt lgkmcnt(7)
    v_mfma_f32_16x16x32_bf16 v[36:39], v[144:147], v[88:91], v[36:39]
    ds_read_b128 v[136:139], v1 offset:2048
    s_waitcnt vmcnt(14)
    v_mfma_f32_16x16x32_bf16 v[20:23], v[148:151], v[92:95], v[20:23]
    ds_read_b128 v[140:143], v1 offset:3072
    buffer_load_dwordx4 v1, s[8:11], s93 offen offset:3072  lds
    s_waitcnt lgkmcnt(7)
    v_mfma_f32_16x16x32_bf16 v[24:27], v[152:155], v[92:95], v[24:27]
    ds_read_b128 v[144:147], v1 offset:4096
    ds_read_b32 v63, v71 offset:960
    v_mfma_f32_16x16x32_bf16 v[28:31], v[156:159], v[92:95], v[28:31]
    ds_read_b128 v[148:151], v1 offset:5120
    s_waitcnt lgkmcnt(8)
    v_mfma_f32_16x16x32_bf16 v[32:35], v[160:163], v[92:95], v[32:35]
    ds_read_b128 v[152:155], v1 offset:6144
    s_add_u32 m0, m0, 4096
    s_add_u32 s93, s93, 4096
    buffer_load_dwordx4 v1, s[8:11], s93 offen offset:0  lds
    v_mfma_f32_16x16x32_bf16 v[36:39], v[164:167], v[92:95], v[36:39]
    ds_read_b128 v[156:159], v1 offset:7168
    s_waitcnt vmcnt(15) lgkmcnt(7)
    v_mfma_f32_16x16x32_bf16 v[20:23], v[128:131], v[96:99], v[20:23]
    ds_read_b128 v[160:163], v1 offset:8192
    ds_read_b32 v67, v70 offset:1216
    v_mfma_f32_16x16x32_bf16 v[24:27], v[132:135], v[96:99], v[24:27]
    ds_read_b128 v[164:167], v1 offset:9216
    s_add_u32 m0, s63, 102400
    s_add_u32 s93, s60, 5283840
    buffer_load_dwordx4 v1, s[8:11], s93 offen offset:0  lds
    s_waitcnt lgkmcnt(8)
    v_mfma_f32_16x16x32_bf16 v[28:31], v[136:139], v[96:99], v[28:31]
    ds_read_b128 v[128:131], v1 offset:10240
    s_waitcnt lgkmcnt(2)
    v_add_f32 v60, v60, v61
    v_mfma_f32_16x16x32_bf16 v[32:35], v[140:143], v[96:99], v[32:35]
    ds_read_b128 v[132:135], v1 offset:11264
    buffer_load_dwordx4 v1, s[8:11], s93 offen offset:1024  lds
    v_mfma_f32_16x16x32_bf16 v[36:39], v[144:147], v[96:99], v[36:39]
    ds_read_b128 v[136:139], v1 offset:12288
    s_waitcnt vmcnt(16)
    v_add_f32 v62, v62, v63
    v_mfma_f32_16x16x32_bf16 v[20:23], v[148:151], v[100:103], v[20:23]
    ds_read_b128 v[140:143], v1 offset:13312
    v_add_f32 v64, v64, v65
    v_mfma_f32_16x16x32_bf16 v[24:27], v[152:155], v[100:103], v[24:27]
    ds_read_b128 v[144:147], v1 offset:14336
    buffer_load_dwordx4 v1, s[8:11], s93 offen offset:2048  lds
    v_mfma_f32_16x16x32_bf16 v[28:31], v[156:159], v[100:103], v[28:31]
    ds_read_b128 v[148:151], v1 offset:15360
    s_waitcnt lgkmcnt(6)
    v_add_f32 v66, v66, v67
    v_mfma_f32_16x16x32_bf16 v[32:35], v[160:163], v[100:103], v[32:35]
    ds_read_b128 v[152:155], v1 offset:16384
    buffer_load_dwordx4 v1, s[8:11], s93 offen offset:3072  lds
    v_mfma_f32_16x16x32_bf16 v[36:39], v[164:167], v[100:103], v[36:39]
    ds_read_b128 v[156:159], v1 offset:17408
    s_waitcnt vmcnt(17) lgkmcnt(6)
    v_add_f32 v60, v60, v62
    v_mfma_f32_16x16x32_bf16 v[20:23], v[128:131], v[104:107], v[20:23]
    ds_read_b128 v[160:163], v1 offset:18432
    v_add_f32 v64, v64, v66
    v_mfma_f32_16x16x32_bf16 v[24:27], v[132:135], v[104:107], v[24:27]
    ds_read_b128 v[164:167], v1 offset:19456
    s_add_u32 m0, m0, 4096
    s_add_u32 s93, s93, 4096
    buffer_load_dwordx4 v1, s[8:11], s93 offen offset:0  lds
    s_waitcnt lgkmcnt(6)
    v_mfma_f32_16x16x32_bf16 v[28:31], v[136:139], v[104:107], v[28:31]
    v_accvgpr_write_b32 a249, v60
    v_accvgpr_write_b32 a250, v64
    v_mfma_f32_16x16x32_bf16 v[32:35], v[140:143], v[104:107], v[32:35]
    s_waitcnt lgkmcnt(4) vmcnt(15)
    v_or3_b32 v76, v172, v173, v174
    v_mfma_f32_16x16x32_bf16 v[36:39], v[144:147], v[104:107], v[36:39]
    v_or_b32 v76, v76, v175
    v_and_b32 v76, 1, v76
    v_mfma_f32_16x16x32_bf16 v[20:23], v[148:151], v[108:111], v[20:23]
    s_waitcnt lgkmcnt(2)
    v_cmp_ne_u32 vcc, 0, v76
    s_nop 0
    s_cmp_lg_u64 vcc, 0
    s_cbranch_scc1 STR_13
STB_14:
    v_mfma_f32_16x16x32_bf16 v[24:27], v[152:155], v[108:111], v[24:27]
    v_add_f32 v172, v172, v174
    v_add_f32 v173, v173, v175
    v_mfma_f32_16x16x32_bf16 v[28:31], v[156:159], v[108:111], v[28:31]
    s_waitcnt lgkmcnt(0)
    v_permlane32_swap_b32 v172, v173
    v_add_f32 v172, v172, v173
    v_mfma_f32_16x16x32_bf16 v[32:35], v[160:163], v[108:111], v[32:35]
    v_mov_b32 v173, v172
    s_nop 1
    v_permlane16_swap_b32 v172, v173
    v_mfma_f32_16x16x32_bf16 v[36:39], v[164:167], v[108:111], v[36:39]
    v_add_f32 v172, v172, v173
    v_mov_b32 v173, v172
    s_nop 1
    v_permlane32_swap_b32 v172, v173
    v_mul_f32 v76, 0xbacccccd, v172
    v_mul_f32 v173, 0x3acccccd, v173
    v_fma_f32 v173, -v76, v76, v173
    v_max_f32 v173, 0, v173
    v_add_f32 v174, 0x3727c5ac, v173
    v_rsq_f32 v78, v174
    s_nop 0
    v_mul_f32 v173, v173, v78
    v_mul_f32 v173, v173, v78
    v_add_f32 v173, 0x3727c5ac, v173
    v_rsq_f32 v173, v173
    s_nop 0
    v_mul_f32 v74, v78, v173
    v_mov_b32 v168, v76
    v_rcp_f32 v169, v74
    v_mul_f32 v171, 0xc0135761, v74
    v_mul_f32 v170, v74, v74
    v_mul_f32 v170, v170, v171
    v_mul_f32 v170, 0x3d372713, v170
    v_mov_b32_dpp v128, v60 row_newbcast:0 row_mask:0xf bank_mask:0xf
    v_mov_b32_dpp v129, v60 row_newbcast:1 row_mask:0xf bank_mask:0xf
    v_mov_b32_dpp v130, v60 row_newbcast:2 row_mask:0xf bank_mask:0xf
    v_mov_b32_dpp v131, v60 row_newbcast:3 row_mask:0xf bank_mask:0xf
    v_mov_b32_dpp v132, v60 row_newbcast:4 row_mask:0xf bank_mask:0xf
    v_mov_b32_dpp v133, v60 row_newbcast:5 row_mask:0xf bank_mask:0xf
    v_mov_b32_dpp v134, v60 row_newbcast:6 row_mask:0xf bank_mask:0xf
    v_mov_b32_dpp v135, v60 row_newbcast:7 row_mask:0xf bank_mask:0xf
    v_mov_b32_dpp v136, v60 row_newbcast:8 row_mask:0xf bank_mask:0xf
    v_mov_b32_dpp v137, v60 row_newbcast:9 row_mask:0xf bank_mask:0xf
    v_mov_b32_dpp v138, v60 row_newbcast:10 row_mask:0xf bank_mask:0xf
    v_mov_b32_dpp v139, v60 row_newbcast:11 row_mask:0xf bank_mask:0xf
    v_mov_b32_dpp v140, v60 row_newbcast:12 row_mask:0xf bank_mask:0xf
    v_mov_b32_dpp v141, v60 row_newbcast:13 row_mask:0xf bank_mask:0xf
    v_mov_b32_dpp v142, v60 row_newbcast:14 row_mask:0xf bank_mask:0xf
    v_mov_b32_dpp v143, v60 row_newbcast:15 row_mask:0xf bank_mask:0xf
    v_mov_b32_dpp v144, v64 row_newbcast:0 row_mask:0xf bank_mask:0xf
    v_mov_b32_dpp v145, v64 row_newbcast:1 row_mask:0xf bank_mask:0xf
    v_mov_b32_dpp v146, v64 row_newbcast:2 row_mask:0xf bank_mask:0xf
    v_mov_b32_dpp v147, v64 row_newbcast:3 row_mask:0xf bank_mask:0xf
    v_pk_fma_f32 v[20:21], v[128:129], v[168:169], v[20:21] op_sel_hi:[1,0,1]
    s_add_u32 m0, s63, 122880
    s_add_u32 s93, s60, 5304320
    buffer_load_dwordx4 v1, s[8:11], s93 offen offset:0  lds
    v_pk_fma_f32 v[22:23], v[130:131], v[168:169], v[22:23] op_sel_hi:[1,0,1]
    v_pk_fma_f32 v[24:25], v[132:133], v[168:169], v[24:25] op_sel_hi:[1,0,1]
    v_pk_fma_f32 v[26:27], v[134:135], v[168:169], v[26:27] op_sel_hi:[1,0,1]
    v_pk_fma_f32 v[28:29], v[136:137], v[168:169], v[28:29] op_sel_hi:[1,0,1]
    v_pk_fma_f32 v[30:31], v[138:139], v[168:169], v[30:31] op_sel_hi:[1,0,1]
    v_pk_fma_f32 v[32:33], v[140:141], v[168:169], v[32:33] op_sel_hi:[1,0,1]
    v_pk_fma_f32 v[34:35], v[142:143], v[168:169], v[34:35] op_sel_hi:[1,0,1]
    v_pk_fma_f32 v[36:37], v[144:145], v[168:169], v[36:37] op_sel_hi:[1,0,1]
    buffer_load_dwordx4 v1, s[8:11], s93 offen offset:1024  lds
    v_pk_fma_f32 v[38:39], v[146:147], v[168:169], v[38:39] op_sel_hi:[1,0,1]
    v_pk_mul_f32 v[80:81], v[20:21], v[20:21]
    v_pk_mul_f32 v[82:83], v[22:23], v[22:23]
    v_pk_mul_f32 v[84:85], v[24:25], v[24:25]
    v_pk_mul_f32 v[86:87], v[26:27], v[26:27]
    v_pk_mul_f32 v[88:89], v[28:29], v[28:29]
    v_pk_mul_f32 v[90:91], v[30:31], v[30:31]
    v_pk_mul_f32 v[92:93], v[32:33], v[32:33]
    buffer_load_dwordx4 v1, s[8:11], s93 offen offset:2048  lds
    v_pk_mul_f32 v[94:95], v[34:35], v[34:35]
    v_pk_mul_f32 v[96:97], v[36:37], v[36:37]
    v_pk_mul_f32 v[98:99], v[38:39], v[38:39]
    v_pk_fma_f32 v[80:81], v[80:81], v[170:171], v[170:171] op_sel:[0,0,1] op_sel_hi:[1,0,1]
    v_pk_fma_f32 v[82:83], v[82:83], v[170:171], v[170:171] op_sel:[0,0,1] op_sel_hi:[1,0,1]
    v_pk_fma_f32 v[84:85], v[84:85], v[170:171], v[170:171] op_sel:[0,0,1] op_sel_hi:[1,0,1]
    v_pk_fma_f32 v[86:87], v[86:87], v[170:171], v[170:171] op_sel:[0,0,1] op_sel_hi:[1,0,1]
    v_pk_fma_f32 v[88:89], v[88:89], v[170:171], v[170:171] op_sel:[0,0,1] op_sel_hi:[1,0,1]
    buffer_load_dwordx4 v1, s[8:11], s93 offen offset:3072  lds
    v_pk_fma_f32 v[90:91], v[90:91], v[170:171], v[170:171] op_sel:[0,0,1] op_sel_hi:[1,0,1]
    v_pk_fma_f32 v[92:93], v[92:93], v[170:171], v[170:171] op_sel:[0,0,1] op_sel_hi:[1,0,1]
    v_pk_fma_f32 v[94:95], v[94:95], v[170:171], v[170:171] op_sel:[0,0,1] op_sel_hi:[1,0,1]
    v_pk_fma_f32 v[96:97], v[96:97], v[170:171], v[170:171] op_sel:[0,0,1] op_sel_hi:[1,0,1]
    v_pk_fma_f32 v[98:99], v[98:99], v[170:171], v[170:171] op_sel:[0,0,1] op_sel_hi:[1,0,1]
    v_pk_mul_f32 v[80:81], v[80:81], v[20:21]
    v_pk_mul_f32 v[82:83], v[82:83], v[22:23]
    v_pk_mul_f32 v[84:85], v[84:85], v[24:25]
    s_add_u32 m0, m0, 4096
    s_add_u32 s93, s93, 4096
    buffer_load_dwordx4 v1, s[8:11], s93 offen offset:0  lds
    v_pk_mul_f32 v[86:87], v[86:87], v[26:27]
    v_pk_mul_f32 v[88:89], v[88:89], v[28:29]
    v_pk_mul_f32 v[90:91], v[90:91], v[30:31]
    v_pk_mul_f32 v[92:93], v[92:93], v[32:33]
    v_pk_mul_f32 v[94:95], v[94:95], v[34:35]
    v_pk_mul_f32 v[96:97], v[96:97], v[36:37]
    v_pk_mul_f32 v[98:99], v[98:99], v[38:39]
    v_exp_f32 v80, v80
    v_exp_f32 v81, v81
    v_exp_f32 v82, v82
    v_exp_f32 v83, v83
    v_exp_f32 v84, v84
    v_exp_f32 v85, v85
    v_exp_f32 v86, v86
    v_exp_f32 v87, v87
    v_exp_f32 v88, v88
    v_exp_f32 v89, v89
    v_exp_f32 v90, v90
    v_exp_f32 v91, v91
    v_exp_f32 v92, v92
    v_exp_f32 v93, v93
    v_exp_f32 v94, v94
    v_exp_f32 v95, v95
    v_exp_f32 v96, v96
    v_exp_f32 v97, v97
    v_exp_f32 v98, v98
    v_exp_f32 v99, v99
    v_pk_fma_f32 v[80:81], v[80:81], v[168:169], v[168:169] op_sel:[0,1,1] op_sel_hi:[1,1,1]
    v_pk_fma_f32 v[82:83], v[82:83], v[168:169], v[168:169] op_sel:[0,1,1] op_sel_hi:[1,1,1]
    v_pk_fma_f32 v[84:85], v[84:85], v[168:169], v[168:169] op_sel:[0,1,1] op_sel_hi:[1,1,1]
    v_pk_fma_f32 v[86:87], v[86:87], v[168:169], v[168:169] op_sel:[0,1,1] op_sel_hi:[1,1,1]
    v_pk_fma_f32 v[88:89], v[88:89], v[168:169], v[168:169] op_sel:[0,1,1] op_sel_hi:[1,1,1]
    v_pk_fma_f32 v[90:91], v[90:91], v[168:169], v[168:169] op_sel:[0,1,1] op_sel_hi:[1,1,1]
    v_pk_fma_f32 v[92:93], v[92:93], v[168:169], v[168:169] op_sel:[0,1,1] op_sel_hi:[1,1,1]
    v_pk_fma_f32 v[94:95], v[94:95], v[168:169], v[168:169] op_sel:[0,1,1] op_sel_hi:[1,1,1]
    v_pk_fma_f32 v[96:97], v[96:97], v[168:169], v[168:169] op_sel:[0,1,1] op_sel_hi:[1,1,1]
    v_pk_fma_f32 v[98:99], v[98:99], v[168:169], v[168:169] op_sel:[0,1,1] op_sel_hi:[1,1,1]
    v_rcp_f32 v80, v80
    v_rcp_f32 v81, v81
    v_rcp_f32 v82, v82
    v_rcp_f32 v83, v83
    v_rcp_f32 v84, v84
    v_rcp_f32 v85, v85
    v_rcp_f32 v86, v86
    v_rcp_f32 v87, v87
    v_rcp_f32 v88, v88
    v_rcp_f32 v89, v89
    v_rcp_f32 v90, v90
    v_rcp_f32 v91, v91
    v_rcp_f32 v92, v92
    v_rcp_f32 v93, v93
    v_rcp_f32 v94, v94
    v_rcp_f32 v95, v95
    v_rcp_f32 v96, v96
    v_rcp_f32 v97, v97
    v_rcp_f32 v98, v98
    v_rcp_f32 v99, v99
    v_pk_mul_f32 v[20:21], v[20:21], v[80:81]
    v_pk_mul_f32 v[22:23], v[22:23], v[82:83]
    v_pk_mul_f32 v[24:25], v[24:25], v[84:85]
    v_pk_mul_f32 v[26:27], v[26:27], v[86:87]
    v_pk_mul_f32 v[28:29], v[28:29], v[88:89]
    v_pk_mul_f32 v[30:31], v[30:31], v[90:91]
    v_pk_mul_f32 v[32:33], v[32:33], v[92:93]
    v_pk_mul_f32 v[34:35], v[34:35], v[94:95]
    v_pk_mul_f32 v[36:37], v[36:37], v[96:97]
    v_pk_mul_f32 v[38:39], v[38:39], v[98:99]
    v_cvt_pk_bf16_f32 v60, v20, v21
    v_cvt_pk_bf16_f32 v61, v22, v23
    v_cvt_pk_bf16_f32 v62, v24, v25
    v_cvt_pk_bf16_f32 v63, v26, v27
    v_cvt_pk_bf16_f32 v64, v28, v29
    v_cvt_pk_bf16_f32 v65, v30, v31
    v_cvt_pk_bf16_f32 v66, v32, v33
    v_cvt_pk_bf16_f32 v67, v34, v35
    v_cvt_pk_bf16_f32 v68, v36, v37
    v_cvt_pk_bf16_f32 v69, v38, v39
    v_or_b32 v70, s66, v1
    v_or_b32 v71, s66, v4
    s_add_u32 s82, s56, 22020096
    s_add_u32 s83, s57, 22020096
    s_cmp_eq_u32 s50, 0
    s_cbranch_scc1 SLOW_7
    buffer_store_dwordx4 v[60:63], v1, s[8:11], s82 offen
    buffer_store_dwordx4 v[64:67], v1, s[8:11], s82 offen offset:1024
    buffer_store_dwordx2 v[68:69], v4, s[8:11], s83 offen
BACK_7:
    s_add_u32 s82, s56, 31457280
    s_add_u32 s83, s57, 31457280
    buffer_store_dwordx4 v[60:63], v70, s[8:11], s82 offen sc1
    buffer_store_dwordx4 v[64:67], v70, s[8:11], s82 offen offset:1024 sc1
    buffer_store_dwordx2 v[68:69], v71, s[8:11], s83 offen sc1
    v_pk_add_f32 v[20:21], v[40:41], v[76:77] op_sel_hi:[1,0]
    v_pk_add_f32 v[22:23], v[42:43], v[76:77] op_sel_hi:[1,0]
    v_pk_add_f32 v[24:25], v[44:45], v[76:77] op_sel_hi:[1,0]
    v_pk_add_f32 v[26:27], v[46:47], v[76:77] op_sel_hi:[1,0]
    v_pk_add_f32 v[28:29], v[48:49], v[76:77] op_sel_hi:[1,0]
    v_pk_add_f32 v[30:31], v[50:51], v[76:77] op_sel_hi:[1,0]
    v_pk_add_f32 v[32:33], v[52:53], v[76:77] op_sel_hi:[1,0]
    v_pk_add_f32 v[34:35], v[54:55], v[76:77] op_sel_hi:[1,0]
    v_pk_add_f32 v[36:37], v[56:57], v[76:77] op_sel_hi:[1,0]
    v_pk_add_f32 v[38:39], v[58:59], v[76:77] op_sel_hi:[1,0]
    v_pk_mul_f32 v[20:21], v[20:21], v[78:79] op_sel_hi:[1,0]
    v_pk_mul_f32 v[22:23], v[22:23], v[78:79] op_sel_hi:[1,0]
    v_pk_mul_f32 v[24:25], v[24:25], v[78:79] op_sel_hi:[1,0]
    v_pk_mul_f32 v[26:27], v[26:27], v[78:79] op_sel_hi:[1,0]
    v_pk_mul_f32 v[28:29], v[28:29], v[78:79] op_sel_hi:[1,0]
    v_pk_mul_f32 v[30:31], v[30:31], v[78:79] op_sel_hi:[1,0]
    v_pk_mul_f32 v[32:33], v[32:33], v[78:79] op_sel_hi:[1,0]
    v_pk_mul_f32 v[34:35], v[34:35], v[78:79] op_sel_hi:[1,0]
    v_pk_mul_f32 v[36:37], v[36:37], v[78:79] op_sel_hi:[1,0]
    v_pk_mul_f32 v[38:39], v[38:39], v[78:79] op_sel_hi:[1,0]
    s_lshl_b32 s85, s51, 4
    v_and_b32 v84, 15, v0
    v_add_u32 v84, s85, v84
    v_lshrrev_b32 v85, 4, v0
    v_lshlrev_b32 v85, 8, v85
    v_mov_b32 v88, 2147483648
    v_mov_b32 v89, 9437184
    v_add_u32 v86, -1, v84
    v_lshrrev_b32 v87, 4, v86
    v_and_b32 v87, 0xff, v87
    v_mul_u32_u24 v87, 20480, v87
    v_and_b32 v168, 15, v86
    v_lshl_add_u32 v168, v168, 4, v87
    v_add_u32 v168, v168, v85
    v_lshrrev_b32 v87, 8, v86
    v_cmp_ne_u32 vcc, s44, v87
    s_nop 1
    v_cndmask_b32 v87, 0, v89, vcc
    v_add_u32 v168, v168, v87
    v_cmp_gt_u32 vcc, 0x800, v86
    s_nop 1
    v_cndmask_b32 v168, v88, v168, vcc
    v_add_u32 v86, 1, v84
    v_lshrrev_b32 v87, 4, v86
    v_and_b32 v87, 0xff, v87
    v_mul_u32_u24 v87, 20480, v87
    v_and_b32 v169, 15, v86
    v_lshl_add_u32 v169, v169, 4, v87
    v_add_u32 v169, v169, v85
    v_lshrrev_b32 v87, 8, v86
    v_cmp_ne_u32 vcc, s44, v87
    s_nop 1
    v_cndmask_b32 v87, 0, v89, vcc
    v_add_u32 v169, v169, v87
    v_cmp_gt_u32 vcc, 0x800, v86
    s_nop 1
    v_cndmask_b32 v169, v88, v169, vcc
    s_waitcnt vmcnt(3)
    v_mov_b32 v7, 2
    v_mov_b32 v18, 0
    s_mov_b64 exec, 1
    s_cmp_eq_u32 s50, 0
    s_cbranch_scc1 SLOW_8
    buffer_store_dword v7, v18, s[8:11], s76 offen
BACK_8:
    s_mov_b64 exec, -1
    v_add_u32 v86, -2, v84
    v_lshrrev_b32 v87, 4, v86
    v_and_b32 v87, 0xff, v87
    v_mul_u32_u24 v87, 20480, v87
    v_and_b32 v170, 15, v86
    v_lshl_add_u32 v170, v170, 4, v87
    v_add_u32 v170, v170, v85
    v_lshrrev_b32 v87, 8, v86
    v_cmp_ne_u32 vcc, s44, v87
    s_nop 1
    v_cndmask_b32 v87, 0, v89, vcc
    v_add_u32 v170, v170, v87
    v_cmp_gt_u32 vcc, 0x800, v86
    s_nop 1
    v_cndmask_b32 v170, v88, v170, vcc
    v_add_u32 v86, 2, v84
    v_lshrrev_b32 v87, 4, v86
    v_and_b32 v87, 0xff, v87
    v_mul_u32_u24 v87, 20480, v87
    v_and_b32 v171, 15, v86
    v_lshl_add_u32 v171, v171, 4, v87
    v_add_u32 v171, v171, v85
    v_lshrrev_b32 v87, 8, v86
    v_cmp_ne_u32 vcc, s44, v87
    s_nop 1
    v_cndmask_b32 v87, 0, v89, vcc
    v_add_u32 v171, v171, v87
    v_cmp_gt_u32 vcc, 0x800, v86
    s_nop 1
    v_cndmask_b32 v171, v88, v171, vcc
    s_barrier
    ds_read_b128 v[128:131], v1 offset:20480
    ds_read_b128 v[132:135], v1 offset:21504
    ds_read_b128 v[136:139], v1 offset:22528
    ds_read_b128 v[140:143], v1 offset:23552
    ds_read_b128 v[144:147], v1 offset:24576
    ds_read_b128 v[148:151], v1 offset:25600
    ds_read_b128 v[152:155], v1 offset:26624
    ds_read_b128 v[156:159], v1 offset:27648
    s_add_u32 m0, s63, 61440
    s_add_u32 s93, s60, 5324800
    buffer_load_dwordx4 v1, s[8:11], s93 offen offset:0  lds
    buffer_load_dwordx4 v1, s[8:11], s93 offen offset:1024  lds
    buffer_load_dwordx4 v1, s[8:11], s93 offen offset:2048  lds
    buffer_load_dwordx4 v1, s[8:11], s93 offen offset:3072  lds
    s_add_u32 m0, m0, 4096
    s_add_u32 s93, s93, 4096
    buffer_load_dwordx4 v1, s[8:11], s93 offen offset:0  lds
    s_and_b32 s90, s51, 15
    s_cmp_eq_u32 s90, 0
    s_cselect_b32 s86, 32, 0
    s_cmp_eq_u32 s90, 15
    s_cselect_b32 s87, 32, 64
    v_and_b32 v84, 7, v0
    v_lshlrev_b32 v84, 2, v84
    v_lshrrev_b32 v86, 3, v0
    v_mov_b32 v85, 32
    v_mov_b32 v87, s86
    v_mov_b32 v88, s87
    v_cmp_eq_u32 vcc, 1, v86
    s_nop 1
    v_cndmask_b32 v85, v85, v87, vcc
    v_cmp_eq_u32 vcc, 2, v86
    s_nop 1
    v_cndmask_b32 v85, v85, v88, vcc
    v_add_u32 v85, v85, v84
    s_lshl_b32 s85, s51, 5
    s_add_u32 s85, s85, 13635552
    v_min_u32 v84, 59, v0
    v_add_u32 v87, -20, v84
    v_lshrrev_b32 v88, 1, v87
    v_add_u32 v88, 40, v88
    v_and_b32 v87, 1, v87
    s_xor_b32 s86, s80, 1
    v_cmp_gt_u32 vcc, 20, v84
    s_nop 1
    v_cndmask_b32 v88, v88, v84, vcc
    v_mov_b32 v89, s86
    v_cndmask_b32 v87, v87, v89, vcc
    v_lshlrev_b32 v86, 8, v88
    v_lshl_add_u32 v86, v87, 4, v86
    v_or_b32 v86, s66, v86
    s_cmp_eq_u32 s80, 1
    s_mov_b32 s86, 31437024
    s_cselect_b32 s86, 31482880, s86
    s_add_u32 s86, s86, s58
    s_mov_b32 s92, s67
POLL_16:
    buffer_load_dword v7, v85, s[8:11], s85 offen sc1
    buffer_load_dwordx4 v[88:91], v86, s[8:11], s86 offen sc1
    s_waitcnt vmcnt(0)
    v_max3_u32 v88, v88, v89, v90
    v_max_u32 v88, v88, v91
    v_cmp_le_u32 vcc, 2, v7
    v_cmp_ne_u32 s[6:7], -1, v88
    s_nop 0
    s_and_b64 vcc, vcc, s[6:7]
    s_cmp_eq_u64 vcc, -1
    s_cbranch_scc1 PDONE_17
    s_sub_u32 s92, s92, 1
    s_cbranch_scc0 POLL_16
    s_mov_b32 s67, 0
PDONE_17:
    s_mov_b32 s85, 0
    s_add_u32 s84, s85, 22020096
    buffer_load_dwordx4 v[80:83], v168, s[8:11], s84 offen offset:0 sc1
    buffer_load_dwordx4 v[84:87], v168, s[8:11], s84 offen offset:1024 sc1
    buffer_load_dwordx4 v[88:91], v168, s[8:11], s84 offen offset:2048 sc1
    buffer_load_dwordx4 v[92:95], v168, s[8:11], s84 offen offset:3072 sc1
    s_add_u32 s84, s85, 22024192
    buffer_load_dwordx4 v[96:99], v168, s[8:11], s84 offen offset:0 sc1
    buffer_load_dwordx4 v[100:103], v169, s[8:11], s84 offen offset:1024 sc1
    buffer_load_dwordx4 v[104:107], v169, s[8:11], s84 offen offset:2048 sc1
    buffer_load_dwordx4 v[108:111], v169, s[8:11], s84 offen offset:3072 sc1
    s_waitcnt vmcnt(7) lgkmcnt(6)
    v_mfma_f32_16x16x32_bf16 v[20:23], v[128:131], v[80:83], v[20:23]
    ds_read_b128 v[160:163], v1 offset:28672
    s_add_u32 s84, s85, 22028288
    buffer_load_dwordx4 v[112:115], v169, s[8:11], s84 offen offset:0 sc1
    v_mfma_f32_16x16x32_bf16 v[24:27], v[132:135], v[80:83], v[24:27]
    ds_read_b128 v[164:167], v1 offset:29696
    s_waitcnt lgkmcnt(6)
    v_mfma_f32_16x16x32_bf16 v[28:31], v[136:139], v[80:83], v[28:31]
    ds_read_b128 v[128:131], v1 offset:30720
    v_mfma_f32_16x16x32_bf16 v[32:35], v[140:143], v[80:83], v[32:35]
    ds_read_b128 v[132:135], v1 offset:31744
    s_waitcnt lgkmcnt(6)
    v_mfma_f32_16x16x32_bf16 v[36:39], v[144:147], v[80:83], v[36:39]
    ds_read_b128 v[136:139], v1 offset:32768
    buffer_load_dwordx4 v[116:119], v169, s[8:11], s84 offen offset:1024 sc1
    s_waitcnt vmcnt(8)
    v_mfma_f32_16x16x32_bf16 v[20:23], v[148:151], v[84:87], v[20:23]
    ds_read_b128 v[140:143], v1 offset:33792
    s_waitcnt lgkmcnt(6)
    v_mfma_f32_16x16x32_bf16 v[24:27], v[152:155], v[84:87], v[24:27]
    ds_read_b128 v[144:147], v1 offset:34816
    v_mfma_f32_16x16x32_bf16 v[28:31], v[156:159], v[84:87], v[28:31]
    ds_read_b128 v[148:151], v1 offset:35840
    s_waitcnt lgkmcnt(6)
    v_mfma_f32_16x16x32_bf16 v[32:35], v[160:163], v[84:87], v[32:35]
    ds_read_b128 v[152:155], v1 offset:36864
    buffer_load_dwordx4 v[120:123], v170, s[8:11], s84 offen offset:2048 sc1
    v_mfma_f32_16x16x32_bf16 v[36:39], v[164:167], v[84:87], v[36:39]
    ds_read_b128 v[156:159], v1 offset:37888
    s_waitcnt vmcnt(8) lgkmcnt(6)
    v_mfma_f32_16x16x32_bf16 v[20:23], v[128:131], v[88:91], v[20:23]
    ds_read_b128 v[160:163], v1 offset:38912
    v_mfma_f32_16x16x32_bf16 v[24:27], v[132:135], v[88:91], v[24:27]
    ds_read_b128 v[164:167], v1 offset:39936
    s_waitcnt lgkmcnt(6)
    v_mfma_f32_16x16x32_bf16 v[28:31], v[136:139], v[88:91], v[28:31]
    ds_read_b128 v[128:131], v1 offset:40960
    buffer_load_dwordx4 v[124:127], v170, s[8:11], s84 offen offset:3072 sc1
    v_mfma_f32_16x16x32_bf16 v[32:35], v[140:143], v[88:91], v[32:35]
    ds_read_b128 v[132:135], v1 offset:41984
    s_waitcnt lgkmcnt(6)
    v_mfma_f32_16x16x32_bf16 v[36:39], v[144:147], v[88:91], v[36:39]
    ds_read_b128 v[136:139], v1 offset:43008
    s_waitcnt vmcnt(8)
    v_mfma_f32_16x16x32_bf16 v[20:23], v[148:151], v[92:95], v[20:23]
    ds_read_b128 v[140:143], v1 offset:44032
    s_waitcnt lgkmcnt(6)
    v_mfma_f32_16x16x32_bf16 v[24:27], v[152:155], v[92:95], v[24:27]
    ds_read_b128 v[144:147], v1 offset:45056
    s_add_u32 s84, s85, 22032384
    buffer_load_dwordx4 v[80:83], v170, s[8:11], s84 offen offset:0 sc1
    v_mfma_f32_16x16x32_bf16 v[28:31], v[156:159], v[92:95], v[28:31]
    ds_read_b128 v[148:151], v1 offset:46080
    s_waitcnt lgkmcnt(6)
    v_mfma_f32_16x16x32_bf16 v[32:35], v[160:163], v[92:95], v[32:35]
    ds_read_b128 v[152:155], v1 offset:47104
    v_mfma_f32_16x16x32_bf16 v[36:39], v[164:167], v[92:95], v[36:39]
    ds_read_b128 v[156:159], v1 offset:48128
    s_waitcnt vmcnt(8) lgkmcnt(6)
    v_mfma_f32_16x16x32_bf16 v[20:23], v[128:131], v[96:99], v[20:23]
    ds_read_b128 v[160:163], v1 offset:49152
    buffer_load_dwordx4 v[84:87], v170, s[8:11], s84 offen offset:1024 sc1
    v_mfma_f32_16x16x32_bf16 v[24:27], v[132:135], v[96:99], v[24:27]
    ds_read_b128 v[164:167], v1 offset:50176
    s_waitcnt lgkmcnt(6)
    v_mfma_f32_16x16x32_bf16 v[28:31], v[136:139], v[96:99], v[28:31]
    ds_read_b128 v[128:131], v1 offset:51200
    v_mfma_f32_16x16x32_bf16 v[32:35], v[140:143], v[96:99], v[32:35]
    ds_read_b128 v[132:135], v1 offset:52224
    s_waitcnt lgkmcnt(6)
    v_mfma_f32_16x16x32_bf16 v[36:39], v[144:147], v[96:99], v[36:39]
    ds_read_b128 v[136:139], v1 offset:53248
    buffer_load_dwordx4 v[88:91], v170, s[8:11], s84 offen offset:2048 sc1
    s_waitcnt vmcnt(9)
    v_mfma_f32_16x16x32_bf16 v[20:23], v[148:151], v[100:103], v[20:23]
    ds_read_b128 v[140:143], v1 offset:54272
    s_waitcnt lgkmcnt(6)
    v_mfma_f32_16x16x32_bf16 v[24:27], v[152:155], v[100:103], v[24:27]
    ds_read_b128 v[144:147], v1 offset:55296
    v_mfma_f32_16x16x32_bf16 v[28:31], v[156:159], v[100:103], v[28:31]
    ds_read_b128 v[148:151], v1 offset:56320
    s_waitcnt lgkmcnt(6)
    v_mfma_f32_16x16x32_bf16 v[32:35], v[160:163], v[100:103], v[32:35]
    ds_read_b128 v[152:155], v1 offset:57344
    buffer_load_dwordx4 v[92:95], v171, s[8:11], s84 offen offset:3072 sc1
    v_mfma_f32_16x16x32_bf16 v[36:39], v[164:167], v[100:103], v[36:39]
    ds_read_b128 v[156:159], v1 offset:58368
    s_waitcnt vmcnt(9) lgkmcnt(6)
    v_mfma_f32_16x16x32_bf16 v[20:23], v[128:131], v[104:107], v[20:23]
    ds_read_b128 v[160:163], v1 offset:59392
    v_mfma_f32_16x16x32_bf16 v[24:27], v[132:135], v[104:107], v[24:27]
    ds_read_b128 v[164:167], v1 offset:60416
    s_waitcnt lgkmcnt(6)
    v_mfma_f32_16x16x32_bf16 v[28:31], v[136:139], v[104:107], v[28:31]
    ds_read_b128 v[128:131], v2 offset:36864
    s_add_u32 s84, s85, 22036480
    buffer_load_dwordx4 v[96:99], v171, s[8:11], s84 offen offset:0 sc1
    v_mfma_f32_16x16x32_bf16 v[32:35], v[140:143], v[104:107], v[32:35]
    ds_read_b128 v[132:135], v2 offset:37888
    s_waitcnt lgkmcnt(6)
    v_mfma_f32_16x16x32_bf16 v[36:39], v[144:147], v[104:107], v[36:39]
    ds_read_b128 v[136:139], v2 offset:38912
    s_waitcnt vmcnt(9)
    v_mfma_f32_16x16x32_bf16 v[20:23], v[148:151], v[108:111], v[20:23]
    ds_read_b128 v[140:143], v2 offset:39936
    s_waitcnt lgkmcnt(6)
    v_mfma_f32_16x16x32_bf16 v[24:27], v[152:155], v[108:111], v[24:27]
    ds_read_b128 v[144:147], v2 offset:40960
    buffer_load_dwordx4 v[100:103], v171, s[8:11], s84 offen offset:1024 sc1
    v_mfma_f32_16x16x32_bf16 v[28:31], v[156:159], v[108:111], v[28:31]
    ds_read_b128 v[148:151], v2 offset:41984
    s_waitcnt lgkmcnt(6)
    v_mfma_f32_16x16x32_bf16 v[32:35], v[160:163], v[108:111], v[32:35]
    ds_read_b128 v[152:155], v2 offset:43008
    v_mfma_f32_16x16x32_bf16 v[36:39], v[164:167], v[108:111], v[36:39]
    ds_read_b128 v[156:159], v2 offset:44032
    s_waitcnt vmcnt(9) lgkmcnt(6)
    v_mfma_f32_16x16x32_bf16 v[20:23], v[128:131], v[112:115], v[20:23]
    ds_read_b128 v[160:163], v2 offset:45056
    buffer_load_dwordx4 v[104:107], v171, s[8:11], s84 offen offset:2048 sc1
    v_mfma_f32_16x16x32_bf16 v[24:27], v[132:135], v[112:115], v[24:27]
    ds_read_b128 v[164:167], v2 offset:46080
    s_waitcnt lgkmcnt(6)
    v_mfma_f32_16x16x32_bf16 v[28:31], v[136:139], v[112:115], v[28:31]
    ds_read_b128 v[128:131], v2 offset:47104
    v_mfma_f32_16x16x32_bf16 v[32:35], v[140:143], v[112:115], v[32:35]
    ds_read_b128 v[132:135], v2 offset:48128
    s_waitcnt lgkmcnt(6)
    v_mfma_f32_16x16x32_bf16 v[36:39], v[144:147], v[112:115], v[36:39]
    ds_read_b128 v[136:139], v2 offset:49152
    buffer_load_dwordx4 v[108:111], v171, s[8:11], s84 offen offset:3072 sc1
    s_waitcnt vmcnt(10)
    v_mfma_f32_16x16x32_bf16 v[20:23], v[148:151], v[116:119], v[20:23]
    ds_read_b128 v[140:143], v2 offset:50176
    s_waitcnt lgkmcnt(6)
    v_mfma_f32_16x16x32_bf16 v[24:27], v[152:155], v[116:119], v[24:27]
    ds_read_b128 v[144:147], v2 offset:51200
    v_mfma_f32_16x16x32_bf16 v[28:31], v[156:159], v[116:119], v[28:31]
    ds_read_b128 v[148:151], v2 offset:52224
    s_waitcnt lgkmcnt(6)
    v_mfma_f32_16x16x32_bf16 v[32:35], v[160:163], v[116:119], v[32:35]
    ds_read_b128 v[152:155], v2 offset:53248
    v_mfma_f32_16x16x32_bf16 v[36:39], v[164:167], v[116:119], v[36:39]
    ds_read_b128 v[156:159], v2 offset:54272
    s_waitcnt vmcnt(9) lgkmcnt(6)
    v_mfma_f32_16x16x32_bf16 v[20:23], v[128:131], v[120:123], v[20:23]
    ds_read_b128 v[160:163], v2 offset:55296
    s_getpc_b64 s[4:5]
PCL_18:
    s_lshl_b32 s6, s45, 2
    s_add_u32 s6, s6, s49
    s_and_b32 s6, s6, 31
    s_lshl_b32 s6, s6, 10
    v_add_u32 v19, s6, v1
    v_min_u32 v19, CODE_END-PCL_18-16, v19
    global_load_dword a253, v19, s[4:5]
    v_mfma_f32_16x16x32_bf16 v[24:27], v[132:135], v[120:123], v[24:27]
    ds_read_b128 v[164:167], v2 offset:56320
    s_waitcnt lgkmcnt(6)
    v_mfma_f32_16x16x32_bf16 v[28:31], v[136:139], v[120:123], v[28:31]
    ds_read_b128 v[128:131], v2 offset:57344
    v_mfma_f32_16x16x32_bf16 v[32:35], v[140:143], v[120:123], v[32:35]
    ds_read_b128 v[132:135], v2 offset:58368
    s_waitcnt lgkmcnt(6)
    v_mfma_f32_16x16x32_bf16 v[36:39], v[144:147], v[120:123], v[36:39]
    ds_read_b128 v[136:139], v2 offset:59392
    s_add_u32 m0, s63, 81920
    s_add_u32 s93, s61, 8388608
    buffer_load_dwordx4 v1, s[8:11], s93 offen offset:0  lds
    s_waitcnt vmcnt(10)
    v_mfma_f32_16x16x32_bf16 v[20:23], v[148:151], v[124:127], v[20:23]
    ds_read_b128 v[140:143], v2 offset:60416
    s_waitcnt lgkmcnt(6)
    v_mfma_f32_16x16x32_bf16 v[24:27], v[152:155], v[124:127], v[24:27]
    ds_read_b128 v[144:147], v2 offset:61440
    v_mfma_f32_16x16x32_bf16 v[28:31], v[156:159], v[124:127], v[28:31]
    ds_read_b128 v[148:151], v2 offset:62464
    s_waitcnt lgkmcnt(6)
    v_mfma_f32_16x16x32_bf16 v[32:35], v[160:163], v[124:127], v[32:35]
    ds_read_b128 v[152:155], v2 offset:63488
    buffer_load_dwordx4 v1, s[8:11], s93 offen offset:1024  lds
    v_mfma_f32_16x16x32_bf16 v[36:39], v[164:167], v[124:127], v[36:39]
    ds_read_b128 v[156:159], v2 offset:64512
    s_waitcnt vmcnt(10) lgkmcnt(6)
    v_mfma_f32_16x16x32_bf16 v[20:23], v[128:131], v[80:83], v[20:23]
    ds_read_b128 v[160:163], v3 offset:0
    v_mfma_f32_16x16x32_bf16 v[24:27], v[132:135], v[80:83], v[24:27]
    ds_read_b128 v[164:167], v3 offset:1024
    s_waitcnt lgkmcnt(6)
    v_mfma_f32_16x16x32_bf16 v[28:31], v[136:139], v[80:83], v[28:31]
    ds_read_b128 v[128:131], v3 offset:2048
    buffer_load_dwordx4 v1, s[8:11], s93 offen offset:2048  lds
    v_mfma_f32_16x16x32_bf16 v[32:35], v[140:143], v[80:83], v[32:35]
    ds_read_b128 v[132:135], v3 offset:3072
    s_waitcnt lgkmcnt(6)
    v_mfma_f32_16x16x32_bf16 v[36:39], v[144:147], v[80:83], v[36:39]
    ds_read_b128 v[136:139], v3 offset:4096
    s_waitcnt vmcnt(10)
    v_mfma_f32_16x16x32_bf16 v[20:23], v[148:151], v[84:87], v[20:23]
    ds_read_b128 v[140:143], v3 offset:5120
    s_waitcnt lgkmcnt(6)
    v_mfma_f32_16x16x32_bf16 v[24:27], v[152:155], v[84:87], v[24:27]
    ds_read_b128 v[144:147], v3 offset:6144
    buffer_load_dwordx4 v1, s[8:11], s93 offen offset:3072  lds
    v_mfma_f32_16x16x32_bf16 v[28:31], v[156:159], v[84:87], v[28:31]
    ds_read_b128 v[148:151], v3 offset:7168
    s_waitcnt lgkmcnt(6)
    v_mfma_f32_16x16x32_bf16 v[32:35], v[160:163], v[84:87], v[32:35]
    s_barrier
    ds_read_b128 v[152:155], v3 offset:8192
    v_mfma_f32_16x16x32_bf16 v[36:39], v[164:167], v[84:87], v[36:39]
    ds_read_b128 v[156:159], v3 offset:9216
    s_waitcnt vmcnt(10) lgkmcnt(6)
    v_mfma_f32_16x16x32_bf16 v[20:23], v[128:131], v[88:91], v[20:23]
    ds_read_b128 v[160:163], v3 offset:10240
    s_add_u32 m0, m0, 4096
    s_add_u32 s93, s93, 4096
    buffer_load_dwordx4 v1, s[8:11], s93 offen offset:0  lds
    v_mfma_f32_16x16x32_bf16 v[24:27], v[132:135], v[88:91], v[24:27]
    ds_read_b128 v[164:167], v3 offset:11264
    s_waitcnt lgkmcnt(6)
    v_mfma_f32_16x16x32_bf16 v[28:31], v[136:139], v[88:91], v[28:31]
    ds_read_b128 v[128:131], v1 offset:61440
    v_mfma_f32_16x16x32_bf16 v[32:35], v[140:143], v[88:91], v[32:35]
    ds_read_b128 v[132:135], v1 offset:62464
    s_waitcnt lgkmcnt(6)
    v_mfma_f32_16x16x32_bf16 v[36:39], v[144:147], v[88:91], v[36:39]
    ds_read_b128 v[136:139], v1 offset:63488
    s_add_u32 m0, s63, 143360
    s_add_u32 s93, s61, 8409088
    buffer_load_dwordx4 v1, s[8:11], s93 offen offset:0  lds
    s_waitcnt vmcnt(11)
    v_mfma_f32_16x16x32_bf16 v[20:23], v[148:151], v[92:95], v[20:23]
    ds_read_b128 v[140:143], v1 offset:64512
    s_waitcnt lgkmcnt(6)
    v_mfma_f32_16x16x32_bf16 v[24:27], v[152:155], v[92:95], v[24:27]
    ds_read_b128 v[144:147], v2 offset:0
    v_mfma_f32_16x16x32_bf16 v[28:31], v[156:159], v[92:95], v[28:31]
    ds_read_b128 v[148:151], v2 offset:1024
    s_waitcnt lgkmcnt(6)
    v_mfma_f32_16x16x32_bf16 v[32:35], v[160:163], v[92:95], v[32:35]
    ds_read_b128 v[152:155], v2 offset:2048
    buffer_load_dwordx4 v1, s[8:11], s93 offen offset:1024  lds
    v_mfma_f32_16x16x32_bf16 v[36:39], v[164:167], v[92:95], v[36:39]
    ds_read_b128 v[156:159], v2 offset:3072
    s_waitcnt vmcnt(11) lgkmcnt(6)
    v_mfma_f32_16x16x32_bf16 v[20:23], v[128:131], v[96:99], v[20:23]
    ds_read_b128 v[160:163], v2 offset:4096
    v_mfma_f32_16x16x32_bf16 v[24:27], v[132:135], v[96:99], v[24:27]
    ds_read_b128 v[164:167], v2 offset:5120
    s_waitcnt lgkmcnt(6)
    v_mfma_f32_16x16x32_bf16 v[28:31], v[136:139], v[96:99], v[28:31]
    ds_read_b128 v[128:131], v2 offset:6144
    buffer_load_dwordx4 v1, s[8:11], s93 offen offset:2048  lds
    v_mfma_f32_16x16x32_bf16 v[32:35], v[140:143], v[96:99], v[32:35]
    ds_read_b128 v[132:135], v2 offset:7168
    s_waitcnt lgkmcnt(6)
    v_mfma_f32_16x16x32_bf16 v[36:39], v[144:147], v[96:99], v[36:39]
    ds_read_b128 v[136:139], v2 offset:8192
    s_waitcnt vmcnt(11)
    v_mfma_f32_16x16x32_bf16 v[20:23], v[148:151], v[100:103], v[20:23]
    ds_read_b128 v[140:143], v2 offset:9216
    s_waitcnt lgkmcnt(6)
    v_mfma_f32_16x16x32_bf16 v[24:27], v[152:155], v[100:103], v[24:27]
    ds_read_b128 v[144:147], v2 offset:10240
    buffer_load_dwordx4 v1, s[8:11], s93 offen offset:3072  lds
    v_mfma_f32_16x16x32_bf16 v[28:31], v[156:159], v[100:103], v[28:31]
    ds_read_b128 v[148:151], v2 offset:11264
    s_waitcnt lgkmcnt(6)
    v_mfma_f32_16x16x32_bf16 v[32:35], v[160:163], v[100:103], v[32:35]
    ds_read_b128 v[152:155], v2 offset:12288
    v_mfma_f32_16x16x32_bf16 v[36:39], v[164:167], v[100:103], v[36:39]
    ds_read_b128 v[156:159], v2 offset:13312
    s_waitcnt vmcnt(11) lgkmcnt(6)
    v_mfma_f32_16x16x32_bf16 v[20:23], v[128:131], v[104:107], v[20:23]
    ds_read_b128 v[160:163], v2 offset:14336
    s_add_u32 m0, m0, 4096
    s_add_u32 s93, s93, 4096
    buffer_load_dwordx4 v1, s[8:11], s93 offen offset:0  lds
    v_mfma_f32_16x16x32_bf16 v[24:27], v[132:135], v[104:107], v[24:27]
    ds_read_b128 v[164:167], v2 offset:15360
    s_waitcnt lgkmcnt(6)
    v_mfma_f32_16x16x32_bf16 v[28:31], v[136:139], v[104:107], v[28:31]
    v_mfma_f32_16x16x32_bf16 v[32:35], v[140:143], v[104:107], v[32:35]
    s_waitcnt lgkmcnt(4)
    v_mfma_f32_16x16x32_bf16 v[36:39], v[144:147], v[104:107], v[36:39]
    s_waitcnt vmcnt(11)
    v_mfma_f32_16x16x32_bf16 v[20:23], v[148:151], v[108:111], v[20:23]
    s_waitcnt lgkmcnt(2)
    v_mfma_f32_16x16x32_bf16 v[24:27], v[152:155], v[108:111], v[24:27]
    v_mfma_f32_16x16x32_bf16 v[28:31], v[156:159], v[108:111], v[28:31]
    s_waitcnt lgkmcnt(0)
    v_mfma_f32_16x16x32_bf16 v[32:35], v[160:163], v[108:111], v[32:35]
    v_mfma_f32_16x16x32_bf16 v[36:39], v[164:167], v[108:111], v[36:39]
    s_nop 1
    v_cvt_pk_bf16_f32 v60, v20, v21
    v_cvt_pk_bf16_f32 v61, v22, v23
    v_cvt_pk_bf16_f32 v62, v24, v25
    v_cvt_pk_bf16_f32 v63, v26, v27
    v_cvt_pk_bf16_f32 v64, v28, v29
    v_cvt_pk_bf16_f32 v65, v30, v31
    v_cvt_pk_bf16_f32 v66, v32, v33
    v_cvt_pk_bf16_f32 v67, v34, v35
    v_cvt_pk_bf16_f32 v68, v36, v37
    v_cvt_pk_bf16_f32 v69, v38, v39
    s_add_u32 s82, s52, 18874368
    s_add_u32 s83, s53, 18874368
    s_cmp_eq_u32 s50, 0
    s_cbranch_scc1 SLOW_9
    buffer_store_dwordx4 v[60:63], v1, s[8:11], s82 offen
    buffer_store_dwordx4 v[64:67], v1, s[8:11], s82 offen offset:1024
    buffer_store_dwordx2 v[68:69], v4, s[8:11], s83 offen
BACK_9:
    v_pk_add_f32 v[72:73], v[20:21], v[22:23]
    v_pk_mul_f32 v[74:75], v[20:21], v[20:21]
    v_pk_fma_f32 v[74:75], v[22:23], v[22:23], v[74:75]
    v_pk_add_f32 v[72:73], v[72:73], v[24:25]
    v_pk_fma_f32 v[74:75], v[24:25], v[24:25], v[74:75]
    v_pk_add_f32 v[72:73], v[72:73], v[26:27]
    v_pk_fma_f32 v[74:75], v[26:27], v[26:27], v[74:75]
    v_pk_add_f32 v[72:73], v[72:73], v[28:29]
    v_pk_fma_f32 v[74:75], v[28:29], v[28:29], v[74:75]
    v_pk_add_f32 v[72:73], v[72:73], v[30:31]
    v_pk_fma_f32 v[74:75], v[30:31], v[30:31], v[74:75]
    v_pk_add_f32 v[72:73], v[72:73], v[32:33]
    v_pk_fma_f32 v[74:75], v[32:33], v[32:33], v[74:75]
    v_pk_add_f32 v[72:73], v[72:73], v[34:35]
    v_pk_fma_f32 v[74:75], v[34:35], v[34:35], v[74:75]
    v_pk_add_f32 v[72:73], v[72:73], v[36:37]
    v_pk_fma_f32 v[74:75], v[36:37], v[36:37], v[74:75]
    v_pk_add_f32 v[72:73], v[72:73], v[38:39]
    v_pk_fma_f32 v[74:75], v[38:39], v[38:39], v[74:75]
    v_add_f32 v72, v72, v73
    v_add_f32 v74, v74, v75
    s_nop 1
    v_permlane32_swap_b32 v72, v74
    v_add_f32 v72, v72, v74
    v_mov_b32 v73, v72
    s_nop 1
    v_permlane16_swap_b32 v72, v73
    v_add_f32 v72, v72, v73
    v_and_or_b32 v72, v72, -4, 1
    s_add_u32 s82, s54, 18874368
    s_cmp_eq_u32 s50, 0
    s_cbranch_scc1 SLOW_10
    buffer_store_dword v72, v5, s[8:11], s82 offen
BACK_10:
    s_add_u32 s3, s81, 6291456
    buffer_load_dwordx4 a[0:3], v1, s[8:11], s3 offen
    s_add_u32 s3, s81, 6311936
    buffer_load_dwordx4 a[80:83], v1, s[8:11], s3 offen
    s_add_u32 s3, s81, 6332416
    buffer_load_dwordx4 a[160:163], v1, s[8:11], s3 offen
    s_add_u32 s3, s81, 6292480
    buffer_load_dwordx4 a[4:7], v1, s[8:11], s3 offen
    s_add_u32 s3, s81, 6312960
    buffer_load_dwordx4 a[84:87], v1, s[8:11], s3 offen
    s_add_u32 s3, s81, 6333440
    buffer_load_dwordx4 a[164:167], v1, s[8:11], s3 offen
    v_pk_add_f32 v[40:41], v[40:41], v[20:21]
    v_pk_add_f32 v[42:43], v[42:43], v[22:23]
    v_pk_add_f32 v[44:45], v[44:45], v[24:25]
    v_pk_add_f32 v[46:47], v[46:47], v[26:27]
    v_pk_add_f32 v[48:49], v[48:49], v[28:29]
    v_pk_add_f32 v[50:51], v[50:51], v[30:31]
    v_pk_add_f32 v[52:53], v[52:53], v[32:33]
    v_pk_add_f32 v[54:55], v[54:55], v[34:35]
    v_pk_add_f32 v[56:57], v[56:57], v[36:37]
    v_pk_add_f32 v[58:59], v[58:59], v[38:39]
    s_waitcnt vmcnt(7)
    v_mov_b32 v7, 3
    v_mov_b32 v18, 0
    s_mov_b64 exec, 1
    s_cmp_eq_u32 s50, 0
    s_cbranch_scc1 SLOW_11
    buffer_store_dword v7, v18, s[8:11], s76 offen
BACK_11:
    s_mov_b64 exec, -1
    s_barrier
    s_lshl_b32 s85, s48, 7
    s_add_u32 s85, s85, 13635584
    v_mov_b32 v32, 0x3f803f80
    v_mov_b32 v33, 0x3f803f80
    v_mov_b32 v34, 0x3f803f80
    v_mov_b32 v35, 0x3f803f80
    s_mov_b32 s88, 20480
    s_cmp_eq_u32 s49, 1
    s_cselect_b32 s88, 40960, s88
    s_cmp_eq_u32 s49, 2
    s_cselect_b32 s88, 102400, s88
    s_cmp_eq_u32 s49, 3
    s_cselect_b32 s88, 122880, s88
    s_mov_b32 s92, s67
POLL_21:
    buffer_load_dword v7, v6, s[8:11], s85 offen sc1
    s_waitcnt vmcnt(0)
    v_cmp_le_u32 vcc, 3, v7
    s_nop 0
    s_cmp_eq_u64 vcc, -1
    s_cbranch_scc1 PDONE_22
    s_sub_u32 s92, s92, 1
    s_cbranch_scc0 POLL_21
    s_mov_b32 s67, 0
PDONE_22:
    s_add_u32 m0, s88, 0
    s_add_u32 s93, s55, 18874368
    buffer_load_dwordx4 v1, s[8:11], s93 offen offset:0 sc1 lds
    buffer_load_dwordx4 v1, s[8:11], s93 offen offset:1024 sc1 lds
    buffer_load_dwordx4 v1, s[8:11], s93 offen offset:2048 sc1 lds
    buffer_load_dwordx4 v1, s[8:11], s93 offen offset:3072 sc1 lds
    s_add_u32 m0, m0, 4096
    s_add_u32 s93, s93, 4096
    buffer_load_dwordx4 v1, s[8:11], s93 offen offset:0 sc1 lds
    s_add_u32 m0, s88, 5120
    s_add_u32 s93, s55, 18879488
    buffer_load_dwordx4 v1, s[8:11], s93 offen offset:0 sc1 lds
    buffer_load_dwordx4 v1, s[8:11], s93 offen offset:1024 sc1 lds
    buffer_load_dwordx4 v1, s[8:11], s93 offen offset:2048 sc1 lds
    buffer_load_dwordx4 v1, s[8:11], s93 offen offset:3072 sc1 lds
    s_add_u32 m0, m0, 4096
    s_add_u32 s93, s93, 4096
    buffer_load_dwordx4 v1, s[8:11], s93 offen offset:0 sc1 lds
    s_add_u32 s3, s81, 6293504
    buffer_load_dwordx4 a[8:11], v1, s[8:11], s3 offen
    s_add_u32 s3, s81, 6313984
    buffer_load_dwordx4 a[88:91], v1, s[8:11], s3 offen
    s_add_u32 s3, s81, 6334464
    buffer_load_dwordx4 a[168:171], v1, s[8:11], s3 offen
    s_add_u32 s3, s81, 6294528
    buffer_load_dwordx4 a[12:15], v1, s[8:11], s3 offen
    s_add_u32 s3, s81, 6315008
    buffer_load_dwordx4 a[92:95], v1, s[8:11], s3 offen
    s_add_u32 s3, s81, 6335488
    buffer_load_dwordx4 a[172:175], v1, s[8:11], s3 offen
    s_add_u32 s3, s81, 6295552
    buffer_load_dwordx4 a[16:19], v1, s[8:11], s3 offen
    s_add_u32 s3, s81, 6316032
    buffer_load_dwordx4 a[96:99], v1, s[8:11], s3 offen
    s_add_u32 s3, s81, 6336512
    buffer_load_dwordx4 a[176:179], v1, s[8:11], s3 offen
    s_waitcnt vmcnt(14)
    s_barrier
    ds_read_b128 v[128:131], v1 offset:20480
    ds_read_b128 v[132:135], v1 offset:40960
    ds_read_b128 v[136:139], v2 offset:36864
    ds_read_b128 v[140:143], v2 offset:57344
    ds_read_b128 v[144:147], v1 offset:21504
    ds_read_b128 v[148:151], v1 offset:41984
    s_waitcnt lgkmcnt(5)
    v_mfma_f32_16x16x32_bf16 v[80:83], a[0:3], v[128:131], 0
    ds_read_b128 v[152:155], v2 offset:37888
    v_mfma_f32_16x16x32_bf16 v[84:87], a[80:83], v[128:131], 0
    s_add_u32 s3, s81, 6296576
    buffer_load_dwordx4 a[20:23], v1, s[8:11], s3 offen
    v_mfma_f32_16x16x32_bf16 v[88:91], a[160:163], v[128:131], 0
    s_waitcnt lgkmcnt(5)
    v_mfma_f32_16x16x32_bf16 v[92:95], a[0:3], v[132:135], 0
    ds_read_b128 v[156:159], v2 offset:58368
    v_mfma_f32_16x16x32_bf16 v[96:99], a[80:83], v[132:135], 0
    s_add_u32 s3, s81, 6317056
    buffer_load_dwordx4 a[100:103], v1, s[8:11], s3 offen
    v_mfma_f32_16x16x32_bf16 v[100:103], a[160:163], v[132:135], 0
    s_waitcnt lgkmcnt(5)
    v_mfma_f32_16x16x32_bf16 v[104:107], a[0:3], v[136:139], 0
    ds_read_b128 v[128:131], v1 offset:22528
    v_mfma_f32_16x16x32_bf16 v[108:111], a[80:83], v[136:139], 0
    s_add_u32 s3, s81, 6337536
    buffer_load_dwordx4 a[180:183], v1, s[8:11], s3 offen
    v_mfma_f32_16x16x32_bf16 v[112:115], a[160:163], v[136:139], 0
    s_waitcnt lgkmcnt(5)
    v_mfma_f32_16x16x32_bf16 v[116:119], a[0:3], v[140:143], 0
    ds_read_b128 v[132:135], v1 offset:43008
    v_mfma_f32_16x16x32_bf16 v[120:123], a[80:83], v[140:143], 0
    v_mfma_f32_16x16x32_bf16 v[124:127], a[160:163], v[140:143], 0
    v_mfma_f32_16x16x32_bf16 v[20:23], a[0:3], v[32:35], 0
    v_mfma_f32_16x16x32_bf16 v[24:27], a[80:83], v[32:35], 0
    s_add_u32 m0, s88, 10240
    s_add_u32 s93, s55, 18884608
    buffer_load_dwordx4 v1, s[8:11], s93 offen offset:0 sc1 lds
    v_mfma_f32_16x16x32_bf16 v[28:31], a[160:163], v[32:35], 0
    s_waitcnt lgkmcnt(5)
    v_mfma_f32_16x16x32_bf16 v[80:83], a[4:7], v[144:147], v[80:83]
    ds_read_b128 v[136:139], v2 offset:38912
    v_mfma_f32_16x16x32_bf16 v[84:87], a[84:87], v[144:147], v[84:87]
    s_add_u32 s3, s81, 6297600
    buffer_load_dwordx4 a[24:27], v1, s[8:11], s3 offen
    v_mfma_f32_16x16x32_bf16 v[88:91], a[164:167], v[144:147], v[88:91]
    s_waitcnt lgkmcnt(5)
    v_mfma_f32_16x16x32_bf16 v[92:95], a[4:7], v[148:151], v[92:95]
    ds_read_b128 v[140:143], v2 offset:59392
    v_mfma_f32_16x16x32_bf16 v[96:99], a[84:87], v[148:151], v[96:99]
    s_add_u32 s3, s81, 6318080
    buffer_load_dwordx4 a[104:107], v1, s[8:11], s3 offen
    v_mfma_f32_16x16x32_bf16 v[100:103], a[164:167], v[148:151], v[100:103]
    s_waitcnt lgkmcnt(5)
    v_mfma_f32_16x16x32_bf16 v[104:107], a[4:7], v[152:155], v[104:107]
    ds_read_b128 v[144:147], v1 offset:23552
    v_mfma_f32_16x16x32_bf16 v[108:111], a[84:87], v[152:155], v[108:111]
    s_add_u32 s3, s81, 6338560
    buffer_load_dwordx4 a[184:187], v1, s[8:11], s3 offen
    v_mfma_f32_16x16x32_bf16 v[112:115], a[164:167], v[152:155], v[112:115]
    s_waitcnt lgkmcnt(5)
    v_mfma_f32_16x16x32_bf16 v[116:119], a[4:7], v[156:159], v[116:119]
    ds_read_b128 v[148:151], v1 offset:44032
    v_mfma_f32_16x16x32_bf16 v[120:123], a[84:87], v[156:159], v[120:123]
    v_mfma_f32_16x16x32_bf16 v[124:127], a[164:167], v[156:159], v[124:127]
    v_mfma_f32_16x16x32_bf16 v[20:23], a[4:7], v[32:35], v[20:23]
    v_mfma_f32_16x16x32_bf16 v[24:27], a[84:87], v[32:35], v[24:27]
    buffer_load_dwordx4 v1, s[8:11], s93 offen offset:1024 sc1 lds
    v_mfma_f32_16x16x32_bf16 v[28:31], a[164:167], v[32:35], v[28:31]
    s_waitcnt vmcnt(14) lgkmcnt(5)
    v_mfma_f32_16x16x32_bf16 v[80:83], a[8:11], v[128:131], v[80:83]
    ds_read_b128 v[152:155], v2 offset:39936
    v_mfma_f32_16x16x32_bf16 v[84:87], a[88:91], v[128:131], v[84:87]
    s_add_u32 s3, s81, 6298624
    buffer_load_dwordx4 a[28:31], v1, s[8:11], s3 offen
    v_mfma_f32_16x16x32_bf16 v[88:91], a[168:171], v[128:131], v[88:91]
    s_waitcnt lgkmcnt(5)
    v_mfma_f32_16x16x32_bf16 v[92:95], a[8:11], v[132:135], v[92:95]
    ds_read_b128 v[156:159], v2 offset:60416
    v_mfma_f32_16x16x32_bf16 v[96:99], a[88:91], v[132:135], v[96:99]
    s_add_u32 s3, s81, 6319104
    buffer_load_dwordx4 a[108:111], v1, s[8:11], s3 offen
    v_mfma_f32_16x16x32_bf16 v[100:103], a[168:171], v[132:135], v[100:103]
    s_waitcnt lgkmcnt(5)
    v_mfma_f32_16x16x32_bf16 v[104:107], a[8:11], v[136:139], v[104:107]
    ds_read_b128 v[128:131], v1 offset:24576
    v_mfma_f32_16x16x32_bf16 v[108:111], a[88:91], v[136:139], v[108:111]
    s_add_u32 s3, s81, 6339584
    buffer_load_dwordx4 a[188:191], v1, s[8:11], s3 offen
    v_mfma_f32_16x16x32_bf16 v[112:115], a[168:171], v[136:139], v[112:115]
    s_waitcnt lgkmcnt(5)
    v_mfma_f32_16x16x32_bf16 v[116:119], a[8:11], v[140:143], v[116:119]
    ds_read_b128 v[132:135], v1 offset:45056
    v_mfma_f32_16x16x32_bf16 v[120:123], a[88:91], v[140:143], v[120:123]
    v_mfma_f32_16x16x32_bf16 v[124:127], a[168:171], v[140:143], v[124:127]
    v_mfma_f32_16x16x32_bf16 v[20:23], a[8:11], v[32:35], v[20:23]
    v_mfma_f32_16x16x32_bf16 v[24:27], a[88:91], v[32:35], v[24:27]
    buffer_load_dwordx4 v1, s[8:11], s93 offen offset:2048 sc1 lds
    v_mfma_f32_16x16x32_bf16 v[28:31], a[168:171], v[32:35], v[28:31]
    s_waitcnt vmcnt(15) lgkmcnt(5)
    v_mfma_f32_16x16x32_bf16 v[80:83], a[12:15], v[144:147], v[80:83]
    ds_read_b128 v[136:139], v2 offset:40960
    v_mfma_f32_16x16x32_bf16 v[84:87], a[92:95], v[144:147], v[84:87]
    s_add_u32 s3, s81, 6299648
    buffer_load_dwordx4 a[32:35], v1, s[8:11], s3 offen
    v_mfma_f32_16x16x32_bf16 v[88:91], a[172:175], v[144:147], v[88:91]
    s_waitcnt lgkmcnt(5)
    v_mfma_f32_16x16x32_bf16 v[92:95], a[12:15], v[148:151], v[92:95]
    ds_read_b128 v[140:143], v2 offset:61440
    v_mfma_f32_16x16x32_bf16 v[96:99], a[92:95], v[148:151], v[96:99]
    s_add_u32 s3, s81, 6320128
    buffer_load_dwordx4 a[112:115], v1, s[8:11], s3 offen
    v_mfma_f32_16x16x32_bf16 v[100:103], a[172:175], v[148:151], v[100:103]
    s_waitcnt lgkmcnt(5)
    v_mfma_f32_16x16x32_bf16 v[104:107], a[12:15], v[152:155], v[104:107]
    s_barrier
    ds_read_b128 v[144:147], v1 offset:25600
    v_mfma_f32_16x16x32_bf16 v[108:111], a[92:95], v[152:155], v[108:111]
    s_add_u32 s3, s81, 6340608
    buffer_load_dwordx4 a[192:195], v1, s[8:11], s3 offen
    v_mfma_f32_16x16x32_bf16 v[112:115], a[172:175], v[152:155], v[112:115]
    s_waitcnt lgkmcnt(5)
    v_mfma_f32_16x16x32_bf16 v[116:119], a[12:15], v[156:159], v[116:119]
    ds_read_b128 v[148:151], v1 offset:46080
    v_mfma_f32_16x16x32_bf16 v[120:123], a[92:95], v[156:159], v[120:123]
    v_mfma_f32_16x16x32_bf16 v[124:127], a[172:175], v[156:159], v[124:127]
    v_mfma_f32_16x16x32_bf16 v[20:23], a[12:15], v[32:35], v[20:23]
    v_mfma_f32_16x16x32_bf16 v[24:27], a[92:95], v[32:35], v[24:27]
    buffer_load_dwordx4 v1, s[8:11], s93 offen offset:3072 sc1 lds
    v_mfma_f32_16x16x32_bf16 v[28:31], a[172:175], v[32:35], v[28:31]
    s_waitcnt vmcnt(16) lgkmcnt(5)
    v_mfma_f32_16x16x32_bf16 v[80:83], a[16:19], v[128:131], v[80:83]
    ds_read_b128 v[152:155], v2 offset:41984
    v_mfma_f32_16x16x32_bf16 v[84:87], a[96:99], v[128:131], v[84:87]
    s_add_u32 s3, s81, 6300672
    buffer_load_dwordx4 a[36:39], v1, s[8:11], s3 offen
    v_mfma_f32_16x16x32_bf16 v[88:91], a[176:179], v[128:131], v[88:91]
    s_waitcnt lgkmcnt(5)
    v_mfma_f32_16x16x32_bf16 v[92:95], a[16:19], v[132:135], v[92:95]
    ds_read_b128 v[156:159], v2 offset:62464
    v_mfma_f32_16x16x32_bf16 v[96:99], a[96:99], v[132:135], v[96:99]
    s_add_u32 s3, s81, 6321152
    buffer_load_dwordx4 a[116:119], v1, s[8:11], s3 offen
    v_mfma_f32_16x16x32_bf16 v[100:103], a[176:179], v[132:135], v[100:103]
    s_waitcnt lgkmcnt(5)
    v_mfma_f32_16x16x32_bf16 v[104:107], a[16:19], v[136:139], v[104:107]
    ds_read_b128 v[128:131], v1 offset:26624
    v_mfma_f32_16x16x32_bf16 v[108:111], a[96:99], v[136:139], v[108:111]
    s_add_u32 s3, s81, 6341632
    buffer_load_dwordx4 a[196:199], v1, s[8:11], s3 offen
    v_mfma_f32_16x16x32_bf16 v[112:115], a[176:179], v[136:139], v[112:115]
    s_waitcnt lgkmcnt(5)
    v_mfma_f32_16x16x32_bf16 v[116:119], a[16:19], v[140:143], v[116:119]
    ds_read_b128 v[132:135], v1 offset:47104
    v_mfma_f32_16x16x32_bf16 v[120:123], a[96:99], v[140:143], v[120:123]
    v_mfma_f32_16x16x32_bf16 v[124:127], a[176:179], v[140:143], v[124:127]
    v_mfma_f32_16x16x32_bf16 v[20:23], a[16:19], v[32:35], v[20:23]
    v_mfma_f32_16x16x32_bf16 v[24:27], a[96:99], v[32:35], v[24:27]
    s_add_u32 m0, m0, 4096
    s_add_u32 s93, s93, 4096
    buffer_load_dwordx4 v1, s[8:11], s93 offen offset:0 sc1 lds
    v_mfma_f32_16x16x32_bf16 v[28:31], a[176:179], v[32:35], v[28:31]
    s_waitcnt vmcnt(17) lgkmcnt(5)
    v_mfma_f32_16x16x32_bf16 v[80:83], a[20:23], v[144:147], v[80:83]
    ds_read_b128 v[136:139], v2 offset:43008
    v_mfma_f32_16x16x32_bf16 v[84:87], a[100:103], v[144:147], v[84:87]
    s_add_u32 s3, s81, 6301696
    buffer_load_dwordx4 a[40:43], v1, s[8:11], s3 offen
    v_mfma_f32_16x16x32_bf16 v[88:91], a[180:183], v[144:147], v[88:91]
    s_waitcnt lgkmcnt(5)
    v_mfma_f32_16x16x32_bf16 v[92:95], a[20:23], v[148:151], v[92:95]
    ds_read_b128 v[140:143], v2 offset:63488
    v_mfma_f32_16x16x32_bf16 v[96:99], a[100:103], v[148:151], v[96:99]
    s_add_u32 s3, s81, 6322176
    buffer_load_dwordx4 a[120:123], v1, s[8:11], s3 offen
    v_mfma_f32_16x16x32_bf16 v[100:103], a[180:183], v[148:151], v[100:103]
    s_waitcnt lgkmcnt(5)
    v_mfma_f32_16x16x32_bf16 v[104:107], a[20:23], v[152:155], v[104:107]
    ds_read_b128 v[144:147], v1 offset:27648
    v_mfma_f32_16x16x32_bf16 v[108:111], a[100:103], v[152:155], v[108:111]
    s_add_u32 s3, s81, 6342656
    buffer_load_dwordx4 a[200:203], v1, s[8:11], s3 offen
    v_mfma_f32_16x16x32_bf16 v[112:115], a[180:183], v[152:155], v[112:115]
    s_waitcnt lgkmcnt(5)
    v_mfma_f32_16x16x32_bf16 v[116:119], a[20:23], v[156:159], v[116:119]
    ds_read_b128 v[148:151], v1 offset:48128
    v_mfma_f32_16x16x32_bf16 v[120:123], a[100:103], v[156:159], v[120:123]
    v_mfma_f32_16x16x32_bf16 v[124:127], a[180:183], v[156:159], v[124:127]
    v_mfma_f32_16x16x32_bf16 v[20:23], a[20:23], v[32:35], v[20:23]
    v_mfma_f32_16x16x32_bf16 v[24:27], a[100:103], v[32:35], v[24:27]
    s_add_u32 m0, s88, 15360
    s_add_u32 s93, s55, 18889728
    buffer_load_dwordx4 v1, s[8:11], s93 offen offset:0 sc1 lds
    v_mfma_f32_16x16x32_bf16 v[28:31], a[180:183], v[32:35], v[28:31]
    s_waitcnt vmcnt(17) lgkmcnt(5)
    v_mfma_f32_16x16x32_bf16 v[80:83], a[24:27], v[128:131], v[80:83]
    ds_read_b128 v[152:155], v2 offset:44032
    v_mfma_f32_16x16x32_bf16 v[84:87], a[104:107], v[128:131], v[84:87]
    s_add_u32 s3, s81, 6302720
    buffer_load_dwordx4 a[44:47], v1, s[8:11], s3 offen
    v_mfma_f32_16x16x32_bf16 v[88:91], a[184:187], v[128:131], v[88:91]
    s_waitcnt lgkmcnt(5)
    v_mfma_f32_16x16x32_bf16 v[92:95], a[24:27], v[132:135], v[92:95]
    ds_read_b128 v[156:159], v2 offset:64512
    v_mfma_f32_16x16x32_bf16 v[96:99], a[104:107], v[132:135], v[96:99]
    s_add_u32 s3, s81, 6323200
    buffer_load_dwordx4 a[124:127], v1, s[8:11], s3 offen
    v_mfma_f32_16x16x32_bf16 v[100:103], a[184:187], v[132:135], v[100:103]
    s_waitcnt lgkmcnt(5)
    v_mfma_f32_16x16x32_bf16 v[104:107], a[24:27], v[136:139], v[104:107]
    ds_read_b128 v[128:131], v1 offset:28672
    v_mfma_f32_16x16x32_bf16 v[108:111], a[104:107], v[136:139], v[108:111]
    s_add_u32 s3, s81, 6343680
    buffer_load_dwordx4 a[204:207], v1, s[8:11], s3 offen
    v_mfma_f32_16x16x32_bf16 v[112:115], a[184:187], v[136:139], v[112:115]
    s_waitcnt lgkmcnt(5)
    v_mfma_f32_16x16x32_bf16 v[116:119], a[24:27], v[140:143], v[116:119]
    ds_read_b128 v[132:135], v1 offset:49152
    v_mfma_f32_16x16x32_bf16 v[120:123], a[104:107], v[140:143], v[120:123]
    v_mfma_f32_16x16x32_bf16 v[124:127], a[184:187], v[140:143], v[124:127]
    v_mfma_f32_16x16x32_bf16 v[20:23], a[24:27], v[32:35], v[20:23]
    v_mfma_f32_16x16x32_bf16 v[24:27], a[104:107], v[32:35], v[24:27]
    buffer_load_dwordx4 v1, s[8:11], s93 offen offset:1024 sc1 lds
    v_mfma_f32_16x16x32_bf16 v[28:31], a[184:187], v[32:35], v[28:31]
    s_waitcnt vmcnt(17) lgkmcnt(5)
    v_mfma_f32_16x16x32_bf16 v[80:83], a[28:31], v[144:147], v[80:83]
    ds_read_b128 v[136:139], v2 offset:45056
    v_mfma_f32_16x16x32_bf16 v[84:87], a[108:111], v[144:147], v[84:87]
    s_add_u32 s3, s81, 6303744
    buffer_load_dwordx4 a[48:51], v1, s[8:11], s3 offen
    v_mfma_f32_16x16x32_bf16 v[88:91], a[188:191], v[144:147], v[88:91]
    s_waitcnt lgkmcnt(5)
    v_mfma_f32_16x16x32_bf16 v[92:95], a[28:31], v[148:151], v[92:95]
    ds_read_b128 v[140:143], v3 offset:0
    v_mfma_f32_16x16x32_bf16 v[96:99], a[108:111], v[148:151], v[96:99]
    s_add_u32 s3, s81, 6324224
    buffer_load_dwordx4 a[128:131], v1, s[8:11], s3 offen
    v_mfma_f32_16x16x32_bf16 v[100:103], a[188:191], v[148:151], v[100:103]
    s_waitcnt lgkmcnt(5)
    v_mfma_f32_16x16x32_bf16 v[104:107], a[28:31], v[152:155], v[104:107]
    ds_read_b128 v[144:147], v1 offset:29696
    v_mfma_f32_16x16x32_bf16 v[108:111], a[108:111], v[152:155], v[108:111]
    s_add_u32 s3, s81, 6344704
    buffer_load_dwordx4 a[208:211], v1, s[8:11], s3 offen
    v_mfma_f32_16x16x32_bf16 v[112:115], a[188:191], v[152:155], v[112:115]
    s_waitcnt lgkmcnt(5)
    v_mfma_f32_16x16x32_bf16 v[116:119], a[28:31], v[156:159], v[116:119]
    ds_read_b128 v[148:151], v1 offset:50176
    v_mfma_f32_16x16x32_bf16 v[120:123], a[108:111], v[156:159], v[120:123]
    v_mfma_f32_16x16x32_bf16 v[124:127], a[188:191], v[156:159], v[124:127]
    v_mfma_f32_16x16x32_bf16 v[20:23], a[28:31], v[32:35], v[20:23]
    v_mfma_f32_16x16x32_bf16 v[24:27], a[108:111], v[32:35], v[24:27]
    buffer_load_dwordx4 v1, s[8:11], s93 offen offset:2048 sc1 lds
    v_mfma_f32_16x16x32_bf16 v[28:31], a[188:191], v[32:35], v[28:31]
    s_waitcnt vmcnt(17) lgkmcnt(5)
    v_mfma_f32_16x16x32_bf16 v[80:83], a[32:35], v[128:131], v[80:83]
    ds_read_b128 v[152:155], v2 offset:46080
    v_mfma_f32_16x16x32_bf16 v[84:87], a[112:115], v[128:131], v[84:87]
    s_add_u32 s3, s81, 6304768
    buffer_load_dwordx4 a[52:55], v1, s[8:11], s3 offen
    v_mfma_f32_16x16x32_bf16 v[88:91], a[192:195], v[128:131], v[88:91]
    s_waitcnt lgkmcnt(5)
    v_mfma_f32_16x16x32_bf16 v[92:95], a[32:35], v[132:135], v[92:95]
    ds_read_b128 v[156:159], v3 offset:1024
    v_mfma_f32_16x16x32_bf16 v[96:99], a[112:115], v[132:135], v[96:99]
    s_add_u32 s3, s81, 6325248
    buffer_load_dwordx4 a[132:135], v1, s[8:11], s3 offen
    v_mfma_f32_16x16x32_bf16 v[100:103], a[192:195], v[132:135], v[100:103]
    s_waitcnt lgkmcnt(5)
    v_mfma_f32_16x16x32_bf16 v[104:107], a[32:35], v[136:139], v[104:107]
    s_waitcnt vmcnt(14)
    s_barrier
    ds_read_b128 v[128:131], v1 offset:30720
    v_mfma_f32_16x16x32_bf16 v[108:111], a[112:115], v[136:139], v[108:111]
    s_add_u32 s3, s81, 6345728
    buffer_load_dwordx4 a[212:215], v1, s[8:11], s3 offen
    v_mfma_f32_16x16x32_bf16 v[112:115], a[192:195], v[136:139], v[112:115]
    s_waitcnt lgkmcnt(5)
    v_mfma_f32_16x16x32_bf16 v[116:119], a[32:35], v[140:143], v[116:119]
    ds_read_b128 v[132:135], v1 offset:51200
    v_mfma_f32_16x16x32_bf16 v[120:123], a[112:115], v[140:143], v[120:123]
    v_mfma_f32_16x16x32_bf16 v[124:127], a[192:195], v[140:143], v[124:127]
    v_mfma_f32_16x16x32_bf16 v[20:23], a[32:35], v[32:35], v[20:23]
    v_mfma_f32_16x16x32_bf16 v[24:27], a[112:115], v[32:35], v[24:27]
    buffer_load_dwordx4 v1, s[8:11], s93 offen offset:3072 sc1 lds
    v_mfma_f32_16x16x32_bf16 v[28:31], a[192:195], v[32:35], v[28:31]
    s_waitcnt lgkmcnt(5)
    v_mfma_f32_16x16x32_bf16 v[80:83], a[36:39], v[144:147], v[80:83]
    ds_read_b128 v[136:139], v2 offset:47104
    v_mfma_f32_16x16x32_bf16 v[84:87], a[116:119], v[144:147], v[84:87]
    s_add_u32 s3, s81, 6305792
    buffer_load_dwordx4 a[56:59], v1, s[8:11], s3 offen
    v_mfma_f32_16x16x32_bf16 v[88:91], a[196:199], v[144:147], v[88:91]
    s_waitcnt lgkmcnt(5)
    v_mfma_f32_16x16x32_bf16 v[92:95], a[36:39], v[148:151], v[92:95]
    ds_read_b128 v[140:143], v3 offset:2048
    v_mfma_f32_16x16x32_bf16 v[96:99], a[116:119], v[148:151], v[96:99]
    s_add_u32 s3, s81, 6326272
    buffer_load_dwordx4 a[136:139], v1, s[8:11], s3 offen
    v_mfma_f32_16x16x32_bf16 v[100:103], a[196:199], v[148:151], v[100:103]
    s_waitcnt lgkmcnt(5)
    v_mfma_f32_16x16x32_bf16 v[104:107], a[36:39], v[152:155], v[104:107]
    ds_read_b128 v[144:147], v1 offset:31744
    v_mfma_f32_16x16x32_bf16 v[108:111], a[116:119], v[152:155], v[108:111]
    s_add_u32 s3, s81, 6346752
    buffer_load_dwordx4 a[216:219], v1, s[8:11], s3 offen
    v_mfma_f32_16x16x32_bf16 v[112:115], a[196:199], v[152:155], v[112:115]
    s_waitcnt lgkmcnt(5)
    v_mfma_f32_16x16x32_bf16 v[116:119], a[36:39], v[156:159], v[116:119]
    ds_read_b128 v[148:151], v1 offset:52224
    v_mfma_f32_16x16x32_bf16 v[120:123], a[116:119], v[156:159], v[120:123]
    v_mfma_f32_16x16x32_bf16 v[124:127], a[196:199], v[156:159], v[124:127]
    v_mfma_f32_16x16x32_bf16 v[20:23], a[36:39], v[32:35], v[20:23]
    v_mfma_f32_16x16x32_bf16 v[24:27], a[116:119], v[32:35], v[24:27]
    s_add_u32 m0, m0, 4096
    s_add_u32 s93, s93, 4096
    buffer_load_dwordx4 v1, s[8:11], s93 offen offset:0 sc1 lds
    v_mfma_f32_16x16x32_bf16 v[28:31], a[196:199], v[32:35], v[28:31]
    s_waitcnt vmcnt(17) lgkmcnt(5)
    v_mfma_f32_16x16x32_bf16 v[80:83], a[40:43], v[128:131], v[80:83]
    ds_read_b128 v[152:155], v2 offset:48128
    v_mfma_f32_16x16x32_bf16 v[84:87], a[120:123], v[128:131], v[84:87]
    s_add_u32 s3, s81, 6306816
    buffer_load_dwordx4 a[60:63], v1, s[8:11], s3 offen
    v_mfma_f32_16x16x32_bf16 v[88:91], a[200:203], v[128:131], v[88:91]
    s_waitcnt lgkmcnt(5)
    v_mfma_f32_16x16x32_bf16 v[92:95], a[40:43], v[132:135], v[92:95]
    ds_read_b128 v[156:159], v3 offset:3072
    v_mfma_f32_16x16x32_bf16 v[96:99], a[120:123], v[132:135], v[96:99]
    s_add_u32 s3, s81, 6327296
    buffer_load_dwordx4 a[140:143], v1, s[8:11], s3 offen
    v_mfma_f32_16x16x32_bf16 v[100:103], a[200:203], v[132:135], v[100:103]
    s_waitcnt lgkmcnt(5)
    v_mfma_f32_16x16x32_bf16 v[104:107], a[40:43], v[136:139], v[104:107]
    ds_read_b128 v[128:131], v1 offset:32768
    v_mfma_f32_16x16x32_bf16 v[108:111], a[120:123], v[136:139], v[108:111]
    s_add_u32 s3, s81, 6347776
    buffer_load_dwordx4 a[220:223], v1, s[8:11], s3 offen
    v_mfma_f32_16x16x32_bf16 v[112:115], a[200:203], v[136:139], v[112:115]
    s_waitcnt lgkmcnt(5)
    v_mfma_f32_16x16x32_bf16 v[116:119], a[40:43], v[140:143], v[116:119]
    ds_read_b128 v[132:135], v1 offset:53248
    v_mfma_f32_16x16x32_bf16 v[120:123], a[120:123], v[140:143], v[120:123]
    v_mfma_f32_16x16x32_bf16 v[124:127], a[200:203], v[140:143], v[124:127]
    v_mfma_f32_16x16x32_bf16 v[20:23], a[40:43], v[32:35], v[20:23]
    v_mfma_f32_16x16x32_bf16 v[24:27], a[120:123], v[32:35], v[24:27]
    s_add_u32 s84, s75, 18894848
    buffer_load_dwordx4 v[60:63], v1, s[8:11], s84 offen offset:0 sc1
    v_mfma_f32_16x16x32_bf16 v[28:31], a[200:203], v[32:35], v[28:31]
    s_waitcnt vmcnt(17) lgkmcnt(5)
    v_mfma_f32_16x16x32_bf16 v[80:83], a[44:47], v[144:147], v[80:83]
    ds_read_b128 v[136:139], v2 offset:49152
    v_mfma_f32_16x16x32_bf16 v[84:87], a[124:127], v[144:147], v[84:87]
    s_add_u32 s3, s81, 6307840
    buffer_load_dwordx4 a[64:67], v1, s[8:11], s3 offen
    v_mfma_f32_16x16x32_bf16 v[88:91], a[204:207], v[144:147], v[88:91]
    s_waitcnt lgkmcnt(5)
    v_mfma_f32_16x16x32_bf16 v[92:95], a[44:47], v[148:151], v[92:95]
    ds_read_b128 v[140:143], v3 offset:4096
    v_mfma_f32_16x16x32_bf16 v[96:99], a[124:127], v[148:151], v[96:99]
    s_add_u32 s3, s81, 6328320
    buffer_load_dwordx4 a[144:147], v1, s[8:11], s3 offen
    v_mfma_f32_16x16x32_bf16 v[100:103], a[204:207], v[148:151], v[100:103]
    s_waitcnt lgkmcnt(5)
    v_mfma_f32_16x16x32_bf16 v[104:107], a[44:47], v[152:155], v[104:107]
    ds_read_b128 v[144:147], v1 offset:33792
    v_mfma_f32_16x16x32_bf16 v[108:111], a[124:127], v[152:155], v[108:111]
    s_add_u32 s3, s81, 6348800
    buffer_load_dwordx4 a[224:227], v1, s[8:11], s3 offen
    v_mfma_f32_16x16x32_bf16 v[112:115], a[204:207], v[152:155], v[112:115]
    s_waitcnt lgkmcnt(5)
    v_mfma_f32_16x16x32_bf16 v[116:119], a[44:47], v[156:159], v[116:119]
    ds_read_b128 v[148:151], v1 offset:54272
    v_mfma_f32_16x16x32_bf16 v[120:123], a[124:127], v[156:159], v[120:123]
    v_mfma_f32_16x16x32_bf16 v[124:127], a[204:207], v[156:159], v[124:127]
    v_mfma_f32_16x16x32_bf16 v[20:23], a[44:47], v[32:35], v[20:23]
    v_mfma_f32_16x16x32_bf16 v[24:27], a[124:127], v[32:35], v[24:27]
    s_add_u32 s84, s75, 18916352
    buffer_load_dwordx4 v[64:67], v1, s[8:11], s84 offen offset:0 sc1
    v_mfma_f32_16x16x32_bf16 v[28:31], a[204:207], v[32:35], v[28:31]
    s_waitcnt vmcnt(17) lgkmcnt(5)
    v_mfma_f32_16x16x32_bf16 v[80:83], a[48:51], v[128:131], v[80:83]
    ds_read_b128 v[152:155], v2 offset:50176
    v_mfma_f32_16x16x32_bf16 v[84:87], a[128:131], v[128:131], v[84:87]
    s_add_u32 s3, s81, 6308864
    buffer_load_dwordx4 a[68:71], v1, s[8:11], s3 offen
    v_mfma_f32_16x16x32_bf16 v[88:91], a[208:211], v[128:131], v[88:91]
    s_waitcnt lgkmcnt(5)
    v_mfma_f32_16x16x32_bf16 v[92:95], a[48:51], v[132:135], v[92:95]
    ds_read_b128 v[156:159], v3 offset:5120
    v_mfma_f32_16x16x32_bf16 v[96:99], a[128:131], v[132:135], v[96:99]
    s_add_u32 s3, s81, 6329344
    buffer_load_dwordx4 a[148:151], v1, s[8:11], s3 offen
    v_mfma_f32_16x16x32_bf16 v[100:103], a[208:211], v[132:135], v[100:103]
    s_waitcnt lgkmcnt(5)
    v_mfma_f32_16x16x32_bf16 v[104:107], a[48:51], v[136:139], v[104:107]
    ds_read_b128 v[128:131], v1 offset:34816
    v_mfma_f32_16x16x32_bf16 v[108:111], a[128:131], v[136:139], v[108:111]
    s_add_u32 s3, s81, 6349824
    buffer_load_dwordx4 a[228:231], v1, s[8:11], s3 offen
    v_mfma_f32_16x16x32_bf16 v[112:115], a[208:211], v[136:139], v[112:115]
    s_waitcnt lgkmcnt(5)
    v_mfma_f32_16x16x32_bf16 v[116:119], a[48:51], v[140:143], v[116:119]
    ds_read_b128 v[132:135], v1 offset:55296
    v_mfma_f32_16x16x32_bf16 v[120:123], a[128:131], v[140:143], v[120:123]
    v_mfma_f32_16x16x32_bf16 v[124:127], a[208:211], v[140:143], v[124:127]
    v_mfma_f32_16x16x32_bf16 v[20:23], a[48:51], v[32:35], v[20:23]
    v_mfma_f32_16x16x32_bf16 v[24:27], a[128:131], v[32:35], v[24:27]
    s_add_u32 s84, s75, 18937856
    buffer_load_dwordx4 v[68:71], v1, s[8:11], s84 offen offset:0 sc1
    v_mfma_f32_16x16x32_bf16 v[28:31], a[208:211], v[32:35], v[28:31]
    s_waitcnt vmcnt(17) lgkmcnt(5)
    v_mfma_f32_16x16x32_bf16 v[80:83], a[52:55], v[144:147], v[80:83]
    ds_read_b128 v[136:139], v2 offset:51200
    v_mfma_f32_16x16x32_bf16 v[84:87], a[132:135], v[144:147], v[84:87]
    s_add_u32 s3, s81, 6309888
    buffer_load_dwordx4 a[72:75], v1, s[8:11], s3 offen
    v_mfma_f32_16x16x32_bf16 v[88:91], a[212:215], v[144:147], v[88:91]
    s_waitcnt lgkmcnt(5)
    v_mfma_f32_16x16x32_bf16 v[92:95], a[52:55], v[148:151], v[92:95]
    ds_read_b128 v[140:143], v3 offset:6144
    v_mfma_f32_16x16x32_bf16 v[96:99], a[132:135], v[148:151], v[96:99]
    s_add_u32 s3, s81, 6330368
    buffer_load_dwordx4 a[152:155], v1, s[8:11], s3 offen
    v_mfma_f32_16x16x32_bf16 v[100:103], a[212:215], v[148:151], v[100:103]
    s_waitcnt lgkmcnt(5)
    v_mfma_f32_16x16x32_bf16 v[104:107], a[52:55], v[152:155], v[104:107]
    s_waitcnt vmcnt(14)
    s_barrier
    ds_read_b128 v[144:147], v1 offset:35840
    v_mfma_f32_16x16x32_bf16 v[108:111], a[132:135], v[152:155], v[108:111]
    s_add_u32 s3, s81, 6350848
    buffer_load_dwordx4 a[232:235], v1, s[8:11], s3 offen
    v_mfma_f32_16x16x32_bf16 v[112:115], a[212:215], v[152:155], v[112:115]
    s_waitcnt lgkmcnt(5)
    v_mfma_f32_16x16x32_bf16 v[116:119], a[52:55], v[156:159], v[116:119]
    ds_read_b128 v[148:151], v1 offset:56320
    v_mfma_f32_16x16x32_bf16 v[120:123], a[132:135], v[156:159], v[120:123]
    v_mfma_f32_16x16x32_bf16 v[124:127], a[212:215], v[156:159], v[124:127]
    v_mfma_f32_16x16x32_bf16 v[20:23], a[52:55], v[32:35], v[20:23]
    v_mfma_f32_16x16x32_bf16 v[24:27], a[132:135], v[32:35], v[24:27]
    s_add_u32 s84, s75, 18959360
    buffer_load_dwordx4 v[72:75], v1, s[8:11], s84 offen offset:0 sc1
    v_mfma_f32_16x16x32_bf16 v[28:31], a[212:215], v[32:35], v[28:31]
    s_waitcnt lgkmcnt(5)
    v_mfma_f32_16x16x32_bf16 v[80:83], a[56:59], v[128:131], v[80:83]
    ds_read_b128 v[152:155], v2 offset:52224
    v_mfma_f32_16x16x32_bf16 v[84:87], a[136:139], v[128:131], v[84:87]
    s_add_u32 s3, s81, 6310912
    buffer_load_dwordx4 a[76:79], v1, s[8:11], s3 offen
    v_mfma_f32_16x16x32_bf16 v[88:91], a[216:219], v[128:131], v[88:91]
    s_waitcnt lgkmcnt(5)
    v_mfma_f32_16x16x32_bf16 v[92:95], a[56:59], v[132:135], v[92:95]
    ds_read_b128 v[156:159], v3 offset:7168
    v_mfma_f32_16x16x32_bf16 v[96:99], a[136:139], v[132:135], v[96:99]
    s_add_u32 s3, s81, 6331392
    buffer_load_dwordx4 a[156:159], v1, s[8:11], s3 offen
    v_mfma_f32_16x16x32_bf16 v[100:103], a[216:219], v[132:135], v[100:103]
    s_waitcnt lgkmcnt(5)
    v_mfma_f32_16x16x32_bf16 v[104:107], a[56:59], v[136:139], v[104:107]
    ds_read_b128 v[128:131], v1 offset:36864
    v_mfma_f32_16x16x32_bf16 v[108:111], a[136:139], v[136:139], v[108:111]
    s_add_u32 s3, s81, 6351872
    buffer_load_dwordx4 a[236:239], v1, s[8:11], s3 offen
    v_mfma_f32_16x16x32_bf16 v[112:115], a[216:219], v[136:139], v[112:115]
    s_waitcnt lgkmcnt(5)
    v_mfma_f32_16x16x32_bf16 v[116:119], a[56:59], v[140:143], v[116:119]
    ds_read_b128 v[132:135], v1 offset:57344
    v_mfma_f32_16x16x32_bf16 v[120:123], a[136:139], v[140:143], v[120:123]
    v_mfma_f32_16x16x32_bf16 v[124:127], a[216:219], v[140:143], v[124:127]
    v_mfma_f32_16x16x32_bf16 v[20:23], a[56:59], v[32:35], v[20:23]
    v_mfma_f32_16x16x32_bf16 v[24:27], a[136:139], v[32:35], v[24:27]
    s_add_u32 m0, s63, 0
    s_add_u32 s93, s61, 8429568
    buffer_load_dwordx4 v1, s[8:11], s93 offen offset:0  lds
    v_mfma_f32_16x16x32_bf16 v[28:31], a[216:219], v[32:35], v[28:31]
    s_waitcnt vmcnt(17) lgkmcnt(5)
    v_mfma_f32_16x16x32_bf16 v[80:83], a[60:63], v[144:147], v[80:83]
    ds_read_b128 v[136:139], v2 offset:53248
    v_mfma_f32_16x16x32_bf16 v[84:87], a[140:143], v[144:147], v[84:87]
    buffer_load_dwordx4 v1, s[8:11], s93 offen offset:1024  lds
    v_mfma_f32_16x16x32_bf16 v[88:91], a[220:223], v[144:147], v[88:91]
    s_waitcnt lgkmcnt(5)
    v_mfma_f32_16x16x32_bf16 v[92:95], a[60:63], v[148:151], v[92:95]
    ds_read_b128 v[140:143], v3 offset:8192
    v_mfma_f32_16x16x32_bf16 v[96:99], a[140:143], v[148:151], v[96:99]
    v_mfma_f32_16x16x32_bf16 v[100:103], a[220:223], v[148:151], v[100:103]
    s_waitcnt lgkmcnt(5)
    v_mfma_f32_16x16x32_bf16 v[104:107], a[60:63], v[152:155], v[104:107]
    ds_read_b128 v[144:147], v1 offset:37888
    v_mfma_f32_16x16x32_bf16 v[108:111], a[140:143], v[152:155], v[108:111]
    buffer_load_dwordx4 v1, s[8:11], s93 offen offset:2048  lds
    v_mfma_f32_16x16x32_bf16 v[112:115], a[220:223], v[152:155], v[112:115]
    s_waitcnt lgkmcnt(5)
    v_mfma_f32_16x16x32_bf16 v[116:119], a[60:63], v[156:159], v[116:119]
    ds_read_b128 v[148:151], v1 offset:58368
    v_mfma_f32_16x16x32_bf16 v[120:123], a[140:143], v[156:159], v[120:123]
    v_mfma_f32_16x16x32_bf16 v[124:127], a[220:223], v[156:159], v[124:127]
    v_mfma_f32_16x16x32_bf16 v[20:23], a[60:63], v[32:35], v[20:23]
    v_mfma_f32_16x16x32_bf16 v[24:27], a[140:143], v[32:35], v[24:27]
    buffer_load_dwordx4 v1, s[8:11], s93 offen offset:3072  lds
    v_mfma_f32_16x16x32_bf16 v[28:31], a[220:223], v[32:35], v[28:31]
    s_waitcnt vmcnt(16) lgkmcnt(5)
    v_mfma_f32_16x16x32_bf16 v[80:83], a[64:67], v[128:131], v[80:83]
    ds_read_b128 v[152:155], v2 offset:54272
    s_waitcnt vmcnt(7)
    v_or3_b32 v160, v60, v61, v62
    v_mfma_f32_16x16x32_bf16 v[84:87], a[144:147], v[128:131], v[84:87]
    s_add_u32 m0, m0, 4096
    s_add_u32 s93, s93, 4096
    buffer_load_dwordx4 v1, s[8:11], s93 offen offset:0  lds
    v_mfma_f32_16x16x32_bf16 v[88:91], a[224:227], v[128:131], v[88:91]
    s_waitcnt lgkmcnt(5)
    v_or3_b32 v160, v160, v63, v64
    v_or3_b32 v160, v160, v65, v66
    v_mfma_f32_16x16x32_bf16 v[92:95], a[64:67], v[132:135], v[92:95]
    ds_read_b128 v[156:159], v3 offset:9216
    v_or3_b32 v160, v160, v67, v68
    v_mfma_f32_16x16x32_bf16 v[96:99], a[144:147], v[132:135], v[96:99]
    v_or3_b32 v160, v160, v69, v70
    v_or3_b32 v160, v160, v71, v72
    v_mfma_f32_16x16x32_bf16 v[100:103], a[224:227], v[132:135], v[100:103]
    s_waitcnt lgkmcnt(5)
    v_or3_b32 v160, v160, v73, v74
    v_or_b32 v160, v160, v75
    v_mfma_f32_16x16x32_bf16 v[104:107], a[64:67], v[136:139], v[104:107]
    ds_read_b128 v[128:131], v1 offset:38912
    v_and_b32 v160, 2, v160
    v_mfma_f32_16x16x32_bf16 v[108:111], a[144:147], v[136:139], v[108:111]
    s_add_u32 m0, s63, 61440
    s_add_u32 s93, s61, 8450048
    buffer_load_dwordx4 v1, s[8:11], s93 offen offset:0  lds
    v_mfma_f32_16x16x32_bf16 v[112:115], a[224:227], v[136:139], v[112:115]
    s_waitcnt lgkmcnt(5)
    v_cmp_ne_u32 vcc, 0, v160
    s_nop 0
    s_cmp_lg_u64 vcc, 0
    s_cbranch_scc1 STR_19
STB_20:
    v_mfma_f32_16x16x32_bf16 v[116:119], a[64:67], v[140:143], v[116:119]
    ds_read_b128 v[132:135], v1 offset:59392
    v_add_f32 v60, v60, v62
    v_mfma_f32_16x16x32_bf16 v[120:123], a[144:147], v[140:143], v[120:123]
    v_add_f32 v64, v64, v66
    v_add_f32 v68, v68, v70
    v_mfma_f32_16x16x32_bf16 v[124:127], a[224:227], v[140:143], v[124:127]
    v_add_f32 v72, v72, v74
    v_add_f32 v61, v61, v63
    v_mfma_f32_16x16x32_bf16 v[20:23], a[64:67], v[32:35], v[20:23]
    v_add_f32 v65, v65, v67
    v_add_f32 v69, v69, v71
    v_mfma_f32_16x16x32_bf16 v[24:27], a[144:147], v[32:35], v[24:27]
    buffer_load_dwordx4 v1, s[8:11], s93 offen offset:1024  lds
    v_mfma_f32_16x16x32_bf16 v[28:31], a[224:227], v[32:35], v[28:31]
    s_waitcnt lgkmcnt(5)
    v_add_f32 v73, v73, v75
    v_mfma_f32_16x16x32_bf16 v[80:83], a[68:71], v[144:147], v[80:83]
    ds_read_b128 v[136:139], v2 offset:55296
    v_permlane32_swap_b32 v60, v61
    v_mfma_f32_16x16x32_bf16 v[84:87], a[148:151], v[144:147], v[84:87]
    buffer_load_dwordx4 v1, s[8:11], s93 offen offset:2048  lds
    v_mfma_f32_16x16x32_bf16 v[88:91], a[228:231], v[144:147], v[88:91]
    s_waitcnt lgkmcnt(5)
    v_permlane32_swap_b32 v64, v65
    v_permlane32_swap_b32 v68, v69
    v_mfma_f32_16x16x32_bf16 v[92:95], a[68:71], v[148:151], v[92:95]
    ds_read_b128 v[140:143], v3 offset:10240
    v_permlane32_swap_b32 v72, v73
    v_mfma_f32_16x16x32_bf16 v[96:99], a[148:151], v[148:151], v[96:99]
    v_add_f32 v60, v60, v61
    v_add_f32 v64, v64, v65
    v_mfma_f32_16x16x32_bf16 v[100:103], a[228:231], v[148:151], v[100:103]
    s_waitcnt lgkmcnt(5)
    v_add_f32 v68, v68, v69
    v_add_f32 v72, v72, v73
    v_mfma_f32_16x16x32_bf16 v[104:107], a[68:71], v[152:155], v[104:107]
    ds_read_b128 v[144:147], v1 offset:39936
    v_mov_b32 v61, v60
    v_mfma_f32_16x16x32_bf16 v[108:111], a[148:151], v[152:155], v[108:111]
    buffer_load_dwordx4 v1, s[8:11], s93 offen offset:3072  lds
    v_mfma_f32_16x16x32_bf16 v[112:115], a[228:231], v[152:155], v[112:115]
    s_waitcnt lgkmcnt(5)
    v_mov_b32 v65, v64
    v_mov_b32 v69, v68
    v_mfma_f32_16x16x32_bf16 v[116:119], a[68:71], v[156:159], v[116:119]
    ds_read_b128 v[148:151], v1 offset:60416
    v_mov_b32 v73, v72
    v_mfma_f32_16x16x32_bf16 v[120:123], a[148:151], v[156:159], v[120:123]
    v_permlane16_swap_b32 v60, v61
    v_permlane16_swap_b32 v64, v65
    v_mfma_f32_16x16x32_bf16 v[124:127], a[228:231], v[156:159], v[124:127]
    v_permlane16_swap_b32 v68, v69
    v_permlane16_swap_b32 v72, v73
    v_mfma_f32_16x16x32_bf16 v[20:23], a[68:71], v[32:35], v[20:23]
    v_add_f32 v60, v60, v61
    v_add_f32 v64, v64, v65
    v_mfma_f32_16x16x32_bf16 v[24:27], a[148:151], v[32:35], v[24:27]
    s_add_u32 m0, m0, 4096
    s_add_u32 s93, s93, 4096
    buffer_load_dwordx4 v1, s[8:11], s93 offen offset:0  lds
    v_mfma_f32_16x16x32_bf16 v[28:31], a[228:231], v[32:35], v[28:31]
    s_waitcnt lgkmcnt(5)
    v_add_f32 v68, v68, v69
    v_mfma_f32_16x16x32_bf16 v[80:83], a[72:75], v[128:131], v[80:83]
    ds_read_b128 v[152:155], v2 offset:56320
    v_add_f32 v72, v72, v73
    v_mfma_f32_16x16x32_bf16 v[84:87], a[152:155], v[128:131], v[84:87]
    v_mov_b32 v61, v60
    v_mov_b32 v65, v64
    v_mfma_f32_16x16x32_bf16 v[88:91], a[232:235], v[128:131], v[88:91]
    s_waitcnt lgkmcnt(5)
    v_mov_b32 v69, v68
    v_mov_b32 v73, v72
    v_mfma_f32_16x16x32_bf16 v[92:95], a[72:75], v[132:135], v[92:95]
    ds_read_b128 v[156:159], v3 offset:11264
    v_permlane32_swap_b32 v60, v61
    v_mfma_f32_16x16x32_bf16 v[96:99], a[152:155], v[132:135], v[96:99]
    v_permlane32_swap_b32 v64, v65
    v_permlane32_swap_b32 v68, v69
    v_mfma_f32_16x16x32_bf16 v[100:103], a[232:235], v[132:135], v[100:103]
    s_waitcnt lgkmcnt(5)
    v_permlane32_swap_b32 v72, v73
    v_mul_f32 v160, 0xbacccccd, v60
    v_mfma_f32_16x16x32_bf16 v[104:107], a[72:75], v[136:139], v[104:107]
    v_mul_f32 v164, 0xbacccccd, v64
    v_mul_f32 v168, 0xbacccccd, v68
    v_mfma_f32_16x16x32_bf16 v[108:111], a[152:155], v[136:139], v[108:111]
    v_mul_f32 v172, 0xbacccccd, v72
    v_mul_f32 v61, 0x3acccccd, v61
    v_mfma_f32_16x16x32_bf16 v[112:115], a[232:235], v[136:139], v[112:115]
    s_waitcnt lgkmcnt(4)
    v_mul_f32 v65, 0x3acccccd, v65
    v_mul_f32 v69, 0x3acccccd, v69
    v_mfma_f32_16x16x32_bf16 v[116:119], a[72:75], v[140:143], v[116:119]
    v_mul_f32 v73, 0x3acccccd, v73
    v_fma_f32 v61, -v160, v160, v61
    v_mfma_f32_16x16x32_bf16 v[120:123], a[152:155], v[140:143], v[120:123]
    v_fma_f32 v65, -v164, v164, v65
    v_fma_f32 v69, -v168, v168, v69
    v_mfma_f32_16x16x32_bf16 v[124:127], a[232:235], v[140:143], v[124:127]
    v_fma_f32 v73, -v172, v172, v73
    v_max_f32 v61, 0, v61
    v_mfma_f32_16x16x32_bf16 v[20:23], a[72:75], v[32:35], v[20:23]
    v_max_f32 v65, 0, v65
    v_max_f32 v69, 0, v69
    v_mfma_f32_16x16x32_bf16 v[24:27], a[152:155], v[32:35], v[24:27]
    v_max_f32 v73, 0, v73
    v_add_f32 v62, 0x3727c5ac, v61
    v_mfma_f32_16x16x32_bf16 v[28:31], a[232:235], v[32:35], v[28:31]
    s_waitcnt vmcnt(10) lgkmcnt(3)
    v_add_f32 v66, 0x3727c5ac, v65
    v_mfma_f32_16x16x32_bf16 v[80:83], a[76:79], v[144:147], v[80:83]
    v_add_f32 v70, 0x3727c5ac, v69
    v_add_f32 v74, 0x3727c5ac, v73
    v_mfma_f32_16x16x32_bf16 v[84:87], a[156:159], v[144:147], v[84:87]
    v_rsq_f32 v63, v62
    v_mfma_f32_16x16x32_bf16 v[88:91], a[236:239], v[144:147], v[88:91]
    s_waitcnt lgkmcnt(2)
    v_rsq_f32 v67, v66
    v_mfma_f32_16x16x32_bf16 v[92:95], a[76:79], v[148:151], v[92:95]
    v_rsq_f32 v71, v70
    v_mfma_f32_16x16x32_bf16 v[96:99], a[156:159], v[148:151], v[96:99]
    v_rsq_f32 v75, v74
    v_mfma_f32_16x16x32_bf16 v[100:103], a[236:239], v[148:151], v[100:103]
    s_waitcnt lgkmcnt(1)
    v_rcp_f32 v161, v63
    v_mfma_f32_16x16x32_bf16 v[104:107], a[76:79], v[152:155], v[104:107]
    v_rcp_f32 v165, v67
    v_mfma_f32_16x16x32_bf16 v[108:111], a[156:159], v[152:155], v[108:111]
    v_rcp_f32 v169, v71
    v_mfma_f32_16x16x32_bf16 v[112:115], a[236:239], v[152:155], v[112:115]
    s_waitcnt lgkmcnt(0)
    v_rcp_f32 v173, v75
    v_mfma_f32_16x16x32_bf16 v[116:119], a[76:79], v[156:159], v[116:119]
    v_mul_f32 v163, 0xc0135761, v63
    v_mul_f32 v167, 0xc0135761, v67
    v_mfma_f32_16x16x32_bf16 v[120:123], a[156:159], v[156:159], v[120:123]
    v_mul_f32 v171, 0xc0135761, v71
    v_mul_f32 v175, 0xc0135761, v75
    v_mfma_f32_16x16x32_bf16 v[124:127], a[236:239], v[156:159], v[124:127]
    v_mul_f32 v162, v63, v63
    v_mul_f32 v166, v67, v67
    v_mfma_f32_16x16x32_bf16 v[20:23], a[76:79], v[32:35], v[20:23]
    v_mul_f32 v170, v71, v71
    v_mul_f32 v174, v75, v75
    v_mfma_f32_16x16x32_bf16 v[24:27], a[156:159], v[32:35], v[24:27]
    v_mul_f32 v162, v162, v163
    v_mul_f32 v166, v166, v167
    v_mfma_f32_16x16x32_bf16 v[28:31], a[236:239], v[32:35], v[28:31]
    v_mul_f32 v170, v170, v171
    v_mul_f32 v174, v174, v175
    v_mul_f32 v162, 0x3d372713, v162
    v_mul_f32 v166, 0x3d372713, v166
    v_mul_f32 v170, 0x3d372713, v170
    v_mul_f32 v174, 0x3d372713, v174
    s_barrier
    v_pk_fma_f32 v[80:81], v[20:21], v[160:161], v[80:81] op_sel_hi:[1,0,1]
    s_add_u32 m0, s63, 20480
    s_add_u32 s93, s61, 8470528
    buffer_load_dwordx4 v1, s[8:11], s93 offen offset:0  lds
    v_pk_fma_f32 v[82:83], v[22:23], v[160:161], v[82:83] op_sel_hi:[1,0,1]
    v_pk_fma_f32 v[84:85], v[24:25], v[160:161], v[84:85] op_sel_hi:[1,0,1]
    v_pk_fma_f32 v[86:87], v[26:27], v[160:161], v[86:87] op_sel_hi:[1,0,1]
    v_pk_fma_f32 v[88:89], v[28:29], v[160:161], v[88:89] op_sel_hi:[1,0,1]
    v_pk_fma_f32 v[90:91], v[30:31], v[160:161], v[90:91] op_sel_hi:[1,0,1]
    v_pk_mul_f32 v[60:61], v[80:81], v[80:81]
    v_pk_mul_f32 v[62:63], v[82:83], v[82:83]
    v_pk_mul_f32 v[64:65], v[84:85], v[84:85]
    v_pk_mul_f32 v[66:67], v[86:87], v[86:87]
    v_pk_mul_f32 v[68:69], v[88:89], v[88:89]
    v_pk_mul_f32 v[70:71], v[90:91], v[90:91]
    v_pk_fma_f32 v[60:61], v[60:61], v[162:163], v[162:163] op_sel:[0,0,1] op_sel_hi:[1,0,1]
    v_pk_fma_f32 v[62:63], v[62:63], v[162:163], v[162:163] op_sel:[0,0,1] op_sel_hi:[1,0,1]
    v_pk_fma_f32 v[64:65], v[64:65], v[162:163], v[162:163] op_sel:[0,0,1] op_sel_hi:[1,0,1]
    v_pk_fma_f32 v[66:67], v[66:67], v[162:163], v[162:163] op_sel:[0,0,1] op_sel_hi:[1,0,1]
    v_pk_fma_f32 v[68:69], v[68:69], v[162:163], v[162:163] op_sel:[0,0,1] op_sel_hi:[1,0,1]
    buffer_load_dwordx4 v1, s[8:11], s93 offen offset:1024  lds
    v_pk_fma_f32 v[70:71], v[70:71], v[162:163], v[162:163] op_sel:[0,0,1] op_sel_hi:[1,0,1]
    v_pk_mul_f32 v[60:61], v[60:61], v[80:81]
    v_pk_mul_f32 v[62:63], v[62:63], v[82:83]
    v_pk_mul_f32 v[64:65], v[64:65], v[84:85]
    v_pk_mul_f32 v[66:67], v[66:67], v[86:87]
    v_pk_mul_f32 v[68:69], v[68:69], v[88:89]
    v_pk_mul_f32 v[70:71], v[70:71], v[90:91]
    v_exp_f32 v60, v60
    v_exp_f32 v61, v61
    v_exp_f32 v62, v62
    v_exp_f32 v63, v63
    v_exp_f32 v64, v64
    buffer_load_dwordx4 v1, s[8:11], s93 offen offset:2048  lds
    v_exp_f32 v65, v65
    v_exp_f32 v66, v66
    v_exp_f32 v67, v67
    v_exp_f32 v68, v68
    v_exp_f32 v69, v69
    v_exp_f32 v70, v70
    v_exp_f32 v71, v71
    v_pk_fma_f32 v[60:61], v[60:61], v[160:161], v[160:161] op_sel:[0,1,1] op_sel_hi:[1,1,1]
    v_pk_fma_f32 v[62:63], v[62:63], v[160:161], v[160:161] op_sel:[0,1,1] op_sel_hi:[1,1,1]
    buffer_load_dwordx4 v1, s[8:11], s93 offen offset:3072  lds
    v_pk_fma_f32 v[64:65], v[64:65], v[160:161], v[160:161] op_sel:[0,1,1] op_sel_hi:[1,1,1]
    v_pk_fma_f32 v[66:67], v[66:67], v[160:161], v[160:161] op_sel:[0,1,1] op_sel_hi:[1,1,1]
    v_pk_fma_f32 v[68:69], v[68:69], v[160:161], v[160:161] op_sel:[0,1,1] op_sel_hi:[1,1,1]
    v_pk_fma_f32 v[70:71], v[70:71], v[160:161], v[160:161] op_sel:[0,1,1] op_sel_hi:[1,1,1]
    v_rcp_f32 v60, v60
    v_rcp_f32 v61, v61
    v_rcp_f32 v62, v62
    v_rcp_f32 v63, v63
    v_rcp_f32 v64, v64
    v_rcp_f32 v65, v65
    s_add_u32 m0, m0, 4096
    s_add_u32 s93, s93, 4096
    buffer_load_dwordx4 v1, s[8:11], s93 offen offset:0  lds
    v_rcp_f32 v66, v66
    v_rcp_f32 v67, v67
    v_rcp_f32 v68, v68
    v_rcp_f32 v69, v69
    v_rcp_f32 v70, v70
    v_rcp_f32 v71, v71
    v_pk_mul_f32 v[80:81], v[80:81], v[60:61]
    v_pk_mul_f32 v[82:83], v[82:83], v[62:63]
    v_pk_mul_f32 v[84:85], v[84:85], v[64:65]
    v_pk_mul_f32 v[86:87], v[86:87], v[66:67]
    v_pk_mul_f32 v[88:89], v[88:89], v[68:69]
    v_pk_mul_f32 v[90:91], v[90:91], v[70:71]
    v_cvt_pk_bf16_f32 v80, v80, v81
    v_cvt_pk_bf16_f32 v81, v82, v83
    v_cvt_pk_bf16_f32 v82, v84, v85
    v_cvt_pk_bf16_f32 v83, v86, v87
    v_cvt_pk_bf16_f32 v84, v88, v89
    v_cvt_pk_bf16_f32 v85, v90, v91
    s_add_u32 s82, s73, 37748736
    s_add_u32 s83, s74, 37748736
    buffer_store_dwordx4 v[80:83], v1, s[8:11], s82 offen sc1
    buffer_store_dwordx2 v[84:85], v4, s[8:11], s83 offen sc1
    v_pk_fma_f32 v[92:93], v[20:21], v[164:165], v[92:93] op_sel_hi:[1,0,1]
    s_add_u32 m0, s63, 40960
    s_add_u32 s93, s61, 8491008
    buffer_load_dwordx4 v1, s[8:11], s93 offen offset:0  lds
    v_pk_fma_f32 v[94:95], v[22:23], v[164:165], v[94:95] op_sel_hi:[1,0,1]
    v_pk_fma_f32 v[96:97], v[24:25], v[164:165], v[96:97] op_sel_hi:[1,0,1]
    v_pk_fma_f32 v[98:99], v[26:27], v[164:165], v[98:99] op_sel_hi:[1,0,1]
    v_pk_fma_f32 v[100:101], v[28:29], v[164:165], v[100:101] op_sel_hi:[1,0,1]
    v_pk_fma_f32 v[102:103], v[30:31], v[164:165], v[102:103] op_sel_hi:[1,0,1]
    v_pk_mul_f32 v[60:61], v[92:93], v[92:93]
    v_pk_mul_f32 v[62:63], v[94:95], v[94:95]
    v_pk_mul_f32 v[64:65], v[96:97], v[96:97]
    v_pk_mul_f32 v[66:67], v[98:99], v[98:99]
    v_pk_mul_f32 v[68:69], v[100:101], v[100:101]
    v_pk_mul_f32 v[70:71], v[102:103], v[102:103]
    v_pk_fma_f32 v[60:61], v[60:61], v[166:167], v[166:167] op_sel:[0,0,1] op_sel_hi:[1,0,1]
    v_pk_fma_f32 v[62:63], v[62:63], v[166:167], v[166:167] op_sel:[0,0,1] op_sel_hi:[1,0,1]
    v_pk_fma_f32 v[64:65], v[64:65], v[166:167], v[166:167] op_sel:[0,0,1] op_sel_hi:[1,0,1]
    v_pk_fma_f32 v[66:67], v[66:67], v[166:167], v[166:167] op_sel:[0,0,1] op_sel_hi:[1,0,1]
    v_pk_fma_f32 v[68:69], v[68:69], v[166:167], v[166:167] op_sel:[0,0,1] op_sel_hi:[1,0,1]
    buffer_load_dwordx4 v1, s[8:11], s93 offen offset:1024  lds
    v_pk_fma_f32 v[70:71], v[70:71], v[166:167], v[166:167] op_sel:[0,0,1] op_sel_hi:[1,0,1]
    v_pk_mul_f32 v[60:61], v[60:61], v[92:93]
    v_pk_mul_f32 v[62:63], v[62:63], v[94:95]
    v_pk_mul_f32 v[64:65], v[64:65], v[96:97]
    v_pk_mul_f32 v[66:67], v[66:67], v[98:99]
    v_pk_mul_f32 v[68:69], v[68:69], v[100:101]
    v_pk_mul_f32 v[70:71], v[70:71], v[102:103]
    v_exp_f32 v60, v60
    v_exp_f32 v61, v61
    v_exp_f32 v62, v62
    v_exp_f32 v63, v63
    v_exp_f32 v64, v64
    buffer_load_dwordx4 v1, s[8:11], s93 offen offset:2048  lds
    v_exp_f32 v65, v65
    v_exp_f32 v66, v66
    v_exp_f32 v67, v67
    v_exp_f32 v68, v68
    v_exp_f32 v69, v69
    v_exp_f32 v70, v70
    v_exp_f32 v71, v71
    v_pk_fma_f32 v[60:61], v[60:61], v[164:165], v[164:165] op_sel:[0,1,1] op_sel_hi:[1,1,1]
    v_pk_fma_f32 v[62:63], v[62:63], v[164:165], v[164:165] op_sel:[0,1,1] op_sel_hi:[1,1,1]
    buffer_load_dwordx4 v1, s[8:11], s93 offen offset:3072  lds
    v_pk_fma_f32 v[64:65], v[64:65], v[164:165], v[164:165] op_sel:[0,1,1] op_sel_hi:[1,1,1]
    v_pk_fma_f32 v[66:67], v[66:67], v[164:165], v[164:165] op_sel:[0,1,1] op_sel_hi:[1,1,1]
    v_pk_fma_f32 v[68:69], v[68:69], v[164:165], v[164:165] op_sel:[0,1,1] op_sel_hi:[1,1,1]
    v_pk_fma_f32 v[70:71], v[70:71], v[164:165], v[164:165] op_sel:[0,1,1] op_sel_hi:[1,1,1]
    v_rcp_f32 v60, v60
    v_rcp_f32 v61, v61
    v_rcp_f32 v62, v62
    v_rcp_f32 v63, v63
    v_rcp_f32 v64, v64
    v_rcp_f32 v65, v65
    s_add_u32 m0, m0, 4096
    s_add_u32 s93, s93, 4096
    buffer_load_dwordx4 v1, s[8:11], s93 offen offset:0  lds
    v_rcp_f32 v66, v66
    v_rcp_f32 v67, v67
    v_rcp_f32 v68, v68
    v_rcp_f32 v69, v69
    v_rcp_f32 v70, v70
    v_rcp_f32 v71, v71
    v_pk_mul_f32 v[92:93], v[92:93], v[60:61]
    v_pk_mul_f32 v[94:95], v[94:95], v[62:63]
    v_pk_mul_f32 v[96:97], v[96:97], v[64:65]
    v_pk_mul_f32 v[98:99], v[98:99], v[66:67]
    v_pk_mul_f32 v[100:101], v[100:101], v[68:69]
    v_pk_mul_f32 v[102:103], v[102:103], v[70:71]
    v_cvt_pk_bf16_f32 v92, v92, v93
    v_cvt_pk_bf16_f32 v93, v94, v95
    v_cvt_pk_bf16_f32 v94, v96, v97
    v_cvt_pk_bf16_f32 v95, v98, v99
    v_cvt_pk_bf16_f32 v96, v100, v101
    v_cvt_pk_bf16_f32 v97, v102, v103
    s_add_u32 s82, s73, 37797888
    s_add_u32 s83, s74, 37797888
    buffer_store_dwordx4 v[92:95], v1, s[8:11], s82 offen sc1
    buffer_store_dwordx2 v[96:97], v4, s[8:11], s83 offen sc1
    v_pk_fma_f32 v[104:105], v[20:21], v[168:169], v[104:105] op_sel_hi:[1,0,1]
    s_add_u32 m0, s63, 102400
    s_add_u32 s93, s61, 8511488
    buffer_load_dwordx4 v1, s[8:11], s93 offen offset:0  lds
    v_pk_fma_f32 v[106:107], v[22:23], v[168:169], v[106:107] op_sel_hi:[1,0,1]
    v_pk_fma_f32 v[108:109], v[24:25], v[168:169], v[108:109] op_sel_hi:[1,0,1]
    v_pk_fma_f32 v[110:111], v[26:27], v[168:169], v[110:111] op_sel_hi:[1,0,1]
    v_pk_fma_f32 v[112:113], v[28:29], v[168:169], v[112:113] op_sel_hi:[1,0,1]
    v_pk_fma_f32 v[114:115], v[30:31], v[168:169], v[114:115] op_sel_hi:[1,0,1]
    v_pk_mul_f32 v[60:61], v[104:105], v[104:105]
    v_pk_mul_f32 v[62:63], v[106:107], v[106:107]
    v_pk_mul_f32 v[64:65], v[108:109], v[108:109]
    v_pk_mul_f32 v[66:67], v[110:111], v[110:111]
    v_pk_mul_f32 v[68:69], v[112:113], v[112:113]
    v_pk_mul_f32 v[70:71], v[114:115], v[114:115]
    v_pk_fma_f32 v[60:61], v[60:61], v[170:171], v[170:171] op_sel:[0,0,1] op_sel_hi:[1,0,1]
    v_pk_fma_f32 v[62:63], v[62:63], v[170:171], v[170:171] op_sel:[0,0,1] op_sel_hi:[1,0,1]
    v_pk_fma_f32 v[64:65], v[64:65], v[170:171], v[170:171] op_sel:[0,0,1] op_sel_hi:[1,0,1]
    v_pk_fma_f32 v[66:67], v[66:67], v[170:171], v[170:171] op_sel:[0,0,1] op_sel_hi:[1,0,1]
    v_pk_fma_f32 v[68:69], v[68:69], v[170:171], v[170:171] op_sel:[0,0,1] op_sel_hi:[1,0,1]
    buffer_load_dwordx4 v1, s[8:11], s93 offen offset:1024  lds
    v_pk_fma_f32 v[70:71], v[70:71], v[170:171], v[170:171] op_sel:[0,0,1] op_sel_hi:[1,0,1]
    v_pk_mul_f32 v[60:61], v[60:61], v[104:105]
    v_pk_mul_f32 v[62:63], v[62:63], v[106:107]
    v_pk_mul_f32 v[64:65], v[64:65], v[108:109]
    v_pk_mul_f32 v[66:67], v[66:67], v[110:111]
    v_pk_mul_f32 v[68:69], v[68:69], v[112:113]
    v_pk_mul_f32 v[70:71], v[70:71], v[114:115]
    v_exp_f32 v60, v60
    v_exp_f32 v61, v61
    v_exp_f32 v62, v62
    v_exp_f32 v63, v63
    v_exp_f32 v64, v64
    buffer_load_dwordx4 v1, s[8:11], s93 offen offset:2048  lds
    v_exp_f32 v65, v65
    v_exp_f32 v66, v66
    v_exp_f32 v67, v67
    v_exp_f32 v68, v68
    v_exp_f32 v69, v69
    v_exp_f32 v70, v70
    v_exp_f32 v71, v71
    v_pk_fma_f32 v[60:61], v[60:61], v[168:169], v[168:169] op_sel:[0,1,1] op_sel_hi:[1,1,1]
    v_pk_fma_f32 v[62:63], v[62:63], v[168:169], v[168:169] op_sel:[0,1,1] op_sel_hi:[1,1,1]
    buffer_load_dwordx4 v1, s[8:11], s93 offen offset:3072  lds
    v_pk_fma_f32 v[64:65], v[64:65], v[168:169], v[168:169] op_sel:[0,1,1] op_sel_hi:[1,1,1]
    v_pk_fma_f32 v[66:67], v[66:67], v[168:169], v[168:169] op_sel:[0,1,1] op_sel_hi:[1,1,1]
    v_pk_fma_f32 v[68:69], v[68:69], v[168:169], v[168:169] op_sel:[0,1,1] op_sel_hi:[1,1,1]
    v_pk_fma_f32 v[70:71], v[70:71], v[168:169], v[168:169] op_sel:[0,1,1] op_sel_hi:[1,1,1]
    v_rcp_f32 v60, v60
    v_rcp_f32 v61, v61
    v_rcp_f32 v62, v62
    v_rcp_f32 v63, v63
    v_rcp_f32 v64, v64
    v_rcp_f32 v65, v65
    s_add_u32 m0, m0, 4096
    s_add_u32 s93, s93, 4096
    buffer_load_dwordx4 v1, s[8:11], s93 offen offset:0  lds
    v_rcp_f32 v66, v66
    v_rcp_f32 v67, v67
    v_rcp_f32 v68, v68
    v_rcp_f32 v69, v69
    v_rcp_f32 v70, v70
    v_rcp_f32 v71, v71
    v_pk_mul_f32 v[104:105], v[104:105], v[60:61]
    v_pk_mul_f32 v[106:107], v[106:107], v[62:63]
    v_pk_mul_f32 v[108:109], v[108:109], v[64:65]
    v_pk_mul_f32 v[110:111], v[110:111], v[66:67]
    v_pk_mul_f32 v[112:113], v[112:113], v[68:69]
    v_pk_mul_f32 v[114:115], v[114:115], v[70:71]
    v_cvt_pk_bf16_f32 v104, v104, v105
    v_cvt_pk_bf16_f32 v105, v106, v107
    v_cvt_pk_bf16_f32 v106, v108, v109
    v_cvt_pk_bf16_f32 v107, v110, v111
    v_cvt_pk_bf16_f32 v108, v112, v113
    v_cvt_pk_bf16_f32 v109, v114, v115
    s_add_u32 s82, s73, 37847040
    s_add_u32 s83, s74, 37847040
    buffer_store_dwordx4 v[104:107], v1, s[8:11], s82 offen sc1
    buffer_store_dwordx2 v[108:109], v4, s[8:11], s83 offen sc1
    v_pk_fma_f32 v[116:117], v[20:21], v[172:173], v[116:117] op_sel_hi:[1,0,1]
    v_pk_fma_f32 v[118:119], v[22:23], v[172:173], v[118:119] op_sel_hi:[1,0,1]
    v_pk_fma_f32 v[120:121], v[24:25], v[172:173], v[120:121] op_sel_hi:[1,0,1]
    v_pk_fma_f32 v[122:123], v[26:27], v[172:173], v[122:123] op_sel_hi:[1,0,1]
    v_pk_fma_f32 v[124:125], v[28:29], v[172:173], v[124:125] op_sel_hi:[1,0,1]
    v_pk_fma_f32 v[126:127], v[30:31], v[172:173], v[126:127] op_sel_hi:[1,0,1]
    v_pk_mul_f32 v[60:61], v[116:117], v[116:117]
    v_pk_mul_f32 v[62:63], v[118:119], v[118:119]
    v_pk_mul_f32 v[64:65], v[120:121], v[120:121]
    v_pk_mul_f32 v[66:67], v[122:123], v[122:123]
    v_pk_mul_f32 v[68:69], v[124:125], v[124:125]
    v_pk_mul_f32 v[70:71], v[126:127], v[126:127]
    v_pk_fma_f32 v[60:61], v[60:61], v[174:175], v[174:175] op_sel:[0,0,1] op_sel_hi:[1,0,1]
    v_pk_fma_f32 v[62:63], v[62:63], v[174:175], v[174:175] op_sel:[0,0,1] op_sel_hi:[1,0,1]
    v_pk_fma_f32 v[64:65], v[64:65], v[174:175], v[174:175] op_sel:[0,0,1] op_sel_hi:[1,0,1]
    v_pk_fma_f32 v[66:67], v[66:67], v[174:175], v[174:175] op_sel:[0,0,1] op_sel_hi:[1,0,1]
    v_pk_fma_f32 v[68:69], v[68:69], v[174:175], v[174:175] op_sel:[0,0,1] op_sel_hi:[1,0,1]
    v_pk_fma_f32 v[70:71], v[70:71], v[174:175], v[174:175] op_sel:[0,0,1] op_sel_hi:[1,0,1]
    v_pk_mul_f32 v[60:61], v[60:61], v[116:117]
    v_pk_mul_f32 v[62:63], v[62:63], v[118:119]
    v_pk_mul_f32 v[64:65], v[64:65], v[120:121]
    v_pk_mul_f32 v[66:67], v[66:67], v[122:123]
    v_pk_mul_f32 v[68:69], v[68:69], v[124:125]
    v_pk_mul_f32 v[70:71], v[70:71], v[126:127]
    v_exp_f32 v60, v60
    v_exp_f32 v61, v61
    v_exp_f32 v62, v62
    v_exp_f32 v63, v63
    v_exp_f32 v64, v64
    v_exp_f32 v65, v65
    v_exp_f32 v66, v66
    v_exp_f32 v67, v67
    v_exp_f32 v68, v68
    v_exp_f32 v69, v69
    v_exp_f32 v70, v70
    v_exp_f32 v71, v71
    v_pk_fma_f32 v[60:61], v[60:61], v[172:173], v[172:173] op_sel:[0,1,1] op_sel_hi:[1,1,1]
    v_pk_fma_f32 v[62:63], v[62:63], v[172:173], v[172:173] op_sel:[0,1,1] op_sel_hi:[1,1,1]
    v_pk_fma_f32 v[64:65], v[64:65], v[172:173], v[172:173] op_sel:[0,1,1] op_sel_hi:[1,1,1]
    v_pk_fma_f32 v[66:67], v[66:67], v[172:173], v[172:173] op_sel:[0,1,1] op_sel_hi:[1,1,1]
    v_pk_fma_f32 v[68:69], v[68:69], v[172:173], v[172:173] op_sel:[0,1,1] op_sel_hi:[1,1,1]
    v_pk_fma_f32 v[70:71], v[70:71], v[172:173], v[172:173] op_sel:[0,1,1] op_sel_hi:[1,1,1]
    v_rcp_f32 v60, v60
    v_rcp_f32 v61, v61
    v_rcp_f32 v62, v62
    v_rcp_f32 v63, v63
    v_rcp_f32 v64, v64
    v_rcp_f32 v65, v65
    v_rcp_f32 v66, v66
    v_rcp_f32 v67, v67
    v_rcp_f32 v68, v68
    v_rcp_f32 v69, v69
    v_rcp_f32 v70, v70
    v_rcp_f32 v71, v71
    v_pk_mul_f32 v[116:117], v[116:117], v[60:61]
    v_pk_mul_f32 v[118:119], v[118:119], v[62:63]
    v_pk_mul_f32 v[120:121], v[120:121], v[64:65]
    v_pk_mul_f32 v[122:123], v[122:123], v[66:67]
    v_pk_mul_f32 v[124:125], v[124:125], v[68:69]
    v_pk_mul_f32 v[126:127], v[126:127], v[70:71]
    v_cvt_pk_bf16_f32 v116, v116, v117
    v_cvt_pk_bf16_f32 v117, v118, v119
    v_cvt_pk_bf16_f32 v118, v120, v121
    v_cvt_pk_bf16_f32 v119, v122, v123
    v_cvt_pk_bf16_f32 v120, v124, v125
    v_cvt_pk_bf16_f32 v121, v126, v127
    s_add_u32 s82, s73, 37896192
    s_add_u32 s83, s74, 37896192
    buffer_store_dwordx4 v[116:119], v1, s[8:11], s82 offen sc1
    buffer_store_dwordx2 v[120:121], v4, s[8:11], s83 offen sc1
    s_add_u32 m0, s63, 122880
    s_add_u32 s93, s61, 8531968
    buffer_load_dwordx4 v1, s[8:11], s93 offen offset:0  lds
    buffer_load_dwordx4 v1, s[8:11], s93 offen offset:1024  lds
    buffer_load_dwordx4 v1, s[8:11], s93 offen offset:2048  lds
    buffer_load_dwordx4 v1, s[8:11], s93 offen offset:3072  lds
    s_add_u32 m0, m0, 4096
    s_add_u32 s93, s93, 4096
    buffer_load_dwordx4 v1, s[8:11], s93 offen offset:0  lds
    v_and_b32 v33, 15, v0
    v_mov_b32 v32, v20
    v_cmp_eq_u32 vcc, 1, v33
    s_nop 1
    v_cndmask_b32 v32, v32, v21, vcc
    v_cmp_eq_u32 vcc, 2, v33
    s_nop 1
    v_cndmask_b32 v32, v32, v22, vcc
    v_cmp_eq_u32 vcc, 3, v33
    s_nop 1
    v_cndmask_b32 v32, v32, v23, vcc
    v_cmp_eq_u32 vcc, 4, v33
    s_nop 1
    v_cndmask_b32 v32, v32, v24, vcc
    v_cmp_eq_u32 vcc, 5, v33
    s_nop 1
    v_cndmask_b32 v32, v32, v25, vcc
    v_cmp_eq_u32 vcc, 6, v33
    s_nop 1
    v_cndmask_b32 v32, v32, v26, vcc
    v_cmp_eq_u32 vcc, 7, v33
    s_nop 1
    v_cndmask_b32 v32, v32, v27, vcc
    v_cmp_eq_u32 vcc, 8, v33
    s_nop 1
    v_cndmask_b32 v32, v32, v28, vcc
    v_cmp_eq_u32 vcc, 9, v33
    s_nop 1
    v_cndmask_b32 v32, v32, v29, vcc
    v_cmp_eq_u32 vcc, 10, v33
    s_nop 1
    v_cndmask_b32 v32, v32, v30, vcc
    v_cmp_eq_u32 vcc, 11, v33
    s_nop 1
    v_cndmask_b32 v32, v32, v31, vcc
    v_accvgpr_write_b32 a251, v32
    s_waitcnt vmcnt(5)
    v_mov_b32 v7, 4
    v_mov_b32 v18, 0
    s_mov_b64 exec, 1
    s_cmp_eq_u32 s50, 0
    s_cbranch_scc1 SLOW_12
    buffer_store_dword v7, v18, s[8:11], s76 offen
BACK_12:
    s_mov_b64 exec, -1
    s_barrier
    ds_read_b128 v[128:131], v2 offset:16384
    ds_read_b128 v[132:135], v2 offset:17408
    ds_read_b128 v[136:139], v2 offset:18432
    ds_read_b128 v[140:143], v2 offset:19456
    ds_read_b128 v[144:147], v2 offset:20480
    ds_read_b128 v[148:151], v2 offset:21504
    ds_read_b128 v[152:155], v2 offset:22528
    ds_read_b128 v[156:159], v2 offset:23552
    s_lshl_b32 s85, s48, 7
    s_add_u32 s85, s85, 13635584
    s_mov_b32 s92, s67
POLL_23:
    buffer_load_dword v7, v6, s[8:11], s85 offen sc1
    s_waitcnt vmcnt(0)
    v_cmp_le_u32 vcc, 4, v7
    s_nop 0
    s_cmp_eq_u64 vcc, -1
    s_cbranch_scc1 PDONE_24
    s_sub_u32 s92, s92, 1
    s_cbranch_scc0 POLL_23
    s_mov_b32 s67, 0
PDONE_24:
    s_add_u32 s84, s59, 37748736
    buffer_load_dwordx4 v[80:83], v1, s[8:11], s84 offen offset:0 sc1
    buffer_load_dwordx4 v[84:87], v1, s[8:11], s84 offen offset:1024 sc1
    buffer_load_dwordx4 v[88:91], v1, s[8:11], s84 offen offset:2048 sc1
    buffer_load_dwordx4 v[92:95], v1, s[8:11], s84 offen offset:3072 sc1
    s_add_u32 s84, s59, 37752832
    buffer_load_dwordx4 v[96:99], v1, s[8:11], s84 offen offset:0 sc1
    buffer_load_dwordx4 v[100:103], v1, s[8:11], s84 offen offset:1024 sc1
    buffer_load_dwordx4 v[104:107], v1, s[8:11], s84 offen offset:2048 sc1
    buffer_load_dwordx4 v[108:111], v1, s[8:11], s84 offen offset:3072 sc1
    s_add_u32 s84, s59, 37756928
    buffer_load_dwordx4 v[112:115], v1, s[8:11], s84 offen offset:0 sc1
    buffer_load_dwordx4 v[116:119], v1, s[8:11], s84 offen offset:1024 sc1
    buffer_load_dwordx4 v[120:123], v1, s[8:11], s84 offen offset:2048 sc1
    v_add_u32 v168, s63, v1
    v_add_u32 v169, s63, v2
    v_add_u32 v170, s63, v3
    s_waitcnt vmcnt(10) lgkmcnt(6)
    v_mfma_f32_16x16x32_bf16 v[40:43], v[128:131], v[80:83], v[40:43]
    ds_read_b128 v[160:163], v2 offset:24576
    v_mfma_f32_16x16x32_bf16 v[44:47], v[132:135], v[80:83], v[44:47]
    ds_read_b128 v[164:167], v2 offset:25600
    buffer_load_dwordx4 v[124:127], v1, s[8:11], s84 offen offset:3072 sc1
    s_waitcnt lgkmcnt(6)
    v_mfma_f32_16x16x32_bf16 v[48:51], v[136:139], v[80:83], v[48:51]
    ds_read_b128 v[128:131], v2 offset:26624
    v_mfma_f32_16x16x32_bf16 v[52:55], v[140:143], v[80:83], v[52:55]
    ds_read_b128 v[132:135], v2 offset:27648
    s_waitcnt lgkmcnt(6)
    v_mfma_f32_16x16x32_bf16 v[56:59], v[144:147], v[80:83], v[56:59]
    ds_read_b128 v[136:139], v2 offset:28672
    s_waitcnt vmcnt(10)
    v_mfma_f32_16x16x32_bf16 v[40:43], v[148:151], v[84:87], v[40:43]
    ds_read_b128 v[140:143], v2 offset:29696
    s_waitcnt lgkmcnt(6)
    v_mfma_f32_16x16x32_bf16 v[44:47], v[152:155], v[84:87], v[44:47]
    ds_read_b128 v[144:147], v2 offset:30720
    s_add_u32 s84, s59, 37761024
    buffer_load_dwordx4 v[80:83], v1, s[8:11], s84 offen offset:0 sc1
    v_mfma_f32_16x16x32_bf16 v[48:51], v[156:159], v[84:87], v[48:51]
    ds_read_b128 v[148:151], v2 offset:31744
    s_waitcnt lgkmcnt(6)
    v_mfma_f32_16x16x32_bf16 v[52:55], v[160:163], v[84:87], v[52:55]
    ds_read_b128 v[152:155], v2 offset:32768
    v_mfma_f32_16x16x32_bf16 v[56:59], v[164:167], v[84:87], v[56:59]
    ds_read_b128 v[156:159], v2 offset:33792
    s_waitcnt vmcnt(10) lgkmcnt(6)
    v_mfma_f32_16x16x32_bf16 v[40:43], v[128:131], v[88:91], v[40:43]
    ds_read_b128 v[160:163], v2 offset:34816
    v_mfma_f32_16x16x32_bf16 v[44:47], v[132:135], v[88:91], v[44:47]
    ds_read_b128 v[164:167], v2 offset:35840
    buffer_load_dwordx4 v[84:87], v1, s[8:11], s84 offen offset:1024 sc1
    s_waitcnt lgkmcnt(6)
    v_mfma_f32_16x16x32_bf16 v[48:51], v[136:139], v[88:91], v[48:51]
    ds_read_b128 v[128:131], v3 offset:12288
    v_mfma_f32_16x16x32_bf16 v[52:55], v[140:143], v[88:91], v[52:55]
    ds_read_b128 v[132:135], v3 offset:13312
    s_waitcnt lgkmcnt(6)
    v_mfma_f32_16x16x32_bf16 v[56:59], v[144:147], v[88:91], v[56:59]
    ds_read_b128 v[136:139], v3 offset:14336
    s_waitcnt vmcnt(10)
    v_mfma_f32_16x16x32_bf16 v[40:43], v[148:151], v[92:95], v[40:43]
    ds_read_b128 v[140:143], v3 offset:15360
    s_waitcnt lgkmcnt(6)
    v_mfma_f32_16x16x32_bf16 v[44:47], v[152:155], v[92:95], v[44:47]
    ds_read_b128 v[144:147], v3 offset:16384
    buffer_load_dwordx4 v[88:91], v1, s[8:11], s84 offen offset:2048 sc1
    v_mfma_f32_16x16x32_bf16 v[48:51], v[156:159], v[92:95], v[48:51]
    ds_read_b128 v[148:151], v3 offset:17408
    s_waitcnt lgkmcnt(6)
    v_mfma_f32_16x16x32_bf16 v[52:55], v[160:163], v[92:95], v[52:55]
    ds_read_b128 v[152:155], v3 offset:18432
    v_mfma_f32_16x16x32_bf16 v[56:59], v[164:167], v[92:95], v[56:59]
    ds_read_b128 v[156:159], v3 offset:19456
    s_waitcnt vmcnt(10) lgkmcnt(6)
    v_mfma_f32_16x16x32_bf16 v[40:43], v[128:131], v[96:99], v[40:43]
    ds_read_b128 v[160:163], v3 offset:20480
    v_mfma_f32_16x16x32_bf16 v[44:47], v[132:135], v[96:99], v[44:47]
    ds_read_b128 v[164:167], v3 offset:21504
    buffer_load_dwordx4 v[92:95], v1, s[8:11], s84 offen offset:3072 sc1
    s_waitcnt lgkmcnt(6)
    v_mfma_f32_16x16x32_bf16 v[48:51], v[136:139], v[96:99], v[48:51]
    ds_read_b128 v[128:131], v3 offset:22528
    v_mfma_f32_16x16x32_bf16 v[52:55], v[140:143], v[96:99], v[52:55]
    ds_read_b128 v[132:135], v3 offset:23552
    s_waitcnt lgkmcnt(6)
    v_mfma_f32_16x16x32_bf16 v[56:59], v[144:147], v[96:99], v[56:59]
    ds_read_b128 v[136:139], v3 offset:24576
    s_waitcnt vmcnt(10)
    v_mfma_f32_16x16x32_bf16 v[40:43], v[148:151], v[100:103], v[40:43]
    ds_read_b128 v[140:143], v3 offset:25600
    s_waitcnt lgkmcnt(6)
    v_mfma_f32_16x16x32_bf16 v[44:47], v[152:155], v[100:103], v[44:47]
    ds_read_b128 v[144:147], v3 offset:26624
    s_add_u32 s84, s59, 37765120
    buffer_load_dwordx4 v[96:99], v1, s[8:11], s84 offen offset:0 sc1
    v_mfma_f32_16x16x32_bf16 v[48:51], v[156:159], v[100:103], v[48:51]
    ds_read_b128 v[148:151], v3 offset:27648
    s_waitcnt lgkmcnt(6)
    v_mfma_f32_16x16x32_bf16 v[52:55], v[160:163], v[100:103], v[52:55]
    ds_read_b128 v[152:155], v3 offset:28672
    v_mfma_f32_16x16x32_bf16 v[56:59], v[164:167], v[100:103], v[56:59]
    ds_read_b128 v[156:159], v3 offset:29696
    s_waitcnt vmcnt(10) lgkmcnt(6)
    v_mfma_f32_16x16x32_bf16 v[40:43], v[128:131], v[104:107], v[40:43]
    ds_read_b128 v[160:163], v3 offset:30720
    v_mfma_f32_16x16x32_bf16 v[44:47], v[132:135], v[104:107], v[44:47]
    ds_read_b128 v[164:167], v3 offset:31744
    buffer_load_dwordx4 v[100:103], v1, s[8:11], s84 offen offset:1024 sc1
    s_waitcnt lgkmcnt(6)
    v_mfma_f32_16x16x32_bf16 v[48:51], v[136:139], v[104:107], v[48:51]
    ds_read_b128 v[128:131], v1 offset:0
    v_mfma_f32_16x16x32_bf16 v[52:55], v[140:143], v[104:107], v[52:55]
    ds_read_b128 v[132:135], v1 offset:1024
    s_waitcnt lgkmcnt(6)
    v_mfma_f32_16x16x32_bf16 v[56:59], v[144:147], v[104:107], v[56:59]
    ds_read_b128 v[136:139], v1 offset:2048
    s_waitcnt vmcnt(10)
    v_mfma_f32_16x16x32_bf16 v[40:43], v[148:151], v[108:111], v[40:43]
    ds_read_b128 v[140:143], v1 offset:3072
    s_waitcnt lgkmcnt(6)
    v_mfma_f32_16x16x32_bf16 v[44:47], v[152:155], v[108:111], v[44:47]
    ds_read_b128 v[144:147], v1 offset:4096
    buffer_load_dwordx4 v[104:107], v1, s[8:11], s84 offen offset:2048 sc1
    v_mfma_f32_16x16x32_bf16 v[48:51], v[156:159], v[108:111], v[48:51]
    ds_read_b128 v[148:151], v1 offset:5120
    s_waitcnt lgkmcnt(6)
    v_mfma_f32_16x16x32_bf16 v[52:55], v[160:163], v[108:111], v[52:55]
    ds_read_b128 v[152:155], v1 offset:6144
    v_mfma_f32_16x16x32_bf16 v[56:59], v[164:167], v[108:111], v[56:59]
    ds_read_b128 v[156:159], v1 offset:7168
    s_waitcnt vmcnt(10) lgkmcnt(6)
    v_mfma_f32_16x16x32_bf16 v[40:43], v[128:131], v[112:115], v[40:43]
    s_barrier
    ds_read_b128 v[160:163], v1 offset:8192
    v_mfma_f32_16x16x32_bf16 v[44:47], v[132:135], v[112:115], v[44:47]
    ds_read_b128 v[164:167], v1 offset:9216
    buffer_load_dwordx4 v[108:111], v1, s[8:11], s84 offen offset:3072 sc1
    s_waitcnt lgkmcnt(6)
    v_mfma_f32_16x16x32_bf16 v[48:51], v[136:139], v[112:115], v[48:51]
    ds_read_b128 v[128:131], v1 offset:10240
    v_mfma_f32_16x16x32_bf16 v[52:55], v[140:143], v[112:115], v[52:55]
    ds_read_b128 v[132:135], v1 offset:11264
    s_add_u32 m0, s63, 81920
    s_add_u32 s93, s61, 8552448
    buffer_load_dwordx4 v1, s[8:11], s93 offen offset:0  lds
    s_waitcnt lgkmcnt(6)
    v_mfma_f32_16x16x32_bf16 v[56:59], v[144:147], v[112:115], v[56:59]
    ds_read_b128 v[136:139], v1 offset:12288
    s_waitcnt vmcnt(11)
    v_mfma_f32_16x16x32_bf16 v[40:43], v[148:151], v[116:119], v[40:43]
    ds_read_b128 v[140:143], v1 offset:13312
    s_waitcnt lgkmcnt(6)
    v_mfma_f32_16x16x32_bf16 v[44:47], v[152:155], v[116:119], v[44:47]
    ds_read_b128 v[144:147], v1 offset:14336
    s_add_u32 s84, s59, 37769216
    buffer_load_dwordx4 v[112:115], v1, s[8:11], s84 offen offset:0 sc1
    v_mfma_f32_16x16x32_bf16 v[48:51], v[156:159], v[116:119], v[48:51]
    ds_read_b128 v[148:151], v1 offset:15360
    s_waitcnt lgkmcnt(6)
    v_mfma_f32_16x16x32_bf16 v[52:55], v[160:163], v[116:119], v[52:55]
    ds_read_b128 v[152:155], v1 offset:16384
    buffer_load_dwordx4 v1, s[8:11], s93 offen offset:1024  lds
    v_mfma_f32_16x16x32_bf16 v[56:59], v[164:167], v[116:119], v[56:59]
    ds_read_b128 v[156:159], v1 offset:17408
    s_waitcnt vmcnt(12) lgkmcnt(6)
    v_mfma_f32_16x16x32_bf16 v[40:43], v[128:131], v[120:123], v[40:43]
    ds_read_b128 v[160:163], v1 offset:18432
    v_mfma_f32_16x16x32_bf16 v[44:47], v[132:135], v[120:123], v[44:47]
    ds_read_b128 v[164:167], v1 offset:19456
    buffer_load_dwordx4 v[116:119], v1, s[8:11], s84 offen offset:1024 sc1
    s_waitcnt lgkmcnt(6)
    v_mfma_f32_16x16x32_bf16 v[48:51], v[136:139], v[120:123], v[48:51]
    ds_read_b128 v[128:131], v1 offset:61440
    v_mfma_f32_16x16x32_bf16 v[52:55], v[140:143], v[120:123], v[52:55]
    ds_read_b128 v[132:135], v1 offset:62464
    buffer_load_dwordx4 v1, s[8:11], s93 offen offset:2048  lds
    s_waitcnt lgkmcnt(6)
    v_mfma_f32_16x16x32_bf16 v[56:59], v[144:147], v[120:123], v[56:59]
    ds_read_b128 v[136:139], v1 offset:63488
    s_waitcnt vmcnt(13)
    v_mfma_f32_16x16x32_bf16 v[40:43], v[148:151], v[124:127], v[40:43]
    ds_read_b128 v[140:143], v1 offset:64512
    s_waitcnt lgkmcnt(6)
    v_mfma_f32_16x16x32_bf16 v[44:47], v[152:155], v[124:127], v[44:47]
    ds_read_b128 v[144:147], v2 offset:0
    buffer_load_dwordx4 v[120:123], v1, s[8:11], s84 offen offset:2048 sc1
    v_mfma_f32_16x16x32_bf16 v[48:51], v[156:159], v[124:127], v[48:51]
    ds_read_b128 v[148:151], v2 offset:1024
    s_waitcnt lgkmcnt(6)
    v_mfma_f32_16x16x32_bf16 v[52:55], v[160:163], v[124:127], v[52:55]
    ds_read_b128 v[152:155], v2 offset:2048
    buffer_load_dwordx4 v1, s[8:11], s93 offen offset:3072  lds
    v_mfma_f32_16x16x32_bf16 v[56:59], v[164:167], v[124:127], v[56:59]
    ds_read_b128 v[156:159], v2 offset:3072
    s_waitcnt vmcnt(14) lgkmcnt(6)
    v_mfma_f32_16x16x32_bf16 v[40:43], v[128:131], v[80:83], v[40:43]
    ds_read_b128 v[160:163], v2 offset:4096
    v_mfma_f32_16x16x32_bf16 v[44:47], v[132:135], v[80:83], v[44:47]
    ds_read_b128 v[164:167], v2 offset:5120
    buffer_load_dwordx4 v[124:127], v1, s[8:11], s84 offen offset:3072 sc1
    s_waitcnt lgkmcnt(6)
    v_mfma_f32_16x16x32_bf16 v[48:51], v[136:139], v[80:83], v[48:51]
    ds_read_b128 v[128:131], v2 offset:6144
    v_mfma_f32_16x16x32_bf16 v[52:55], v[140:143], v[80:83], v[52:55]
    ds_read_b128 v[132:135], v2 offset:7168
    s_add_u32 m0, m0, 4096
    s_add_u32 s93, s93, 4096
    buffer_load_dwordx4 v1, s[8:11], s93 offen offset:0  lds
    s_waitcnt lgkmcnt(6)
    v_mfma_f32_16x16x32_bf16 v[56:59], v[144:147], v[80:83], v[56:59]
    ds_read_b128 v[136:139], v2 offset:8192
    s_waitcnt vmcnt(15)
    v_mfma_f32_16x16x32_bf16 v[40:43], v[148:151], v[84:87], v[40:43]
    ds_read_b128 v[140:143], v2 offset:9216
    s_waitcnt lgkmcnt(6)
    v_mfma_f32_16x16x32_bf16 v[44:47], v[152:155], v[84:87], v[44:47]
    ds_read_b128 v[144:147], v2 offset:10240
    s_add_u32 s84, s59, 37773312
    buffer_load_dwordx4 v[80:83], v1, s[8:11], s84 offen offset:0 sc1
    v_mfma_f32_16x16x32_bf16 v[48:51], v[156:159], v[84:87], v[48:51]
    ds_read_b128 v[148:151], v2 offset:11264
    s_waitcnt lgkmcnt(6)
    v_mfma_f32_16x16x32_bf16 v[52:55], v[160:163], v[84:87], v[52:55]
    ds_read_b128 v[152:155], v2 offset:12288
    s_add_u32 m0, s63, 143360
    s_add_u32 s93, s61, 8572928
    buffer_load_dwordx4 v1, s[8:11], s93 offen offset:0  lds
    v_mfma_f32_16x16x32_bf16 v[56:59], v[164:167], v[84:87], v[56:59]
    ds_read_b128 v[156:159], v2 offset:13312
    s_waitcnt vmcnt(16) lgkmcnt(6)
    v_mfma_f32_16x16x32_bf16 v[40:43], v[128:131], v[88:91], v[40:43]
    ds_read_b128 v[160:163], v2 offset:14336
    v_mfma_f32_16x16x32_bf16 v[44:47], v[132:135], v[88:91], v[44:47]
    ds_read_b128 v[164:167], v2 offset:15360
    buffer_load_dwordx4 v[84:87], v1, s[8:11], s84 offen offset:1024 sc1
    s_waitcnt lgkmcnt(6)
    v_mfma_f32_16x16x32_bf16 v[48:51], v[136:139], v[88:91], v[48:51]
    ds_read_b128 v[128:131], v1 offset:20480
    v_mfma_f32_16x16x32_bf16 v[52:55], v[140:143], v[88:91], v[52:55]
    ds_read_b128 v[132:135], v1 offset:21504
    buffer_load_dwordx4 v1, s[8:11], s93 offen offset:1024  lds
    s_waitcnt lgkmcnt(6)
    v_mfma_f32_16x16x32_bf16 v[56:59], v[144:147], v[88:91], v[56:59]
    ds_read_b128 v[136:139], v1 offset:22528
    s_waitcnt vmcnt(17)
    v_mfma_f32_16x16x32_bf16 v[40:43], v[148:151], v[92:95], v[40:43]
    ds_read_b128 v[140:143], v1 offset:23552
    s_waitcnt lgkmcnt(6)
    v_mfma_f32_16x16x32_bf16 v[44:47], v[152:155], v[92:95], v[44:47]
    ds_read_b128 v[144:147], v1 offset:24576
    buffer_load_dwordx4 v[88:91], v1, s[8:11], s84 offen offset:2048 sc1
    v_mfma_f32_16x16x32_bf16 v[48:51], v[156:159], v[92:95], v[48:51]
    ds_read_b128 v[148:151], v1 offset:25600
    s_waitcnt lgkmcnt(6)
    v_mfma_f32_16x16x32_bf16 v[52:55], v[160:163], v[92:95], v[52:55]
    ds_read_b128 v[152:155], v1 offset:26624
    buffer_load_dwordx4 v1, s[8:11], s93 offen offset:2048  lds
    v_mfma_f32_16x16x32_bf16 v[56:59], v[164:167], v[92:95], v[56:59]
    ds_read_b128 v[156:159], v1 offset:27648
    s_waitcnt vmcnt(18) lgkmcnt(6)
    v_mfma_f32_16x16x32_bf16 v[40:43], v[128:131], v[96:99], v[40:43]
    ds_read_b128 v[160:163], v1 offset:28672
    v_mfma_f32_16x16x32_bf16 v[44:47], v[132:135], v[96:99], v[44:47]
    ds_read_b128 v[164:167], v1 offset:29696
    buffer_load_dwordx4 v[92:95], v1, s[8:11], s84 offen offset:3072 sc1
    s_waitcnt lgkmcnt(6)
    v_mfma_f32_16x16x32_bf16 v[48:51], v[136:139], v[96:99], v[48:51]
    ds_read_b128 v[128:131], v1 offset:30720
    v_mfma_f32_16x16x32_bf16 v[52:55], v[140:143], v[96:99], v[52:55]
    ds_read_b128 v[132:135], v1 offset:31744
    buffer_load_dwordx4 v1, s[8:11], s93 offen offset:3072  lds
    s_waitcnt lgkmcnt(6)
    v_mfma_f32_16x16x32_bf16 v[56:59], v[144:147], v[96:99], v[56:59]
    ds_read_b128 v[136:139], v1 offset:32768
    s_waitcnt vmcnt(19)
    v_mfma_f32_16x16x32_bf16 v[40:43], v[148:151], v[100:103], v[40:43]
    ds_read_b128 v[140:143], v1 offset:33792
    s_waitcnt lgkmcnt(6)
    v_mfma_f32_16x16x32_bf16 v[44:47], v[152:155], v[100:103], v[44:47]
    ds_read_b128 v[144:147], v1 offset:34816
    s_add_u32 s84, s59, 37777408
    buffer_load_dwordx4 v[96:99], v1, s[8:11], s84 offen offset:0 sc1
    v_mfma_f32_16x16x32_bf16 v[48:51], v[156:159], v[100:103], v[48:51]
    ds_read_b128 v[148:151], v1 offset:35840
    s_waitcnt lgkmcnt(6)
    v_mfma_f32_16x16x32_bf16 v[52:55], v[160:163], v[100:103], v[52:55]
    ds_read_b128 v[152:155], v1 offset:36864
    s_add_u32 m0, m0, 4096
    s_add_u32 s93, s93, 4096
    buffer_load_dwordx4 v1, s[8:11], s93 offen offset:0  lds
    v_mfma_f32_16x16x32_bf16 v[56:59], v[164:167], v[100:103], v[56:59]
    ds_read_b128 v[156:159], v1 offset:37888
    s_waitcnt vmcnt(20) lgkmcnt(6)
    v_mfma_f32_16x16x32_bf16 v[40:43], v[128:131], v[104:107], v[40:43]
    s_barrier
    ds_read_b128 v[160:163], v1 offset:38912
    v_mfma_f32_16x16x32_bf16 v[44:47], v[132:135], v[104:107], v[44:47]
    ds_read_b128 v[164:167], v1 offset:39936
    buffer_load_dwordx4 v[100:103], v1, s[8:11], s84 offen offset:1024 sc1
    s_waitcnt lgkmcnt(6)
    v_mfma_f32_16x16x32_bf16 v[48:51], v[136:139], v[104:107], v[48:51]
    ds_read_b128 v[128:131], v1 offset:40960
    v_mfma_f32_16x16x32_bf16 v[52:55], v[140:143], v[104:107], v[52:55]
    ds_read_b128 v[132:135], v1 offset:41984
    s_add_u32 m0, s63, 0
    s_add_u32 s93, s61, 8593408
    buffer_load_dwordx4 v1, s[8:11], s93 offen offset:0  lds
    s_waitcnt lgkmcnt(6)
    v_mfma_f32_16x16x32_bf16 v[56:59], v[144:147], v[104:107], v[56:59]
    ds_read_b128 v[136:139], v1 offset:43008
    s_waitcnt vmcnt(21)
    v_mfma_f32_16x16x32_bf16 v[40:43], v[148:151], v[108:111], v[40:43]
    ds_read_b128 v[140:143], v1 offset:44032
    s_waitcnt lgkmcnt(6)
    v_mfma_f32_16x16x32_bf16 v[44:47], v[152:155], v[108:111], v[44:47]
    ds_read_b128 v[144:147], v1 offset:45056
    buffer_load_dwordx4 v[104:107], v1, s[8:11], s84 offen offset:2048 sc1
    v_mfma_f32_16x16x32_bf16 v[48:51], v[156:159], v[108:111], v[48:51]
    ds_read_b128 v[148:151], v1 offset:46080
    s_waitcnt lgkmcnt(6)
    v_mfma_f32_16x16x32_bf16 v[52:55], v[160:163], v[108:111], v[52:55]
    ds_read_b128 v[152:155], v1 offset:47104
    buffer_load_dwordx4 v1, s[8:11], s93 offen offset:1024  lds
    v_mfma_f32_16x16x32_bf16 v[56:59], v[164:167], v[108:111], v[56:59]
    ds_read_b128 v[156:159], v1 offset:48128
    s_waitcnt vmcnt(21) lgkmcnt(6)
    v_mfma_f32_16x16x32_bf16 v[40:43], v[128:131], v[112:115], v[40:43]
    ds_read_b128 v[160:163], v1 offset:49152
    v_mfma_f32_16x16x32_bf16 v[44:47], v[132:135], v[112:115], v[44:47]
    ds_read_b128 v[164:167], v1 offset:50176
    buffer_load_dwordx4 v[108:111], v1, s[8:11], s84 offen offset:3072 sc1
    s_waitcnt lgkmcnt(6)
    v_mfma_f32_16x16x32_bf16 v[48:51], v[136:139], v[112:115], v[48:51]
    ds_read_b128 v[128:131], v1 offset:51200
    v_mfma_f32_16x16x32_bf16 v[52:55], v[140:143], v[112:115], v[52:55]
    ds_read_b128 v[132:135], v1 offset:52224
    buffer_load_dwordx4 v1, s[8:11], s93 offen offset:2048  lds
    s_waitcnt lgkmcnt(6)
    v_mfma_f32_16x16x32_bf16 v[56:59], v[144:147], v[112:115], v[56:59]
    ds_read_b128 v[136:139], v1 offset:53248
    s_waitcnt vmcnt(21)
    v_mfma_f32_16x16x32_bf16 v[40:43], v[148:151], v[116:119], v[40:43]
    ds_read_b128 v[140:143], v1 offset:54272
    s_waitcnt lgkmcnt(6)
    v_mfma_f32_16x16x32_bf16 v[44:47], v[152:155], v[116:119], v[44:47]
    ds_read_b128 v[144:147], v1 offset:55296
    s_add_u32 s84, s59, 37781504
    buffer_load_dwordx4 v[112:115], v1, s[8:11], s84 offen offset:0 sc1
    v_mfma_f32_16x16x32_bf16 v[48:51], v[156:159], v[116:119], v[48:51]
    ds_read_b128 v[148:151], v1 offset:56320
    s_waitcnt lgkmcnt(6)
    v_mfma_f32_16x16x32_bf16 v[52:55], v[160:163], v[116:119], v[52:55]
    ds_read_b128 v[152:155], v1 offset:57344
    buffer_load_dwordx4 v1, s[8:11], s93 offen offset:3072  lds
    v_mfma_f32_16x16x32_bf16 v[56:59], v[164:167], v[116:119], v[56:59]
    ds_read_b128 v[156:159], v1 offset:58368
    s_waitcnt vmcnt(21) lgkmcnt(6)
    v_mfma_f32_16x16x32_bf16 v[40:43], v[128:131], v[120:123], v[40:43]
    ds_read_b128 v[160:163], v1 offset:59392
    v_mfma_f32_16x16x32_bf16 v[44:47], v[132:135], v[120:123], v[44:47]
    ds_read_b128 v[164:167], v1 offset:60416
    buffer_load_dwordx4 v[116:119], v1, s[8:11], s84 offen offset:1024 sc1
    s_waitcnt lgkmcnt(6)
    v_mfma_f32_16x16x32_bf16 v[48:51], v[136:139], v[120:123], v[48:51]
    ds_read_b128 v[128:131], v2 offset:36864
    v_mfma_f32_16x16x32_bf16 v[52:55], v[140:143], v[120:123], v[52:55]
    ds_read_b128 v[132:135], v2 offset:37888
    s_add_u32 m0, m0, 4096
    s_add_u32 s93, s93, 4096
    buffer_load_dwordx4 v1, s[8:11], s93 offen offset:0  lds
    s_waitcnt lgkmcnt(6)
    v_mfma_f32_16x16x32_bf16 v[56:59], v[144:147], v[120:123], v[56:59]
    ds_read_b128 v[136:139], v2 offset:38912
    s_waitcnt vmcnt(21)
    v_mfma_f32_16x16x32_bf16 v[40:43], v[148:151], v[124:127], v[40:43]
    ds_read_b128 v[140:143], v2 offset:39936
    s_waitcnt lgkmcnt(6)
    v_mfma_f32_16x16x32_bf16 v[44:47], v[152:155], v[124:127], v[44:47]
    ds_read_b128 v[144:147], v2 offset:40960
    buffer_load_dwordx4 v[120:123], v1, s[8:11], s84 offen offset:2048 sc1
    v_mfma_f32_16x16x32_bf16 v[48:51], v[156:159], v[124:127], v[48:51]
    ds_read_b128 v[148:151], v2 offset:41984
    s_waitcnt lgkmcnt(6)
    v_mfma_f32_16x16x32_bf16 v[52:55], v[160:163], v[124:127], v[52:55]
    ds_read_b128 v[152:155], v2 offset:43008
    s_add_u32 m0, s63, 61440
    s_add_u32 s93, s61, 8613888
    buffer_load_dwordx4 v1, s[8:11], s93 offen offset:0  lds
    v_mfma_f32_16x16x32_bf16 v[56:59], v[164:167], v[124:127], v[56:59]
    ds_read_b128 v[156:159], v2 offset:44032
    s_waitcnt vmcnt(21) lgkmcnt(6)
    v_mfma_f32_16x16x32_bf16 v[40:43], v[128:131], v[80:83], v[40:43]
    ds_read_b128 v[160:163], v2 offset:45056
    v_mfma_f32_16x16x32_bf16 v[44:47], v[132:135], v[80:83], v[44:47]
    ds_read_b128 v[164:167], v2 offset:46080
    buffer_load_dwordx4 v[124:127], v1, s[8:11], s84 offen offset:3072 sc1
    s_waitcnt lgkmcnt(6)
    v_mfma_f32_16x16x32_bf16 v[48:51], v[136:139], v[80:83], v[48:51]
    ds_read_b128 v[128:131], v2 offset:47104
    v_mfma_f32_16x16x32_bf16 v[52:55], v[140:143], v[80:83], v[52:55]
    ds_read_b128 v[132:135], v2 offset:48128
    buffer_load_dwordx4 v1, s[8:11], s93 offen offset:1024  lds
    s_waitcnt lgkmcnt(6)
    v_mfma_f32_16x16x32_bf16 v[56:59], v[144:147], v[80:83], v[56:59]
    ds_read_b128 v[136:139], v2 offset:49152
    s_waitcnt vmcnt(21)
    v_mfma_f32_16x16x32_bf16 v[40:43], v[148:151], v[84:87], v[40:43]
    ds_read_b128 v[140:143], v2 offset:50176
    s_waitcnt lgkmcnt(6)
    v_mfma_f32_16x16x32_bf16 v[44:47], v[152:155], v[84:87], v[44:47]
    ds_read_b128 v[144:147], v2 offset:51200
    s_add_u32 s84, s59, 37785600
    buffer_load_dwordx4 v[80:83], v1, s[8:11], s84 offen offset:0 sc1
    v_mfma_f32_16x16x32_bf16 v[48:51], v[156:159], v[84:87], v[48:51]
    ds_read_b128 v[148:151], v2 offset:52224
    s_waitcnt lgkmcnt(6)
    v_mfma_f32_16x16x32_bf16 v[52:55], v[160:163], v[84:87], v[52:55]
    ds_read_b128 v[152:155], v2 offset:53248
    buffer_load_dwordx4 v1, s[8:11], s93 offen offset:2048  lds
    v_mfma_f32_16x16x32_bf16 v[56:59], v[164:167], v[84:87], v[56:59]
    ds_read_b128 v[156:159], v2 offset:54272
    s_waitcnt vmcnt(21) lgkmcnt(6)
    v_mfma_f32_16x16x32_bf16 v[40:43], v[128:131], v[88:91], v[40:43]
    ds_read_b128 v[160:163], v2 offset:55296
    v_mfma_f32_16x16x32_bf16 v[44:47], v[132:135], v[88:91], v[44:47]
    ds_read_b128 v[164:167], v2 offset:56320
    buffer_load_dwordx4 v[84:87], v1, s[8:11], s84 offen offset:1024 sc1
    s_waitcnt lgkmcnt(6)
    v_mfma_f32_16x16x32_bf16 v[48:51], v[136:139], v[88:91], v[48:51]
    ds_read_b128 v[128:131], v2 offset:57344
    v_mfma_f32_16x16x32_bf16 v[52:55], v[140:143], v[88:91], v[52:55]
    ds_read_b128 v[132:135], v2 offset:58368
    buffer_load_dwordx4 v1, s[8:11], s93 offen offset:3072  lds
    s_waitcnt lgkmcnt(6)
    v_mfma_f32_16x16x32_bf16 v[56:59], v[144:147], v[88:91], v[56:59]
    ds_read_b128 v[136:139], v2 offset:59392
    s_waitcnt vmcnt(21)
    v_mfma_f32_16x16x32_bf16 v[40:43], v[148:151], v[92:95], v[40:43]
    ds_read_b128 v[140:143], v2 offset:60416
    s_waitcnt lgkmcnt(6)
    v_mfma_f32_16x16x32_bf16 v[44:47], v[152:155], v[92:95], v[44:47]
    ds_read_b128 v[144:147], v2 offset:61440
    buffer_load_dwordx4 v[88:91], v1, s[8:11], s84 offen offset:2048 sc1
    v_mfma_f32_16x16x32_bf16 v[48:51], v[156:159], v[92:95], v[48:51]
    ds_read_b128 v[148:151], v2 offset:62464
    s_waitcnt lgkmcnt(6)
    v_mfma_f32_16x16x32_bf16 v[52:55], v[160:163], v[92:95], v[52:55]
    ds_read_b128 v[152:155], v2 offset:63488
    s_add_u32 m0, m0, 4096
    s_add_u32 s93, s93, 4096
    buffer_load_dwordx4 v1, s[8:11], s93 offen offset:0  lds
    v_mfma_f32_16x16x32_bf16 v[56:59], v[164:167], v[92:95], v[56:59]
    ds_read_b128 v[156:159], v2 offset:64512
    s_waitcnt vmcnt(21) lgkmcnt(6)
    v_mfma_f32_16x16x32_bf16 v[40:43], v[128:131], v[96:99], v[40:43]
    ds_read_b128 v[160:163], v3 offset:0
    v_mfma_f32_16x16x32_bf16 v[44:47], v[132:135], v[96:99], v[44:47]
    ds_read_b128 v[164:167], v3 offset:1024
    buffer_load_dwordx4 v[92:95], v1, s[8:11], s84 offen offset:3072 sc1
    s_waitcnt lgkmcnt(6)
    v_mfma_f32_16x16x32_bf16 v[48:51], v[136:139], v[96:99], v[48:51]
    ds_read_b128 v[128:131], v3 offset:2048
    v_mfma_f32_16x16x32_bf16 v[52:55], v[140:143], v[96:99], v[52:55]
    ds_read_b128 v[132:135], v3 offset:3072
    s_waitcnt lgkmcnt(6)
    v_mfma_f32_16x16x32_bf16 v[56:59], v[144:147], v[96:99], v[56:59]
    ds_read_b128 v[136:139], v3 offset:4096
    s_waitcnt vmcnt(20)
    v_mfma_f32_16x16x32_bf16 v[40:43], v[148:151], v[100:103], v[40:43]
    ds_read_b128 v[140:143], v3 offset:5120
    s_waitcnt lgkmcnt(6)
    v_mfma_f32_16x16x32_bf16 v[44:47], v[152:155], v[100:103], v[44:47]
    ds_read_b128 v[144:147], v3 offset:6144
    s_add_u32 s84, s59, 37789696
    buffer_load_dwordx4 v[96:99], v1, s[8:11], s84 offen offset:0 sc1
    v_mfma_f32_16x16x32_bf16 v[48:51], v[156:159], v[100:103], v[48:51]
    ds_read_b128 v[148:151], v3 offset:7168
    s_waitcnt lgkmcnt(6)
    v_mfma_f32_16x16x32_bf16 v[52:55], v[160:163], v[100:103], v[52:55]
    ds_read_b128 v[152:155], v3 offset:8192
    v_mfma_f32_16x16x32_bf16 v[56:59], v[164:167], v[100:103], v[56:59]
    s_barrier
    ds_read_b128 v[156:159], v3 offset:9216
    s_waitcnt vmcnt(19) lgkmcnt(6)
    v_mfma_f32_16x16x32_bf16 v[40:43], v[128:131], v[104:107], v[40:43]
    ds_read_b128 v[160:163], v3 offset:10240
    v_mfma_f32_16x16x32_bf16 v[44:47], v[132:135], v[104:107], v[44:47]
    ds_read_b128 v[164:167], v3 offset:11264
    buffer_load_dwordx4 v[100:103], v1, s[8:11], s84 offen offset:1024 sc1
    s_waitcnt lgkmcnt(6)
    v_mfma_f32_16x16x32_bf16 v[48:51], v[136:139], v[104:107], v[48:51]
    ds_read_b128 v[128:131], v2 offset:16384
    v_mfma_f32_16x16x32_bf16 v[52:55], v[140:143], v[104:107], v[52:55]
    ds_read_b128 v[132:135], v2 offset:17408
    s_waitcnt lgkmcnt(6)
    v_mfma_f32_16x16x32_bf16 v[56:59], v[144:147], v[104:107], v[56:59]
    ds_read_b128 v[136:139], v2 offset:18432
    s_waitcnt vmcnt(18)
    v_mfma_f32_16x16x32_bf16 v[40:43], v[148:151], v[108:111], v[40:43]
    ds_read_b128 v[140:143], v2 offset:19456
    s_waitcnt lgkmcnt(6)
    v_mfma_f32_16x16x32_bf16 v[44:47], v[152:155], v[108:111], v[44:47]
    ds_read_b128 v[144:147], v2 offset:20480
    buffer_load_dwordx4 v[104:107], v1, s[8:11], s84 offen offset:2048 sc1
    v_mfma_f32_16x16x32_bf16 v[48:51], v[156:159], v[108:111], v[48:51]
    ds_read_b128 v[148:151], v2 offset:21504
    s_waitcnt lgkmcnt(6)
    v_mfma_f32_16x16x32_bf16 v[52:55], v[160:163], v[108:111], v[52:55]
    ds_read_b128 v[152:155], v2 offset:22528
    v_mfma_f32_16x16x32_bf16 v[56:59], v[164:167], v[108:111], v[56:59]
    ds_read_b128 v[156:159], v2 offset:23552
    s_waitcnt vmcnt(17) lgkmcnt(6)
    v_mfma_f32_16x16x32_bf16 v[40:43], v[128:131], v[112:115], v[40:43]
    ds_read_b128 v[160:163], v2 offset:24576
    v_mfma_f32_16x16x32_bf16 v[44:47], v[132:135], v[112:115], v[44:47]
    ds_read_b128 v[164:167], v2 offset:25600
    buffer_load_dwordx4 v[108:111], v1, s[8:11], s84 offen offset:3072 sc1
    s_waitcnt lgkmcnt(6)
    v_mfma_f32_16x16x32_bf16 v[48:51], v[136:139], v[112:115], v[48:51]
    ds_read_b128 v[128:131], v2 offset:26624
    v_mfma_f32_16x16x32_bf16 v[52:55], v[140:143], v[112:115], v[52:55]
    ds_read_b128 v[132:135], v2 offset:27648
    s_waitcnt lgkmcnt(6)
    v_mfma_f32_16x16x32_bf16 v[56:59], v[144:147], v[112:115], v[56:59]
    ds_read_b128 v[136:139], v2 offset:28672
    s_waitcnt vmcnt(16)
    v_mfma_f32_16x16x32_bf16 v[40:43], v[148:151], v[116:119], v[40:43]
    ds_read_b128 v[140:143], v2 offset:29696
    s_waitcnt lgkmcnt(6)
    v_mfma_f32_16x16x32_bf16 v[44:47], v[152:155], v[116:119], v[44:47]
    ds_read_b128 v[144:147], v2 offset:30720
    s_add_u32 s84, s59, 37793792
    buffer_load_dwordx4 v[112:115], v1, s[8:11], s84 offen offset:0 sc1
    v_mfma_f32_16x16x32_bf16 v[48:51], v[156:159], v[116:119], v[48:51]
    ds_read_b128 v[148:151], v2 offset:31744
    s_waitcnt lgkmcnt(6)
    v_mfma_f32_16x16x32_bf16 v[52:55], v[160:163], v[116:119], v[52:55]
    ds_read_b128 v[152:155], v2 offset:32768
    v_mfma_f32_16x16x32_bf16 v[56:59], v[164:167], v[116:119], v[56:59]
    ds_read_b128 v[156:159], v2 offset:33792
    s_waitcnt vmcnt(15) lgkmcnt(6)
    v_mfma_f32_16x16x32_bf16 v[40:43], v[128:131], v[120:123], v[40:43]
    ds_read_b128 v[160:163], v2 offset:34816
    v_mfma_f32_16x16x32_bf16 v[44:47], v[132:135], v[120:123], v[44:47]
    ds_read_b128 v[164:167], v2 offset:35840
    buffer_load_dwordx4 v[116:119], v1, s[8:11], s84 offen offset:1024 sc1
    s_waitcnt lgkmcnt(6)
    v_mfma_f32_16x16x32_bf16 v[48:51], v[136:139], v[120:123], v[48:51]
    ds_read_b128 v[128:131], v3 offset:12288
    v_mfma_f32_16x16x32_bf16 v[52:55], v[140:143], v[120:123], v[52:55]
    ds_read_b128 v[132:135], v3 offset:13312
    s_waitcnt lgkmcnt(6)
    v_mfma_f32_16x16x32_bf16 v[56:59], v[144:147], v[120:123], v[56:59]
    ds_read_b128 v[136:139], v3 offset:14336
    s_waitcnt vmcnt(14)
    v_mfma_f32_16x16x32_bf16 v[40:43], v[148:151], v[124:127], v[40:43]
    ds_read_b128 v[140:143], v3 offset:15360
    s_waitcnt lgkmcnt(6)
    v_mfma_f32_16x16x32_bf16 v[44:47], v[152:155], v[124:127], v[44:47]
    ds_read_b128 v[144:147], v3 offset:16384
    buffer_load_dwordx4 v[120:123], v1, s[8:11], s84 offen offset:2048 sc1
    v_mfma_f32_16x16x32_bf16 v[48:51], v[156:159], v[124:127], v[48:51]
    ds_read_b128 v[148:151], v3 offset:17408
    s_waitcnt lgkmcnt(6)
    v_mfma_f32_16x16x32_bf16 v[52:55], v[160:163], v[124:127], v[52:55]
    ds_read_b128 v[152:155], v3 offset:18432
    v_mfma_f32_16x16x32_bf16 v[56:59], v[164:167], v[124:127], v[56:59]
    ds_read_b128 v[156:159], v3 offset:19456
    s_waitcnt vmcnt(13) lgkmcnt(6)
    v_mfma_f32_16x16x32_bf16 v[40:43], v[128:131], v[80:83], v[40:43]
    ds_read_b128 v[160:163], v3 offset:20480
    v_mfma_f32_16x16x32_bf16 v[44:47], v[132:135], v[80:83], v[44:47]
    ds_read_b128 v[164:167], v3 offset:21504
    buffer_load_dwordx4 v[124:127], v1, s[8:11], s84 offen offset:3072 sc1
    s_waitcnt lgkmcnt(6)
    v_mfma_f32_16x16x32_bf16 v[48:51], v[136:139], v[80:83], v[48:51]
    ds_read_b128 v[128:131], v3 offset:22528
    v_mfma_f32_16x16x32_bf16 v[52:55], v[140:143], v[80:83], v[52:55]
    ds_read_b128 v[132:135], v3 offset:23552
    s_waitcnt lgkmcnt(6)
    v_mfma_f32_16x16x32_bf16 v[56:59], v[144:147], v[80:83], v[56:59]
    ds_read_b128 v[136:139], v3 offset:24576
    s_waitcnt vmcnt(12)
    v_mfma_f32_16x16x32_bf16 v[40:43], v[148:151], v[84:87], v[40:43]
    ds_read_b128 v[140:143], v3 offset:25600
    s_waitcnt lgkmcnt(6)
    v_mfma_f32_16x16x32_bf16 v[44:47], v[152:155], v[84:87], v[44:47]
    ds_read_b128 v[144:147], v3 offset:26624
    v_mfma_f32_16x16x32_bf16 v[48:51], v[156:159], v[84:87], v[48:51]
    ds_read_b128 v[148:151], v3 offset:27648
    s_waitcnt lgkmcnt(6)
    v_mfma_f32_16x16x32_bf16 v[52:55], v[160:163], v[84:87], v[52:55]
    ds_read_b128 v[152:155], v3 offset:28672
    v_mfma_f32_16x16x32_bf16 v[56:59], v[164:167], v[84:87], v[56:59]
    s_waitcnt vmcnt(9)
    s_barrier
    ds_read_b128 v[156:159], v3 offset:29696
    s_waitcnt lgkmcnt(6)
    v_mfma_f32_16x16x32_bf16 v[40:43], v[128:131], v[88:91], v[40:43]
    ds_read_b128 v[160:163], v3 offset:30720
    v_mfma_f32_16x16x32_bf16 v[44:47], v[132:135], v[88:91], v[44:47]
    ds_read_b128 v[164:167], v3 offset:31744
    s_waitcnt lgkmcnt(6)
    v_mfma_f32_16x16x32_bf16 v[48:51], v[136:139], v[88:91], v[48:51]
    ds_read_b128 v[128:131], v1 offset:0
    v_mfma_f32_16x16x32_bf16 v[52:55], v[140:143], v[88:91], v[52:55]
    ds_read_b128 v[132:135], v1 offset:1024
    s_waitcnt lgkmcnt(6)
    v_mfma_f32_16x16x32_bf16 v[56:59], v[144:147], v[88:91], v[56:59]
    ds_read_b128 v[136:139], v1 offset:2048
    s_waitcnt vmcnt(8)
    v_mfma_f32_16x16x32_bf16 v[40:43], v[148:151], v[92:95], v[40:43]
    ds_read_b128 v[140:143], v1 offset:3072
    s_getpc_b64 s[4:5]
PCL_25:
    s_lshl_b32 s6, s45, 2
    s_add_u32 s6, s6, s49
    s_and_b32 s6, s6, 31
    s_lshl_b32 s6, s6, 10
    v_add_u32 v19, s6, v1
    v_min_u32 v19, CODE_END-PCL_25-16, v19
    global_load_dword a253, v19, s[4:5]
    s_waitcnt lgkmcnt(6)
    v_mfma_f32_16x16x32_bf16 v[44:47], v[152:155], v[92:95], v[44:47]
    ds_read_b128 v[144:147], v1 offset:4096
    v_mfma_f32_16x16x32_bf16 v[48:51], v[156:159], v[92:95], v[48:51]
    ds_read_b128 v[148:151], v1 offset:5120
    s_waitcnt lgkmcnt(6)
    v_mfma_f32_16x16x32_bf16 v[52:55], v[160:163], v[92:95], v[52:55]
    ds_read_b128 v[152:155], v1 offset:6144
    v_mfma_f32_16x16x32_bf16 v[56:59], v[164:167], v[92:95], v[56:59]
    ds_read_b128 v[156:159], v1 offset:7168
    s_waitcnt vmcnt(8) lgkmcnt(6)
    v_mfma_f32_16x16x32_bf16 v[40:43], v[128:131], v[96:99], v[40:43]
    ds_read_b128 v[160:163], v1 offset:8192
    v_mfma_f32_16x16x32_bf16 v[44:47], v[132:135], v[96:99], v[44:47]
    ds_read_b128 v[164:167], v1 offset:9216
    s_waitcnt lgkmcnt(6)
    v_mfma_f32_16x16x32_bf16 v[48:51], v[136:139], v[96:99], v[48:51]
    ds_read_b128 v[128:131], v1 offset:10240
    v_mfma_f32_16x16x32_bf16 v[52:55], v[140:143], v[96:99], v[52:55]
    ds_read_b128 v[132:135], v1 offset:11264
    s_waitcnt lgkmcnt(6)
    v_mfma_f32_16x16x32_bf16 v[56:59], v[144:147], v[96:99], v[56:59]
    ds_read_b128 v[136:139], v1 offset:12288
    s_waitcnt vmcnt(7)
    v_mfma_f32_16x16x32_bf16 v[40:43], v[148:151], v[100:103], v[40:43]
    ds_read_b128 v[140:143], v1 offset:13312
    s_waitcnt lgkmcnt(6)
    v_mfma_f32_16x16x32_bf16 v[44:47], v[152:155], v[100:103], v[44:47]
    ds_read_b128 v[144:147], v1 offset:14336
    v_mfma_f32_16x16x32_bf16 v[48:51], v[156:159], v[100:103], v[48:51]
    ds_read_b128 v[148:151], v1 offset:15360
    s_waitcnt lgkmcnt(6)
    v_mfma_f32_16x16x32_bf16 v[52:55], v[160:163], v[100:103], v[52:55]
    ds_read_b128 v[152:155], v1 offset:16384
    v_mfma_f32_16x16x32_bf16 v[56:59], v[164:167], v[100:103], v[56:59]
    ds_read_b128 v[156:159], v1 offset:17408
    s_waitcnt vmcnt(6) lgkmcnt(6)
    v_mfma_f32_16x16x32_bf16 v[40:43], v[128:131], v[104:107], v[40:43]
    ds_read_b128 v[160:163], v1 offset:18432
    v_mfma_f32_16x16x32_bf16 v[44:47], v[132:135], v[104:107], v[44:47]
    ds_read_b128 v[164:167], v1 offset:19456
    s_waitcnt lgkmcnt(6)
    v_mfma_f32_16x16x32_bf16 v[48:51], v[136:139], v[104:107], v[48:51]
    ds_read_b128 v[128:131], v1 offset:61440
    v_mfma_f32_16x16x32_bf16 v[52:55], v[140:143], v[104:107], v[52:55]
    ds_read_b128 v[132:135], v1 offset:62464
    s_waitcnt lgkmcnt(6)
    v_mfma_f32_16x16x32_bf16 v[56:59], v[144:147], v[104:107], v[56:59]
    ds_read_b128 v[136:139], v1 offset:63488
    s_waitcnt vmcnt(5)
    v_mfma_f32_16x16x32_bf16 v[40:43], v[148:151], v[108:111], v[40:43]
    ds_read_b128 v[140:143], v1 offset:64512
    s_waitcnt lgkmcnt(6)
    v_mfma_f32_16x16x32_bf16 v[44:47], v[152:155], v[108:111], v[44:47]
    ds_read_b128 v[144:147], v2 offset:0
    v_mfma_f32_16x16x32_bf16 v[48:51], v[156:159], v[108:111], v[48:51]
    ds_read_b128 v[148:151], v2 offset:1024
    s_waitcnt lgkmcnt(6)
    v_mfma_f32_16x16x32_bf16 v[52:55], v[160:163], v[108:111], v[52:55]
    ds_read_b128 v[152:155], v2 offset:2048
    v_mfma_f32_16x16x32_bf16 v[56:59], v[164:167], v[108:111], v[56:59]
    ds_read_b128 v[156:159], v2 offset:3072
    s_waitcnt vmcnt(4) lgkmcnt(6)
    v_mfma_f32_16x16x32_bf16 v[40:43], v[128:131], v[112:115], v[40:43]
    ds_read_b128 v[160:163], v2 offset:4096
    v_mfma_f32_16x16x32_bf16 v[44:47], v[132:135], v[112:115], v[44:47]
    ds_read_b128 v[164:167], v2 offset:5120
    s_waitcnt lgkmcnt(6)
    v_mfma_f32_16x16x32_bf16 v[48:51], v[136:139], v[112:115], v[48:51]
    ds_read_b128 v[128:131], v2 offset:6144
    v_mfma_f32_16x16x32_bf16 v[52:55], v[140:143], v[112:115], v[52:55]
    ds_read_b128 v[132:135], v2 offset:7168
    s_waitcnt lgkmcnt(6)
    v_mfma_f32_16x16x32_bf16 v[56:59], v[144:147], v[112:115], v[56:59]
    ds_read_b128 v[136:139], v2 offset:8192
    s_waitcnt vmcnt(3)
    v_mfma_f32_16x16x32_bf16 v[40:43], v[148:151], v[116:119], v[40:43]
    ds_read_b128 v[140:143], v2 offset:9216
    s_waitcnt lgkmcnt(6)
    v_mfma_f32_16x16x32_bf16 v[44:47], v[152:155], v[116:119], v[44:47]
    ds_read_b128 v[144:147], v2 offset:10240
    v_mfma_f32_16x16x32_bf16 v[48:51], v[156:159], v[116:119], v[48:51]
    ds_read_b128 v[148:151], v2 offset:11264
    s_waitcnt lgkmcnt(6)
    v_mfma_f32_16x16x32_bf16 v[52:55], v[160:163], v[116:119], v[52:55]
    ds_read_b128 v[152:155], v2 offset:12288
    v_mfma_f32_16x16x32_bf16 v[56:59], v[164:167], v[116:119], v[56:59]
    ds_read_b128 v[156:159], v2 offset:13312
    ds_write_b128 v168, v[176:179] offset:20480
    s_waitcnt vmcnt(2) lgkmcnt(7)
    v_mfma_f32_16x16x32_bf16 v[40:43], v[128:131], v[120:123], v[40:43]
    ds_read_b128 v[160:163], v2 offset:14336
    ds_write_b128 v168, v[180:183] offset:21504
    v_mfma_f32_16x16x32_bf16 v[44:47], v[132:135], v[120:123], v[44:47]
    ds_read_b128 v[164:167], v2 offset:15360
    ds_write_b128 v168, v[184:187] offset:22528
    s_waitcnt lgkmcnt(9)
    v_mfma_f32_16x16x32_bf16 v[48:51], v[136:139], v[120:123], v[48:51]
    ds_write_b128 v168, v[188:191] offset:23552
    v_mfma_f32_16x16x32_bf16 v[52:55], v[140:143], v[120:123], v[52:55]
    ds_write_b128 v168, v[192:195] offset:24576
    s_waitcnt lgkmcnt(9)
    v_mfma_f32_16x16x32_bf16 v[56:59], v[144:147], v[120:123], v[56:59]
    ds_write_b128 v168, v[196:199] offset:40960
    s_waitcnt vmcnt(1)
    v_mfma_f32_16x16x32_bf16 v[40:43], v[148:151], v[124:127], v[40:43]
    s_waitcnt lgkmcnt(8)
    v_mfma_f32_16x16x32_bf16 v[44:47], v[152:155], v[124:127], v[44:47]
    v_mfma_f32_16x16x32_bf16 v[48:51], v[156:159], v[124:127], v[48:51]
    s_waitcnt lgkmcnt(4)
    v_mfma_f32_16x16x32_bf16 v[52:55], v[160:163], v[124:127], v[52:55]
    v_mfma_f32_16x16x32_bf16 v[56:59], v[164:167], v[124:127], v[56:59]
    s_nop 1
    v_cvt_pk_bf16_f32 v8, v40, v41
    v_cvt_pk_bf16_f32 v9, v42, v43
    v_cvt_pk_bf16_f32 v10, v44, v45
    v_cvt_pk_bf16_f32 v11, v46, v47
    v_cvt_pk_bf16_f32 v12, v48, v49
    v_cvt_pk_bf16_f32 v13, v50, v51
    v_cvt_pk_bf16_f32 v14, v52, v53
    v_cvt_pk_bf16_f32 v15, v54, v55
    v_cvt_pk_bf16_f32 v16, v56, v57
    v_cvt_pk_bf16_f32 v17, v58, v59
    s_add_u32 s82, s52, 18874368
    s_add_u32 s83, s53, 18874368
    s_cmp_eq_u32 s50, 0
    s_cbranch_scc1 SLOW_13
    buffer_store_dwordx4 v[8:11], v1, s[8:11], s82 offen
    buffer_store_dwordx4 v[12:15], v1, s[8:11], s82 offen offset:1024
    buffer_store_dwordx2 v[16:17], v4, s[8:11], s83 offen
BACK_13:
    v_pk_add_f32 v[72:73], v[40:41], v[42:43]
    v_pk_mul_f32 v[74:75], v[40:41], v[40:41]
    v_pk_fma_f32 v[74:75], v[42:43], v[42:43], v[74:75]
    v_pk_add_f32 v[72:73], v[72:73], v[44:45]
    v_pk_fma_f32 v[74:75], v[44:45], v[44:45], v[74:75]
    v_pk_add_f32 v[72:73], v[72:73], v[46:47]
    v_pk_fma_f32 v[74:75], v[46:47], v[46:47], v[74:75]
    v_pk_add_f32 v[72:73], v[72:73], v[48:49]
    v_pk_fma_f32 v[74:75], v[48:49], v[48:49], v[74:75]
    v_pk_add_f32 v[72:73], v[72:73], v[50:51]
    v_pk_fma_f32 v[74:75], v[50:51], v[50:51], v[74:75]
    v_pk_add_f32 v[72:73], v[72:73], v[52:53]
    v_pk_fma_f32 v[74:75], v[52:53], v[52:53], v[74:75]
    v_pk_add_f32 v[72:73], v[72:73], v[54:55]
    v_pk_fma_f32 v[74:75], v[54:55], v[54:55], v[74:75]
    v_pk_add_f32 v[72:73], v[72:73], v[56:57]
    v_pk_fma_f32 v[74:75], v[56:57], v[56:57], v[74:75]
    v_pk_add_f32 v[72:73], v[72:73], v[58:59]
    v_pk_fma_f32 v[74:75], v[58:59], v[58:59], v[74:75]
    v_add_f32 v72, v72, v73
    v_add_f32 v74, v74, v75
    s_nop 1
    v_permlane32_swap_b32 v72, v74
    v_add_f32 v72, v72, v74
    v_mov_b32 v73, v72
    s_nop 1
    v_permlane16_swap_b32 v72, v73
    v_add_f32 v72, v72, v73
    v_and_or_b32 v72, v72, -4, 2
    s_add_u32 s82, s54, 18874368
    s_cmp_eq_u32 s50, 0
    s_cbranch_scc1 SLOW_14
    buffer_store_dword v72, v5, s[8:11], s82 offen
BACK_14:
    ds_write_b128 v168, v[200:203] offset:41984
    ds_write_b128 v168, v[204:207] offset:43008
    ds_write_b128 v168, v[208:211] offset:44032
    ds_write_b128 v168, v[212:215] offset:45056
    ds_write_b128 v169, v[216:219] offset:36864
    ds_write_b128 v169, v[220:223] offset:37888
    s_waitcnt vmcnt(1)
    v_mov_b32 v7, 5
    v_mov_b32 v18, 0
    s_mov_b64 exec, 1
    s_cmp_eq_u32 s50, 0
    s_cbranch_scc1 SLOW_15
    buffer_store_dword v7, v18, s[8:11], s76 offen
BACK_15:
    s_mov_b64 exec, -1
    ds_write_b128 v169, v[224:227] offset:38912
    ds_write_b128 v169, v[228:231] offset:39936
    ds_write_b128 v169, v[232:235] offset:40960
    ds_write_b128 v169, v[236:239] offset:57344
    ds_write_b128 v169, v[240:243] offset:58368
    ds_write_b128 v169, v[244:247] offset:59392
    ds_write_b128 v169, v[248:251] offset:60416
    ds_write_b128 v169, v[252:255] offset:61440
    v_add_u32 v44, 21504, v1
    v_add_u32 v45, 43008, v1
    v_add_u32 v46, 64512, v1
    s_lshl_b32 s85, s49, 10
    v_accvgpr_read_b32 v76, a240
    v_accvgpr_read_b32 v77, a241
    v_accvgpr_read_b32 v78, a242
    v_accvgpr_read_b32 v79, a243
    v_accvgpr_read_b32 v80, a244
    v_accvgpr_read_b32 v81, a245
    v_accvgpr_read_b32 v82, a246
    v_accvgpr_read_b32 v83, a247
    v_bfe_u32 v64, v0, 3, 1
    v_add_u32 v64, -1, v64
    v_not_b32 v65, v64
    v_and_b32 v84, v76, v64
    v_and_b32 v85, v77, v64
    v_and_b32 v86, v78, v64
    v_and_b32 v87, v79, v64
    v_and_b32 v88, v80, v64
    v_and_b32 v89, v81, v64
    v_and_b32 v90, v82, v64
    v_and_b32 v91, v83, v64
    v_and_b32 v92, v76, v65
    v_and_b32 v93, v77, v65
    v_and_b32 v94, v78, v65
    v_and_b32 v95, v79, v65
    v_and_b32 v96, v80, v65
    v_and_b32 v97, v81, v65
    v_and_b32 v98, v82, v65
    v_and_b32 v99, v83, v65
    v_add_u32 v64, 81920, v1
    v_add_u32 v65, s85, v64
    ds_write_b128 v65, v[84:87]
    ds_write_b128 v64, v[88:91] offset:4096
    ds_write_b128 v65, v[92:95] offset:5120
    ds_write_b128 v64, v[96:99] offset:9216
    v_mov_b32 v72, 0
    v_mov_b32 v73, 0
    v_mov_b32 v74, 0
    v_mov_b32 v75, 0
    v_min_u32 v64, 560, v1
    v_add_u32 v64, 97248, v64
    ds_write_b128 v64, v[72:75]
    s_waitcnt lgkmcnt(0)
    s_barrier
    ds_read_b128 v[104:107], v1 offset:20480
    ds_read_b128 v[108:111], v1 offset:21504
    ds_read_b128 v[112:115], v1 offset:22528
    ds_read_b128 v[116:119], v1 offset:23552
    ds_read_b128 v[120:123], v1 offset:24576
    s_lshl_b32 s85, s44, 2
    s_add_u32 s85, s85, s49
    s_lshl_b32 s85, s85, 7
    s_add_u32 s85, s85, 13635584
    s_mov_b32 s92, s67
POLL_26:
    buffer_load_dword v7, v6, s[8:11], s85 offen sc1
    s_waitcnt vmcnt(0)
    v_cmp_le_u32 vcc, 5, v7
    s_nop 0
    s_cmp_eq_u64 vcc, -1
    s_cbranch_scc1 PDONE_27
    s_sub_u32 s92, s92, 1
    s_cbranch_scc0 POLL_26
    s_mov_b32 s67, 0
PDONE_27:
    s_add_u32 s84, s68, s36
    s_add_u32 s84, s84, 18874368
    buffer_load_dwordx4 v[128:131], v1, s[8:11], s84 offen offset:0 sc1
    buffer_load_dwordx4 v[132:135], v44, s[8:11], s84 offen offset:0 sc1
    buffer_load_dwordx4 v[136:139], v45, s[8:11], s84 offen offset:0 sc1
    buffer_load_dwordx4 v[140:143], v46, s[8:11], s84 offen offset:0 sc1
    buffer_load_dwordx4 v[144:147], v1, s[8:11], s84 offen offset:1024 sc1
    buffer_load_dwordx4 v[148:151], v44, s[8:11], s84 offen offset:1024 sc1
    buffer_load_dwordx4 v[152:155], v45, s[8:11], s84 offen offset:1024 sc1
    buffer_load_dwordx4 v[156:159], v46, s[8:11], s84 offen offset:1024 sc1
    buffer_load_dwordx4 v[160:163], v1, s[8:11], s84 offen offset:2048 sc1
    buffer_load_dwordx4 v[164:167], v44, s[8:11], s84 offen offset:2048 sc1
    buffer_load_dwordx4 v[168:171], v45, s[8:11], s84 offen offset:2048 sc1
    buffer_load_dwordx4 v[172:175], v46, s[8:11], s84 offen offset:2048 sc1
    s_waitcnt vmcnt(11) lgkmcnt(4)
    v_mfma_f32_16x16x32_bf16 v[192:195], v[104:107], v[128:131], 0
    ds_read_b128 v[124:127], v1 offset:25600
    s_waitcnt vmcnt(10)
    v_mfma_f32_16x16x32_bf16 v[208:211], v[104:107], v[132:135], 0
    buffer_load_dwordx4 v[176:179], v1, s[8:11], s84 offen offset:3072 sc1
    s_waitcnt vmcnt(10)
    v_mfma_f32_16x16x32_bf16 v[224:227], v[104:107], v[136:139], 0
    s_waitcnt vmcnt(9)
    v_mfma_f32_16x16x32_bf16 v[240:243], v[104:107], v[140:143], 0
    s_waitcnt lgkmcnt(4)
    v_mfma_f32_16x16x32_bf16 v[196:199], v[108:111], v[128:131], 0
    ds_read_b128 v[104:107], v1 offset:26624
    v_accvgpr_read_b32 v64, a248
    v_mfma_f32_16x16x32_bf16 v[212:215], v[108:111], v[132:135], 0
    buffer_load_dwordx4 v[180:183], v44, s[8:11], s84 offen offset:3072 sc1
    v_mfma_f32_16x16x32_bf16 v[228:231], v[108:111], v[136:139], 0
    v_mov_b32_dpp v20, v64 row_newbcast:0 row_mask:0xf bank_mask:0xf
    v_mov_b32_dpp v21, v64 row_newbcast:1 row_mask:0xf bank_mask:0xf
    v_mfma_f32_16x16x32_bf16 v[244:247], v[108:111], v[140:143], 0
    s_waitcnt lgkmcnt(4)
    v_mov_b32_dpp v22, v64 row_newbcast:2 row_mask:0xf bank_mask:0xf
    v_mov_b32_dpp v23, v64 row_newbcast:3 row_mask:0xf bank_mask:0xf
    v_mfma_f32_16x16x32_bf16 v[200:203], v[112:115], v[128:131], 0
    ds_read_b128 v[108:111], v1 offset:27648
    v_mov_b32_dpp v24, v64 row_newbcast:4 row_mask:0xf bank_mask:0xf
    v_mfma_f32_16x16x32_bf16 v[216:219], v[112:115], v[132:135], 0
    buffer_load_dwordx4 v[184:187], v45, s[8:11], s84 offen offset:3072 sc1
    v_mfma_f32_16x16x32_bf16 v[232:235], v[112:115], v[136:139], 0
    v_mov_b32_dpp v25, v64 row_newbcast:5 row_mask:0xf bank_mask:0xf
    v_mov_b32_dpp v26, v64 row_newbcast:6 row_mask:0xf bank_mask:0xf
    v_mfma_f32_16x16x32_bf16 v[248:251], v[112:115], v[140:143], 0
    s_waitcnt lgkmcnt(4)
    v_mov_b32_dpp v27, v64 row_newbcast:7 row_mask:0xf bank_mask:0xf
    v_mov_b32_dpp v28, v64 row_newbcast:8 row_mask:0xf bank_mask:0xf
    v_mfma_f32_16x16x32_bf16 v[204:207], v[116:119], v[128:131], 0
    ds_read_b128 v[112:115], v1 offset:28672
    v_mov_b32_dpp v29, v64 row_newbcast:9 row_mask:0xf bank_mask:0xf
    v_mfma_f32_16x16x32_bf16 v[220:223], v[116:119], v[132:135], 0
    buffer_load_dwordx4 v[188:191], v46, s[8:11], s84 offen offset:3072 sc1
    v_mfma_f32_16x16x32_bf16 v[236:239], v[116:119], v[136:139], 0
    v_mov_b32_dpp v30, v64 row_newbcast:10 row_mask:0xf bank_mask:0xf
    v_mov_b32_dpp v31, v64 row_newbcast:11 row_mask:0xf bank_mask:0xf
    v_mfma_f32_16x16x32_bf16 v[252:255], v[116:119], v[140:143], 0
    s_waitcnt vmcnt(11) lgkmcnt(4)
    v_mov_b32_dpp v32, v64 row_newbcast:12 row_mask:0xf bank_mask:0xf
    v_mov_b32_dpp v33, v64 row_newbcast:13 row_mask:0xf bank_mask:0xf
    v_mfma_f32_16x16x32_bf16 v[192:195], v[120:123], v[144:147], v[192:195]
    ds_read_b128 v[116:119], v1 offset:29696
    s_waitcnt vmcnt(10)
    v_mov_b32_dpp v34, v64 row_newbcast:14 row_mask:0xf bank_mask:0xf
    v_mfma_f32_16x16x32_bf16 v[208:211], v[120:123], v[148:151], v[208:211]
    s_add_u32 s84, s68, s37
    s_add_u32 s84, s84, 18874368
    buffer_load_dwordx4 v[128:131], v1, s[8:11], s84 offen offset:0 sc1
    s_waitcnt vmcnt(10)
    v_mfma_f32_16x16x32_bf16 v[224:227], v[120:123], v[152:155], v[224:227]
    s_waitcnt vmcnt(9)
    v_mov_b32_dpp v35, v64 row_newbcast:15 row_mask:0xf bank_mask:0xf
    v_mfma_f32_16x16x32_bf16 v[240:243], v[120:123], v[156:159], v[240:243]
    s_waitcnt lgkmcnt(4)
    s_mov_b32 s79, 0
    s_cmp_lt_u32 s49, 2
    s_cselect_b32 s79, 143360, s79
    v_mfma_f32_16x16x32_bf16 v[196:199], v[124:127], v[144:147], v[196:199]
    ds_read_b128 v[120:123], v1 offset:30720
    s_and_b32 s85, s49, 1
    v_mfma_f32_16x16x32_bf16 v[212:215], v[124:127], v[148:151], v[212:215]
    buffer_load_dwordx4 v[132:135], v44, s[8:11], s84 offen offset:0 sc1
    v_mfma_f32_16x16x32_bf16 v[228:231], v[124:127], v[152:155], v[228:231]
    s_mul_i32 s85, s85, 10240
    s_add_u32 s79, s79, s85
    v_and_b32 v68, 15, v0
    v_mfma_f32_16x16x32_bf16 v[244:247], v[124:127], v[156:159], v[244:247]
    s_waitcnt lgkmcnt(4)
    v_lshrrev_b32 v69, 4, v0
    v_mfma_f32_16x16x32_bf16 v[200:203], v[104:107], v[144:147], v[200:203]
    ds_read_b128 v[124:127], v1 offset:31744
    s_lshl_b32 s85, s49, 6
    v_mfma_f32_16x16x32_bf16 v[216:219], v[104:107], v[148:151], v[216:219]
    buffer_load_dwordx4 v[136:139], v45, s[8:11], s84 offen offset:0 sc1
    v_mfma_f32_16x16x32_bf16 v[232:235], v[104:107], v[152:155], v[232:235]
    s_add_u32 s85, s85, 94208
    v_lshlrev_b32 v64, 4, v69
    v_add_u32 v63, s85, v64
    v_mfma_f32_16x16x32_bf16 v[248:251], v[104:107], v[156:159], v[248:251]
    s_waitcnt lgkmcnt(4)
    v_add_u32 v62, 94208, v64
    v_lshrrev_b32 v64, 5, v0
    v_mfma_f32_16x16x32_bf16 v[204:207], v[108:111], v[144:147], v[204:207]
    ds_read_b128 v[104:107], v1 offset:32768
    v_lshl_add_u32 v64, v64, 4, v68
    v_mfma_f32_16x16x32_bf16 v[220:223], v[108:111], v[148:151], v[220:223]
    buffer_load_dwordx4 v[140:143], v46, s[8:11], s84 offen offset:0 sc1
    v_mfma_f32_16x16x32_bf16 v[236:239], v[108:111], v[152:155], v[236:239]
    v_mul_u32_u24 v50, 80, v64
    v_and_b32 v64, 1, v69
    v_mfma_f32_16x16x32_bf16 v[252:255], v[108:111], v[156:159], v[252:255]
    s_waitcnt vmcnt(11) lgkmcnt(4)
    v_mul_u32_u24 v64, 40, v64
    v_add3_u32 v50, v50, v64, s79
    v_mfma_f32_16x16x32_bf16 v[192:195], v[112:115], v[160:163], v[192:195]
    ds_read_b128 v[108:111], v1 offset:33792
    s_waitcnt vmcnt(10)
    v_mul_u32_u24 v64, 72, v68
    v_mfma_f32_16x16x32_bf16 v[208:211], v[112:115], v[164:167], v[208:211]
    buffer_load_dwordx4 v[144:147], v1, s[8:11], s84 offen offset:1024 sc1
    s_waitcnt vmcnt(10)
    v_mfma_f32_16x16x32_bf16 v[224:227], v[112:115], v[168:171], v[224:227]
    s_waitcnt vmcnt(9)
    v_add_u32 v64, s79, v64
    v_add_u32 v64, 5120, v64
    v_mfma_f32_16x16x32_bf16 v[240:243], v[112:115], v[172:175], v[240:243]
    s_waitcnt lgkmcnt(4)
    v_lshlrev_b32 v65, 3, v69
    v_add_u32 v51, -8, v65
    v_mfma_f32_16x16x32_bf16 v[196:199], v[116:119], v[160:163], v[196:199]
    ds_read_b128 v[112:115], v1 offset:34816
    v_add_u32 v52, 16, v65
    v_mfma_f32_16x16x32_bf16 v[212:215], v[116:119], v[164:167], v[212:215]
    buffer_load_dwordx4 v[148:151], v44, s[8:11], s84 offen offset:1024 sc1
    v_mfma_f32_16x16x32_bf16 v[228:231], v[116:119], v[168:171], v[228:231]
    v_cmp_eq_u32 vcc, 0, v69
    s_nop 1
    v_cndmask_b32 v51, v51, 48, vcc
    v_mfma_f32_16x16x32_bf16 v[244:247], v[116:119], v[172:175], v[244:247]
    s_waitcnt lgkmcnt(4)
    v_cndmask_b32 v52, v52, 56, vcc
    v_add_u32 v51, v51, v64
    v_mfma_f32_16x16x32_bf16 v[200:203], v[120:123], v[160:163], v[200:203]
    ds_read_b128 v[116:119], v1 offset:35840
    v_add_u32 v52, v52, v64
    v_mfma_f32_16x16x32_bf16 v[216:219], v[120:123], v[164:167], v[216:219]
    buffer_load_dwordx4 v[152:155], v45, s[8:11], s84 offen offset:1024 sc1
    v_mfma_f32_16x16x32_bf16 v[232:235], v[120:123], v[168:171], v[232:235]
    v_lshrrev_b32 v64, 2, v68
    v_lshl_add_u32 v64, v69, 3, v64
    v_mfma_f32_16x16x32_bf16 v[248:251], v[120:123], v[172:175], v[248:251]
    s_waitcnt lgkmcnt(4)
    v_and_b32 v65, 3, v0
    v_lshlrev_b32 v65, 3, v65
    v_mfma_f32_16x16x32_bf16 v[204:207], v[124:127], v[160:163], v[204:207]
    ds_read_b128 v[120:123], v1 offset:36864
    v_add_u32 v65, s79, v65
    v_mfma_f32_16x16x32_bf16 v[220:223], v[124:127], v[164:167], v[220:223]
    buffer_load_dwordx4 v[156:159], v46, s[8:11], s84 offen offset:1024 sc1
    v_mfma_f32_16x16x32_bf16 v[236:239], v[124:127], v[168:171], v[236:239]
    v_mad_u32_u24 v53, v64, 20, v65
    v_mad_u32_u24 v53, v64, 60, v53
    v_mfma_f32_16x16x32_bf16 v[252:255], v[124:127], v[172:175], v[252:255]
    s_waitcnt vmcnt(11) lgkmcnt(4)
    v_mad_u32_u24 v54, v64, 12, v65
    v_mad_u32_u24 v54, v64, 60, v54
    v_mfma_f32_16x16x32_bf16 v[192:195], v[104:107], v[176:179], v[192:195]
    ds_read_b128 v[124:127], v1 offset:37888
    s_waitcnt vmcnt(10)
    v_add_u32 v54, 5120, v54
    v_mfma_f32_16x16x32_bf16 v[208:211], v[104:107], v[180:183], v[208:211]
    buffer_load_dwordx4 v[160:163], v1, s[8:11], s84 offen offset:2048 sc1
    s_waitcnt vmcnt(10)
    v_mfma_f32_16x16x32_bf16 v[224:227], v[104:107], v[184:187], v[224:227]
    s_waitcnt vmcnt(9)
    v_min_u32 v64, 59, v0
    v_mul_u32_u24 v65, 3277, v64
    v_mfma_f32_16x16x32_bf16 v[240:243], v[104:107], v[188:191], v[240:243]
    s_waitcnt lgkmcnt(4)
    v_lshrrev_b32 v65, 16, v65
    v_mul_u32_u24 v66, 20, v65
    v_mfma_f32_16x16x32_bf16 v[196:199], v[108:111], v[176:179], v[196:199]
    ds_read_b128 v[104:107], v1 offset:38912
    v_sub_u32 v64, v64, v66
    v_mfma_f32_16x16x32_bf16 v[212:215], v[108:111], v[180:183], v[212:215]
    buffer_load_dwordx4 v[164:167], v44, s[8:11], s84 offen offset:2048 sc1
    v_mfma_f32_16x16x32_bf16 v[228:231], v[108:111], v[184:187], v[228:231]
    v_mul_u32_u24 v66, 13108, v64
    v_lshrrev_b32 v66, 16, v66
    v_mfma_f32_16x16x32_bf16 v[244:247], v[108:111], v[188:191], v[244:247]
    s_waitcnt lgkmcnt(4)
    v_mul_u32_u24 v67, 5, v66
    v_sub_u32 v64, v64, v67
    s_cmp_eq_u32 s49, 3
    s_cselect_b64 vcc, -1, 0
    v_mfma_f32_16x16x32_bf16 v[200:203], v[112:115], v[176:179], v[200:203]
    ds_read_b128 v[108:111], v1 offset:39936
    v_mov_b32 v67, s49
    v_mfma_f32_16x16x32_bf16 v[216:219], v[112:115], v[180:183], v[216:219]
    buffer_load_dwordx4 v[168:171], v45, s[8:11], s84 offen offset:2048 sc1
    v_mfma_f32_16x16x32_bf16 v[232:235], v[112:115], v[184:187], v[232:235]
    v_cndmask_b32 v65, v67, v65, vcc
    v_cndmask_b32 v66, v69, v66, vcc
    v_mfma_f32_16x16x32_bf16 v[248:251], v[112:115], v[188:191], v[248:251]
    s_waitcnt lgkmcnt(4)
    v_cndmask_b32 v64, v68, v64, vcc
    v_cndmask_b32 v67, 0, 1, vcc
    v_mfma_f32_16x16x32_bf16 v[204:207], v[116:119], v[176:179], v[204:207]
    ds_read_b128 v[112:115], v1 offset:40960
    v_lshlrev_b32 v55, 10, v65
    v_mfma_f32_16x16x32_bf16 v[220:223], v[116:119], v[180:183], v[220:223]
    buffer_load_dwordx4 v[172:175], v46, s[8:11], s84 offen offset:2048 sc1
    v_mfma_f32_16x16x32_bf16 v[236:239], v[116:119], v[184:187], v[236:239]
    s_movk_i32 s86, 3072
    v_mad_u32_u24 v55, v67, s86, v55
    v_lshl_add_u32 v55, v66, 8, v55
    v_mfma_f32_16x16x32_bf16 v[252:255], v[116:119], v[188:191], v[252:255]
    s_waitcnt vmcnt(11) lgkmcnt(4)
    v_lshl_add_u32 v55, v64, 4, v55
    v_lshl_add_u32 v65, v65, 2, v66
    v_mfma_f32_16x16x32_bf16 v[192:195], v[120:123], v[128:131], v[192:195]
    ds_read_b128 v[116:119], v1 offset:41984
    s_waitcnt vmcnt(10)
    v_lshl_add_u32 v64, v67, 4, v64
    v_mfma_f32_16x16x32_bf16 v[208:211], v[120:123], v[132:135], v[208:211]
    buffer_load_dwordx4 v[176:179], v1, s[8:11], s84 offen offset:3072 sc1
    s_waitcnt vmcnt(10)
    v_mfma_f32_16x16x32_bf16 v[224:227], v[120:123], v[136:139], v[224:227]
    s_waitcnt vmcnt(9)
    v_mul_u32_u24 v56, 96, v64
    v_lshl_add_u32 v56, v65, 3, v56
    v_mfma_f32_16x16x32_bf16 v[240:243], v[120:123], v[140:143], v[240:243]
    s_waitcnt lgkmcnt(4)
    v_cmp_le_u32 vcc, 5, v65
    s_nop 1
    v_cndmask_b32 v64, 0, 8, vcc
    v_mfma_f32_16x16x32_bf16 v[196:199], v[124:127], v[128:131], v[196:199]
    ds_read_b128 v[120:123], v1 offset:43008
    v_add_u32 v56, v56, v64
    v_mfma_f32_16x16x32_bf16 v[212:215], v[124:127], v[132:135], v[212:215]
    buffer_load_dwordx4 v[180:183], v44, s[8:11], s84 offen offset:3072 sc1
    v_mfma_f32_16x16x32_bf16 v[228:231], v[124:127], v[136:139], v[228:231]
    v_add_u32 v56, 95232, v56
    v_cmp_gt_u32 vcc, 10, v65
    v_mfma_f32_16x16x32_bf16 v[244:247], v[124:127], v[140:143], v[244:247]
    s_waitcnt lgkmcnt(4)
    v_mov_b32 v64, 98112
    v_cndmask_b32 v56, v64, v56, vcc
    v_mfma_f32_16x16x32_bf16 v[200:203], v[104:107], v[128:131], v[200:203]
    ds_read_b128 v[124:127], v1 offset:44032
    v_mov_b32 v64, 2147483648
    v_mfma_f32_16x16x32_bf16 v[216:219], v[104:107], v[132:135], v[216:219]
    buffer_load_dwordx4 v[184:187], v45, s[8:11], s84 offen offset:3072 sc1
    v_mfma_f32_16x16x32_bf16 v[232:235], v[104:107], v[136:139], v[232:235]
    v_lshlrev_b32 v57, 3, v0
    v_cndmask_b32 v57, v64, v57, vcc
    v_mfma_f32_16x16x32_bf16 v[248:251], v[104:107], v[140:143], v[248:251]
    s_waitcnt lgkmcnt(4)
    v_bfe_u32 v64, v0, 2, 1
    v_and_b32 v65, 3, v0
    v_mfma_f32_16x16x32_bf16 v[204:207], v[108:111], v[128:131], v[204:207]
    ds_read_b128 v[104:107], v1 offset:45056
    v_lshl_add_u32 v66, v64, 3, v65
    v_mfma_f32_16x16x32_bf16 v[220:223], v[108:111], v[132:135], v[220:223]
    buffer_load_dwordx4 v[188:191], v46, s[8:11], s84 offen offset:3072 sc1
    v_mfma_f32_16x16x32_bf16 v[236:239], v[108:111], v[136:139], v[236:239]
    v_lshl_add_u32 v67, v64, 1, v65
    v_add_u32 v67, 16, v67
    v_mfma_f32_16x16x32_bf16 v[252:255], v[108:111], v[140:143], v[252:255]
    s_waitcnt vmcnt(11) lgkmcnt(4)
    v_cmp_le_u32 vcc, 2, v65
    s_nop 1
    v_cndmask_b32 v67, v67, 20, vcc
    v_mfma_f32_16x16x32_bf16 v[192:195], v[112:115], v[144:147], v[192:195]
    ds_read_b128 v[108:111], v1 offset:46080
    s_waitcnt vmcnt(10)
    v_bfe_u32 v64, v0, 3, 1
    v_mfma_f32_16x16x32_bf16 v[208:211], v[112:115], v[148:151], v[208:211]
    s_add_u32 s84, s68, s38
    s_add_u32 s84, s84, 18874368
    buffer_load_dwordx4 v[128:131], v1, s[8:11], s84 offen offset:0 sc1
    s_waitcnt vmcnt(10)
    v_mfma_f32_16x16x32_bf16 v[224:227], v[112:115], v[152:155], v[224:227]
    s_waitcnt vmcnt(9)
    v_lshrrev_b32 v65, 5, v0
    v_cmp_eq_u32 vcc, v64, v65
    v_mfma_f32_16x16x32_bf16 v[240:243], v[112:115], v[156:159], v[240:243]
    s_waitcnt lgkmcnt(4)
    v_cndmask_b32 v66, 21, v66, vcc
    v_cndmask_b32 v67, 21, v67, vcc
    v_mfma_f32_16x16x32_bf16 v[196:199], v[116:119], v[144:147], v[196:199]
    ds_read_b128 v[112:115], v1 offset:47104
    v_and_b32 v64, 1, v69
    v_mfma_f32_16x16x32_bf16 v[212:215], v[116:119], v[148:151], v[212:215]
    buffer_load_dwordx4 v[132:135], v44, s[8:11], s84 offen offset:0 sc1
    v_mfma_f32_16x16x32_bf16 v[228:231], v[116:119], v[152:155], v[228:231]
    v_mul_u32_u24 v64, 48, v64
    v_add_u32 v64, 95232, v64
    v_mfma_f32_16x16x32_bf16 v[244:247], v[116:119], v[156:159], v[244:247]
    s_waitcnt lgkmcnt(4)
    s_movk_i32 s85, 96
    v_mad_u32_u24 v58, v66, s85, v64
    v_mfma_f32_16x16x32_bf16 v[200:203], v[120:123], v[144:147], v[200:203]
    ds_read_b128 v[116:119], v1 offset:48128
    v_mad_u32_u24 v59, v67, s85, v64
    v_mfma_f32_16x16x32_bf16 v[216:219], v[120:123], v[148:151], v[216:219]
    buffer_load_dwordx4 v[136:139], v45, s[8:11], s84 offen offset:0 sc1
    v_mfma_f32_16x16x32_bf16 v[232:235], v[120:123], v[152:155], v[232:235]
    v_mul_u32_u24 v60, 20480, v65
    v_lshl_add_u32 v60, v68, 4, v60
    v_mfma_f32_16x16x32_bf16 v[248:251], v[120:123], v[156:159], v[248:251]
    s_waitcnt lgkmcnt(4)
    v_and_b32 v64, 1, v69
    v_lshl_add_u32 v61, v64, 2, v60
    v_mfma_f32_16x16x32_bf16 v[204:207], v[124:127], v[144:147], v[204:207]
    ds_read_b128 v[120:123], v1 offset:49152
    v_lshl_add_u32 v60, v64, 8, v60
    v_mfma_f32_16x16x32_bf16 v[220:223], v[124:127], v[148:151], v[220:223]
    buffer_load_dwordx4 v[140:143], v46, s[8:11], s84 offen offset:0 sc1
    v_mfma_f32_16x16x32_bf16 v[236:239], v[124:127], v[152:155], v[236:239]
    v_mfma_f32_16x16x32_bf16 v[252:255], v[124:127], v[156:159], v[252:255]
    s_waitcnt vmcnt(11) lgkmcnt(4)
    v_mfma_f32_16x16x32_bf16 v[192:195], v[104:107], v[160:163], v[192:195]
    ds_read_b128 v[124:127], v1 offset:50176
    s_waitcnt vmcnt(10)
    v_mfma_f32_16x16x32_bf16 v[208:211], v[104:107], v[164:167], v[208:211]
    buffer_load_dwordx4 v[144:147], v1, s[8:11], s84 offen offset:1024 sc1
    s_waitcnt vmcnt(10)
    v_mfma_f32_16x16x32_bf16 v[224:227], v[104:107], v[168:171], v[224:227]
    s_waitcnt vmcnt(9)
    v_mfma_f32_16x16x32_bf16 v[240:243], v[104:107], v[172:175], v[240:243]
    s_waitcnt lgkmcnt(4)
    v_mfma_f32_16x16x32_bf16 v[196:199], v[108:111], v[160:163], v[196:199]
    ds_read_b128 v[104:107], v1 offset:51200
    v_mfma_f32_16x16x32_bf16 v[212:215], v[108:111], v[164:167], v[212:215]
    buffer_load_dwordx4 v[148:151], v44, s[8:11], s84 offen offset:1024 sc1
    v_mfma_f32_16x16x32_bf16 v[228:231], v[108:111], v[168:171], v[228:231]
    v_mfma_f32_16x16x32_bf16 v[244:247], v[108:111], v[172:175], v[244:247]
    s_waitcnt lgkmcnt(4)
    v_mfma_f32_16x16x32_bf16 v[200:203], v[112:115], v[160:163], v[200:203]
    ds_read_b128 v[108:111], v1 offset:52224
    v_mfma_f32_16x16x32_bf16 v[216:219], v[112:115], v[164:167], v[216:219]
    buffer_load_dwordx4 v[152:155], v45, s[8:11], s84 offen offset:1024 sc1
    v_mfma_f32_16x16x32_bf16 v[232:235], v[112:115], v[168:171], v[232:235]
    v_mfma_f32_16x16x32_bf16 v[248:251], v[112:115], v[172:175], v[248:251]
    s_waitcnt lgkmcnt(4)
    v_mfma_f32_16x16x32_bf16 v[204:207], v[116:119], v[160:163], v[204:207]
    ds_read_b128 v[112:115], v1 offset:53248
    v_mfma_f32_16x16x32_bf16 v[220:223], v[116:119], v[164:167], v[220:223]
    buffer_load_dwordx4 v[156:159], v46, s[8:11], s84 offen offset:1024 sc1
    v_mfma_f32_16x16x32_bf16 v[236:239], v[116:119], v[168:171], v[236:239]
    v_mfma_f32_16x16x32_bf16 v[252:255], v[116:119], v[172:175], v[252:255]
    s_waitcnt vmcnt(11) lgkmcnt(4)
    v_mfma_f32_16x16x32_bf16 v[192:195], v[120:123], v[176:179], v[192:195]
    ds_read_b128 v[116:119], v1 offset:54272
    s_waitcnt vmcnt(10)
    v_mfma_f32_16x16x32_bf16 v[208:211], v[120:123], v[180:183], v[208:211]
    buffer_load_dwordx4 v[160:163], v1, s[8:11], s84 offen offset:2048 sc1
    s_waitcnt vmcnt(10)
    v_mfma_f32_16x16x32_bf16 v[224:227], v[120:123], v[184:187], v[224:227]
    s_waitcnt vmcnt(9)
    v_mfma_f32_16x16x32_bf16 v[240:243], v[120:123], v[188:191], v[240:243]
    s_waitcnt lgkmcnt(4)
    v_mfma_f32_16x16x32_bf16 v[196:199], v[124:127], v[176:179], v[196:199]
    ds_read_b128 v[120:123], v1 offset:55296
    v_mfma_f32_16x16x32_bf16 v[212:215], v[124:127], v[180:183], v[212:215]
    buffer_load_dwordx4 v[164:167], v44, s[8:11], s84 offen offset:2048 sc1
    v_mfma_f32_16x16x32_bf16 v[228:231], v[124:127], v[184:187], v[228:231]
    v_mfma_f32_16x16x32_bf16 v[244:247], v[124:127], v[188:191], v[244:247]
    s_waitcnt lgkmcnt(4)
    v_mfma_f32_16x16x32_bf16 v[200:203], v[104:107], v[176:179], v[200:203]
    ds_read_b128 v[124:127], v1 offset:56320
    v_mfma_f32_16x16x32_bf16 v[216:219], v[104:107], v[180:183], v[216:219]
    buffer_load_dwordx4 v[168:171], v45, s[8:11], s84 offen offset:2048 sc1
    v_mfma_f32_16x16x32_bf16 v[232:235], v[104:107], v[184:187], v[232:235]
    v_mfma_f32_16x16x32_bf16 v[248:251], v[104:107], v[188:191], v[248:251]
    s_waitcnt lgkmcnt(4)
    v_mfma_f32_16x16x32_bf16 v[204:207], v[108:111], v[176:179], v[204:207]
    ds_read_b128 v[104:107], v1 offset:57344
    v_mfma_f32_16x16x32_bf16 v[220:223], v[108:111], v[180:183], v[220:223]
    buffer_load_dwordx4 v[172:175], v46, s[8:11], s84 offen offset:2048 sc1
    v_mfma_f32_16x16x32_bf16 v[236:239], v[108:111], v[184:187], v[236:239]
    v_mfma_f32_16x16x32_bf16 v[252:255], v[108:111], v[188:191], v[252:255]
    s_waitcnt vmcnt(11) lgkmcnt(4)
    v_mfma_f32_16x16x32_bf16 v[192:195], v[112:115], v[128:131], v[192:195]
    ds_read_b128 v[108:111], v1 offset:58368
    s_waitcnt vmcnt(10)
    v_mfma_f32_16x16x32_bf16 v[208:211], v[112:115], v[132:135], v[208:211]
    buffer_load_dwordx4 v[176:179], v1, s[8:11], s84 offen offset:3072 sc1
    s_waitcnt vmcnt(10)
    v_mfma_f32_16x16x32_bf16 v[224:227], v[112:115], v[136:139], v[224:227]
    s_waitcnt vmcnt(9)
    v_mfma_f32_16x16x32_bf16 v[240:243], v[112:115], v[140:143], v[240:243]
    s_waitcnt lgkmcnt(4)
    v_mfma_f32_16x16x32_bf16 v[196:199], v[116:119], v[128:131], v[196:199]
    ds_read_b128 v[112:115], v1 offset:59392
    v_mfma_f32_16x16x32_bf16 v[212:215], v[116:119], v[132:135], v[212:215]
    buffer_load_dwordx4 v[180:183], v44, s[8:11], s84 offen offset:3072 sc1
    v_mfma_f32_16x16x32_bf16 v[228:231], v[116:119], v[136:139], v[228:231]
    v_mfma_f32_16x16x32_bf16 v[244:247], v[116:119], v[140:143], v[244:247]
    s_waitcnt lgkmcnt(4)
    v_mfma_f32_16x16x32_bf16 v[200:203], v[120:123], v[128:131], v[200:203]
    ds_read_b128 v[116:119], v1 offset:60416
    v_mfma_f32_16x16x32_bf16 v[216:219], v[120:123], v[132:135], v[216:219]
    buffer_load_dwordx4 v[184:187], v45, s[8:11], s84 offen offset:3072 sc1
    v_mfma_f32_16x16x32_bf16 v[232:235], v[120:123], v[136:139], v[232:235]
    v_mfma_f32_16x16x32_bf16 v[248:251], v[120:123], v[140:143], v[248:251]
    s_waitcnt lgkmcnt(4)
    v_mfma_f32_16x16x32_bf16 v[204:207], v[124:127], v[128:131], v[204:207]
    ds_read_b128 v[120:123], v2 offset:36864
    v_mfma_f32_16x16x32_bf16 v[220:223], v[124:127], v[132:135], v[220:223]
    buffer_load_dwordx4 v[188:191], v46, s[8:11], s84 offen offset:3072 sc1
    v_mfma_f32_16x16x32_bf16 v[236:239], v[124:127], v[136:139], v[236:239]
    v_mfma_f32_16x16x32_bf16 v[252:255], v[124:127], v[140:143], v[252:255]
    s_waitcnt vmcnt(11) lgkmcnt(4)
    v_mfma_f32_16x16x32_bf16 v[192:195], v[104:107], v[144:147], v[192:195]
    ds_read_b128 v[124:127], v2 offset:37888
    s_waitcnt vmcnt(10)
    v_mfma_f32_16x16x32_bf16 v[208:211], v[104:107], v[148:151], v[208:211]
    s_add_u32 s84, s68, s39
    s_add_u32 s84, s84, 18874368
    buffer_load_dwordx4 v[128:131], v1, s[8:11], s84 offen offset:0 sc1
    s_waitcnt vmcnt(10)
    v_mfma_f32_16x16x32_bf16 v[224:227], v[104:107], v[152:155], v[224:227]
    s_waitcnt vmcnt(9)
    v_mfma_f32_16x16x32_bf16 v[240:243], v[104:107], v[156:159], v[240:243]
    s_waitcnt lgkmcnt(4)
    v_mfma_f32_16x16x32_bf16 v[196:199], v[108:111], v[144:147], v[196:199]
    ds_read_b128 v[104:107], v2 offset:38912
    v_mfma_f32_16x16x32_bf16 v[212:215], v[108:111], v[148:151], v[212:215]
    buffer_load_dwordx4 v[132:135], v44, s[8:11], s84 offen offset:0 sc1
    v_mfma_f32_16x16x32_bf16 v[228:231], v[108:111], v[152:155], v[228:231]
    v_mfma_f32_16x16x32_bf16 v[244:247], v[108:111], v[156:159], v[244:247]
    s_waitcnt lgkmcnt(4)
    v_mfma_f32_16x16x32_bf16 v[200:203], v[112:115], v[144:147], v[200:203]
    ds_read_b128 v[108:111], v2 offset:39936
    v_mfma_f32_16x16x32_bf16 v[216:219], v[112:115], v[148:151], v[216:219]
    buffer_load_dwordx4 v[136:139], v45, s[8:11], s84 offen offset:0 sc1
    v_mfma_f32_16x16x32_bf16 v[232:235], v[112:115], v[152:155], v[232:235]
    v_mfma_f32_16x16x32_bf16 v[248:251], v[112:115], v[156:159], v[248:251]
    s_waitcnt lgkmcnt(4)
    v_mfma_f32_16x16x32_bf16 v[204:207], v[116:119], v[144:147], v[204:207]
    ds_read_b128 v[112:115], v2 offset:40960
    v_mfma_f32_16x16x32_bf16 v[220:223], v[116:119], v[148:151], v[220:223]
    buffer_load_dwordx4 v[140:143], v46, s[8:11], s84 offen offset:0 sc1
    v_mfma_f32_16x16x32_bf16 v[236:239], v[116:119], v[152:155], v[236:239]
    v_mfma_f32_16x16x32_bf16 v[252:255], v[116:119], v[156:159], v[252:255]
    s_waitcnt vmcnt(11) lgkmcnt(4)
    v_mfma_f32_16x16x32_bf16 v[192:195], v[120:123], v[160:163], v[192:195]
    ds_read_b128 v[116:119], v2 offset:41984
    s_waitcnt vmcnt(10)
    v_mfma_f32_16x16x32_bf16 v[208:211], v[120:123], v[164:167], v[208:211]
    buffer_load_dwordx4 v[144:147], v1, s[8:11], s84 offen offset:1024 sc1
    s_waitcnt vmcnt(10)
    v_mfma_f32_16x16x32_bf16 v[224:227], v[120:123], v[168:171], v[224:227]
    s_waitcnt vmcnt(9)
    v_mfma_f32_16x16x32_bf16 v[240:243], v[120:123], v[172:175], v[240:243]
    s_waitcnt lgkmcnt(4)
    v_mfma_f32_16x16x32_bf16 v[196:199], v[124:127], v[160:163], v[196:199]
    ds_read_b128 v[120:123], v2 offset:43008
    v_mfma_f32_16x16x32_bf16 v[212:215], v[124:127], v[164:167], v[212:215]
    buffer_load_dwordx4 v[148:151], v44, s[8:11], s84 offen offset:1024 sc1
    v_mfma_f32_16x16x32_bf16 v[228:231], v[124:127], v[168:171], v[228:231]
    v_mfma_f32_16x16x32_bf16 v[244:247], v[124:127], v[172:175], v[244:247]
    s_waitcnt lgkmcnt(4)
    v_mfma_f32_16x16x32_bf16 v[200:203], v[104:107], v[160:163], v[200:203]
    ds_read_b128 v[124:127], v2 offset:44032
    v_mfma_f32_16x16x32_bf16 v[216:219], v[104:107], v[164:167], v[216:219]
    buffer_load_dwordx4 v[152:155], v45, s[8:11], s84 offen offset:1024 sc1
    v_mfma_f32_16x16x32_bf16 v[232:235], v[104:107], v[168:171], v[232:235]
    v_mfma_f32_16x16x32_bf16 v[248:251], v[104:107], v[172:175], v[248:251]
    s_waitcnt lgkmcnt(4)
    v_mfma_f32_16x16x32_bf16 v[204:207], v[108:111], v[160:163], v[204:207]
    ds_read_b128 v[104:107], v2 offset:45056
    v_mfma_f32_16x16x32_bf16 v[220:223], v[108:111], v[164:167], v[220:223]
    buffer_load_dwordx4 v[156:159], v46, s[8:11], s84 offen offset:1024 sc1
    v_mfma_f32_16x16x32_bf16 v[236:239], v[108:111], v[168:171], v[236:239]
    v_mfma_f32_16x16x32_bf16 v[252:255], v[108:111], v[172:175], v[252:255]
    s_waitcnt vmcnt(11) lgkmcnt(4)
    v_mfma_f32_16x16x32_bf16 v[192:195], v[112:115], v[176:179], v[192:195]
    ds_read_b128 v[108:111], v2 offset:46080
    s_waitcnt vmcnt(10)
    v_mfma_f32_16x16x32_bf16 v[208:211], v[112:115], v[180:183], v[208:211]
    buffer_load_dwordx4 v[160:163], v1, s[8:11], s84 offen offset:2048 sc1
    s_waitcnt vmcnt(10)
    v_mfma_f32_16x16x32_bf16 v[224:227], v[112:115], v[184:187], v[224:227]
    s_waitcnt vmcnt(9)
    v_mfma_f32_16x16x32_bf16 v[240:243], v[112:115], v[188:191], v[240:243]
    s_waitcnt lgkmcnt(4)
    v_mfma_f32_16x16x32_bf16 v[196:199], v[116:119], v[176:179], v[196:199]
    ds_read_b128 v[112:115], v2 offset:47104
    v_mfma_f32_16x16x32_bf16 v[212:215], v[116:119], v[180:183], v[212:215]
    buffer_load_dwordx4 v[164:167], v44, s[8:11], s84 offen offset:2048 sc1
    v_mfma_f32_16x16x32_bf16 v[228:231], v[116:119], v[184:187], v[228:231]
    v_mfma_f32_16x16x32_bf16 v[244:247], v[116:119], v[188:191], v[244:247]
    s_waitcnt lgkmcnt(4)
    v_mfma_f32_16x16x32_bf16 v[200:203], v[120:123], v[176:179], v[200:203]
    ds_read_b128 v[116:119], v2 offset:48128
    v_mfma_f32_16x16x32_bf16 v[216:219], v[120:123], v[180:183], v[216:219]
    buffer_load_dwordx4 v[168:171], v45, s[8:11], s84 offen offset:2048 sc1
    v_mfma_f32_16x16x32_bf16 v[232:235], v[120:123], v[184:187], v[232:235]
    v_mfma_f32_16x16x32_bf16 v[248:251], v[120:123], v[188:191], v[248:251]
    s_waitcnt lgkmcnt(4)
    v_mfma_f32_16x16x32_bf16 v[204:207], v[124:127], v[176:179], v[204:207]
    ds_read_b128 v[120:123], v2 offset:49152
    v_mfma_f32_16x16x32_bf16 v[220:223], v[124:127], v[180:183], v[220:223]
    buffer_load_dwordx4 v[172:175], v46, s[8:11], s84 offen offset:2048 sc1
    v_mfma_f32_16x16x32_bf16 v[236:239], v[124:127], v[184:187], v[236:239]
    v_mfma_f32_16x16x32_bf16 v[252:255], v[124:127], v[188:191], v[252:255]
    s_waitcnt vmcnt(11) lgkmcnt(4)
    v_mfma_f32_16x16x32_bf16 v[192:195], v[104:107], v[128:131], v[192:195]
    ds_read_b128 v[124:127], v2 offset:50176
    s_waitcnt vmcnt(10)
    v_mfma_f32_16x16x32_bf16 v[208:211], v[104:107], v[132:135], v[208:211]
    buffer_load_dwordx4 v[176:179], v1, s[8:11], s84 offen offset:3072 sc1
    s_waitcnt vmcnt(10)
    v_mfma_f32_16x16x32_bf16 v[224:227], v[104:107], v[136:139], v[224:227]
    s_waitcnt vmcnt(9)
    v_mfma_f32_16x16x32_bf16 v[240:243], v[104:107], v[140:143], v[240:243]
    s_waitcnt lgkmcnt(4)
    v_mfma_f32_16x16x32_bf16 v[196:199], v[108:111], v[128:131], v[196:199]
    ds_read_b128 v[104:107], v2 offset:51200
    v_mfma_f32_16x16x32_bf16 v[212:215], v[108:111], v[132:135], v[212:215]
    buffer_load_dwordx4 v[180:183], v44, s[8:11], s84 offen offset:3072 sc1
    v_mfma_f32_16x16x32_bf16 v[228:231], v[108:111], v[136:139], v[228:231]
    v_mfma_f32_16x16x32_bf16 v[244:247], v[108:111], v[140:143], v[244:247]
    s_waitcnt lgkmcnt(4)
    v_mfma_f32_16x16x32_bf16 v[200:203], v[112:115], v[128:131], v[200:203]
    ds_read_b128 v[108:111], v2 offset:52224
    v_mfma_f32_16x16x32_bf16 v[216:219], v[112:115], v[132:135], v[216:219]
    buffer_load_dwordx4 v[184:187], v45, s[8:11], s84 offen offset:3072 sc1
    v_mfma_f32_16x16x32_bf16 v[232:235], v[112:115], v[136:139], v[232:235]
    v_mfma_f32_16x16x32_bf16 v[248:251], v[112:115], v[140:143], v[248:251]
    s_waitcnt lgkmcnt(4)
    v_mfma_f32_16x16x32_bf16 v[204:207], v[116:119], v[128:131], v[204:207]
    ds_read_b128 v[112:115], v2 offset:53248
    v_mfma_f32_16x16x32_bf16 v[220:223], v[116:119], v[132:135], v[220:223]
    buffer_load_dwordx4 v[188:191], v46, s[8:11], s84 offen offset:3072 sc1
    v_mfma_f32_16x16x32_bf16 v[236:239], v[116:119], v[136:139], v[236:239]
    v_mfma_f32_16x16x32_bf16 v[252:255], v[116:119], v[140:143], v[252:255]
    s_waitcnt vmcnt(11) lgkmcnt(4)
    v_mfma_f32_16x16x32_bf16 v[192:195], v[120:123], v[144:147], v[192:195]
    ds_read_b128 v[116:119], v2 offset:54272
    s_waitcnt vmcnt(10)
    v_mfma_f32_16x16x32_bf16 v[208:211], v[120:123], v[148:151], v[208:211]
    s_add_u32 s84, s68, s40
    s_add_u32 s84, s84, 18874368
    buffer_load_dwordx4 v[128:131], v1, s[8:11], s84 offen offset:0 sc1
    s_waitcnt vmcnt(10)
    v_mfma_f32_16x16x32_bf16 v[224:227], v[120:123], v[152:155], v[224:227]
    s_waitcnt vmcnt(9)
    v_mfma_f32_16x16x32_bf16 v[240:243], v[120:123], v[156:159], v[240:243]
    s_waitcnt lgkmcnt(4)
    v_mfma_f32_16x16x32_bf16 v[196:199], v[124:127], v[144:147], v[196:199]
    ds_read_b128 v[120:123], v2 offset:55296
    v_mfma_f32_16x16x32_bf16 v[212:215], v[124:127], v[148:151], v[212:215]
    buffer_load_dwordx4 v[132:135], v44, s[8:11], s84 offen offset:0 sc1
    v_mfma_f32_16x16x32_bf16 v[228:231], v[124:127], v[152:155], v[228:231]
    v_mfma_f32_16x16x32_bf16 v[244:247], v[124:127], v[156:159], v[244:247]
    s_waitcnt lgkmcnt(4)
    v_mfma_f32_16x16x32_bf16 v[200:203], v[104:107], v[144:147], v[200:203]
    ds_read_b128 v[124:127], v2 offset:56320
    v_mfma_f32_16x16x32_bf16 v[216:219], v[104:107], v[148:151], v[216:219]
    buffer_load_dwordx4 v[136:139], v45, s[8:11], s84 offen offset:0 sc1
    v_mfma_f32_16x16x32_bf16 v[232:235], v[104:107], v[152:155], v[232:235]
    v_mfma_f32_16x16x32_bf16 v[248:251], v[104:107], v[156:159], v[248:251]
    s_waitcnt lgkmcnt(4)
    v_mfma_f32_16x16x32_bf16 v[204:207], v[108:111], v[144:147], v[204:207]
    ds_read_b128 v[104:107], v2 offset:57344
    v_mfma_f32_16x16x32_bf16 v[220:223], v[108:111], v[148:151], v[220:223]
    buffer_load_dwordx4 v[140:143], v46, s[8:11], s84 offen offset:0 sc1
    v_mfma_f32_16x16x32_bf16 v[236:239], v[108:111], v[152:155], v[236:239]
    v_mfma_f32_16x16x32_bf16 v[252:255], v[108:111], v[156:159], v[252:255]
    s_waitcnt vmcnt(11) lgkmcnt(4)
    v_mfma_f32_16x16x32_bf16 v[192:195], v[112:115], v[160:163], v[192:195]
    ds_read_b128 v[108:111], v2 offset:58368
    s_waitcnt vmcnt(10)
    v_mfma_f32_16x16x32_bf16 v[208:211], v[112:115], v[164:167], v[208:211]
    buffer_load_dwordx4 v[144:147], v1, s[8:11], s84 offen offset:1024 sc1
    s_waitcnt vmcnt(10)
    v_mfma_f32_16x16x32_bf16 v[224:227], v[112:115], v[168:171], v[224:227]
    ds_read_b128 v[64:67], v2 offset:16384
    s_waitcnt vmcnt(9)
    v_mfma_f32_16x16x32_bf16 v[240:243], v[112:115], v[172:175], v[240:243]
    s_waitcnt lgkmcnt(5)
    v_mfma_f32_16x16x32_bf16 v[196:199], v[116:119], v[160:163], v[196:199]
    ds_read_b128 v[112:115], v2 offset:59392
    v_mfma_f32_16x16x32_bf16 v[212:215], v[116:119], v[164:167], v[212:215]
    buffer_load_dwordx4 v[148:151], v44, s[8:11], s84 offen offset:1024 sc1
    v_mfma_f32_16x16x32_bf16 v[228:231], v[116:119], v[168:171], v[228:231]
    ds_read_b128 v[68:71], v2 offset:17408
    v_mfma_f32_16x16x32_bf16 v[244:247], v[116:119], v[172:175], v[244:247]
    s_waitcnt lgkmcnt(6)
    v_mfma_f32_16x16x32_bf16 v[200:203], v[120:123], v[160:163], v[200:203]
    ds_read_b128 v[116:119], v2 offset:60416
    v_mfma_f32_16x16x32_bf16 v[216:219], v[120:123], v[164:167], v[216:219]
    buffer_load_dwordx4 v[152:155], v45, s[8:11], s84 offen offset:1024 sc1
    v_mfma_f32_16x16x32_bf16 v[232:235], v[120:123], v[168:171], v[232:235]
    ds_read_b128 v[72:75], v2 offset:18432
    v_mfma_f32_16x16x32_bf16 v[248:251], v[120:123], v[172:175], v[248:251]
    s_waitcnt lgkmcnt(7)
    v_mfma_f32_16x16x32_bf16 v[204:207], v[124:127], v[160:163], v[204:207]
    ds_read_b128 v[120:123], v2 offset:61440
    v_mfma_f32_16x16x32_bf16 v[220:223], v[124:127], v[164:167], v[220:223]
    buffer_load_dwordx4 v[156:159], v46, s[8:11], s84 offen offset:1024 sc1
    v_mfma_f32_16x16x32_bf16 v[236:239], v[124:127], v[168:171], v[236:239]
    ds_read_b128 v[76:79], v2 offset:19456
    v_mfma_f32_16x16x32_bf16 v[252:255], v[124:127], v[172:175], v[252:255]
    s_waitcnt vmcnt(11) lgkmcnt(8)
    v_mfma_f32_16x16x32_bf16 v[192:195], v[104:107], v[176:179], v[192:195]
    ds_read_b128 v[124:127], v2 offset:62464
    s_waitcnt vmcnt(10)
    v_mfma_f32_16x16x32_bf16 v[208:211], v[104:107], v[180:183], v[208:211]
    buffer_load_dwordx4 v[160:163], v1, s[8:11], s84 offen offset:2048 sc1
    s_waitcnt vmcnt(10)
    v_mfma_f32_16x16x32_bf16 v[224:227], v[104:107], v[184:187], v[224:227]
    ds_read_b128 v[80:83], v2 offset:20480
    s_waitcnt vmcnt(9)
    v_mfma_f32_16x16x32_bf16 v[240:243], v[104:107], v[188:191], v[240:243]
    s_waitcnt lgkmcnt(9)
    v_mfma_f32_16x16x32_bf16 v[196:199], v[108:111], v[176:179], v[196:199]
    ds_read_b128 v[104:107], v2 offset:63488
    v_mfma_f32_16x16x32_bf16 v[212:215], v[108:111], v[180:183], v[212:215]
    buffer_load_dwordx4 v[164:167], v44, s[8:11], s84 offen offset:2048 sc1
    v_mfma_f32_16x16x32_bf16 v[228:231], v[108:111], v[184:187], v[228:231]
    ds_read_b128 v[84:87], v2 offset:21504
    v_mfma_f32_16x16x32_bf16 v[244:247], v[108:111], v[188:191], v[244:247]
    s_waitcnt lgkmcnt(9)
    v_mfma_f32_16x16x32_bf16 v[200:203], v[112:115], v[176:179], v[200:203]
    ds_read_b128 v[108:111], v2 offset:64512
    v_mfma_f32_16x16x32_bf16 v[216:219], v[112:115], v[180:183], v[216:219]
    buffer_load_dwordx4 v[168:171], v45, s[8:11], s84 offen offset:2048 sc1
    v_mfma_f32_16x16x32_bf16 v[232:235], v[112:115], v[184:187], v[232:235]
    ds_read_b128 v[88:91], v2 offset:22528
    v_mfma_f32_16x16x32_bf16 v[248:251], v[112:115], v[188:191], v[248:251]
    s_waitcnt lgkmcnt(9)
    v_mfma_f32_16x16x32_bf16 v[204:207], v[116:119], v[176:179], v[204:207]
    ds_read_b128 v[112:115], v3 offset:0
    v_mfma_f32_16x16x32_bf16 v[220:223], v[116:119], v[180:183], v[220:223]
    buffer_load_dwordx4 v[172:175], v46, s[8:11], s84 offen offset:2048 sc1
    v_mfma_f32_16x16x32_bf16 v[236:239], v[116:119], v[184:187], v[236:239]
    ds_read_b128 v[92:95], v2 offset:23552
    v_mfma_f32_16x16x32_bf16 v[252:255], v[116:119], v[188:191], v[252:255]
    s_waitcnt vmcnt(11) lgkmcnt(9)
    v_mfma_f32_16x16x32_bf16 v[192:195], v[120:123], v[128:131], v[192:195]
    ds_read_b128 v[116:119], v3 offset:1024
    s_waitcnt vmcnt(10)
    v_mfma_f32_16x16x32_bf16 v[208:211], v[120:123], v[132:135], v[208:211]
    buffer_load_dwordx4 v[176:179], v1, s[8:11], s84 offen offset:3072 sc1
    s_waitcnt vmcnt(10)
    v_mfma_f32_16x16x32_bf16 v[224:227], v[120:123], v[136:139], v[224:227]
    ds_read_b128 v[96:99], v2 offset:24576
    s_waitcnt vmcnt(9)
    v_mfma_f32_16x16x32_bf16 v[240:243], v[120:123], v[140:143], v[240:243]
    s_waitcnt lgkmcnt(9)
    v_mfma_f32_16x16x32_bf16 v[196:199], v[124:127], v[128:131], v[196:199]
    ds_read_b128 v[120:123], v3 offset:2048
    v_mfma_f32_16x16x32_bf16 v[212:215], v[124:127], v[132:135], v[212:215]
    buffer_load_dwordx4 v[180:183], v44, s[8:11], s84 offen offset:3072 sc1
    v_mfma_f32_16x16x32_bf16 v[228:231], v[124:127], v[136:139], v[228:231]
    ds_read_b128 v[100:103], v2 offset:25600
    v_mfma_f32_16x16x32_bf16 v[244:247], v[124:127], v[140:143], v[244:247]
    s_waitcnt lgkmcnt(9)
    v_mfma_f32_16x16x32_bf16 v[200:203], v[104:107], v[128:131], v[200:203]
    ds_read_b128 v[124:127], v3 offset:3072
    v_mfma_f32_16x16x32_bf16 v[216:219], v[104:107], v[132:135], v[216:219]
    buffer_load_dwordx4 v[184:187], v45, s[8:11], s84 offen offset:3072 sc1
    v_mfma_f32_16x16x32_bf16 v[232:235], v[104:107], v[136:139], v[232:235]
    v_mfma_f32_16x16x32_bf16 v[248:251], v[104:107], v[140:143], v[248:251]
    s_waitcnt lgkmcnt(8)
    v_mfma_f32_16x16x32_bf16 v[204:207], v[108:111], v[128:131], v[204:207]
    ds_read_b128 v[104:107], v3 offset:4096
    v_mfma_f32_16x16x32_bf16 v[220:223], v[108:111], v[132:135], v[220:223]
    buffer_load_dwordx4 v[188:191], v46, s[8:11], s84 offen offset:3072 sc1
    v_mfma_f32_16x16x32_bf16 v[236:239], v[108:111], v[136:139], v[236:239]
    v_mfma_f32_16x16x32_bf16 v[252:255], v[108:111], v[140:143], v[252:255]
    s_waitcnt vmcnt(11) lgkmcnt(7)
    v_mfma_f32_16x16x32_bf16 v[192:195], v[112:115], v[144:147], v[192:195]
    ds_read_b128 v[108:111], v3 offset:5120
    s_waitcnt vmcnt(10)
    v_mfma_f32_16x16x32_bf16 v[208:211], v[112:115], v[148:151], v[208:211]
    s_add_u32 s84, s68, 18894848
    buffer_load_dwordx4 v[128:131], v1, s[8:11], s84 offen offset:0 sc1
    s_waitcnt vmcnt(10)
    v_mfma_f32_16x16x32_bf16 v[224:227], v[112:115], v[152:155], v[224:227]
    s_waitcnt vmcnt(9)
    v_mfma_f32_16x16x32_bf16 v[240:243], v[112:115], v[156:159], v[240:243]
    s_waitcnt lgkmcnt(6)
    v_mfma_f32_16x16x32_bf16 v[196:199], v[116:119], v[144:147], v[196:199]
    ds_read_b128 v[112:115], v3 offset:6144
    v_mfma_f32_16x16x32_bf16 v[212:215], v[116:119], v[148:151], v[212:215]
    buffer_load_dwordx4 v[132:135], v44, s[8:11], s84 offen offset:0 sc1
    v_mfma_f32_16x16x32_bf16 v[228:231], v[116:119], v[152:155], v[228:231]
    v_mfma_f32_16x16x32_bf16 v[244:247], v[116:119], v[156:159], v[244:247]
    s_waitcnt lgkmcnt(5)
    v_mfma_f32_16x16x32_bf16 v[200:203], v[120:123], v[144:147], v[200:203]
    ds_read_b128 v[116:119], v3 offset:7168
    v_mfma_f32_16x16x32_bf16 v[216:219], v[120:123], v[148:151], v[216:219]
    buffer_load_dwordx4 v[136:139], v45, s[8:11], s84 offen offset:0 sc1
    v_mfma_f32_16x16x32_bf16 v[232:235], v[120:123], v[152:155], v[232:235]
    v_mfma_f32_16x16x32_bf16 v[248:251], v[120:123], v[156:159], v[248:251]
    s_waitcnt lgkmcnt(4)
    v_mfma_f32_16x16x32_bf16 v[204:207], v[124:127], v[144:147], v[204:207]
    ds_read_b128 v[120:123], v3 offset:8192
    v_mfma_f32_16x16x32_bf16 v[220:223], v[124:127], v[148:151], v[220:223]
    buffer_load_dwordx4 v[140:143], v46, s[8:11], s84 offen offset:0 sc1
    v_mfma_f32_16x16x32_bf16 v[236:239], v[124:127], v[152:155], v[236:239]
    v_mfma_f32_16x16x32_bf16 v[252:255], v[124:127], v[156:159], v[252:255]
    s_waitcnt vmcnt(11) lgkmcnt(4)
    v_mfma_f32_16x16x32_bf16 v[192:195], v[104:107], v[160:163], v[192:195]
    ds_read_b128 v[124:127], v3 offset:9216
    s_waitcnt vmcnt(10)
    v_mfma_f32_16x16x32_bf16 v[208:211], v[104:107], v[164:167], v[208:211]
    s_waitcnt vmcnt(9)
    v_mfma_f32_16x16x32_bf16 v[224:227], v[104:107], v[168:171], v[224:227]
    s_waitcnt vmcnt(8)
    v_mfma_f32_16x16x32_bf16 v[240:243], v[104:107], v[172:175], v[240:243]
    s_waitcnt lgkmcnt(4)
    v_mfma_f32_16x16x32_bf16 v[196:199], v[108:111], v[160:163], v[196:199]
    ds_read_b128 v[104:107], v3 offset:10240
    v_mfma_f32_16x16x32_bf16 v[212:215], v[108:111], v[164:167], v[212:215]
    v_mfma_f32_16x16x32_bf16 v[228:231], v[108:111], v[168:171], v[228:231]
    v_mfma_f32_16x16x32_bf16 v[244:247], v[108:111], v[172:175], v[244:247]
    s_waitcnt lgkmcnt(4)
    v_mfma_f32_16x16x32_bf16 v[200:203], v[112:115], v[160:163], v[200:203]
    ds_read_b128 v[108:111], v3 offset:11264
    v_mfma_f32_16x16x32_bf16 v[216:219], v[112:115], v[164:167], v[216:219]
    v_mfma_f32_16x16x32_bf16 v[232:235], v[112:115], v[168:171], v[232:235]
    v_mfma_f32_16x16x32_bf16 v[248:251], v[112:115], v[172:175], v[248:251]
    s_waitcnt lgkmcnt(4)
    v_mfma_f32_16x16x32_bf16 v[204:207], v[116:119], v[160:163], v[204:207]
    v_mfma_f32_16x16x32_bf16 v[220:223], v[116:119], v[164:167], v[220:223]
    v_mfma_f32_16x16x32_bf16 v[236:239], v[116:119], v[168:171], v[236:239]
    v_mfma_f32_16x16x32_bf16 v[252:255], v[116:119], v[172:175], v[252:255]
    s_waitcnt vmcnt(7) lgkmcnt(3)
    v_mfma_f32_16x16x32_bf16 v[192:195], v[120:123], v[176:179], v[192:195]
    s_waitcnt vmcnt(6)
    v_mfma_f32_16x16x32_bf16 v[208:211], v[120:123], v[180:183], v[208:211]
    s_waitcnt vmcnt(5)
    v_mfma_f32_16x16x32_bf16 v[224:227], v[120:123], v[184:187], v[224:227]
    s_waitcnt vmcnt(4)
    v_mfma_f32_16x16x32_bf16 v[240:243], v[120:123], v[188:191], v[240:243]
    s_waitcnt lgkmcnt(2)
    v_mfma_f32_16x16x32_bf16 v[196:199], v[124:127], v[176:179], v[196:199]
    v_mfma_f32_16x16x32_bf16 v[212:215], v[124:127], v[180:183], v[212:215]
    v_mfma_f32_16x16x32_bf16 v[228:231], v[124:127], v[184:187], v[228:231]
    v_mfma_f32_16x16x32_bf16 v[244:247], v[124:127], v[188:191], v[244:247]
    s_waitcnt lgkmcnt(1)
    v_mfma_f32_16x16x32_bf16 v[200:203], v[104:107], v[176:179], v[200:203]
    s_waitcnt vmcnt(0)
    v_or3_b32 v36, v128, v129, v130
    v_or3_b32 v36, v36, v131, v132
    v_mfma_f32_16x16x32_bf16 v[216:219], v[104:107], v[180:183], v[216:219]
    v_or3_b32 v36, v36, v133, v134
    v_or3_b32 v36, v36, v135, v136
    v_mfma_f32_16x16x32_bf16 v[232:235], v[104:107], v[184:187], v[232:235]
    v_or3_b32 v36, v36, v137, v138
    v_or3_b32 v36, v36, v139, v140
    v_mfma_f32_16x16x32_bf16 v[248:251], v[104:107], v[188:191], v[248:251]
    s_waitcnt lgkmcnt(0)
    v_or3_b32 v36, v36, v141, v142
    v_or_b32 v36, v36, v143
    v_mfma_f32_16x16x32_bf16 v[204:207], v[108:111], v[176:179], v[204:207]
    v_and_b32 v36, 1, v36
    v_cmp_ne_u32 vcc, 0, v36
    s_nop 0
    s_cmp_lg_u64 vcc, 0
    s_cbranch_scc1 STR_28
STB_29:
    v_mfma_f32_16x16x32_bf16 v[220:223], v[108:111], v[180:183], v[220:223]
    v_add_f32 v128, v128, v130
    v_add_f32 v132, v132, v134
    v_mfma_f32_16x16x32_bf16 v[236:239], v[108:111], v[184:187], v[236:239]
    v_add_f32 v136, v136, v138
    v_add_f32 v140, v140, v142
    v_mfma_f32_16x16x32_bf16 v[252:255], v[108:111], v[188:191], v[252:255]
    v_add_f32 v129, v129, v131
    v_add_f32 v133, v133, v135
    s_mul_i32 s6, s78, 6400
    s_add_u32 s6, s6, 3145728
    v_min_u32 v19, 49, v0
    v_lshlrev_b32 v19, 7, v19
    buffer_load_dword a252, v19, s[8:11], s6 offen sc1
    s_lshr_b32 s7, s78, 4
    s_mul_i32 s7, s7, 102400
    s_and_b32 s6, s78, 7
    s_mul_i32 s6, s6, 2560
    s_add_u32 s7, s7, s6
    s_bitcmp1_b32 s78, 3
    s_cselect_b32 s6, 81920, 0
    s_add_u32 s7, s7, s6
    s_add_u32 s6, s7, 5242880
    v_min_u32 v19, 19, v0
    v_lshlrev_b32 v19, 7, v19
    buffer_load_dword a252, v19, s[8:11], s6 offen sc1
    s_getpc_b64 s[4:5]
PCL_30:
    s_lshl_b32 s6, s45, 2
    s_add_u32 s6, s6, s49
    s_and_b32 s6, s6, 31
    s_lshl_b32 s6, s6, 10
    v_add_u32 v19, s6, v1
    v_min_u32 v19, CODE_END-PCL_30-16, v19
    global_load_dword a253, v19, s[4:5]
    v_add_f32 v137, v137, v139
    v_add_f32 v141, v141, v143
    v_permlane32_swap_b32 v128, v129
    v_permlane32_swap_b32 v132, v133
    v_permlane32_swap_b32 v136, v137
    v_permlane32_swap_b32 v140, v141
    v_add_f32 v128, v128, v129
    v_add_f32 v132, v132, v133
    v_add_f32 v136, v136, v137
    v_add_f32 v140, v140, v141
    v_mov_b32 v129, v128
    v_mov_b32 v133, v132
    v_mov_b32 v137, v136
    v_mov_b32 v141, v140
    v_permlane16_swap_b32 v128, v129
    v_permlane16_swap_b32 v132, v133
    v_permlane16_swap_b32 v136, v137
    v_permlane16_swap_b32 v140, v141
    v_add_f32 v128, v128, v129
    v_add_f32 v132, v132, v133
    v_add_f32 v136, v136, v137
    v_add_f32 v140, v140, v141
    v_mov_b32 v129, v128
    v_mov_b32 v133, v132
    v_mov_b32 v137, v136
    v_mov_b32 v141, v140
    v_permlane32_swap_b32 v128, v129
    v_permlane32_swap_b32 v132, v133
    v_permlane32_swap_b32 v136, v137
    v_permlane32_swap_b32 v140, v141
    v_mul_f32 v36, 0xbacccccd, v128
    v_mul_f32 v38, 0xbacccccd, v132
    v_mul_f32 v40, 0xbacccccd, v136
    v_mul_f32 v42, 0xbacccccd, v140
    v_mul_f32 v129, 0x3acccccd, v129
    v_mul_f32 v133, 0x3acccccd, v133
    v_mul_f32 v137, 0x3acccccd, v137
    v_mul_f32 v141, 0x3acccccd, v141
    v_fma_f32 v129, -v36, v36, v129
    v_fma_f32 v133, -v38, v38, v133
    v_fma_f32 v137, -v40, v40, v137
    v_fma_f32 v141, -v42, v42, v141
    v_max_f32 v129, 0, v129
    v_max_f32 v133, 0, v133
    v_max_f32 v137, 0, v137
    v_max_f32 v141, 0, v141
    v_add_f32 v130, 0x3727c5ac, v129
    v_add_f32 v134, 0x3727c5ac, v133
    v_add_f32 v138, 0x3727c5ac, v137
    v_add_f32 v142, 0x3727c5ac, v141
    v_rsq_f32 v37, v130
    v_rsq_f32 v39, v134
    v_rsq_f32 v41, v138
    v_rsq_f32 v43, v142
    v_pk_fma_f32 v[192:193], v[20:21], v[36:37], v[192:193] op_sel_hi:[1,0,1]
    v_pk_fma_f32 v[194:195], v[22:23], v[36:37], v[194:195] op_sel_hi:[1,0,1]
    v_pk_fma_f32 v[196:197], v[24:25], v[36:37], v[196:197] op_sel_hi:[1,0,1]
    v_pk_fma_f32 v[198:199], v[26:27], v[36:37], v[198:199] op_sel_hi:[1,0,1]
    v_pk_fma_f32 v[204:205], v[32:33], v[36:37], v[204:205] op_sel_hi:[1,0,1]
    v_pk_fma_f32 v[206:207], v[34:35], v[36:37], v[206:207] op_sel_hi:[1,0,1]
    v_pk_mul_f32 v[192:193], v[192:193], v[36:37] op_sel:[0,1] op_sel_hi:[1,1]
    v_pk_mul_f32 v[194:195], v[194:195], v[36:37] op_sel:[0,1] op_sel_hi:[1,1]
    v_pk_mul_f32 v[196:197], v[196:197], v[36:37] op_sel:[0,1] op_sel_hi:[1,1]
    v_pk_mul_f32 v[198:199], v[198:199], v[36:37] op_sel:[0,1] op_sel_hi:[1,1]
    v_pk_mul_f32 v[204:205], v[204:205], v[36:37] op_sel:[0,1] op_sel_hi:[1,1]
    v_pk_mul_f32 v[206:207], v[206:207], v[36:37] op_sel:[0,1] op_sel_hi:[1,1]
    v_pk_fma_f32 v[208:209], v[20:21], v[38:39], v[208:209] op_sel_hi:[1,0,1]
    v_pk_fma_f32 v[210:211], v[22:23], v[38:39], v[210:211] op_sel_hi:[1,0,1]
    v_pk_fma_f32 v[212:213], v[24:25], v[38:39], v[212:213] op_sel_hi:[1,0,1]
    v_pk_fma_f32 v[214:215], v[26:27], v[38:39], v[214:215] op_sel_hi:[1,0,1]
    v_pk_fma_f32 v[220:221], v[32:33], v[38:39], v[220:221] op_sel_hi:[1,0,1]
    v_pk_fma_f32 v[222:223], v[34:35], v[38:39], v[222:223] op_sel_hi:[1,0,1]
    v_pk_mul_f32 v[208:209], v[208:209], v[38:39] op_sel:[0,1] op_sel_hi:[1,1]
    v_pk_mul_f32 v[210:211], v[210:211], v[38:39] op_sel:[0,1] op_sel_hi:[1,1]
    v_pk_mul_f32 v[212:213], v[212:213], v[38:39] op_sel:[0,1] op_sel_hi:[1,1]
    v_pk_mul_f32 v[214:215], v[214:215], v[38:39] op_sel:[0,1] op_sel_hi:[1,1]
    v_pk_mul_f32 v[220:221], v[220:221], v[38:39] op_sel:[0,1] op_sel_hi:[1,1]
    v_pk_mul_f32 v[222:223], v[222:223], v[38:39] op_sel:[0,1] op_sel_hi:[1,1]
    v_pk_fma_f32 v[224:225], v[20:21], v[40:41], v[224:225] op_sel_hi:[1,0,1]
    v_pk_fma_f32 v[226:227], v[22:23], v[40:41], v[226:227] op_sel_hi:[1,0,1]
    v_pk_fma_f32 v[228:229], v[24:25], v[40:41], v[228:229] op_sel_hi:[1,0,1]
    v_pk_fma_f32 v[230:231], v[26:27], v[40:41], v[230:231] op_sel_hi:[1,0,1]
    v_pk_fma_f32 v[236:237], v[32:33], v[40:41], v[236:237] op_sel_hi:[1,0,1]
    v_pk_fma_f32 v[238:239], v[34:35], v[40:41], v[238:239] op_sel_hi:[1,0,1]
    v_pk_mul_f32 v[224:225], v[224:225], v[40:41] op_sel:[0,1] op_sel_hi:[1,1]
    v_pk_mul_f32 v[226:227], v[226:227], v[40:41] op_sel:[0,1] op_sel_hi:[1,1]
    v_pk_mul_f32 v[228:229], v[228:229], v[40:41] op_sel:[0,1] op_sel_hi:[1,1]
    v_pk_mul_f32 v[230:231], v[230:231], v[40:41] op_sel:[0,1] op_sel_hi:[1,1]
    v_pk_mul_f32 v[236:237], v[236:237], v[40:41] op_sel:[0,1] op_sel_hi:[1,1]
    v_pk_mul_f32 v[238:239], v[238:239], v[40:41] op_sel:[0,1] op_sel_hi:[1,1]
    v_pk_fma_f32 v[240:241], v[20:21], v[42:43], v[240:241] op_sel_hi:[1,0,1]
    v_pk_fma_f32 v[242:243], v[22:23], v[42:43], v[242:243] op_sel_hi:[1,0,1]
    v_pk_fma_f32 v[244:245], v[24:25], v[42:43], v[244:245] op_sel_hi:[1,0,1]
    v_pk_fma_f32 v[246:247], v[26:27], v[42:43], v[246:247] op_sel_hi:[1,0,1]
    v_pk_fma_f32 v[252:253], v[32:33], v[42:43], v[252:253] op_sel_hi:[1,0,1]
    v_pk_fma_f32 v[254:255], v[34:35], v[42:43], v[254:255] op_sel_hi:[1,0,1]
    v_pk_mul_f32 v[240:241], v[240:241], v[42:43] op_sel:[0,1] op_sel_hi:[1,1]
    v_pk_mul_f32 v[242:243], v[242:243], v[42:43] op_sel:[0,1] op_sel_hi:[1,1]
    v_pk_mul_f32 v[244:245], v[244:245], v[42:43] op_sel:[0,1] op_sel_hi:[1,1]
    v_pk_mul_f32 v[246:247], v[246:247], v[42:43] op_sel:[0,1] op_sel_hi:[1,1]
    v_pk_mul_f32 v[252:253], v[252:253], v[42:43] op_sel:[0,1] op_sel_hi:[1,1]
    v_pk_mul_f32 v[254:255], v[254:255], v[42:43] op_sel:[0,1] op_sel_hi:[1,1]
    v_pk_fma_f32 v[176:177], v[28:29], v[36:37], v[200:201] op_sel_hi:[1,0,1]
    v_pk_fma_f32 v[178:179], v[30:31], v[36:37], v[202:203] op_sel_hi:[1,0,1]
    v_pk_fma_f32 v[180:181], v[28:29], v[38:39], v[216:217] op_sel_hi:[1,0,1]
    v_pk_fma_f32 v[182:183], v[30:31], v[38:39], v[218:219] op_sel_hi:[1,0,1]
    v_pk_fma_f32 v[184:185], v[28:29], v[40:41], v[232:233] op_sel_hi:[1,0,1]
    v_pk_fma_f32 v[186:187], v[30:31], v[40:41], v[234:235] op_sel_hi:[1,0,1]
    v_pk_fma_f32 v[188:189], v[28:29], v[42:43], v[248:249] op_sel_hi:[1,0,1]
    v_pk_fma_f32 v[190:191], v[30:31], v[42:43], v[250:251] op_sel_hi:[1,0,1]
    v_cvt_pk_bf16_f32 v144, v192, v193
    v_cvt_pk_bf16_f32 v145, v194, v195
    v_cvt_pk_bf16_f32 v146, v196, v197
    v_cvt_pk_bf16_f32 v147, v198, v199
    v_cvt_pk_bf16_f32 v152, v208, v209
    v_cvt_pk_bf16_f32 v153, v210, v211
    v_cvt_pk_bf16_f32 v154, v212, v213
    v_cvt_pk_bf16_f32 v155, v214, v215
    v_lshrrev_b32 v24, 4, v0
    v_cmp_eq_u32 vcc, 3, v24
    v_mov_b32 v24, 0x3f80
    v_mov_b32 v44, 0x3fb8aa3b
    v_mfma_f32_16x16x32_bf16 v[104:107], v[64:67], v[144:147], 0
    v_cvt_pk_bf16_f32 v160, v224, v225
    v_cvt_pk_bf16_f32 v161, v226, v227
    v_mfma_f32_16x16x32_bf16 v[108:111], v[68:71], v[144:147], 0
    v_cvt_pk_bf16_f32 v162, v228, v229
    v_cvt_pk_bf16_f32 v163, v230, v231
    v_mfma_f32_16x16x32_bf16 v[112:115], v[72:75], v[144:147], 0
    v_cvt_pk_bf16_f32 v168, v240, v241
    v_cvt_pk_bf16_f32 v169, v242, v243
    v_mfma_f32_16x16x32_bf16 v[116:119], v[76:79], v[144:147], 0
    v_cvt_pk_bf16_f32 v170, v244, v245
    v_cvt_pk_bf16_f32 v171, v246, v247
    v_mfma_f32_16x16x32_bf16 v[120:123], v[80:83], v[144:147], 0
    v_cvt_pk_bf16_f32 v150, v204, v205
    v_cvt_pk_bf16_f32 v151, v206, v207
    v_mfma_f32_16x16x32_bf16 v[104:107], v[84:87], v[152:155], v[104:107]
    v_cndmask_b32 v150, v150, v24, vcc
    v_cndmask_b32 v151, v151, 0, vcc
    v_mfma_f32_16x16x32_bf16 v[108:111], v[88:91], v[152:155], v[108:111]
    ds_write_b64 v51, v[146:147] offset:0
    ds_write_b64 v52, v[150:151] offset:0
    v_cvt_pk_bf16_f32 v158, v220, v221
    v_mfma_f32_16x16x32_bf16 v[112:115], v[92:95], v[152:155], v[112:115]
    v_cvt_pk_bf16_f32 v159, v222, v223
    v_cndmask_b32 v158, v158, v24, vcc
    v_mfma_f32_16x16x32_bf16 v[116:119], v[96:99], v[152:155], v[116:119]
    v_cndmask_b32 v159, v159, 0, vcc
    v_mfma_f32_16x16x32_bf16 v[120:123], v[100:103], v[152:155], v[120:123]
    ds_write_b64 v51, v[154:155] offset:1152
    ds_write_b64 v52, v[158:159] offset:1152
    v_cvt_pk_bf16_f32 v166, v236, v237
    v_mfma_f32_16x16x32_bf16 v[124:127], v[64:67], v[160:163], 0
    v_cvt_pk_bf16_f32 v167, v238, v239
    v_cndmask_b32 v166, v166, v24, vcc
    v_mfma_f32_16x16x32_bf16 v[128:131], v[68:71], v[160:163], 0
    v_cndmask_b32 v167, v167, 0, vcc
    v_mfma_f32_16x16x32_bf16 v[132:135], v[72:75], v[160:163], 0
    ds_write_b64 v51, v[162:163] offset:2304
    ds_write_b64 v52, v[166:167] offset:2304
    v_cvt_pk_bf16_f32 v174, v252, v253
    v_mfma_f32_16x16x32_bf16 v[136:139], v[76:79], v[160:163], 0
    v_cvt_pk_bf16_f32 v175, v254, v255
    v_cndmask_b32 v174, v174, v24, vcc
    v_mfma_f32_16x16x32_bf16 v[140:143], v[80:83], v[160:163], 0
    v_cndmask_b32 v175, v175, 0, vcc
    v_mfma_f32_16x16x32_bf16 v[124:127], v[84:87], v[168:171], v[124:127]
    ds_write_b64 v51, v[170:171] offset:3456
    ds_write_b64 v52, v[174:175] offset:3456
    v_mfma_f32_16x16x32_bf16 v[128:131], v[88:91], v[168:171], v[128:131]
    v_mfma_f32_16x16x32_bf16 v[132:135], v[92:95], v[168:171], v[132:135]
    v_mfma_f32_16x16x32_bf16 v[136:139], v[96:99], v[168:171], v[136:139]
    v_mfma_f32_16x16x32_bf16 v[140:143], v[100:103], v[168:171], v[140:143]
    v_max3_f32 v46, v104, v105, v106
    v_max3_f32 v47, v107, v108, v109
    v_max3_f32 v46, v46, v110, v111
    ds_read_b64_tr_b16 v[204:205], v54 offset:0
    v_max3_f32 v47, v47, v112, v113
    v_max3_f32 v46, v46, v114, v115
    v_max3_f32 v47, v47, v116, v117
    v_max3_f32 v46, v46, v118, v119
    v_max3_f32 v47, v47, v120, v121
    v_max3_f32 v46, v46, v122, v123
    v_max_f32 v46, v46, v47
    ds_read_b64_tr_b16 v[206:207], v54 offset:288
    v_mul_f32 v46, 0xbfb8aa3b, v46
    v_pk_fma_f32 v[104:105], v[104:105], v[44:45], v[46:47] op_sel_hi:[1,0,0]
    v_pk_fma_f32 v[106:107], v[106:107], v[44:45], v[46:47] op_sel_hi:[1,0,0]
    v_pk_fma_f32 v[108:109], v[108:109], v[44:45], v[46:47] op_sel_hi:[1,0,0]
    v_pk_fma_f32 v[110:111], v[110:111], v[44:45], v[46:47] op_sel_hi:[1,0,0]
    v_pk_fma_f32 v[112:113], v[112:113], v[44:45], v[46:47] op_sel_hi:[1,0,0]
    v_pk_fma_f32 v[114:115], v[114:115], v[44:45], v[46:47] op_sel_hi:[1,0,0]
    ds_read_b64_tr_b16 v[208:209], v54 offset:32
    v_pk_fma_f32 v[116:117], v[116:117], v[44:45], v[46:47] op_sel_hi:[1,0,0]
    v_pk_fma_f32 v[118:119], v[118:119], v[44:45], v[46:47] op_sel_hi:[1,0,0]
    v_pk_fma_f32 v[120:121], v[120:121], v[44:45], v[46:47] op_sel_hi:[1,0,0]
    v_pk_fma_f32 v[122:123], v[122:123], v[44:45], v[46:47] op_sel_hi:[1,0,0]
    v_exp_f32 v104, v104
    v_exp_f32 v105, v105
    ds_read_b64_tr_b16 v[210:211], v54 offset:320
    v_exp_f32 v106, v106
    v_exp_f32 v107, v107
    v_exp_f32 v108, v108
    v_exp_f32 v109, v109
    ds_read_b64_tr_b16 v[224:225], v54 offset:2304
    v_exp_f32 v110, v110
    v_exp_f32 v111, v111
    v_exp_f32 v112, v112
    v_exp_f32 v113, v113
    ds_read_b64_tr_b16 v[226:227], v54 offset:2592
    v_exp_f32 v114, v114
    v_exp_f32 v115, v115
    v_exp_f32 v116, v116
    v_exp_f32 v117, v117
    ds_read_b64_tr_b16 v[228:229], v54 offset:2336
    v_exp_f32 v118, v118
    v_exp_f32 v119, v119
    v_exp_f32 v120, v120
    v_exp_f32 v121, v121
    ds_read_b64_tr_b16 v[230:231], v54 offset:2624
    v_exp_f32 v122, v122
    v_exp_f32 v123, v123
    v_pk_add_f32 v[46:47], v[104:105], v[106:107]
    v_pk_add_f32 v[46:47], v[46:47], v[108:109]
    v_pk_add_f32 v[46:47], v[46:47], v[110:111]
    v_pk_add_f32 v[46:47], v[46:47], v[112:113]
    v_pk_add_f32 v[46:47], v[46:47], v[114:115]
    v_pk_add_f32 v[46:47], v[46:47], v[116:117]
    v_pk_add_f32 v[46:47], v[46:47], v[118:119]
    v_pk_add_f32 v[46:47], v[46:47], v[120:121]
    v_pk_add_f32 v[46:47], v[46:47], v[122:123]
    v_add_f32 v46, v46, v47
    v_rcp_f32 v46, v46
    s_nop 0
    v_pk_mul_f32 v[104:105], v[104:105], v[46:47] op_sel_hi:[1,0]
    v_pk_mul_f32 v[106:107], v[106:107], v[46:47] op_sel_hi:[1,0]
    v_cvt_pk_bf16_f32 v104, v104, v105
    v_cvt_pk_bf16_f32 v105, v106, v107
    ds_write_b64 v50, v[104:105] offset:0
    v_pk_mul_f32 v[108:109], v[108:109], v[46:47] op_sel_hi:[1,0]
    v_pk_mul_f32 v[110:111], v[110:111], v[46:47] op_sel_hi:[1,0]
    v_cvt_pk_bf16_f32 v106, v108, v109
    v_cvt_pk_bf16_f32 v107, v110, v111
    ds_write_b64 v50, v[106:107] offset:8
    v_pk_mul_f32 v[112:113], v[112:113], v[46:47] op_sel_hi:[1,0]
    v_pk_mul_f32 v[114:115], v[114:115], v[46:47] op_sel_hi:[1,0]
    v_cvt_pk_bf16_f32 v108, v112, v113
    v_cvt_pk_bf16_f32 v109, v114, v115
    ds_write_b64 v50, v[108:109] offset:16
    v_pk_mul_f32 v[116:117], v[116:117], v[46:47] op_sel_hi:[1,0]
    v_pk_mul_f32 v[118:119], v[118:119], v[46:47] op_sel_hi:[1,0]
    v_cvt_pk_bf16_f32 v110, v116, v117
    v_cvt_pk_bf16_f32 v111, v118, v119
    ds_write_b64 v50, v[110:111] offset:24
    v_pk_mul_f32 v[120:121], v[120:121], v[46:47] op_sel_hi:[1,0]
    v_pk_mul_f32 v[122:123], v[122:123], v[46:47] op_sel_hi:[1,0]
    v_cvt_pk_bf16_f32 v112, v120, v121
    v_cvt_pk_bf16_f32 v113, v122, v123
    ds_write_b64 v50, v[112:113] offset:32
    v_max3_f32 v46, v124, v125, v126
    v_max3_f32 v47, v127, v128, v129
    v_max3_f32 v46, v46, v130, v131
    ds_read_b64_tr_b16 v[192:193], v53 offset:0
    v_max3_f32 v47, v47, v132, v133
    v_max3_f32 v46, v46, v134, v135
    v_max3_f32 v47, v47, v136, v137
    v_max3_f32 v46, v46, v138, v139
    v_max3_f32 v47, v47, v140, v141
    v_max3_f32 v46, v46, v142, v143
    v_max_f32 v46, v46, v47
    ds_read_b64_tr_b16 v[194:195], v53 offset:320
    v_mul_f32 v46, 0xbfb8aa3b, v46
    v_pk_fma_f32 v[124:125], v[124:125], v[44:45], v[46:47] op_sel_hi:[1,0,0]
    v_pk_fma_f32 v[126:127], v[126:127], v[44:45], v[46:47] op_sel_hi:[1,0,0]
    v_pk_fma_f32 v[128:129], v[128:129], v[44:45], v[46:47] op_sel_hi:[1,0,0]
    v_pk_fma_f32 v[130:131], v[130:131], v[44:45], v[46:47] op_sel_hi:[1,0,0]
    v_pk_fma_f32 v[132:133], v[132:133], v[44:45], v[46:47] op_sel_hi:[1,0,0]
    v_pk_fma_f32 v[134:135], v[134:135], v[44:45], v[46:47] op_sel_hi:[1,0,0]
    ds_read_b64_tr_b16 v[196:197], v53 offset:32
    v_pk_fma_f32 v[136:137], v[136:137], v[44:45], v[46:47] op_sel_hi:[1,0,0]
    v_pk_fma_f32 v[138:139], v[138:139], v[44:45], v[46:47] op_sel_hi:[1,0,0]
    v_pk_fma_f32 v[140:141], v[140:141], v[44:45], v[46:47] op_sel_hi:[1,0,0]
    v_pk_fma_f32 v[142:143], v[142:143], v[44:45], v[46:47] op_sel_hi:[1,0,0]
    v_exp_f32 v124, v124
    v_exp_f32 v125, v125
    ds_read_b64_tr_b16 v[198:199], v53 offset:352
    v_exp_f32 v126, v126
    v_exp_f32 v127, v127
    v_exp_f32 v128, v128
    v_exp_f32 v129, v129
    ds_read_b64_tr_b16 v[200:201], v53 offset:64
    v_exp_f32 v130, v130
    v_exp_f32 v131, v131
    v_exp_f32 v132, v132
    v_exp_f32 v133, v133
    ds_read_b64_tr_b16 v[202:203], v53 offset:384
    v_exp_f32 v134, v134
    v_exp_f32 v135, v135
    v_exp_f32 v136, v136
    v_exp_f32 v137, v137
    v_exp_f32 v138, v138
    v_exp_f32 v139, v139
    v_exp_f32 v140, v140
    v_exp_f32 v141, v141
    v_exp_f32 v142, v142
    v_exp_f32 v143, v143
    v_pk_add_f32 v[46:47], v[124:125], v[126:127]
    v_pk_add_f32 v[46:47], v[46:47], v[128:129]
    v_pk_add_f32 v[46:47], v[46:47], v[130:131]
    v_pk_add_f32 v[46:47], v[46:47], v[132:133]
    v_pk_add_f32 v[46:47], v[46:47], v[134:135]
    v_pk_add_f32 v[46:47], v[46:47], v[136:137]
    v_pk_add_f32 v[46:47], v[46:47], v[138:139]
    v_pk_add_f32 v[46:47], v[46:47], v[140:141]
    v_pk_add_f32 v[46:47], v[46:47], v[142:143]
    v_add_f32 v46, v46, v47
    v_rcp_f32 v46, v46
    s_nop 0
    v_pk_mul_f32 v[124:125], v[124:125], v[46:47] op_sel_hi:[1,0]
    v_pk_mul_f32 v[126:127], v[126:127], v[46:47] op_sel_hi:[1,0]
    v_cvt_pk_bf16_f32 v124, v124, v125
    v_cvt_pk_bf16_f32 v125, v126, v127
    ds_write_b64 v50, v[124:125] offset:2560
    v_pk_mul_f32 v[128:129], v[128:129], v[46:47] op_sel_hi:[1,0]
    v_pk_mul_f32 v[130:131], v[130:131], v[46:47] op_sel_hi:[1,0]
    v_cvt_pk_bf16_f32 v126, v128, v129
    v_cvt_pk_bf16_f32 v127, v130, v131
    ds_write_b64 v50, v[126:127] offset:2568
    v_pk_mul_f32 v[132:133], v[132:133], v[46:47] op_sel_hi:[1,0]
    v_pk_mul_f32 v[134:135], v[134:135], v[46:47] op_sel_hi:[1,0]
    v_cvt_pk_bf16_f32 v128, v132, v133
    v_cvt_pk_bf16_f32 v129, v134, v135
    ds_write_b64 v50, v[128:129] offset:2576
    v_pk_mul_f32 v[136:137], v[136:137], v[46:47] op_sel_hi:[1,0]
    v_pk_mul_f32 v[138:139], v[138:139], v[46:47] op_sel_hi:[1,0]
    v_cvt_pk_bf16_f32 v130, v136, v137
    v_cvt_pk_bf16_f32 v131, v138, v139
    ds_write_b64 v50, v[130:131] offset:2584
    v_pk_mul_f32 v[140:141], v[140:141], v[46:47] op_sel_hi:[1,0]
    v_pk_mul_f32 v[142:143], v[142:143], v[46:47] op_sel_hi:[1,0]
    v_cvt_pk_bf16_f32 v132, v140, v141
    v_cvt_pk_bf16_f32 v133, v142, v143
    ds_write_b64 v50, v[132:133] offset:2592
    ds_read_b64_tr_b16 v[212:213], v53 offset:2560
    ds_read_b64_tr_b16 v[214:215], v53 offset:2880
    ds_read_b64_tr_b16 v[216:217], v53 offset:2592
    ds_read_b64_tr_b16 v[218:219], v53 offset:2912
    ds_read_b64_tr_b16 v[220:221], v53 offset:2624
    ds_read_b64_tr_b16 v[222:223], v53 offset:2944
    v_add_u32 v24, s79, v1
    s_waitcnt lgkmcnt(11)
    v_mfma_f32_16x16x32_bf16 v[232:235], v[192:195], v[204:207], 0
    v_mfma_f32_16x16x32_bf16 v[236:239], v[196:199], v[204:207], 0
    v_mfma_f32_16x16x32_bf16 v[240:243], v[200:203], v[204:207], 0
    v_mfma_f32_16x16x32_bf16 v[244:247], v[192:195], v[208:211], 0
    v_mfma_f32_16x16x32_bf16 v[248:251], v[196:199], v[208:211], 0
    v_mfma_f32_16x16x32_bf16 v[252:255], v[200:203], v[208:211], 0
    s_waitcnt lgkmcnt(0)
    v_mfma_f32_16x16x32_bf16 v[232:235], v[212:215], v[224:227], v[232:235]
    v_mfma_f32_16x16x32_bf16 v[236:239], v[216:219], v[224:227], v[236:239]
    v_mfma_f32_16x16x32_bf16 v[240:243], v[220:223], v[224:227], v[240:243]
    v_mfma_f32_16x16x32_bf16 v[244:247], v[212:215], v[228:231], v[244:247]
    v_mfma_f32_16x16x32_bf16 v[248:251], v[216:219], v[228:231], v[248:251]
    v_mfma_f32_16x16x32_bf16 v[252:255], v[220:223], v[228:231], v[252:255]
    v_add_u32 v25, 143360, v55
    v_add_u32 v26, 153600, v55
    v_add_u32 v27, 0, v55
    v_add_u32 v28, 10240, v55
    s_add_u32 s85, s71, 2097152
    ds_write_b128 v24, v[232:235] offset:0
    ds_write_b128 v24, v[236:239] offset:1024
    ds_write_b128 v24, v[240:243] offset:2048
    ds_write_b128 v24, v[244:247] offset:3072
    ds_write_b128 v24, v[248:251] offset:4096
    ds_write_b128 v24, v[252:255] offset:5120
    s_waitcnt lgkmcnt(0)
    s_barrier
    ds_read_b128 v[192:195], v25
    ds_read_b128 v[196:199], v26
    ds_read_b128 v[200:203], v27
    ds_read_b128 v[204:207], v28
    v_pk_mul_f32 v[176:177], v[176:177], v[36:37] op_sel:[0,1] op_sel_hi:[1,1]
    v_pk_mul_f32 v[178:179], v[178:179], v[36:37] op_sel:[0,1] op_sel_hi:[1,1]
    v_pk_mul_f32 v[180:181], v[180:181], v[38:39] op_sel:[0,1] op_sel_hi:[1,1]
    v_pk_mul_f32 v[182:183], v[182:183], v[38:39] op_sel:[0,1] op_sel_hi:[1,1]
    v_pk_mul_f32 v[184:185], v[184:185], v[40:41] op_sel:[0,1] op_sel_hi:[1,1]
    v_pk_mul_f32 v[186:187], v[186:187], v[40:41] op_sel:[0,1] op_sel_hi:[1,1]
    v_pk_mul_f32 v[188:189], v[188:189], v[42:43] op_sel:[0,1] op_sel_hi:[1,1]
    v_pk_mul_f32 v[190:191], v[190:191], v[42:43] op_sel:[0,1] op_sel_hi:[1,1]
    v_cvt_pk_bf16_f32 v148, v176, v177
    v_cvt_pk_bf16_f32 v149, v178, v179
    v_cvt_pk_bf16_f32 v156, v180, v181
    v_cvt_pk_bf16_f32 v157, v182, v183
    v_cvt_pk_bf16_f32 v164, v184, v185
    v_cvt_pk_bf16_f32 v165, v186, v187
    v_cvt_pk_bf16_f32 v172, v188, v189
    v_cvt_pk_bf16_f32 v173, v190, v191
    s_waitcnt lgkmcnt(0)
    v_pk_add_f32 v[192:193], v[192:193], v[196:197]
    v_pk_add_f32 v[200:201], v[200:201], v[204:205]
    v_pk_add_f32 v[194:195], v[194:195], v[198:199]
    v_pk_add_f32 v[202:203], v[202:203], v[206:207]
    v_pk_add_f32 v[192:193], v[192:193], v[200:201]
    v_pk_add_f32 v[194:195], v[194:195], v[202:203]
    v_cvt_pk_bf16_f32 v192, v192, v193
    v_cvt_pk_bf16_f32 v193, v194, v195
    buffer_store_dwordx2 v[192:193], v57, s[8:11], s85 offen sc1
    v_mfma_f32_16x16x32_bf16 v[104:107], v[64:67], v[148:151], 0
    s_add_u32 m0, s63, 61440
    s_add_u32 s93, s60, 3145728
    buffer_load_dwordx4 v1, s[8:11], s93 offen offset:0  lds
    v_mfma_f32_16x16x32_bf16 v[108:111], v[68:71], v[148:151], 0
    v_mfma_f32_16x16x32_bf16 v[112:115], v[72:75], v[148:151], 0
    v_mfma_f32_16x16x32_bf16 v[116:119], v[76:79], v[148:151], 0
    v_mfma_f32_16x16x32_bf16 v[120:123], v[80:83], v[148:151], 0
    buffer_load_dwordx4 v1, s[8:11], s93 offen offset:1024  lds
    v_mfma_f32_16x16x32_bf16 v[104:107], v[84:87], v[156:159], v[104:107]
    v_mfma_f32_16x16x32_bf16 v[108:111], v[88:91], v[156:159], v[108:111]
    v_mfma_f32_16x16x32_bf16 v[112:115], v[92:95], v[156:159], v[112:115]
    v_mfma_f32_16x16x32_bf16 v[116:119], v[96:99], v[156:159], v[116:119]
    buffer_load_dwordx4 v1, s[8:11], s93 offen offset:2048  lds
    v_mfma_f32_16x16x32_bf16 v[120:123], v[100:103], v[156:159], v[120:123]
    v_mfma_f32_16x16x32_bf16 v[124:127], v[64:67], v[164:167], 0
    v_mfma_f32_16x16x32_bf16 v[128:131], v[68:71], v[164:167], 0
    v_mfma_f32_16x16x32_bf16 v[132:135], v[72:75], v[164:167], 0
    buffer_load_dwordx4 v1, s[8:11], s93 offen offset:3072  lds
    v_mfma_f32_16x16x32_bf16 v[136:139], v[76:79], v[164:167], 0
    v_mfma_f32_16x16x32_bf16 v[140:143], v[80:83], v[164:167], 0
    v_mfma_f32_16x16x32_bf16 v[124:127], v[84:87], v[172:175], v[124:127]
    v_mfma_f32_16x16x32_bf16 v[128:131], v[88:91], v[172:175], v[128:131]
    s_add_u32 m0, m0, 4096
    s_add_u32 s93, s93, 4096
    buffer_load_dwordx4 v1, s[8:11], s93 offen offset:0  lds
    v_mfma_f32_16x16x32_bf16 v[132:135], v[92:95], v[172:175], v[132:135]
    v_mfma_f32_16x16x32_bf16 v[136:139], v[96:99], v[172:175], v[136:139]
    v_mfma_f32_16x16x32_bf16 v[140:143], v[100:103], v[172:175], v[140:143]
    v_max3_f32 v46, v104, v105, v106
    s_add_u32 m0, s63, 20480
    s_add_u32 s93, s60, 3166208
    buffer_load_dwordx4 v1, s[8:11], s93 offen offset:0  lds
    v_max3_f32 v47, v107, v108, v109
    v_max3_f32 v46, v46, v110, v111
    v_max3_f32 v47, v47, v112, v113
    v_max3_f32 v46, v46, v114, v115
    v_max3_f32 v47, v47, v116, v117
    v_max3_f32 v46, v46, v118, v119
    v_max3_f32 v47, v47, v120, v121
    v_max3_f32 v46, v46, v122, v123
    v_max_f32 v46, v46, v47
    v_mul_f32 v46, 0xbfb8aa3b, v46
    v_pk_fma_f32 v[104:105], v[104:105], v[44:45], v[46:47] op_sel_hi:[1,0,0]
    buffer_load_dwordx4 v1, s[8:11], s93 offen offset:1024  lds
    v_pk_fma_f32 v[106:107], v[106:107], v[44:45], v[46:47] op_sel_hi:[1,0,0]
    v_pk_fma_f32 v[108:109], v[108:109], v[44:45], v[46:47] op_sel_hi:[1,0,0]
    v_pk_fma_f32 v[110:111], v[110:111], v[44:45], v[46:47] op_sel_hi:[1,0,0]
    v_pk_fma_f32 v[112:113], v[112:113], v[44:45], v[46:47] op_sel_hi:[1,0,0]
    v_pk_fma_f32 v[114:115], v[114:115], v[44:45], v[46:47] op_sel_hi:[1,0,0]
    v_pk_fma_f32 v[116:117], v[116:117], v[44:45], v[46:47] op_sel_hi:[1,0,0]
    v_pk_fma_f32 v[118:119], v[118:119], v[44:45], v[46:47] op_sel_hi:[1,0,0]
    v_pk_fma_f32 v[120:121], v[120:121], v[44:45], v[46:47] op_sel_hi:[1,0,0]
    v_pk_fma_f32 v[122:123], v[122:123], v[44:45], v[46:47] op_sel_hi:[1,0,0]
    v_exp_f32 v104, v104
    buffer_load_dwordx4 v1, s[8:11], s93 offen offset:2048  lds
    v_exp_f32 v105, v105
    v_exp_f32 v106, v106
    v_exp_f32 v107, v107
    v_exp_f32 v108, v108
    v_exp_f32 v109, v109
    v_exp_f32 v110, v110
    buffer_load_dwordx4 v1, s[8:11], s93 offen offset:3072  lds
    v_exp_f32 v111, v111
    v_exp_f32 v112, v112
    v_exp_f32 v113, v113
    v_exp_f32 v114, v114
    v_exp_f32 v115, v115
    v_exp_f32 v116, v116
    s_add_u32 m0, m0, 4096
    s_add_u32 s93, s93, 4096
    buffer_load_dwordx4 v1, s[8:11], s93 offen offset:0  lds
    v_exp_f32 v117, v117
    v_exp_f32 v118, v118
    v_exp_f32 v119, v119
    v_exp_f32 v120, v120
    v_exp_f32 v121, v121
    v_exp_f32 v122, v122
    s_add_u32 m0, s63, 40960
    s_add_u32 s93, s60, 3186688
    buffer_load_dwordx4 v1, s[8:11], s93 offen offset:0  lds
    v_exp_f32 v123, v123
    v_pk_add_f32 v[46:47], v[104:105], v[106:107]
    v_pk_add_f32 v[46:47], v[46:47], v[108:109]
    v_pk_add_f32 v[46:47], v[46:47], v[110:111]
    v_pk_add_f32 v[46:47], v[46:47], v[112:113]
    v_pk_add_f32 v[46:47], v[46:47], v[114:115]
    v_pk_add_f32 v[46:47], v[46:47], v[116:117]
    v_pk_add_f32 v[46:47], v[46:47], v[118:119]
    v_pk_add_f32 v[46:47], v[46:47], v[120:121]
    v_pk_add_f32 v[46:47], v[46:47], v[122:123]
    buffer_load_dwordx4 v1, s[8:11], s93 offen offset:1024  lds
    v_add_f32 v46, v46, v47
    v_rcp_f32 v46, v46
    s_nop 0
    v_pk_mul_f32 v[104:105], v[104:105], v[46:47] op_sel_hi:[1,0]
    v_pk_mul_f32 v[106:107], v[106:107], v[46:47] op_sel_hi:[1,0]
    v_pk_mul_f32 v[108:109], v[108:109], v[46:47] op_sel_hi:[1,0]
    v_pk_mul_f32 v[110:111], v[110:111], v[46:47] op_sel_hi:[1,0]
    v_pk_mul_f32 v[112:113], v[112:113], v[46:47] op_sel_hi:[1,0]
    v_pk_mul_f32 v[114:115], v[114:115], v[46:47] op_sel_hi:[1,0]
    v_pk_mul_f32 v[116:117], v[116:117], v[46:47] op_sel_hi:[1,0]
    v_pk_mul_f32 v[118:119], v[118:119], v[46:47] op_sel_hi:[1,0]
    buffer_load_dwordx4 v1, s[8:11], s93 offen offset:2048  lds
    v_pk_mul_f32 v[120:121], v[120:121], v[46:47] op_sel_hi:[1,0]
    v_pk_mul_f32 v[122:123], v[122:123], v[46:47] op_sel_hi:[1,0]
    v_cvt_pk_bf16_f32 v104, v104, v105
    v_cvt_pk_bf16_f32 v105, v106, v107
    v_cvt_pk_bf16_f32 v106, v108, v109
    v_cvt_pk_bf16_f32 v107, v110, v111
    v_cvt_pk_bf16_f32 v108, v112, v113
    v_cvt_pk_bf16_f32 v109, v114, v115
    v_cvt_pk_bf16_f32 v110, v116, v117
    v_cvt_pk_bf16_f32 v111, v118, v119
    v_cvt_pk_bf16_f32 v112, v120, v121
    v_cvt_pk_bf16_f32 v113, v122, v123
    v_max3_f32 v46, v124, v125, v126
    buffer_load_dwordx4 v1, s[8:11], s93 offen offset:3072  lds
    v_max3_f32 v47, v127, v128, v129
    v_max3_f32 v46, v46, v130, v131
    v_max3_f32 v47, v47, v132, v133
    v_max3_f32 v46, v46, v134, v135
    v_max3_f32 v47, v47, v136, v137
    v_max3_f32 v46, v46, v138, v139
    v_max3_f32 v47, v47, v140, v141
    v_max3_f32 v46, v46, v142, v143
    v_max_f32 v46, v46, v47
    v_mul_f32 v46, 0xbfb8aa3b, v46
    v_pk_fma_f32 v[124:125], v[124:125], v[44:45], v[46:47] op_sel_hi:[1,0,0]
    v_pk_fma_f32 v[126:127], v[126:127], v[44:45], v[46:47] op_sel_hi:[1,0,0]
    s_add_u32 m0, m0, 4096
    s_add_u32 s93, s93, 4096
    buffer_load_dwordx4 v1, s[8:11], s93 offen offset:0  lds
    v_pk_fma_f32 v[128:129], v[128:129], v[44:45], v[46:47] op_sel_hi:[1,0,0]
    v_pk_fma_f32 v[130:131], v[130:131], v[44:45], v[46:47] op_sel_hi:[1,0,0]
    v_pk_fma_f32 v[132:133], v[132:133], v[44:45], v[46:47] op_sel_hi:[1,0,0]
    v_pk_fma_f32 v[134:135], v[134:135], v[44:45], v[46:47] op_sel_hi:[1,0,0]
    v_pk_fma_f32 v[136:137], v[136:137], v[44:45], v[46:47] op_sel_hi:[1,0,0]
    v_pk_fma_f32 v[138:139], v[138:139], v[44:45], v[46:47] op_sel_hi:[1,0,0]
    v_pk_fma_f32 v[140:141], v[140:141], v[44:45], v[46:47] op_sel_hi:[1,0,0]
    v_pk_fma_f32 v[142:143], v[142:143], v[44:45], v[46:47] op_sel_hi:[1,0,0]
    v_exp_f32 v124, v124
    v_exp_f32 v125, v125
    s_add_u32 m0, s63, 102400
    s_add_u32 s93, s60, 3207168
    buffer_load_dwordx4 v1, s[8:11], s93 offen offset:0  lds
    v_exp_f32 v126, v126
    v_exp_f32 v127, v127
    v_exp_f32 v128, v128
    v_exp_f32 v129, v129
    v_exp_f32 v130, v130
    v_exp_f32 v131, v131
    buffer_load_dwordx4 v1, s[8:11], s93 offen offset:1024  lds
    v_exp_f32 v132, v132
    v_exp_f32 v133, v133
    v_exp_f32 v134, v134
    v_exp_f32 v135, v135
    v_exp_f32 v136, v136
    v_exp_f32 v137, v137
    buffer_load_dwordx4 v1, s[8:11], s93 offen offset:2048  lds
    v_exp_f32 v138, v138
    v_exp_f32 v139, v139
    v_exp_f32 v140, v140
    v_exp_f32 v141, v141
    v_exp_f32 v142, v142
    v_exp_f32 v143, v143
    buffer_load_dwordx4 v1, s[8:11], s93 offen offset:3072  lds
    v_pk_add_f32 v[46:47], v[124:125], v[126:127]
    v_pk_add_f32 v[46:47], v[46:47], v[128:129]
    v_pk_add_f32 v[46:47], v[46:47], v[130:131]
    v_pk_add_f32 v[46:47], v[46:47], v[132:133]
    v_pk_add_f32 v[46:47], v[46:47], v[134:135]
    v_pk_add_f32 v[46:47], v[46:47], v[136:137]
    v_pk_add_f32 v[46:47], v[46:47], v[138:139]
    v_pk_add_f32 v[46:47], v[46:47], v[140:141]
    v_pk_add_f32 v[46:47], v[46:47], v[142:143]
    v_add_f32 v46, v46, v47
    v_rcp_f32 v46, v46
    s_add_u32 m0, m0, 4096
    s_add_u32 s93, s93, 4096
    buffer_load_dwordx4 v1, s[8:11], s93 offen offset:0  lds
    v_pk_mul_f32 v[124:125], v[124:125], v[46:47] op_sel_hi:[1,0]
    v_pk_mul_f32 v[126:127], v[126:127], v[46:47] op_sel_hi:[1,0]
    v_pk_mul_f32 v[128:129], v[128:129], v[46:47] op_sel_hi:[1,0]
    v_pk_mul_f32 v[130:131], v[130:131], v[46:47] op_sel_hi:[1,0]
    v_pk_mul_f32 v[132:133], v[132:133], v[46:47] op_sel_hi:[1,0]
    v_pk_mul_f32 v[134:135], v[134:135], v[46:47] op_sel_hi:[1,0]
    v_pk_mul_f32 v[136:137], v[136:137], v[46:47] op_sel_hi:[1,0]
    v_pk_mul_f32 v[138:139], v[138:139], v[46:47] op_sel_hi:[1,0]
    v_pk_mul_f32 v[140:141], v[140:141], v[46:47] op_sel_hi:[1,0]
    v_pk_mul_f32 v[142:143], v[142:143], v[46:47] op_sel_hi:[1,0]
    v_cvt_pk_bf16_f32 v124, v124, v125
    v_cvt_pk_bf16_f32 v125, v126, v127
    v_cvt_pk_bf16_f32 v126, v128, v129
    v_cvt_pk_bf16_f32 v127, v130, v131
    v_cvt_pk_bf16_f32 v128, v132, v133
    v_cvt_pk_bf16_f32 v129, v134, v135
    v_cvt_pk_bf16_f32 v130, v136, v137
    v_cvt_pk_bf16_f32 v131, v138, v139
    v_cvt_pk_bf16_f32 v132, v140, v141
    v_cvt_pk_bf16_f32 v133, v142, v143
    s_mov_b32 s92, s67
    s_add_u32 s85, s72, 2097152
    buffer_load_dwordx2 v[64:65], v57, s[8:11], s85 offen sc1
    s_add_u32 s85, s72, 2105344
    buffer_load_dwordx2 v[66:67], v57, s[8:11], s85 offen sc1
    s_add_u32 s85, s72, 2113536
    buffer_load_dwordx2 v[68:69], v57, s[8:11], s85 offen sc1
    s_add_u32 s85, s72, 2121728
    buffer_load_dwordx2 v[70:71], v57, s[8:11], s85 offen sc1
    s_add_u32 s85, s72, 2129920
    buffer_load_dwordx2 v[72:73], v57, s[8:11], s85 offen sc1
    s_add_u32 s85, s72, 2138112
    buffer_load_dwordx2 v[74:75], v57, s[8:11], s85 offen sc1
    s_add_u32 s85, s72, 2146304
    buffer_load_dwordx2 v[76:77], v57, s[8:11], s85 offen sc1
    s_add_u32 s85, s72, 2154496
    buffer_load_dwordx2 v[78:79], v57, s[8:11], s85 offen sc1
    s_add_u32 m0, s63, 122880
    s_add_u32 s93, s60, 3227648
    buffer_load_dwordx4 v1, s[8:11], s93 offen offset:0  lds
    buffer_load_dwordx4 v1, s[8:11], s93 offen offset:1024  lds
    buffer_load_dwordx4 v1, s[8:11], s93 offen offset:2048  lds
    buffer_load_dwordx4 v1, s[8:11], s93 offen offset:3072  lds
    s_add_u32 m0, m0, 4096
    s_add_u32 s93, s93, 4096
    buffer_load_dwordx4 v1, s[8:11], s93 offen offset:0  lds
    v_mov_b32 v26, 0x3f80
    v_mov_b32 v27, 0x3f800000
    v_mov_b32 v80, 0
    v_mov_b32 v81, 0
    v_mov_b32 v82, 0
    v_mov_b32 v83, 0
    s_waitcnt vmcnt(5)
KVCHK_33:
    v_max3_u32 v24, v64, v65, v66
    v_max3_u32 v25, v67, v68, v69
    v_max3_u32 v24, v24, v70, v71
    v_max3_u32 v25, v25, v72, v73
    v_max3_u32 v24, v24, v74, v75
    v_max3_u32 v25, v25, v76, v77
    v_max3_u32 v24, v24, v78, v79
    v_max_u32 v24, v24, v25
    v_cmp_eq_u32 vcc, -1, v24
    s_nop 0
    s_cmp_lg_u64 vcc, 0
    s_cbranch_scc1 KVPOLL_31
KVDONE_32:
    v_dot2c_f32_bf16 v80, v64, v26
    v_dot2c_f32_bf16 v81, v64, v27
    v_dot2c_f32_bf16 v82, v65, v26
    v_dot2c_f32_bf16 v83, v65, v27
    v_dot2c_f32_bf16 v80, v66, v26
    v_dot2c_f32_bf16 v81, v66, v27
    v_dot2c_f32_bf16 v82, v67, v26
    v_dot2c_f32_bf16 v83, v67, v27
    v_dot2c_f32_bf16 v80, v68, v26
    v_dot2c_f32_bf16 v81, v68, v27
    v_dot2c_f32_bf16 v82, v69, v26
    v_dot2c_f32_bf16 v83, v69, v27
    v_dot2c_f32_bf16 v80, v70, v26
    v_dot2c_f32_bf16 v81, v70, v27
    v_dot2c_f32_bf16 v82, v71, v26
    v_dot2c_f32_bf16 v83, v71, v27
    v_dot2c_f32_bf16 v80, v72, v26
    v_dot2c_f32_bf16 v81, v72, v27
    v_dot2c_f32_bf16 v82, v73, v26
    v_dot2c_f32_bf16 v83, v73, v27
    v_dot2c_f32_bf16 v80, v74, v26
    v_dot2c_f32_bf16 v81, v74, v27
    v_dot2c_f32_bf16 v82, v75, v26
    v_dot2c_f32_bf16 v83, v75, v27
    v_dot2c_f32_bf16 v80, v76, v26
    v_dot2c_f32_bf16 v81, v76, v27
    v_dot2c_f32_bf16 v82, v77, v26
    v_dot2c_f32_bf16 v83, v77, v27
    v_dot2c_f32_bf16 v80, v78, v26
    v_dot2c_f32_bf16 v81, v78, v27
    v_dot2c_f32_bf16 v82, v79, v26
    v_dot2c_f32_bf16 v83, v79, v27
    s_nop 2
    v_cvt_pk_bf16_f32 v64, v80, v81
    v_cvt_pk_bf16_f32 v65, v82, v83
    ds_write_b64 v56, v[64:65]
    s_add_u32 s86, s69, 22020096
    s_add_u32 s87, s70, 22020096
    s_add_u32 s88, s69, 22061056
    s_add_u32 s89, s70, 22061056
    s_waitcnt lgkmcnt(0)
    s_barrier
    ds_read_b128 v[136:139], v58 offset:0
    ds_read_b128 v[148:151], v58 offset:384
    ds_read_b128 v[160:163], v59 offset:0
    ds_read_b128 v[140:143], v58 offset:16
    ds_read_b128 v[152:155], v58 offset:400
    ds_read_b128 v[164:167], v59 offset:16
    ds_read_b64 v[144:145], v58 offset:32
    ds_read_b64 v[156:157], v58 offset:416
    ds_read_b64 v[168:169], v59 offset:32
    s_waitcnt lgkmcnt(6)
    v_mfma_f32_16x16x32_bf16 v[64:67], v[136:139], v[104:107], 0
    v_mfma_f32_16x16x32_bf16 v[68:71], v[148:151], v[104:107], 0
    v_mfma_f32_16x16x32_bf16 v[72:75], v[160:163], v[104:107], 0
    s_waitcnt lgkmcnt(3)
    v_mfma_f32_16x16x32_bf16 v[64:67], v[140:143], v[108:111], v[64:67]
    v_mfma_f32_16x16x32_bf16 v[68:71], v[152:155], v[108:111], v[68:71]
    v_mfma_f32_16x16x32_bf16 v[72:75], v[164:167], v[108:111], v[72:75]
    s_waitcnt lgkmcnt(0)
    v_mfma_f32_16x16x16_bf16 v[64:67], v[144:145], v[112:113], v[64:67]
    v_mfma_f32_16x16x16_bf16 v[68:71], v[156:157], v[112:113], v[68:71]
    v_mfma_f32_16x16x16_bf16 v[72:75], v[168:169], v[112:113], v[72:75]
    v_mfma_f32_16x16x32_bf16 v[80:83], v[136:139], v[124:127], 0
    v_mfma_f32_16x16x32_bf16 v[84:87], v[148:151], v[124:127], 0
    v_mfma_f32_16x16x32_bf16 v[88:91], v[160:163], v[124:127], 0
    s_nop 4
    v_add_f32 v74, 0x358637bd, v74
    v_mfma_f32_16x16x32_bf16 v[80:83], v[140:143], v[128:131], v[80:83]
    v_rcp_f32 v74, v74
    v_mfma_f32_16x16x32_bf16 v[84:87], v[152:155], v[128:131], v[84:87]
    v_mul_f32 v64, v64, v74
    v_mul_f32 v65, v65, v74
    v_mfma_f32_16x16x32_bf16 v[88:91], v[164:167], v[128:131], v[88:91]
    v_mul_f32 v66, v66, v74
    v_mul_f32 v67, v67, v74
    v_mfma_f32_16x16x16_bf16 v[80:83], v[144:145], v[132:133], v[80:83]
    v_mul_f32 v68, v68, v74
    v_mul_f32 v69, v69, v74
    v_mfma_f32_16x16x16_bf16 v[84:87], v[156:157], v[132:133], v[84:87]
    v_mul_f32 v70, v70, v74
    v_mul_f32 v71, v71, v74
    v_mfma_f32_16x16x16_bf16 v[88:91], v[168:169], v[132:133], v[88:91]
    v_mul_f32 v72, v72, v74
    v_mul_f32 v73, v73, v74
    v_cvt_pk_bf16_f32 v64, v64, v65
    v_cvt_pk_bf16_f32 v65, v66, v67
    v_cvt_pk_bf16_f32 v66, v68, v69
    v_cvt_pk_bf16_f32 v67, v70, v71
    v_cvt_pk_bf16_f32 v68, v72, v73
    s_cmp_eq_u32 s50, 0
    s_cbranch_scc1 SLOW_16
    buffer_store_dwordx4 v[64:67], v60, s[8:11], s86 offen
    buffer_store_dword v68, v61, s[8:11], s87 offen
BACK_16:
    v_add_f32 v90, 0x358637bd, v90
    v_rcp_f32 v90, v90
    s_nop 0
    v_pk_mul_f32 v[80:81], v[80:81], v[90:91] op_sel_hi:[1,0]
    v_pk_mul_f32 v[82:83], v[82:83], v[90:91] op_sel_hi:[1,0]
    v_pk_mul_f32 v[84:85], v[84:85], v[90:91] op_sel_hi:[1,0]
    v_pk_mul_f32 v[86:87], v[86:87], v[90:91] op_sel_hi:[1,0]
    v_pk_mul_f32 v[88:89], v[88:89], v[90:91] op_sel_hi:[1,0]
    v_cvt_pk_bf16_f32 v80, v80, v81
    v_cvt_pk_bf16_f32 v81, v82, v83
    v_cvt_pk_bf16_f32 v82, v84, v85
    v_cvt_pk_bf16_f32 v83, v86, v87
    v_cvt_pk_bf16_f32 v84, v88, v89
    s_cmp_eq_u32 s50, 0
    s_cbranch_scc1 SLOW_17
    buffer_store_dwordx4 v[80:83], v60, s[8:11], s88 offen
    buffer_store_dword v84, v61, s[8:11], s89 offen
BACK_17:
    s_add_u32 m0, s63, 143360
    s_add_u32 s93, s60, 4194304
    buffer_load_dwordx4 v1, s[8:11], s93 offen offset:0  lds
    buffer_load_dwordx4 v1, s[8:11], s93 offen offset:1024  lds
    buffer_load_dwordx4 v1, s[8:11], s93 offen offset:2048  lds
    buffer_load_dwordx4 v1, s[8:11], s93 offen offset:3072  lds
    s_add_u32 m0, m0, 4096
    s_add_u32 s93, s93, 4096
    buffer_load_dwordx4 v1, s[8:11], s93 offen offset:0  lds
    s_waitcnt vmcnt(5)
    v_mov_b32 v7, 2
    v_mov_b32 v18, 0
    s_mov_b64 exec, 1
    s_cmp_eq_u32 s50, 0
    s_cbranch_scc1 SLOW_18
    buffer_store_dword v7, v18, s[8:11], s77 offen
BACK_18:
    s_mov_b64 exec, -1
    s_barrier
    ds_read_b128 v[208:211], v1 offset:61440
    ds_read_b128 v[212:215], v1 offset:62464
    ds_read_b128 v[216:219], v1 offset:63488
    ds_read_b128 v[220:223], v1 offset:64512
    ds_read_b128 v[224:227], v2 offset:0
    ds_read_b128 v[228:231], v2 offset:1024
    ds_read_b128 v[232:235], v2 offset:2048
    ds_read_b128 v[236:239], v2 offset:3072
    ds_read_b128 v[240:243], v2 offset:4096
    ds_read_b128 v[244:247], v2 offset:5120
    v_lshlrev_b32 v20, 16, v8
    v_and_b32 v21, 0xffff0000, v8
    v_lshlrev_b32 v22, 16, v9
    v_and_b32 v23, 0xffff0000, v9
    v_lshlrev_b32 v24, 16, v10
    v_and_b32 v25, 0xffff0000, v10
    v_lshlrev_b32 v26, 16, v11
    v_and_b32 v27, 0xffff0000, v11
    v_lshlrev_b32 v28, 16, v12
    v_and_b32 v29, 0xffff0000, v12
    v_lshlrev_b32 v30, 16, v13
    v_and_b32 v31, 0xffff0000, v13
    v_lshlrev_b32 v32, 16, v14
    v_and_b32 v33, 0xffff0000, v14
    v_lshlrev_b32 v34, 16, v15
    v_and_b32 v35, 0xffff0000, v15
    v_lshlrev_b32 v36, 16, v16
    v_and_b32 v37, 0xffff0000, v16
    v_lshlrev_b32 v38, 16, v17
    v_and_b32 v39, 0xffff0000, v17
    s_lshl_b32 s85, s48, 7
    s_add_u32 s85, s85, 13639680
    buffer_load_dword v7, v6, s[8:11], s85 offen sc1
    s_add_u32 m0, s63, 0
    s_add_u32 s93, s60, 4214784
    buffer_load_dwordx4 v1, s[8:11], s93 offen offset:0  lds
    buffer_load_dwordx4 v1, s[8:11], s93 offen offset:1024  lds
    buffer_load_dwordx4 v1, s[8:11], s93 offen offset:2048  lds
    buffer_load_dwordx4 v1, s[8:11], s93 offen offset:3072  lds
    s_add_u32 m0, m0, 4096
    s_add_u32 s93, s93, 4096
    buffer_load_dwordx4 v1, s[8:11], s93 offen offset:0  lds
    s_waitcnt vmcnt(5)
    v_cmp_le_u32 vcc, 2, v7
    s_nop 0
    s_cmp_lg_u64 vcc, -1
    s_cbranch_scc1 POLL_34
PDONE_35:
    s_add_u32 s84, s58, 22020096
    buffer_load_dwordx4 v[80:83], v1, s[8:11], s84 offen offset:0 sc1
    buffer_load_dwordx4 v[84:87], v1, s[8:11], s84 offen offset:1024 sc1
    buffer_load_dwordx4 v[88:91], v1, s[8:11], s84 offen offset:2048 sc1
    buffer_load_dwordx4 v[92:95], v1, s[8:11], s84 offen offset:3072 sc1
    s_add_u32 s84, s58, 22024192
    buffer_load_dwordx4 v[96:99], v1, s[8:11], s84 offen offset:0 sc1
    buffer_load_dwordx4 v[100:103], v1, s[8:11], s84 offen offset:1024 sc1
    buffer_load_dwordx4 v[104:107], v1, s[8:11], s84 offen offset:2048 sc1
    buffer_load_dwordx4 v[108:111], v1, s[8:11], s84 offen offset:3072 sc1
    s_waitcnt vmcnt(7) lgkmcnt(8)
    v_mfma_f32_16x16x32_bf16 v[20:23], v[208:211], v[80:83], v[20:23]
    ds_read_b128 v[248:251], v2 offset:6144
    s_add_u32 s84, s58, 22028288
    buffer_load_dwordx4 v[112:115], v1, s[8:11], s84 offen offset:0 sc1
    v_mfma_f32_16x16x32_bf16 v[24:27], v[212:215], v[80:83], v[24:27]
    ds_read_b128 v[252:255], v2 offset:7168
    s_waitcnt lgkmcnt(8)
    v_mfma_f32_16x16x32_bf16 v[28:31], v[216:219], v[80:83], v[28:31]
    ds_read_b128 v[208:211], v2 offset:8192
    v_mfma_f32_16x16x32_bf16 v[32:35], v[220:223], v[80:83], v[32:35]
    ds_read_b128 v[212:215], v2 offset:9216
    s_waitcnt lgkmcnt(8)
    v_mfma_f32_16x16x32_bf16 v[36:39], v[224:227], v[80:83], v[36:39]
    ds_read_b128 v[216:219], v2 offset:10240
    buffer_load_dwordx4 v[116:119], v1, s[8:11], s84 offen offset:1024 sc1
    s_waitcnt vmcnt(8)
    v_mfma_f32_16x16x32_bf16 v[20:23], v[228:231], v[84:87], v[20:23]
    ds_read_b128 v[220:223], v2 offset:11264
    s_waitcnt lgkmcnt(8)
    v_mfma_f32_16x16x32_bf16 v[24:27], v[232:235], v[84:87], v[24:27]
    ds_read_b128 v[224:227], v2 offset:12288
    v_mfma_f32_16x16x32_bf16 v[28:31], v[236:239], v[84:87], v[28:31]
    ds_read_b128 v[228:231], v2 offset:13312
    s_waitcnt lgkmcnt(8)
    v_mfma_f32_16x16x32_bf16 v[32:35], v[240:243], v[84:87], v[32:35]
    ds_read_b128 v[232:235], v2 offset:14336
    buffer_load_dwordx4 v[120:123], v1, s[8:11], s84 offen offset:2048 sc1
    v_mfma_f32_16x16x32_bf16 v[36:39], v[244:247], v[84:87], v[36:39]
    ds_read_b128 v[236:239], v2 offset:15360
    s_waitcnt vmcnt(8) lgkmcnt(8)
    v_mfma_f32_16x16x32_bf16 v[20:23], v[248:251], v[88:91], v[20:23]
    ds_read_b128 v[240:243], v1 offset:20480
    v_mfma_f32_16x16x32_bf16 v[24:27], v[252:255], v[88:91], v[24:27]
    ds_read_b128 v[244:247], v1 offset:21504
    s_waitcnt lgkmcnt(8)
    v_mfma_f32_16x16x32_bf16 v[28:31], v[208:211], v[88:91], v[28:31]
    ds_read_b128 v[248:251], v1 offset:22528
    buffer_load_dwordx4 v[124:127], v1, s[8:11], s84 offen offset:3072 sc1
    v_mfma_f32_16x16x32_bf16 v[32:35], v[212:215], v[88:91], v[32:35]
    ds_read_b128 v[252:255], v1 offset:23552
    s_waitcnt lgkmcnt(8)
    v_mfma_f32_16x16x32_bf16 v[36:39], v[216:219], v[88:91], v[36:39]
    ds_read_b128 v[208:211], v1 offset:24576
    s_waitcnt vmcnt(8)
    v_mfma_f32_16x16x32_bf16 v[20:23], v[220:223], v[92:95], v[20:23]
    ds_read_b128 v[212:215], v1 offset:25600
    s_waitcnt lgkmcnt(8)
    v_mfma_f32_16x16x32_bf16 v[24:27], v[224:227], v[92:95], v[24:27]
    ds_read_b128 v[216:219], v1 offset:26624
    s_add_u32 s84, s58, 22032384
    buffer_load_dwordx4 v[128:131], v1, s[8:11], s84 offen offset:0 sc1
    v_mfma_f32_16x16x32_bf16 v[28:31], v[228:231], v[92:95], v[28:31]
    ds_read_b128 v[220:223], v1 offset:27648
    s_waitcnt lgkmcnt(8)
    v_mfma_f32_16x16x32_bf16 v[32:35], v[232:235], v[92:95], v[32:35]
    ds_read_b128 v[224:227], v1 offset:28672
    v_mfma_f32_16x16x32_bf16 v[36:39], v[236:239], v[92:95], v[36:39]
    ds_read_b128 v[228:231], v1 offset:29696
    s_waitcnt vmcnt(8) lgkmcnt(8)
    v_mfma_f32_16x16x32_bf16 v[20:23], v[240:243], v[96:99], v[20:23]
    ds_read_b128 v[232:235], v1 offset:30720
    buffer_load_dwordx4 v[132:135], v1, s[8:11], s84 offen offset:1024 sc1
    v_mfma_f32_16x16x32_bf16 v[24:27], v[244:247], v[96:99], v[24:27]
    ds_read_b128 v[236:239], v1 offset:31744
    s_waitcnt lgkmcnt(8)
    v_mfma_f32_16x16x32_bf16 v[28:31], v[248:251], v[96:99], v[28:31]
    ds_read_b128 v[240:243], v1 offset:32768
    v_mfma_f32_16x16x32_bf16 v[32:35], v[252:255], v[96:99], v[32:35]
    ds_read_b128 v[244:247], v1 offset:33792
    s_waitcnt lgkmcnt(8)
    v_mfma_f32_16x16x32_bf16 v[36:39], v[208:211], v[96:99], v[36:39]
    ds_read_b128 v[248:251], v1 offset:34816
    buffer_load_dwordx4 v[136:139], v1, s[8:11], s84 offen offset:2048 sc1
    s_waitcnt vmcnt(9)
    v_mfma_f32_16x16x32_bf16 v[20:23], v[212:215], v[100:103], v[20:23]
    ds_read_b128 v[252:255], v1 offset:35840
    s_waitcnt lgkmcnt(8)
    v_mfma_f32_16x16x32_bf16 v[24:27], v[216:219], v[100:103], v[24:27]
    ds_read_b128 v[208:211], v1 offset:36864
    v_mfma_f32_16x16x32_bf16 v[28:31], v[220:223], v[100:103], v[28:31]
    ds_read_b128 v[212:215], v1 offset:37888
    s_waitcnt lgkmcnt(8)
    v_mfma_f32_16x16x32_bf16 v[32:35], v[224:227], v[100:103], v[32:35]
    ds_read_b128 v[216:219], v1 offset:38912
    buffer_load_dwordx4 v[140:143], v1, s[8:11], s84 offen offset:3072 sc1
    v_mfma_f32_16x16x32_bf16 v[36:39], v[228:231], v[100:103], v[36:39]
    ds_read_b128 v[220:223], v1 offset:39936
    s_waitcnt vmcnt(9) lgkmcnt(8)
    v_mfma_f32_16x16x32_bf16 v[20:23], v[232:235], v[104:107], v[20:23]
    ds_read_b128 v[224:227], v1 offset:40960
    v_mfma_f32_16x16x32_bf16 v[24:27], v[236:239], v[104:107], v[24:27]
    ds_read_b128 v[228:231], v1 offset:41984
    s_waitcnt lgkmcnt(8)
    v_mfma_f32_16x16x32_bf16 v[28:31], v[240:243], v[104:107], v[28:31]
    ds_read_b128 v[232:235], v1 offset:43008
    s_add_u32 s84, s58, 22036480
    buffer_load_dwordx4 v[144:147], v1, s[8:11], s84 offen offset:0 sc1
    v_mfma_f32_16x16x32_bf16 v[32:35], v[244:247], v[104:107], v[32:35]
    ds_read_b128 v[236:239], v1 offset:44032
    s_waitcnt lgkmcnt(8)
    v_mfma_f32_16x16x32_bf16 v[36:39], v[248:251], v[104:107], v[36:39]
    ds_read_b128 v[240:243], v1 offset:45056
    s_waitcnt vmcnt(9)
    v_mfma_f32_16x16x32_bf16 v[20:23], v[252:255], v[108:111], v[20:23]
    ds_read_b128 v[244:247], v1 offset:46080
    s_waitcnt lgkmcnt(8)
    v_mfma_f32_16x16x32_bf16 v[24:27], v[208:211], v[108:111], v[24:27]
    ds_read_b128 v[248:251], v1 offset:47104
    buffer_load_dwordx4 v[148:151], v1, s[8:11], s84 offen offset:1024 sc1
    v_mfma_f32_16x16x32_bf16 v[28:31], v[212:215], v[108:111], v[28:31]
    ds_read_b128 v[252:255], v1 offset:48128
    s_waitcnt lgkmcnt(8)
    v_mfma_f32_16x16x32_bf16 v[32:35], v[216:219], v[108:111], v[32:35]
    ds_read_b128 v[208:211], v1 offset:49152
    v_mfma_f32_16x16x32_bf16 v[36:39], v[220:223], v[108:111], v[36:39]
    ds_read_b128 v[212:215], v1 offset:50176
    s_waitcnt vmcnt(9) lgkmcnt(8)
    v_mfma_f32_16x16x32_bf16 v[20:23], v[224:227], v[112:115], v[20:23]
    ds_read_b128 v[216:219], v1 offset:51200
    buffer_load_dwordx4 v[152:155], v1, s[8:11], s84 offen offset:2048 sc1
    v_mfma_f32_16x16x32_bf16 v[24:27], v[228:231], v[112:115], v[24:27]
    ds_read_b128 v[220:223], v1 offset:52224
    s_waitcnt lgkmcnt(8)
    v_mfma_f32_16x16x32_bf16 v[28:31], v[232:235], v[112:115], v[28:31]
    ds_read_b128 v[224:227], v1 offset:53248
    v_mfma_f32_16x16x32_bf16 v[32:35], v[236:239], v[112:115], v[32:35]
    ds_read_b128 v[228:231], v1 offset:54272
    s_waitcnt lgkmcnt(8)
    v_mfma_f32_16x16x32_bf16 v[36:39], v[240:243], v[112:115], v[36:39]
    s_barrier
    ds_read_b128 v[232:235], v1 offset:55296
    buffer_load_dwordx4 v[156:159], v1, s[8:11], s84 offen offset:3072 sc1
    s_waitcnt vmcnt(10)
    v_mfma_f32_16x16x32_bf16 v[20:23], v[244:247], v[116:119], v[20:23]
    ds_read_b128 v[236:239], v1 offset:56320
    s_waitcnt lgkmcnt(8)
    v_mfma_f32_16x16x32_bf16 v[24:27], v[248:251], v[116:119], v[24:27]
    ds_read_b128 v[240:243], v1 offset:57344
    v_mfma_f32_16x16x32_bf16 v[28:31], v[252:255], v[116:119], v[28:31]
    ds_read_b128 v[244:247], v1 offset:58368
    s_waitcnt lgkmcnt(8)
    v_mfma_f32_16x16x32_bf16 v[32:35], v[208:211], v[116:119], v[32:35]
    ds_read_b128 v[248:251], v1 offset:59392
    v_mfma_f32_16x16x32_bf16 v[36:39], v[212:215], v[116:119], v[36:39]
    ds_read_b128 v[252:255], v1 offset:60416
    s_waitcnt vmcnt(9) lgkmcnt(8)
    v_mfma_f32_16x16x32_bf16 v[20:23], v[216:219], v[120:123], v[20:23]
    ds_read_b128 v[208:211], v2 offset:36864
    s_getpc_b64 s[4:5]
PCL_36:
    s_lshl_b32 s6, s45, 2
    s_add_u32 s6, s6, s49
    s_and_b32 s6, s6, 31
    s_lshl_b32 s6, s6, 10
    v_add_u32 v19, s6, v1
    v_min_u32 v19, CODE_END-PCL_36-16, v19
    global_load_dword a253, v19, s[4:5]
    v_mfma_f32_16x16x32_bf16 v[24:27], v[220:223], v[120:123], v[24:27]
    ds_read_b128 v[212:215], v2 offset:37888
    s_waitcnt lgkmcnt(8)
    v_mfma_f32_16x16x32_bf16 v[28:31], v[224:227], v[120:123], v[28:31]
    ds_read_b128 v[216:219], v2 offset:38912
    s_add_u32 m0, s63, 81920
    s_add_u32 s93, s60, 4235264
    buffer_load_dwordx4 v1, s[8:11], s93 offen offset:0  lds
    v_mfma_f32_16x16x32_bf16 v[32:35], v[228:231], v[120:123], v[32:35]
    ds_read_b128 v[220:223], v2 offset:39936
    s_waitcnt lgkmcnt(8)
    v_mfma_f32_16x16x32_bf16 v[36:39], v[232:235], v[120:123], v[36:39]
    ds_read_b128 v[224:227], v2 offset:40960
    s_waitcnt vmcnt(10)
    v_mfma_f32_16x16x32_bf16 v[20:23], v[236:239], v[124:127], v[20:23]
    ds_read_b128 v[228:231], v2 offset:41984
    buffer_load_dwordx4 v1, s[8:11], s93 offen offset:1024  lds
    s_waitcnt lgkmcnt(8)
    v_mfma_f32_16x16x32_bf16 v[24:27], v[240:243], v[124:127], v[24:27]
    ds_read_b128 v[232:235], v2 offset:43008
    v_mfma_f32_16x16x32_bf16 v[28:31], v[244:247], v[124:127], v[28:31]
    ds_read_b128 v[236:239], v2 offset:44032
    s_waitcnt lgkmcnt(8)
    v_mfma_f32_16x16x32_bf16 v[32:35], v[248:251], v[124:127], v[32:35]
    ds_read_b128 v[240:243], v2 offset:45056
    buffer_load_dwordx4 v1, s[8:11], s93 offen offset:2048  lds
    v_mfma_f32_16x16x32_bf16 v[36:39], v[252:255], v[124:127], v[36:39]
    ds_read_b128 v[244:247], v2 offset:46080
    s_waitcnt vmcnt(11) lgkmcnt(8)
    v_mfma_f32_16x16x32_bf16 v[20:23], v[208:211], v[128:131], v[20:23]
    ds_read_b128 v[248:251], v2 offset:47104
    v_mfma_f32_16x16x32_bf16 v[24:27], v[212:215], v[128:131], v[24:27]
    ds_read_b128 v[252:255], v2 offset:48128
    buffer_load_dwordx4 v1, s[8:11], s93 offen offset:3072  lds
    s_waitcnt lgkmcnt(8)
    v_mfma_f32_16x16x32_bf16 v[28:31], v[216:219], v[128:131], v[28:31]
    ds_read_b128 v[208:211], v2 offset:49152
    v_mfma_f32_16x16x32_bf16 v[32:35], v[220:223], v[128:131], v[32:35]
    ds_read_b128 v[212:215], v2 offset:50176
    s_add_u32 m0, m0, 4096
    s_add_u32 s93, s93, 4096
    buffer_load_dwordx4 v1, s[8:11], s93 offen offset:0  lds
    s_waitcnt lgkmcnt(8)
    v_mfma_f32_16x16x32_bf16 v[36:39], v[224:227], v[128:131], v[36:39]
    ds_read_b128 v[216:219], v2 offset:51200
    s_waitcnt vmcnt(12)
    v_mfma_f32_16x16x32_bf16 v[20:23], v[228:231], v[132:135], v[20:23]
    ds_read_b128 v[220:223], v2 offset:52224
    s_waitcnt lgkmcnt(8)
    v_mfma_f32_16x16x32_bf16 v[24:27], v[232:235], v[132:135], v[24:27]
    ds_read_b128 v[224:227], v2 offset:53248
    s_add_u32 m0, s63, 61440
    s_add_u32 s93, s60, 4255744
    buffer_load_dwordx4 v1, s[8:11], s93 offen offset:0  lds
    v_mfma_f32_16x16x32_bf16 v[28:31], v[236:239], v[132:135], v[28:31]
    ds_read_b128 v[228:231], v2 offset:54272
    s_waitcnt lgkmcnt(8)
    v_mfma_f32_16x16x32_bf16 v[32:35], v[240:243], v[132:135], v[32:35]
    ds_read_b128 v[232:235], v2 offset:55296
    v_mfma_f32_16x16x32_bf16 v[36:39], v[244:247], v[132:135], v[36:39]
    ds_read_b128 v[236:239], v2 offset:56320
    buffer_load_dwordx4 v1, s[8:11], s93 offen offset:1024  lds
    s_waitcnt vmcnt(13) lgkmcnt(8)
    v_mfma_f32_16x16x32_bf16 v[20:23], v[248:251], v[136:139], v[20:23]
    ds_read_b128 v[240:243], v2 offset:57344
    v_mfma_f32_16x16x32_bf16 v[24:27], v[252:255], v[136:139], v[24:27]
    ds_read_b128 v[244:247], v2 offset:58368
    s_waitcnt lgkmcnt(8)
    v_mfma_f32_16x16x32_bf16 v[28:31], v[208:211], v[136:139], v[28:31]
    ds_read_b128 v[248:251], v2 offset:59392
    buffer_load_dwordx4 v1, s[8:11], s93 offen offset:2048  lds
    v_mfma_f32_16x16x32_bf16 v[32:35], v[212:215], v[136:139], v[32:35]
    ds_read_b128 v[252:255], v2 offset:60416
    s_waitcnt lgkmcnt(8)
    v_mfma_f32_16x16x32_bf16 v[36:39], v[216:219], v[136:139], v[36:39]
    ds_read_b128 v[208:211], v2 offset:61440
    buffer_load_dwordx4 v1, s[8:11], s93 offen offset:3072  lds
    s_waitcnt vmcnt(14)
    v_mfma_f32_16x16x32_bf16 v[20:23], v[220:223], v[140:143], v[20:23]
    ds_read_b128 v[212:215], v2 offset:62464
    s_waitcnt lgkmcnt(8)
    v_mfma_f32_16x16x32_bf16 v[24:27], v[224:227], v[140:143], v[24:27]
    ds_read_b128 v[216:219], v2 offset:63488
    v_mfma_f32_16x16x32_bf16 v[28:31], v[228:231], v[140:143], v[28:31]
    ds_read_b128 v[220:223], v2 offset:64512
    s_add_u32 m0, m0, 4096
    s_add_u32 s93, s93, 4096
    buffer_load_dwordx4 v1, s[8:11], s93 offen offset:0  lds
    s_waitcnt lgkmcnt(8)
    v_mfma_f32_16x16x32_bf16 v[32:35], v[232:235], v[140:143], v[32:35]
    ds_read_b128 v[224:227], v3 offset:0
    v_mfma_f32_16x16x32_bf16 v[36:39], v[236:239], v[140:143], v[36:39]
    ds_read_b128 v[228:231], v3 offset:1024
    s_waitcnt vmcnt(14) lgkmcnt(8)
    v_mfma_f32_16x16x32_bf16 v[20:23], v[240:243], v[144:147], v[20:23]
    ds_read_b128 v[232:235], v3 offset:2048
    s_add_u32 m0, s63, 20480
    s_add_u32 s93, s60, 4276224
    buffer_load_dwordx4 v1, s[8:11], s93 offen offset:0  lds
    v_mfma_f32_16x16x32_bf16 v[24:27], v[244:247], v[144:147], v[24:27]
    ds_read_b128 v[236:239], v3 offset:3072
    s_waitcnt lgkmcnt(8)
    v_mfma_f32_16x16x32_bf16 v[28:31], v[248:251], v[144:147], v[28:31]
    ds_read_b128 v[240:243], v3 offset:4096
    v_mfma_f32_16x16x32_bf16 v[32:35], v[252:255], v[144:147], v[32:35]
    ds_read_b128 v[244:247], v3 offset:5120
    buffer_load_dwordx4 v1, s[8:11], s93 offen offset:1024  lds
    s_waitcnt lgkmcnt(8)
    v_mfma_f32_16x16x32_bf16 v[36:39], v[208:211], v[144:147], v[36:39]
    ds_read_b128 v[248:251], v3 offset:6144
    s_waitcnt vmcnt(15)
    v_mfma_f32_16x16x32_bf16 v[20:23], v[212:215], v[148:151], v[20:23]
    ds_read_b128 v[252:255], v3 offset:7168
    buffer_load_dwordx4 v1, s[8:11], s93 offen offset:2048  lds
    s_waitcnt lgkmcnt(8)
    v_mfma_f32_16x16x32_bf16 v[24:27], v[216:219], v[148:151], v[24:27]
    ds_read_b128 v[208:211], v3 offset:8192
    v_mfma_f32_16x16x32_bf16 v[28:31], v[220:223], v[148:151], v[28:31]
    ds_read_b128 v[212:215], v3 offset:9216
    s_waitcnt lgkmcnt(8)
    v_mfma_f32_16x16x32_bf16 v[32:35], v[224:227], v[148:151], v[32:35]
    ds_read_b128 v[216:219], v3 offset:10240
    buffer_load_dwordx4 v1, s[8:11], s93 offen offset:3072  lds
    v_mfma_f32_16x16x32_bf16 v[36:39], v[228:231], v[148:151], v[36:39]
    ds_read_b128 v[220:223], v3 offset:11264
    s_waitcnt vmcnt(16) lgkmcnt(8)
    v_mfma_f32_16x16x32_bf16 v[20:23], v[232:235], v[152:155], v[20:23]
    v_mfma_f32_16x16x32_bf16 v[24:27], v[236:239], v[152:155], v[24:27]
    s_add_u32 m0, m0, 4096
    s_add_u32 s93, s93, 4096
    buffer_load_dwordx4 v1, s[8:11], s93 offen offset:0  lds
    s_waitcnt lgkmcnt(6)
    v_mfma_f32_16x16x32_bf16 v[28:31], v[240:243], v[152:155], v[28:31]
    v_mfma_f32_16x16x32_bf16 v[32:35], v[244:247], v[152:155], v[32:35]
    s_waitcnt lgkmcnt(4)
    v_mfma_f32_16x16x32_bf16 v[36:39], v[248:251], v[152:155], v[36:39]
    s_waitcnt vmcnt(16)
    v_mfma_f32_16x16x32_bf16 v[20:23], v[252:255], v[156:159], v[20:23]
    s_waitcnt lgkmcnt(2)
    v_mfma_f32_16x16x32_bf16 v[24:27], v[208:211], v[156:159], v[24:27]
    v_mfma_f32_16x16x32_bf16 v[28:31], v[212:215], v[156:159], v[28:31]
    s_waitcnt lgkmcnt(0)
    v_mfma_f32_16x16x32_bf16 v[32:35], v[216:219], v[156:159], v[32:35]
    v_mfma_f32_16x16x32_bf16 v[36:39], v[220:223], v[156:159], v[36:39]
    s_nop 1
    v_cvt_pk_bf16_f32 v60, v20, v21
    v_cvt_pk_bf16_f32 v61, v22, v23
    v_cvt_pk_bf16_f32 v62, v24, v25
    v_cvt_pk_bf16_f32 v63, v26, v27
    v_cvt_pk_bf16_f32 v64, v28, v29
    v_cvt_pk_bf16_f32 v65, v30, v31
    v_cvt_pk_bf16_f32 v66, v32, v33
    v_cvt_pk_bf16_f32 v67, v34, v35
    v_cvt_pk_bf16_f32 v68, v36, v37
    v_cvt_pk_bf16_f32 v69, v38, v39
    s_add_u32 s82, s52, 18874368
    s_add_u32 s83, s53, 18874368
    s_cmp_eq_u32 s50, 0
    s_cbranch_scc1 SLOW_19
    buffer_store_dwordx4 v[60:63], v1, s[8:11], s82 offen
    buffer_store_dwordx4 v[64:67], v1, s[8:11], s82 offen offset:1024
    buffer_store_dwordx2 v[68:69], v4, s[8:11], s83 offen
BACK_19:
    v_pk_add_f32 v[72:73], v[20:21], v[22:23]
    v_pk_mul_f32 v[74:75], v[20:21], v[20:21]
    v_pk_fma_f32 v[74:75], v[22:23], v[22:23], v[74:75]
    v_pk_add_f32 v[72:73], v[72:73], v[24:25]
    v_pk_fma_f32 v[74:75], v[24:25], v[24:25], v[74:75]
    v_pk_add_f32 v[72:73], v[72:73], v[26:27]
    v_pk_fma_f32 v[74:75], v[26:27], v[26:27], v[74:75]
    v_pk_add_f32 v[72:73], v[72:73], v[28:29]
    v_pk_fma_f32 v[74:75], v[28:29], v[28:29], v[74:75]
    v_pk_add_f32 v[72:73], v[72:73], v[30:31]
    v_pk_fma_f32 v[74:75], v[30:31], v[30:31], v[74:75]
    v_pk_add_f32 v[72:73], v[72:73], v[32:33]
    v_pk_fma_f32 v[74:75], v[32:33], v[32:33], v[74:75]
    v_pk_add_f32 v[72:73], v[72:73], v[34:35]
    v_pk_fma_f32 v[74:75], v[34:35], v[34:35], v[74:75]
    v_pk_add_f32 v[72:73], v[72:73], v[36:37]
    v_pk_fma_f32 v[74:75], v[36:37], v[36:37], v[74:75]
    v_pk_add_f32 v[72:73], v[72:73], v[38:39]
    v_pk_fma_f32 v[74:75], v[38:39], v[38:39], v[74:75]
    v_add_f32 v72, v72, v73
    v_add_f32 v74, v74, v75
    s_nop 1
    v_permlane32_swap_b32 v72, v74
    v_add_f32 v72, v72, v74
    v_mov_b32 v73, v72
    s_nop 1
    v_permlane16_swap_b32 v72, v73
    v_add_f32 v72, v72, v73
    v_and_or_b32 v72, v72, -4, 1
    s_add_u32 s82, s54, 18874368
    s_cmp_eq_u32 s50, 0
    s_cbranch_scc1 SLOW_20
    buffer_store_dword v72, v5, s[8:11], s82 offen
BACK_20:
    v_mov_b32 v40, v20
    v_mov_b32 v41, v21
    v_mov_b32 v42, v22
    v_mov_b32 v43, v23
    v_mov_b32 v44, v24
    v_mov_b32 v45, v25
    v_mov_b32 v46, v26
    v_mov_b32 v47, v27
    v_mov_b32 v48, v28
    v_mov_b32 v49, v29
    v_mov_b32 v50, v30
    v_mov_b32 v51, v31
    v_mov_b32 v52, v32
    v_mov_b32 v53, v33
    v_mov_b32 v54, v34
    v_mov_b32 v55, v35
    v_mov_b32 v56, v36
    v_mov_b32 v57, v37
    v_mov_b32 v58, v38
    v_mov_b32 v59, v39
    s_waitcnt vmcnt(1)
    v_mov_b32 v7, 9
    v_mov_b32 v18, 0
    s_mov_b64 exec, 1
    s_cmp_eq_u32 s50, 0
    s_cbranch_scc1 SLOW_21
    buffer_store_dword v7, v18, s[8:11], s76 offen
BACK_21:
    s_mov_b64 exec, -1
    v_accvgpr_read_b32 v70, a249
    s_nop 1
    v_mov_b32_dpp v176, v70 row_newbcast:0 row_mask:0xf bank_mask:0xf
    v_mov_b32_dpp v177, v70 row_newbcast:1 row_mask:0xf bank_mask:0xf
    v_mov_b32_dpp v178, v70 row_newbcast:2 row_mask:0xf bank_mask:0xf
    v_mov_b32_dpp v179, v70 row_newbcast:3 row_mask:0xf bank_mask:0xf
    v_mov_b32_dpp v180, v70 row_newbcast:4 row_mask:0xf bank_mask:0xf
    v_mov_b32_dpp v181, v70 row_newbcast:5 row_mask:0xf bank_mask:0xf
    v_mov_b32_dpp v182, v70 row_newbcast:6 row_mask:0xf bank_mask:0xf
    v_mov_b32_dpp v183, v70 row_newbcast:7 row_mask:0xf bank_mask:0xf
    v_mov_b32_dpp v184, v70 row_newbcast:8 row_mask:0xf bank_mask:0xf
    v_mov_b32_dpp v185, v70 row_newbcast:9 row_mask:0xf bank_mask:0xf
    v_mov_b32_dpp v186, v70 row_newbcast:10 row_mask:0xf bank_mask:0xf
    v_mov_b32_dpp v187, v70 row_newbcast:11 row_mask:0xf bank_mask:0xf
    v_mov_b32_dpp v188, v70 row_newbcast:12 row_mask:0xf bank_mask:0xf
    v_mov_b32_dpp v189, v70 row_newbcast:13 row_mask:0xf bank_mask:0xf
    v_mov_b32_dpp v190, v70 row_newbcast:14 row_mask:0xf bank_mask:0xf
    v_mov_b32_dpp v191, v70 row_newbcast:15 row_mask:0xf bank_mask:0xf
    v_accvgpr_read_b32 v70, a250
    s_nop 1
    v_mov_b32_dpp v192, v70 row_newbcast:0 row_mask:0xf bank_mask:0xf
    v_mov_b32_dpp v193, v70 row_newbcast:1 row_mask:0xf bank_mask:0xf
    v_mov_b32_dpp v194, v70 row_newbcast:2 row_mask:0xf bank_mask:0xf
    v_mov_b32_dpp v195, v70 row_newbcast:3 row_mask:0xf bank_mask:0xf
    s_barrier
    ds_read_b128 v[208:211], v3 offset:12288
    ds_read_b128 v[212:215], v3 offset:13312
    ds_read_b128 v[216:219], v3 offset:14336
    ds_read_b128 v[220:223], v3 offset:15360
    ds_read_b128 v[224:227], v3 offset:16384
    ds_read_b128 v[228:231], v3 offset:17408
    ds_read_b128 v[232:235], v3 offset:18432
    ds_read_b128 v[236:239], v3 offset:19456
    ds_read_b128 v[240:243], v3 offset:20480
    ds_read_b128 v[244:247], v3 offset:21504
    v_and_b32 v168, 7, v0
    v_lshlrev_b32 v168, 2, v168
    s_lshl_b32 s85, s51, 5
    s_add_u32 s85, s85, 13635584
    buffer_load_dword v7, v168, s[8:11], s85 offen sc1
    s_add_u32 m0, s63, 40960
    s_add_u32 s93, s60, 5242880
    buffer_load_dwordx4 v1, s[8:11], s93 offen offset:0  lds
    buffer_load_dwordx4 v1, s[8:11], s93 offen offset:1024  lds
    buffer_load_dwordx4 v1, s[8:11], s93 offen offset:2048  lds
    buffer_load_dwordx4 v1, s[8:11], s93 offen offset:3072  lds
    s_add_u32 m0, m0, 4096
    s_add_u32 s93, s93, 4096
    buffer_load_dwordx4 v1, s[8:11], s93 offen offset:0  lds
    s_waitcnt vmcnt(5)
    v_cmp_le_u32 vcc, 9, v7
    s_nop 0
    s_cmp_lg_u64 vcc, -1
    s_cbranch_scc1 POLL_37
PDONE_38:
    s_add_u32 s84, s55, 18874368
    buffer_load_dwordx4 v[80:83], v1, s[8:11], s84 offen offset:0 sc1
    buffer_load_dwordx4 v[84:87], v1, s[8:11], s84 offen offset:1024 sc1
    buffer_load_dwordx4 v[88:91], v1, s[8:11], s84 offen offset:2048 sc1
    buffer_load_dwordx4 v[92:95], v1, s[8:11], s84 offen offset:3072 sc1
    s_add_u32 s84, s55, 18878464
    buffer_load_dwordx4 v[96:99], v1, s[8:11], s84 offen offset:0 sc1
    buffer_load_dwordx4 v[100:103], v1, s[8:11], s84 offen offset:1024 sc1
    buffer_load_dwordx4 v[104:107], v1, s[8:11], s84 offen offset:2048 sc1
    buffer_load_dwordx4 v[108:111], v1, s[8:11], s84 offen offset:3072 sc1
    s_waitcnt vmcnt(7) lgkmcnt(8)
    v_mfma_f32_16x16x32_bf16 v[20:23], v[208:211], v[80:83], 0
    ds_read_b128 v[248:251], v3 offset:22528
    s_add_u32 s84, s55, 18882560
    buffer_load_dwordx4 v[112:115], v1, s[8:11], s84 offen offset:0 sc1
    v_mfma_f32_16x16x32_bf16 v[24:27], v[212:215], v[80:83], 0
    ds_read_b128 v[252:255], v3 offset:23552
    s_waitcnt lgkmcnt(8)
    v_mfma_f32_16x16x32_bf16 v[28:31], v[216:219], v[80:83], 0
    ds_read_b128 v[208:211], v3 offset:24576
    v_mfma_f32_16x16x32_bf16 v[32:35], v[220:223], v[80:83], 0
    ds_read_b128 v[212:215], v3 offset:25600
    s_waitcnt lgkmcnt(8)
    v_mfma_f32_16x16x32_bf16 v[36:39], v[224:227], v[80:83], 0
    ds_read_b128 v[216:219], v3 offset:26624
    buffer_load_dwordx4 v[116:119], v1, s[8:11], s84 offen offset:1024 sc1
    s_waitcnt vmcnt(8)
    v_mfma_f32_16x16x32_bf16 v[20:23], v[228:231], v[84:87], v[20:23]
    ds_read_b128 v[220:223], v3 offset:27648
    s_waitcnt lgkmcnt(8)
    v_mfma_f32_16x16x32_bf16 v[24:27], v[232:235], v[84:87], v[24:27]
    ds_read_b128 v[224:227], v3 offset:28672
    v_mfma_f32_16x16x32_bf16 v[28:31], v[236:239], v[84:87], v[28:31]
    ds_read_b128 v[228:231], v3 offset:29696
    s_waitcnt lgkmcnt(8)
    v_mfma_f32_16x16x32_bf16 v[32:35], v[240:243], v[84:87], v[32:35]
    ds_read_b128 v[232:235], v3 offset:30720
    buffer_load_dwordx4 v[120:123], v1, s[8:11], s84 offen offset:2048 sc1
    v_mfma_f32_16x16x32_bf16 v[36:39], v[244:247], v[84:87], v[36:39]
    ds_read_b128 v[236:239], v3 offset:31744
    s_waitcnt vmcnt(8) lgkmcnt(8)
    v_mfma_f32_16x16x32_bf16 v[20:23], v[248:251], v[88:91], v[20:23]
    ds_read_b128 v[240:243], v1 offset:0
    v_mfma_f32_16x16x32_bf16 v[24:27], v[252:255], v[88:91], v[24:27]
    ds_read_b128 v[244:247], v1 offset:1024
    s_waitcnt lgkmcnt(8)
    v_mfma_f32_16x16x32_bf16 v[28:31], v[208:211], v[88:91], v[28:31]
    ds_read_b128 v[248:251], v1 offset:2048
    buffer_load_dwordx4 v[124:127], v1, s[8:11], s84 offen offset:3072 sc1
    v_mfma_f32_16x16x32_bf16 v[32:35], v[212:215], v[88:91], v[32:35]
    ds_read_b128 v[252:255], v1 offset:3072
    s_waitcnt lgkmcnt(8)
    v_mfma_f32_16x16x32_bf16 v[36:39], v[216:219], v[88:91], v[36:39]
    ds_read_b128 v[208:211], v1 offset:4096
    s_waitcnt vmcnt(8)
    v_mfma_f32_16x16x32_bf16 v[20:23], v[220:223], v[92:95], v[20:23]
    ds_read_b128 v[212:215], v1 offset:5120
    s_waitcnt lgkmcnt(8)
    v_mfma_f32_16x16x32_bf16 v[24:27], v[224:227], v[92:95], v[24:27]
    ds_read_b128 v[216:219], v1 offset:6144
    s_add_u32 s84, s55, 18886656
    buffer_load_dwordx4 v[128:131], v1, s[8:11], s84 offen offset:0 sc1
    v_mfma_f32_16x16x32_bf16 v[28:31], v[228:231], v[92:95], v[28:31]
    ds_read_b128 v[220:223], v1 offset:7168
    s_waitcnt lgkmcnt(8)
    v_mfma_f32_16x16x32_bf16 v[32:35], v[232:235], v[92:95], v[32:35]
    ds_read_b128 v[224:227], v1 offset:8192
    v_mfma_f32_16x16x32_bf16 v[36:39], v[236:239], v[92:95], v[36:39]
    ds_read_b128 v[228:231], v1 offset:9216
    s_waitcnt vmcnt(8) lgkmcnt(8)
    v_mfma_f32_16x16x32_bf16 v[20:23], v[240:243], v[96:99], v[20:23]
    ds_read_b128 v[232:235], v1 offset:10240
    buffer_load_dwordx4 v[132:135], v1, s[8:11], s84 offen offset:1024 sc1
    v_mfma_f32_16x16x32_bf16 v[24:27], v[244:247], v[96:99], v[24:27]
    ds_read_b128 v[236:239], v1 offset:11264
    s_waitcnt lgkmcnt(8)
    v_mfma_f32_16x16x32_bf16 v[28:31], v[248:251], v[96:99], v[28:31]
    ds_read_b128 v[240:243], v1 offset:12288
    v_mfma_f32_16x16x32_bf16 v[32:35], v[252:255], v[96:99], v[32:35]
    ds_read_b128 v[244:247], v1 offset:13312
    s_waitcnt lgkmcnt(8)
    v_mfma_f32_16x16x32_bf16 v[36:39], v[208:211], v[96:99], v[36:39]
    ds_read_b128 v[248:251], v1 offset:14336
    buffer_load_dwordx4 v[136:139], v1, s[8:11], s84 offen offset:2048 sc1
    s_waitcnt vmcnt(9)
    v_mfma_f32_16x16x32_bf16 v[20:23], v[212:215], v[100:103], v[20:23]
    ds_read_b128 v[252:255], v1 offset:15360
    s_waitcnt lgkmcnt(8)
    v_mfma_f32_16x16x32_bf16 v[24:27], v[216:219], v[100:103], v[24:27]
    ds_read_b128 v[208:211], v1 offset:16384
    v_mfma_f32_16x16x32_bf16 v[28:31], v[220:223], v[100:103], v[28:31]
    ds_read_b128 v[212:215], v1 offset:17408
    s_waitcnt lgkmcnt(8)
    v_mfma_f32_16x16x32_bf16 v[32:35], v[224:227], v[100:103], v[32:35]
    ds_read_b128 v[216:219], v1 offset:18432
    buffer_load_dwordx4 v[140:143], v1, s[8:11], s84 offen offset:3072 sc1
    v_mfma_f32_16x16x32_bf16 v[36:39], v[228:231], v[100:103], v[36:39]
    ds_read_b128 v[220:223], v1 offset:19456
    s_waitcnt vmcnt(9) lgkmcnt(8)
    v_mfma_f32_16x16x32_bf16 v[20:23], v[232:235], v[104:107], v[20:23]
    ds_read_b128 v[224:227], v2 offset:16384
    v_mfma_f32_16x16x32_bf16 v[24:27], v[236:239], v[104:107], v[24:27]
    ds_read_b128 v[228:231], v2 offset:17408
    s_waitcnt lgkmcnt(8)
    v_mfma_f32_16x16x32_bf16 v[28:31], v[240:243], v[104:107], v[28:31]
    ds_read_b128 v[232:235], v2 offset:18432
    s_add_u32 s84, s55, 18890752
    buffer_load_dwordx4 v[144:147], v1, s[8:11], s84 offen offset:0 sc1
    v_mfma_f32_16x16x32_bf16 v[32:35], v[244:247], v[104:107], v[32:35]
    ds_read_b128 v[236:239], v2 offset:19456
    s_waitcnt lgkmcnt(8)
    v_mfma_f32_16x16x32_bf16 v[36:39], v[248:251], v[104:107], v[36:39]
    ds_read_b128 v[240:243], v2 offset:20480
    s_waitcnt vmcnt(9)
    v_mfma_f32_16x16x32_bf16 v[20:23], v[252:255], v[108:111], v[20:23]
    ds_read_b128 v[244:247], v2 offset:21504
    s_waitcnt lgkmcnt(8)
    v_mfma_f32_16x16x32_bf16 v[24:27], v[208:211], v[108:111], v[24:27]
    ds_read_b128 v[248:251], v2 offset:22528
    buffer_load_dwordx4 v[148:151], v1, s[8:11], s84 offen offset:1024 sc1
    v_mfma_f32_16x16x32_bf16 v[28:31], v[212:215], v[108:111], v[28:31]
    ds_read_b128 v[252:255], v2 offset:23552
    s_waitcnt lgkmcnt(8)
    v_mfma_f32_16x16x32_bf16 v[32:35], v[216:219], v[108:111], v[32:35]
    ds_read_b128 v[208:211], v2 offset:24576
    v_mfma_f32_16x16x32_bf16 v[36:39], v[220:223], v[108:111], v[36:39]
    ds_read_b128 v[212:215], v2 offset:25600
    s_waitcnt vmcnt(9) lgkmcnt(8)
    v_mfma_f32_16x16x32_bf16 v[20:23], v[224:227], v[112:115], v[20:23]
    ds_read_b128 v[216:219], v2 offset:26624
    buffer_load_dwordx4 v[152:155], v1, s[8:11], s84 offen offset:2048 sc1
    v_mfma_f32_16x16x32_bf16 v[24:27], v[228:231], v[112:115], v[24:27]
    ds_read_b128 v[220:223], v2 offset:27648
    s_waitcnt lgkmcnt(8)
    v_mfma_f32_16x16x32_bf16 v[28:31], v[232:235], v[112:115], v[28:31]
    ds_read_b128 v[224:227], v2 offset:28672
    v_mfma_f32_16x16x32_bf16 v[32:35], v[236:239], v[112:115], v[32:35]
    ds_read_b128 v[228:231], v2 offset:29696
    s_waitcnt lgkmcnt(8)
    v_mfma_f32_16x16x32_bf16 v[36:39], v[240:243], v[112:115], v[36:39]
    s_barrier
    ds_read_b128 v[232:235], v2 offset:30720
    buffer_load_dwordx4 v[156:159], v1, s[8:11], s84 offen offset:3072 sc1
    s_waitcnt vmcnt(10)
    v_mfma_f32_16x16x32_bf16 v[20:23], v[244:247], v[116:119], v[20:23]
    ds_read_b128 v[236:239], v2 offset:31744
    s_waitcnt lgkmcnt(8)
    v_mfma_f32_16x16x32_bf16 v[24:27], v[248:251], v[116:119], v[24:27]
    ds_read_b128 v[240:243], v2 offset:32768
    v_mfma_f32_16x16x32_bf16 v[28:31], v[252:255], v[116:119], v[28:31]
    ds_read_b128 v[244:247], v2 offset:33792
    s_waitcnt lgkmcnt(8)
    v_mfma_f32_16x16x32_bf16 v[32:35], v[208:211], v[116:119], v[32:35]
    ds_read_b128 v[248:251], v2 offset:34816
    v_mfma_f32_16x16x32_bf16 v[36:39], v[212:215], v[116:119], v[36:39]
    ds_read_b128 v[252:255], v2 offset:35840
    s_waitcnt vmcnt(9) lgkmcnt(8)
    v_mfma_f32_16x16x32_bf16 v[20:23], v[216:219], v[120:123], v[20:23]
    ds_read_b128 v[208:211], v1 offset:61440
    s_getpc_b64 s[4:5]
PCL_41:
    s_lshl_b32 s6, s45, 2
    s_add_u32 s6, s6, s49
    s_and_b32 s6, s6, 31
    s_lshl_b32 s6, s6, 10
    v_add_u32 v19, s6, v1
    v_min_u32 v19, CODE_END-PCL_41-16, v19
    global_load_dword a253, v19, s[4:5]
    v_mfma_f32_16x16x32_bf16 v[24:27], v[220:223], v[120:123], v[24:27]
    ds_read_b128 v[212:215], v1 offset:62464
    s_waitcnt lgkmcnt(8)
    v_mfma_f32_16x16x32_bf16 v[28:31], v[224:227], v[120:123], v[28:31]
    ds_read_b128 v[216:219], v1 offset:63488
    s_add_u32 s84, s55, 18894848
    buffer_load_dwordx4 v[172:175], v1, s[8:11], s84 offen offset:0 sc1
    v_mfma_f32_16x16x32_bf16 v[32:35], v[228:231], v[120:123], v[32:35]
    ds_read_b128 v[220:223], v1 offset:64512
    s_waitcnt lgkmcnt(8)
    v_mfma_f32_16x16x32_bf16 v[36:39], v[232:235], v[120:123], v[36:39]
    ds_read_b128 v[224:227], v2 offset:0
    s_waitcnt vmcnt(10)
    v_mfma_f32_16x16x32_bf16 v[20:23], v[236:239], v[124:127], v[20:23]
    ds_read_b128 v[228:231], v2 offset:1024
    s_add_u32 m0, s63, 102400
    s_add_u32 s93, s60, 5263360
    buffer_load_dwordx4 v1, s[8:11], s93 offen offset:0  lds
    s_waitcnt lgkmcnt(8)
    v_mfma_f32_16x16x32_bf16 v[24:27], v[240:243], v[124:127], v[24:27]
    ds_read_b128 v[232:235], v2 offset:2048
    v_mfma_f32_16x16x32_bf16 v[28:31], v[244:247], v[124:127], v[28:31]
    ds_read_b128 v[236:239], v2 offset:3072
    buffer_load_dwordx4 v1, s[8:11], s93 offen offset:1024  lds
    s_waitcnt lgkmcnt(8)
    v_mfma_f32_16x16x32_bf16 v[32:35], v[248:251], v[124:127], v[32:35]
    ds_read_b128 v[240:243], v2 offset:4096
    v_mfma_f32_16x16x32_bf16 v[36:39], v[252:255], v[124:127], v[36:39]
    ds_read_b128 v[244:247], v2 offset:5120
    s_waitcnt vmcnt(11) lgkmcnt(8)
    v_mfma_f32_16x16x32_bf16 v[20:23], v[208:211], v[128:131], v[20:23]
    ds_read_b128 v[248:251], v2 offset:6144
    buffer_load_dwordx4 v1, s[8:11], s93 offen offset:2048  lds
    v_mfma_f32_16x16x32_bf16 v[24:27], v[212:215], v[128:131], v[24:27]
    ds_read_b128 v[252:255], v2 offset:7168
    s_waitcnt lgkmcnt(8)
    v_mfma_f32_16x16x32_bf16 v[28:31], v[216:219], v[128:131], v[28:31]
    ds_read_b128 v[208:211], v2 offset:8192
    buffer_load_dwordx4 v1, s[8:11], s93 offen offset:3072  lds
    v_mfma_f32_16x16x32_bf16 v[32:35], v[220:223], v[128:131], v[32:35]
    ds_read_b128 v[212:215], v2 offset:9216
    s_waitcnt lgkmcnt(8)
    v_mfma_f32_16x16x32_bf16 v[36:39], v[224:227], v[128:131], v[36:39]
    ds_read_b128 v[216:219], v2 offset:10240
    s_waitcnt vmcnt(12)
    v_mfma_f32_16x16x32_bf16 v[20:23], v[228:231], v[132:135], v[20:23]
    ds_read_b128 v[220:223], v2 offset:11264
    s_add_u32 m0, m0, 4096
    s_add_u32 s93, s93, 4096
    buffer_load_dwordx4 v1, s[8:11], s93 offen offset:0  lds
    s_waitcnt lgkmcnt(8)
    v_mfma_f32_16x16x32_bf16 v[24:27], v[232:235], v[132:135], v[24:27]
    ds_read_b128 v[224:227], v2 offset:12288
    v_mfma_f32_16x16x32_bf16 v[28:31], v[236:239], v[132:135], v[28:31]
    ds_read_b128 v[228:231], v2 offset:13312
    s_waitcnt lgkmcnt(8)
    v_mfma_f32_16x16x32_bf16 v[32:35], v[240:243], v[132:135], v[32:35]
    ds_read_b128 v[232:235], v2 offset:14336
    s_add_u32 m0, s63, 143360
    s_add_u32 s93, s60, 5283840
    buffer_load_dwordx4 v1, s[8:11], s93 offen offset:0  lds
    v_mfma_f32_16x16x32_bf16 v[36:39], v[244:247], v[132:135], v[36:39]
    ds_read_b128 v[236:239], v2 offset:15360
    s_waitcnt vmcnt(13) lgkmcnt(8)
    v_mfma_f32_16x16x32_bf16 v[20:23], v[248:251], v[136:139], v[20:23]
    ds_read_b128 v[240:243], v1 offset:20480
    buffer_load_dwordx4 v1, s[8:11], s93 offen offset:1024  lds
    v_mfma_f32_16x16x32_bf16 v[24:27], v[252:255], v[136:139], v[24:27]
    ds_read_b128 v[244:247], v1 offset:21504
    s_waitcnt lgkmcnt(8)
    v_mfma_f32_16x16x32_bf16 v[28:31], v[208:211], v[136:139], v[28:31]
    ds_read_b128 v[248:251], v1 offset:22528
    s_waitcnt vmcnt(7)
    v_or3_b32 v76, v172, v173, v174
    v_mfma_f32_16x16x32_bf16 v[32:35], v[212:215], v[136:139], v[32:35]
    ds_read_b128 v[252:255], v1 offset:23552
    buffer_load_dwordx4 v1, s[8:11], s93 offen offset:2048  lds
    s_waitcnt lgkmcnt(8)
    v_mfma_f32_16x16x32_bf16 v[36:39], v[216:219], v[136:139], v[36:39]
    ds_read_b128 v[208:211], v1 offset:24576
    v_or_b32 v76, v76, v175
    v_mfma_f32_16x16x32_bf16 v[20:23], v[220:223], v[140:143], v[20:23]
    ds_read_b128 v[212:215], v1 offset:25600
    buffer_load_dwordx4 v1, s[8:11], s93 offen offset:3072  lds
    s_waitcnt lgkmcnt(8)
    v_mfma_f32_16x16x32_bf16 v[24:27], v[224:227], v[140:143], v[24:27]
    ds_read_b128 v[216:219], v1 offset:26624
    v_and_b32 v76, 2, v76
    v_mfma_f32_16x16x32_bf16 v[28:31], v[228:231], v[140:143], v[28:31]
    ds_read_b128 v[220:223], v1 offset:27648
    s_waitcnt lgkmcnt(8)
    v_cmp_ne_u32 vcc, 0, v76
    s_nop 0
    s_cmp_lg_u64 vcc, 0
    s_cbranch_scc1 STR_39
STB_40:
    v_mfma_f32_16x16x32_bf16 v[32:35], v[232:235], v[140:143], v[32:35]
    ds_read_b128 v[224:227], v1 offset:28672
    s_add_u32 m0, m0, 4096
    s_add_u32 s93, s93, 4096
    buffer_load_dwordx4 v1, s[8:11], s93 offen offset:0  lds
    v_mfma_f32_16x16x32_bf16 v[36:39], v[236:239], v[140:143], v[36:39]
    ds_read_b128 v[228:231], v1 offset:29696
    s_waitcnt lgkmcnt(8)
    v_add_f32 v172, v172, v174
    v_mfma_f32_16x16x32_bf16 v[20:23], v[240:243], v[144:147], v[20:23]
    ds_read_b128 v[232:235], v1 offset:30720
    v_add_f32 v173, v173, v175
    v_mfma_f32_16x16x32_bf16 v[24:27], v[244:247], v[144:147], v[24:27]
    ds_read_b128 v[236:239], v1 offset:31744
    s_add_u32 m0, s63, 0
    s_add_u32 s93, s60, 5304320
    buffer_load_dwordx4 v1, s[8:11], s93 offen offset:0  lds
    s_waitcnt lgkmcnt(8)
    v_mfma_f32_16x16x32_bf16 v[28:31], v[248:251], v[144:147], v[28:31]
    ds_read_b128 v[240:243], v1 offset:32768
    v_permlane32_swap_b32 v172, v173
    v_mfma_f32_16x16x32_bf16 v[32:35], v[252:255], v[144:147], v[32:35]
    ds_read_b128 v[244:247], v1 offset:33792
    buffer_load_dwordx4 v1, s[8:11], s93 offen offset:1024  lds
    s_waitcnt lgkmcnt(8)
    v_mfma_f32_16x16x32_bf16 v[36:39], v[208:211], v[144:147], v[36:39]
    ds_read_b128 v[248:251], v1 offset:34816
    v_add_f32 v172, v172, v173
    v_mfma_f32_16x16x32_bf16 v[20:23], v[212:215], v[148:151], v[20:23]
    ds_read_b128 v[252:255], v1 offset:35840
    s_waitcnt lgkmcnt(8)
    v_mov_b32 v173, v172
    v_mfma_f32_16x16x32_bf16 v[24:27], v[216:219], v[148:151], v[24:27]
    ds_read_b128 v[208:211], v1 offset:36864
    buffer_load_dwordx4 v1, s[8:11], s93 offen offset:2048  lds
    v_mfma_f32_16x16x32_bf16 v[28:31], v[220:223], v[148:151], v[28:31]
    ds_read_b128 v[212:215], v1 offset:37888
    s_waitcnt lgkmcnt(8)
    v_permlane16_swap_b32 v172, v173
    v_mfma_f32_16x16x32_bf16 v[32:35], v[224:227], v[148:151], v[32:35]
    ds_read_b128 v[216:219], v1 offset:38912
    buffer_load_dwordx4 v1, s[8:11], s93 offen offset:3072  lds
    v_mfma_f32_16x16x32_bf16 v[36:39], v[228:231], v[148:151], v[36:39]
    ds_read_b128 v[220:223], v1 offset:39936
    s_waitcnt lgkmcnt(8)
    v_add_f32 v172, v172, v173
    v_mfma_f32_16x16x32_bf16 v[20:23], v[232:235], v[152:155], v[20:23]
    v_mov_b32 v173, v172
    s_nop 1
    v_permlane32_swap_b32 v172, v173
    v_mfma_f32_16x16x32_bf16 v[24:27], v[236:239], v[152:155], v[24:27]
    s_add_u32 m0, m0, 4096
    s_add_u32 s93, s93, 4096
    buffer_load_dwordx4 v1, s[8:11], s93 offen offset:0  lds
    s_waitcnt lgkmcnt(6)
    v_mfma_f32_16x16x32_bf16 v[28:31], v[240:243], v[152:155], v[28:31]
    v_mul_f32 v76, 0xbacccccd, v172
    v_mul_f32 v173, 0x3acccccd, v173
    v_mfma_f32_16x16x32_bf16 v[32:35], v[244:247], v[152:155], v[32:35]
    s_waitcnt lgkmcnt(4)
    v_fma_f32 v173, -v76, v76, v173
    v_max_f32 v173, 0, v173
    v_mfma_f32_16x16x32_bf16 v[36:39], v[248:251], v[152:155], v[36:39]
    v_add_f32 v174, 0x3727c5ac, v173
    v_mfma_f32_16x16x32_bf16 v[20:23], v[252:255], v[156:159], v[20:23]
    s_waitcnt lgkmcnt(2)
    v_rsq_f32 v78, v174
    v_mfma_f32_16x16x32_bf16 v[24:27], v[208:211], v[156:159], v[24:27]
    v_mul_f32 v173, v173, v78
    v_mul_f32 v173, v173, v78
    v_mfma_f32_16x16x32_bf16 v[28:31], v[212:215], v[156:159], v[28:31]
    s_waitcnt lgkmcnt(0)
    v_add_f32 v173, 0x3727c5ac, v173
    v_mfma_f32_16x16x32_bf16 v[32:35], v[216:219], v[156:159], v[32:35]
    v_rsq_f32 v173, v173
    v_mfma_f32_16x16x32_bf16 v[36:39], v[220:223], v[156:159], v[36:39]
    v_mul_f32 v74, v78, v173
    v_mov_b32 v168, v76
    v_rcp_f32 v169, v74
    v_mul_f32 v171, 0xc0135761, v74
    v_mul_f32 v170, v74, v74
    v_mul_f32 v170, v170, v171
    v_mul_f32 v170, 0x3d372713, v170
    v_pk_fma_f32 v[20:21], v[176:177], v[168:169], v[20:21] op_sel_hi:[1,0,1]
    s_add_u32 m0, s63, 122880
    s_add_u32 s93, s60, 5324800
    buffer_load_dwordx4 v1, s[8:11], s93 offen offset:0  lds
    v_pk_fma_f32 v[22:23], v[178:179], v[168:169], v[22:23] op_sel_hi:[1,0,1]
    v_pk_fma_f32 v[24:25], v[180:181], v[168:169], v[24:25] op_sel_hi:[1,0,1]
    v_pk_fma_f32 v[26:27], v[182:183], v[168:169], v[26:27] op_sel_hi:[1,0,1]
    v_pk_fma_f32 v[28:29], v[184:185], v[168:169], v[28:29] op_sel_hi:[1,0,1]
    v_pk_fma_f32 v[30:31], v[186:187], v[168:169], v[30:31] op_sel_hi:[1,0,1]
    v_pk_fma_f32 v[32:33], v[188:189], v[168:169], v[32:33] op_sel_hi:[1,0,1]
    v_pk_fma_f32 v[34:35], v[190:191], v[168:169], v[34:35] op_sel_hi:[1,0,1]
    v_pk_fma_f32 v[36:37], v[192:193], v[168:169], v[36:37] op_sel_hi:[1,0,1]
    buffer_load_dwordx4 v1, s[8:11], s93 offen offset:1024  lds
    v_pk_fma_f32 v[38:39], v[194:195], v[168:169], v[38:39] op_sel_hi:[1,0,1]
    v_pk_mul_f32 v[80:81], v[20:21], v[20:21]
    v_pk_mul_f32 v[82:83], v[22:23], v[22:23]
    v_pk_mul_f32 v[84:85], v[24:25], v[24:25]
    v_pk_mul_f32 v[86:87], v[26:27], v[26:27]
    v_pk_mul_f32 v[88:89], v[28:29], v[28:29]
    v_pk_mul_f32 v[90:91], v[30:31], v[30:31]
    v_pk_mul_f32 v[92:93], v[32:33], v[32:33]
    buffer_load_dwordx4 v1, s[8:11], s93 offen offset:2048  lds
    v_pk_mul_f32 v[94:95], v[34:35], v[34:35]
    v_pk_mul_f32 v[96:97], v[36:37], v[36:37]
    v_pk_mul_f32 v[98:99], v[38:39], v[38:39]
    v_pk_fma_f32 v[80:81], v[80:81], v[170:171], v[170:171] op_sel:[0,0,1] op_sel_hi:[1,0,1]
    v_pk_fma_f32 v[82:83], v[82:83], v[170:171], v[170:171] op_sel:[0,0,1] op_sel_hi:[1,0,1]
    v_pk_fma_f32 v[84:85], v[84:85], v[170:171], v[170:171] op_sel:[0,0,1] op_sel_hi:[1,0,1]
    v_pk_fma_f32 v[86:87], v[86:87], v[170:171], v[170:171] op_sel:[0,0,1] op_sel_hi:[1,0,1]
    v_pk_fma_f32 v[88:89], v[88:89], v[170:171], v[170:171] op_sel:[0,0,1] op_sel_hi:[1,0,1]
    buffer_load_dwordx4 v1, s[8:11], s93 offen offset:3072  lds
    v_pk_fma_f32 v[90:91], v[90:91], v[170:171], v[170:171] op_sel:[0,0,1] op_sel_hi:[1,0,1]
    v_pk_fma_f32 v[92:93], v[92:93], v[170:171], v[170:171] op_sel:[0,0,1] op_sel_hi:[1,0,1]
    v_pk_fma_f32 v[94:95], v[94:95], v[170:171], v[170:171] op_sel:[0,0,1] op_sel_hi:[1,0,1]
    v_pk_fma_f32 v[96:97], v[96:97], v[170:171], v[170:171] op_sel:[0,0,1] op_sel_hi:[1,0,1]
    v_pk_fma_f32 v[98:99], v[98:99], v[170:171], v[170:171] op_sel:[0,0,1] op_sel_hi:[1,0,1]
    v_pk_mul_f32 v[80:81], v[80:81], v[20:21]
    v_pk_mul_f32 v[82:83], v[82:83], v[22:23]
    v_pk_mul_f32 v[84:85], v[84:85], v[24:25]
    s_add_u32 m0, m0, 4096
    s_add_u32 s93, s93, 4096
    buffer_load_dwordx4 v1, s[8:11], s93 offen offset:0  lds
    v_pk_mul_f32 v[86:87], v[86:87], v[26:27]
    v_pk_mul_f32 v[88:89], v[88:89], v[28:29]
    v_pk_mul_f32 v[90:91], v[90:91], v[30:31]
    v_pk_mul_f32 v[92:93], v[92:93], v[32:33]
    v_pk_mul_f32 v[94:95], v[94:95], v[34:35]
    v_pk_mul_f32 v[96:97], v[96:97], v[36:37]
    v_pk_mul_f32 v[98:99], v[98:99], v[38:39]
    v_exp_f32 v80, v80
    v_exp_f32 v81, v81
    v_exp_f32 v82, v82
    v_exp_f32 v83, v83
    v_exp_f32 v84, v84
    v_exp_f32 v85, v85
    v_exp_f32 v86, v86
    v_exp_f32 v87, v87
    v_exp_f32 v88, v88
    v_exp_f32 v89, v89
    v_exp_f32 v90, v90
    v_exp_f32 v91, v91
    v_exp_f32 v92, v92
    v_exp_f32 v93, v93
    v_exp_f32 v94, v94
    v_exp_f32 v95, v95
    v_exp_f32 v96, v96
    v_exp_f32 v97, v97
    v_exp_f32 v98, v98
    v_exp_f32 v99, v99
    v_pk_fma_f32 v[80:81], v[80:81], v[168:169], v[168:169] op_sel:[0,1,1] op_sel_hi:[1,1,1]
    v_pk_fma_f32 v[82:83], v[82:83], v[168:169], v[168:169] op_sel:[0,1,1] op_sel_hi:[1,1,1]
    v_pk_fma_f32 v[84:85], v[84:85], v[168:169], v[168:169] op_sel:[0,1,1] op_sel_hi:[1,1,1]
    v_pk_fma_f32 v[86:87], v[86:87], v[168:169], v[168:169] op_sel:[0,1,1] op_sel_hi:[1,1,1]
    v_pk_fma_f32 v[88:89], v[88:89], v[168:169], v[168:169] op_sel:[0,1,1] op_sel_hi:[1,1,1]
    v_pk_fma_f32 v[90:91], v[90:91], v[168:169], v[168:169] op_sel:[0,1,1] op_sel_hi:[1,1,1]
    v_pk_fma_f32 v[92:93], v[92:93], v[168:169], v[168:169] op_sel:[0,1,1] op_sel_hi:[1,1,1]
    v_pk_fma_f32 v[94:95], v[94:95], v[168:169], v[168:169] op_sel:[0,1,1] op_sel_hi:[1,1,1]
    v_pk_fma_f32 v[96:97], v[96:97], v[168:169], v[168:169] op_sel:[0,1,1] op_sel_hi:[1,1,1]
    v_pk_fma_f32 v[98:99], v[98:99], v[168:169], v[168:169] op_sel:[0,1,1] op_sel_hi:[1,1,1]
    v_rcp_f32 v80, v80
    v_rcp_f32 v81, v81
    v_rcp_f32 v82, v82
    v_rcp_f32 v83, v83
    v_rcp_f32 v84, v84
    v_rcp_f32 v85, v85
    v_rcp_f32 v86, v86
    v_rcp_f32 v87, v87
    v_rcp_f32 v88, v88
    v_rcp_f32 v89, v89
    v_rcp_f32 v90, v90
    v_rcp_f32 v91, v91
    v_rcp_f32 v92, v92
    v_rcp_f32 v93, v93
    v_rcp_f32 v94, v94
    v_rcp_f32 v95, v95
    v_rcp_f32 v96, v96
    v_rcp_f32 v97, v97
    v_rcp_f32 v98, v98
    v_rcp_f32 v99, v99
    v_pk_mul_f32 v[20:21], v[20:21], v[80:81]
    v_pk_mul_f32 v[22:23], v[22:23], v[82:83]
    v_pk_mul_f32 v[24:25], v[24:25], v[84:85]
    v_pk_mul_f32 v[26:27], v[26:27], v[86:87]
    v_pk_mul_f32 v[28:29], v[28:29], v[88:89]
    v_pk_mul_f32 v[30:31], v[30:31], v[90:91]
    v_pk_mul_f32 v[32:33], v[32:33], v[92:93]
    v_pk_mul_f32 v[34:35], v[34:35], v[94:95]
    v_pk_mul_f32 v[36:37], v[36:37], v[96:97]
    v_pk_mul_f32 v[38:39], v[38:39], v[98:99]
    v_cvt_pk_bf16_f32 v60, v20, v21
    v_cvt_pk_bf16_f32 v61, v22, v23
    v_cvt_pk_bf16_f32 v62, v24, v25
    v_cvt_pk_bf16_f32 v63, v26, v27
    v_cvt_pk_bf16_f32 v64, v28, v29
    v_cvt_pk_bf16_f32 v65, v30, v31
    v_cvt_pk_bf16_f32 v66, v32, v33
    v_cvt_pk_bf16_f32 v67, v34, v35
    v_cvt_pk_bf16_f32 v68, v36, v37
    v_cvt_pk_bf16_f32 v69, v38, v39
    v_or_b32 v70, s66, v1
    v_or_b32 v71, s66, v4
    s_add_u32 s82, s56, 22020096
    s_add_u32 s83, s57, 22020096
    s_cmp_eq_u32 s50, 0
    s_cbranch_scc1 SLOW_22
    buffer_store_dwordx4 v[60:63], v1, s[8:11], s82 offen
    buffer_store_dwordx4 v[64:67], v1, s[8:11], s82 offen offset:1024
    buffer_store_dwordx2 v[68:69], v4, s[8:11], s83 offen
BACK_22:
    s_add_u32 s82, s56, 34603008
    s_add_u32 s83, s57, 34603008
    buffer_store_dwordx4 v[60:63], v70, s[8:11], s82 offen sc1
    buffer_store_dwordx4 v[64:67], v70, s[8:11], s82 offen offset:1024 sc1
    buffer_store_dwordx2 v[68:69], v71, s[8:11], s83 offen sc1
    v_pk_add_f32 v[20:21], v[40:41], v[76:77] op_sel_hi:[1,0]
    v_pk_add_f32 v[22:23], v[42:43], v[76:77] op_sel_hi:[1,0]
    v_pk_add_f32 v[24:25], v[44:45], v[76:77] op_sel_hi:[1,0]
    v_pk_add_f32 v[26:27], v[46:47], v[76:77] op_sel_hi:[1,0]
    v_pk_add_f32 v[28:29], v[48:49], v[76:77] op_sel_hi:[1,0]
    v_pk_add_f32 v[30:31], v[50:51], v[76:77] op_sel_hi:[1,0]
    v_pk_add_f32 v[32:33], v[52:53], v[76:77] op_sel_hi:[1,0]
    v_pk_add_f32 v[34:35], v[54:55], v[76:77] op_sel_hi:[1,0]
    v_pk_add_f32 v[36:37], v[56:57], v[76:77] op_sel_hi:[1,0]
    v_pk_add_f32 v[38:39], v[58:59], v[76:77] op_sel_hi:[1,0]
    v_pk_mul_f32 v[20:21], v[20:21], v[78:79] op_sel_hi:[1,0]
    v_pk_mul_f32 v[22:23], v[22:23], v[78:79] op_sel_hi:[1,0]
    v_pk_mul_f32 v[24:25], v[24:25], v[78:79] op_sel_hi:[1,0]
    v_pk_mul_f32 v[26:27], v[26:27], v[78:79] op_sel_hi:[1,0]
    v_pk_mul_f32 v[28:29], v[28:29], v[78:79] op_sel_hi:[1,0]
    v_pk_mul_f32 v[30:31], v[30:31], v[78:79] op_sel_hi:[1,0]
    v_pk_mul_f32 v[32:33], v[32:33], v[78:79] op_sel_hi:[1,0]
    v_pk_mul_f32 v[34:35], v[34:35], v[78:79] op_sel_hi:[1,0]
    v_pk_mul_f32 v[36:37], v[36:37], v[78:79] op_sel_hi:[1,0]
    v_pk_mul_f32 v[38:39], v[38:39], v[78:79] op_sel_hi:[1,0]
    s_lshl_b32 s85, s51, 4
    v_and_b32 v84, 15, v0
    v_add_u32 v84, s85, v84
    v_lshrrev_b32 v85, 4, v0
    v_lshlrev_b32 v85, 8, v85
    v_mov_b32 v88, 2147483648
    v_mov_b32 v89, 12582912
    v_add_u32 v86, -1, v84
    v_lshrrev_b32 v87, 4, v86
    v_and_b32 v87, 0xff, v87
    v_mul_u32_u24 v87, 20480, v87
    v_and_b32 v168, 15, v86
    v_lshl_add_u32 v168, v168, 4, v87
    v_add_u32 v168, v168, v85
    v_lshrrev_b32 v87, 8, v86
    v_cmp_ne_u32 vcc, s44, v87
    s_nop 1
    v_cndmask_b32 v87, 0, v89, vcc
    v_add_u32 v168, v168, v87
    v_cmp_gt_u32 vcc, 0x800, v86
    s_nop 1
    v_cndmask_b32 v168, v88, v168, vcc
    v_add_u32 v86, 1, v84
    v_lshrrev_b32 v87, 4, v86
    v_and_b32 v87, 0xff, v87
    v_mul_u32_u24 v87, 20480, v87
    v_and_b32 v169, 15, v86
    v_lshl_add_u32 v169, v169, 4, v87
    v_add_u32 v169, v169, v85
    v_lshrrev_b32 v87, 8, v86
    v_cmp_ne_u32 vcc, s44, v87
    s_nop 1
    v_cndmask_b32 v87, 0, v89, vcc
    v_add_u32 v169, v169, v87
    v_cmp_gt_u32 vcc, 0x800, v86
    s_nop 1
    v_cndmask_b32 v169, v88, v169, vcc
    s_waitcnt vmcnt(3)
    v_mov_b32 v7, 10
    v_mov_b32 v18, 0
    s_mov_b64 exec, 1
    s_cmp_eq_u32 s50, 0
    s_cbranch_scc1 SLOW_23
    buffer_store_dword v7, v18, s[8:11], s76 offen
BACK_23:
    s_mov_b64 exec, -1
    v_add_u32 v86, -2, v84
    v_lshrrev_b32 v87, 4, v86
    v_and_b32 v87, 0xff, v87
    v_mul_u32_u24 v87, 20480, v87
    v_and_b32 v170, 15, v86
    v_lshl_add_u32 v170, v170, 4, v87
    v_add_u32 v170, v170, v85
    v_lshrrev_b32 v87, 8, v86
    v_cmp_ne_u32 vcc, s44, v87
    s_nop 1
    v_cndmask_b32 v87, 0, v89, vcc
    v_add_u32 v170, v170, v87
    v_cmp_gt_u32 vcc, 0x800, v86
    s_nop 1
    v_cndmask_b32 v170, v88, v170, vcc
    v_add_u32 v86, 2, v84
    v_lshrrev_b32 v87, 4, v86
    v_and_b32 v87, 0xff, v87
    v_mul_u32_u24 v87, 20480, v87
    v_and_b32 v171, 15, v86
    v_lshl_add_u32 v171, v171, 4, v87
    v_add_u32 v171, v171, v85
    v_lshrrev_b32 v87, 8, v86
    v_cmp_ne_u32 vcc, s44, v87
    s_nop 1
    v_cndmask_b32 v87, 0, v89, vcc
    v_add_u32 v171, v171, v87
    v_cmp_gt_u32 vcc, 0x800, v86
    s_nop 1
    v_cndmask_b32 v171, v88, v171, vcc
    s_barrier
    ds_read_b128 v[208:211], v1 offset:40960
    ds_read_b128 v[212:215], v1 offset:41984
    ds_read_b128 v[216:219], v1 offset:43008
    ds_read_b128 v[220:223], v1 offset:44032
    ds_read_b128 v[224:227], v1 offset:45056
    ds_read_b128 v[228:231], v1 offset:46080
    ds_read_b128 v[232:235], v1 offset:47104
    ds_read_b128 v[236:239], v1 offset:48128
    ds_read_b128 v[240:243], v1 offset:49152
    ds_read_b128 v[244:247], v1 offset:50176
    s_and_b32 s90, s51, 15
    s_cmp_eq_u32 s90, 0
    s_cselect_b32 s86, 32, 0
    s_cmp_eq_u32 s90, 15
    s_cselect_b32 s87, 32, 64
    v_and_b32 v84, 7, v0
    v_lshlrev_b32 v84, 2, v84
    v_lshrrev_b32 v86, 3, v0
    v_mov_b32 v85, 32
    v_mov_b32 v87, s86
    v_mov_b32 v88, s87
    v_cmp_eq_u32 vcc, 1, v86
    s_nop 1
    v_cndmask_b32 v85, v85, v87, vcc
    v_cmp_eq_u32 vcc, 2, v86
    s_nop 1
    v_cndmask_b32 v85, v85, v88, vcc
    v_add_u32 v85, v85, v84
    s_lshl_b32 s85, s51, 5
    s_add_u32 s85, s85, 13635552
    v_min_u32 v84, 59, v0
    v_add_u32 v87, -20, v84
    v_lshrrev_b32 v88, 1, v87
    v_add_u32 v88, 40, v88
    v_and_b32 v87, 1, v87
    s_xor_b32 s86, s80, 1
    v_cmp_gt_u32 vcc, 20, v84
    s_nop 1
    v_cndmask_b32 v88, v88, v84, vcc
    v_mov_b32 v89, s86
    v_cndmask_b32 v87, v87, v89, vcc
    v_lshlrev_b32 v86, 8, v88
    v_lshl_add_u32 v86, v87, 4, v86
    v_or_b32 v86, s66, v86
    s_cmp_eq_u32 s80, 1
    s_mov_b32 s86, 34582752
    s_cselect_b32 s86, 34628608, s86
    s_add_u32 s86, s86, s58
    s_mov_b32 s92, s67
POLL_42:
    buffer_load_dword v7, v85, s[8:11], s85 offen sc1
    buffer_load_dwordx4 v[88:91], v86, s[8:11], s86 offen sc1
    s_waitcnt vmcnt(0)
    v_max3_u32 v88, v88, v89, v90
    v_max_u32 v88, v88, v91
    v_cmp_le_u32 vcc, 10, v7
    v_cmp_ne_u32 s[6:7], -1, v88
    s_nop 0
    s_and_b64 vcc, vcc, s[6:7]
    s_cmp_eq_u64 vcc, -1
    s_cbranch_scc1 PDONE_43
    s_sub_u32 s92, s92, 1
    s_cbranch_scc0 POLL_42
    s_mov_b32 s67, 0
PDONE_43:
    s_mov_b32 s85, 0
    s_add_u32 s84, s85, 22020096
    buffer_load_dwordx4 v[80:83], v168, s[8:11], s84 offen offset:0 sc1
    buffer_load_dwordx4 v[84:87], v168, s[8:11], s84 offen offset:1024 sc1
    buffer_load_dwordx4 v[88:91], v168, s[8:11], s84 offen offset:2048 sc1
    buffer_load_dwordx4 v[92:95], v168, s[8:11], s84 offen offset:3072 sc1
    s_add_u32 s84, s85, 22024192
    buffer_load_dwordx4 v[96:99], v168, s[8:11], s84 offen offset:0 sc1
    buffer_load_dwordx4 v[100:103], v169, s[8:11], s84 offen offset:1024 sc1
    buffer_load_dwordx4 v[104:107], v169, s[8:11], s84 offen offset:2048 sc1
    buffer_load_dwordx4 v[108:111], v169, s[8:11], s84 offen offset:3072 sc1
    s_waitcnt vmcnt(7) lgkmcnt(8)
    v_mfma_f32_16x16x32_bf16 v[20:23], v[208:211], v[80:83], v[20:23]
    ds_read_b128 v[248:251], v1 offset:51200
    s_add_u32 s84, s85, 22028288
    buffer_load_dwordx4 v[112:115], v169, s[8:11], s84 offen offset:0 sc1
    v_mfma_f32_16x16x32_bf16 v[24:27], v[212:215], v[80:83], v[24:27]
    ds_read_b128 v[252:255], v1 offset:52224
    s_waitcnt lgkmcnt(8)
    v_mfma_f32_16x16x32_bf16 v[28:31], v[216:219], v[80:83], v[28:31]
    ds_read_b128 v[208:211], v1 offset:53248
    v_mfma_f32_16x16x32_bf16 v[32:35], v[220:223], v[80:83], v[32:35]
    ds_read_b128 v[212:215], v1 offset:54272
    s_waitcnt lgkmcnt(8)
    v_mfma_f32_16x16x32_bf16 v[36:39], v[224:227], v[80:83], v[36:39]
    ds_read_b128 v[216:219], v1 offset:55296
    buffer_load_dwordx4 v[116:119], v169, s[8:11], s84 offen offset:1024 sc1
    s_waitcnt vmcnt(8)
    v_mfma_f32_16x16x32_bf16 v[20:23], v[228:231], v[84:87], v[20:23]
    ds_read_b128 v[220:223], v1 offset:56320
    s_waitcnt lgkmcnt(8)
    v_mfma_f32_16x16x32_bf16 v[24:27], v[232:235], v[84:87], v[24:27]
    ds_read_b128 v[224:227], v1 offset:57344
    v_mfma_f32_16x16x32_bf16 v[28:31], v[236:239], v[84:87], v[28:31]
    ds_read_b128 v[228:231], v1 offset:58368
    s_waitcnt lgkmcnt(8)
    v_mfma_f32_16x16x32_bf16 v[32:35], v[240:243], v[84:87], v[32:35]
    ds_read_b128 v[232:235], v1 offset:59392
    buffer_load_dwordx4 v[120:123], v170, s[8:11], s84 offen offset:2048 sc1
    v_mfma_f32_16x16x32_bf16 v[36:39], v[244:247], v[84:87], v[36:39]
    ds_read_b128 v[236:239], v1 offset:60416
    s_waitcnt vmcnt(8) lgkmcnt(8)
    v_mfma_f32_16x16x32_bf16 v[20:23], v[248:251], v[88:91], v[20:23]
    ds_read_b128 v[240:243], v2 offset:36864
    v_mfma_f32_16x16x32_bf16 v[24:27], v[252:255], v[88:91], v[24:27]
    ds_read_b128 v[244:247], v2 offset:37888
    s_waitcnt lgkmcnt(8)
    v_mfma_f32_16x16x32_bf16 v[28:31], v[208:211], v[88:91], v[28:31]
    ds_read_b128 v[248:251], v2 offset:38912
    buffer_load_dwordx4 v[124:127], v170, s[8:11], s84 offen offset:3072 sc1
    v_mfma_f32_16x16x32_bf16 v[32:35], v[212:215], v[88:91], v[32:35]
    ds_read_b128 v[252:255], v2 offset:39936
    s_waitcnt lgkmcnt(8)
    v_mfma_f32_16x16x32_bf16 v[36:39], v[216:219], v[88:91], v[36:39]
    ds_read_b128 v[208:211], v2 offset:40960
    s_waitcnt vmcnt(8)
    v_mfma_f32_16x16x32_bf16 v[20:23], v[220:223], v[92:95], v[20:23]
    ds_read_b128 v[212:215], v2 offset:41984
    s_waitcnt lgkmcnt(8)
    v_mfma_f32_16x16x32_bf16 v[24:27], v[224:227], v[92:95], v[24:27]
    ds_read_b128 v[216:219], v2 offset:43008
    s_add_u32 s84, s85, 22032384
    buffer_load_dwordx4 v[128:131], v170, s[8:11], s84 offen offset:0 sc1
    v_mfma_f32_16x16x32_bf16 v[28:31], v[228:231], v[92:95], v[28:31]
    ds_read_b128 v[220:223], v2 offset:44032
    s_waitcnt lgkmcnt(8)
    v_mfma_f32_16x16x32_bf16 v[32:35], v[232:235], v[92:95], v[32:35]
    ds_read_b128 v[224:227], v2 offset:45056
    v_mfma_f32_16x16x32_bf16 v[36:39], v[236:239], v[92:95], v[36:39]
    ds_read_b128 v[228:231], v2 offset:46080
    s_waitcnt vmcnt(8) lgkmcnt(8)
    v_mfma_f32_16x16x32_bf16 v[20:23], v[240:243], v[96:99], v[20:23]
    ds_read_b128 v[232:235], v2 offset:47104
    buffer_load_dwordx4 v[132:135], v170, s[8:11], s84 offen offset:1024 sc1
    v_mfma_f32_16x16x32_bf16 v[24:27], v[244:247], v[96:99], v[24:27]
    ds_read_b128 v[236:239], v2 offset:48128
    s_waitcnt lgkmcnt(8)
    v_mfma_f32_16x16x32_bf16 v[28:31], v[248:251], v[96:99], v[28:31]
    ds_read_b128 v[240:243], v2 offset:49152
    v_mfma_f32_16x16x32_bf16 v[32:35], v[252:255], v[96:99], v[32:35]
    ds_read_b128 v[244:247], v2 offset:50176
    s_waitcnt lgkmcnt(8)
    v_mfma_f32_16x16x32_bf16 v[36:39], v[208:211], v[96:99], v[36:39]
    ds_read_b128 v[248:251], v2 offset:51200
    buffer_load_dwordx4 v[136:139], v170, s[8:11], s84 offen offset:2048 sc1
    s_waitcnt vmcnt(9)
    v_mfma_f32_16x16x32_bf16 v[20:23], v[212:215], v[100:103], v[20:23]
    ds_read_b128 v[252:255], v2 offset:52224
    s_waitcnt lgkmcnt(8)
    v_mfma_f32_16x16x32_bf16 v[24:27], v[216:219], v[100:103], v[24:27]
    ds_read_b128 v[208:211], v2 offset:53248
    v_mfma_f32_16x16x32_bf16 v[28:31], v[220:223], v[100:103], v[28:31]
    ds_read_b128 v[212:215], v2 offset:54272
    s_waitcnt lgkmcnt(8)
    v_mfma_f32_16x16x32_bf16 v[32:35], v[224:227], v[100:103], v[32:35]
    ds_read_b128 v[216:219], v2 offset:55296
    buffer_load_dwordx4 v[140:143], v171, s[8:11], s84 offen offset:3072 sc1
    v_mfma_f32_16x16x32_bf16 v[36:39], v[228:231], v[100:103], v[36:39]
    ds_read_b128 v[220:223], v2 offset:56320
    s_waitcnt vmcnt(9) lgkmcnt(8)
    v_mfma_f32_16x16x32_bf16 v[20:23], v[232:235], v[104:107], v[20:23]
    ds_read_b128 v[224:227], v3 offset:12288
    v_mfma_f32_16x16x32_bf16 v[24:27], v[236:239], v[104:107], v[24:27]
    ds_read_b128 v[228:231], v3 offset:13312
    s_waitcnt lgkmcnt(8)
    v_mfma_f32_16x16x32_bf16 v[28:31], v[240:243], v[104:107], v[28:31]
    ds_read_b128 v[232:235], v3 offset:14336
    s_add_u32 s84, s85, 22036480
    buffer_load_dwordx4 v[144:147], v171, s[8:11], s84 offen offset:0 sc1
    v_mfma_f32_16x16x32_bf16 v[32:35], v[244:247], v[104:107], v[32:35]
    ds_read_b128 v[236:239], v3 offset:15360
    s_waitcnt lgkmcnt(8)
    v_mfma_f32_16x16x32_bf16 v[36:39], v[248:251], v[104:107], v[36:39]
    ds_read_b128 v[240:243], v3 offset:16384
    s_waitcnt vmcnt(9)
    v_mfma_f32_16x16x32_bf16 v[20:23], v[252:255], v[108:111], v[20:23]
    ds_read_b128 v[244:247], v3 offset:17408
    s_waitcnt lgkmcnt(8)
    v_mfma_f32_16x16x32_bf16 v[24:27], v[208:211], v[108:111], v[24:27]
    ds_read_b128 v[248:251], v3 offset:18432
    buffer_load_dwordx4 v[148:151], v171, s[8:11], s84 offen offset:1024 sc1
    v_mfma_f32_16x16x32_bf16 v[28:31], v[212:215], v[108:111], v[28:31]
    ds_read_b128 v[252:255], v3 offset:19456
    s_waitcnt lgkmcnt(8)
    v_mfma_f32_16x16x32_bf16 v[32:35], v[216:219], v[108:111], v[32:35]
    ds_read_b128 v[208:211], v3 offset:20480
    v_mfma_f32_16x16x32_bf16 v[36:39], v[220:223], v[108:111], v[36:39]
    ds_read_b128 v[212:215], v3 offset:21504
    s_waitcnt vmcnt(9) lgkmcnt(8)
    v_mfma_f32_16x16x32_bf16 v[20:23], v[224:227], v[112:115], v[20:23]
    ds_read_b128 v[216:219], v3 offset:22528
    buffer_load_dwordx4 v[152:155], v171, s[8:11], s84 offen offset:2048 sc1
    v_mfma_f32_16x16x32_bf16 v[24:27], v[228:231], v[112:115], v[24:27]
    ds_read_b128 v[220:223], v3 offset:23552
    s_waitcnt lgkmcnt(8)
    v_mfma_f32_16x16x32_bf16 v[28:31], v[232:235], v[112:115], v[28:31]
    ds_read_b128 v[224:227], v3 offset:24576
    v_mfma_f32_16x16x32_bf16 v[32:35], v[236:239], v[112:115], v[32:35]
    ds_read_b128 v[228:231], v3 offset:25600
    s_waitcnt lgkmcnt(8)
    v_mfma_f32_16x16x32_bf16 v[36:39], v[240:243], v[112:115], v[36:39]
    ds_read_b128 v[232:235], v3 offset:26624
    buffer_load_dwordx4 v[156:159], v171, s[8:11], s84 offen offset:3072 sc1
    s_waitcnt vmcnt(10)
    v_mfma_f32_16x16x32_bf16 v[20:23], v[244:247], v[116:119], v[20:23]
    ds_read_b128 v[236:239], v3 offset:27648
    s_waitcnt lgkmcnt(8)
    v_mfma_f32_16x16x32_bf16 v[24:27], v[248:251], v[116:119], v[24:27]
    ds_read_b128 v[240:243], v3 offset:28672
    v_mfma_f32_16x16x32_bf16 v[28:31], v[252:255], v[116:119], v[28:31]
    ds_read_b128 v[244:247], v3 offset:29696
    s_waitcnt lgkmcnt(8)
    v_mfma_f32_16x16x32_bf16 v[32:35], v[208:211], v[116:119], v[32:35]
    ds_read_b128 v[248:251], v3 offset:30720
    v_mfma_f32_16x16x32_bf16 v[36:39], v[212:215], v[116:119], v[36:39]
    ds_read_b128 v[252:255], v3 offset:31744
    s_waitcnt vmcnt(9) lgkmcnt(8)
    v_mfma_f32_16x16x32_bf16 v[20:23], v[216:219], v[120:123], v[20:23]
    ds_read_b128 v[208:211], v1 offset:0
    s_getpc_b64 s[4:5]
PCL_44:
    s_lshl_b32 s6, s45, 2
    s_add_u32 s6, s6, s49
    s_and_b32 s6, s6, 31
    s_lshl_b32 s6, s6, 10
    v_add_u32 v19, s6, v1
    v_min_u32 v19, CODE_END-PCL_44-16, v19
    global_load_dword a253, v19, s[4:5]
    v_mfma_f32_16x16x32_bf16 v[24:27], v[220:223], v[120:123], v[24:27]
    ds_read_b128 v[212:215], v1 offset:1024
    s_waitcnt lgkmcnt(8)
    v_mfma_f32_16x16x32_bf16 v[28:31], v[224:227], v[120:123], v[28:31]
    ds_read_b128 v[216:219], v1 offset:2048
    v_mfma_f32_16x16x32_bf16 v[32:35], v[228:231], v[120:123], v[32:35]
    ds_read_b128 v[220:223], v1 offset:3072
    s_waitcnt lgkmcnt(8)
    v_mfma_f32_16x16x32_bf16 v[36:39], v[232:235], v[120:123], v[36:39]
    ds_read_b128 v[224:227], v1 offset:4096
    s_waitcnt vmcnt(9)
    v_mfma_f32_16x16x32_bf16 v[20:23], v[236:239], v[124:127], v[20:23]
    ds_read_b128 v[228:231], v1 offset:5120
    s_waitcnt lgkmcnt(8)
    v_mfma_f32_16x16x32_bf16 v[24:27], v[240:243], v[124:127], v[24:27]
    ds_read_b128 v[232:235], v1 offset:6144
    v_mfma_f32_16x16x32_bf16 v[28:31], v[244:247], v[124:127], v[28:31]
    ds_read_b128 v[236:239], v1 offset:7168
    s_waitcnt lgkmcnt(8)
    v_mfma_f32_16x16x32_bf16 v[32:35], v[248:251], v[124:127], v[32:35]
    ds_read_b128 v[240:243], v1 offset:8192
    v_mfma_f32_16x16x32_bf16 v[36:39], v[252:255], v[124:127], v[36:39]
    ds_read_b128 v[244:247], v1 offset:9216
    s_waitcnt vmcnt(8) lgkmcnt(8)
    v_mfma_f32_16x16x32_bf16 v[20:23], v[208:211], v[128:131], v[20:23]
    ds_read_b128 v[248:251], v1 offset:10240
    v_mfma_f32_16x16x32_bf16 v[24:27], v[212:215], v[128:131], v[24:27]
    ds_read_b128 v[252:255], v1 offset:11264
    s_waitcnt lgkmcnt(8)
    v_mfma_f32_16x16x32_bf16 v[28:31], v[216:219], v[128:131], v[28:31]
    ds_read_b128 v[208:211], v1 offset:12288
    v_mfma_f32_16x16x32_bf16 v[32:35], v[220:223], v[128:131], v[32:35]
    ds_read_b128 v[212:215], v1 offset:13312
    s_waitcnt lgkmcnt(8)
    v_mfma_f32_16x16x32_bf16 v[36:39], v[224:227], v[128:131], v[36:39]
    ds_read_b128 v[216:219], v1 offset:14336
    s_waitcnt vmcnt(7)
    v_mfma_f32_16x16x32_bf16 v[20:23], v[228:231], v[132:135], v[20:23]
    ds_read_b128 v[220:223], v1 offset:15360
    s_waitcnt lgkmcnt(8)
    v_mfma_f32_16x16x32_bf16 v[24:27], v[232:235], v[132:135], v[24:27]
    ds_read_b128 v[224:227], v1 offset:16384
    v_mfma_f32_16x16x32_bf16 v[28:31], v[236:239], v[132:135], v[28:31]
    ds_read_b128 v[228:231], v1 offset:17408
    s_waitcnt lgkmcnt(8)
    v_mfma_f32_16x16x32_bf16 v[32:35], v[240:243], v[132:135], v[32:35]
    ds_read_b128 v[232:235], v1 offset:18432
    v_mfma_f32_16x16x32_bf16 v[36:39], v[244:247], v[132:135], v[36:39]
    ds_read_b128 v[236:239], v1 offset:19456
    s_waitcnt vmcnt(6) lgkmcnt(8)
    v_mfma_f32_16x16x32_bf16 v[20:23], v[248:251], v[136:139], v[20:23]
    ds_read_b128 v[240:243], v2 offset:57344
    v_mfma_f32_16x16x32_bf16 v[24:27], v[252:255], v[136:139], v[24:27]
    ds_read_b128 v[244:247], v2 offset:58368
    s_waitcnt lgkmcnt(8)
    v_mfma_f32_16x16x32_bf16 v[28:31], v[208:211], v[136:139], v[28:31]
    ds_read_b128 v[248:251], v2 offset:59392
    v_mfma_f32_16x16x32_bf16 v[32:35], v[212:215], v[136:139], v[32:35]
    ds_read_b128 v[252:255], v2 offset:60416
    s_waitcnt lgkmcnt(8)
    v_mfma_f32_16x16x32_bf16 v[36:39], v[216:219], v[136:139], v[36:39]
    ds_read_b128 v[208:211], v2 offset:61440
    s_waitcnt vmcnt(5)
    v_mfma_f32_16x16x32_bf16 v[20:23], v[220:223], v[140:143], v[20:23]
    ds_read_b128 v[212:215], v2 offset:62464
    s_waitcnt lgkmcnt(8)
    v_mfma_f32_16x16x32_bf16 v[24:27], v[224:227], v[140:143], v[24:27]
    ds_read_b128 v[216:219], v2 offset:63488
    v_mfma_f32_16x16x32_bf16 v[28:31], v[228:231], v[140:143], v[28:31]
    ds_read_b128 v[220:223], v2 offset:64512
    s_waitcnt lgkmcnt(8)
    v_mfma_f32_16x16x32_bf16 v[32:35], v[232:235], v[140:143], v[32:35]
    ds_read_b128 v[224:227], v3 offset:0
    v_mfma_f32_16x16x32_bf16 v[36:39], v[236:239], v[140:143], v[36:39]
    ds_read_b128 v[228:231], v3 offset:1024
    s_waitcnt vmcnt(4) lgkmcnt(8)
    v_mfma_f32_16x16x32_bf16 v[20:23], v[240:243], v[144:147], v[20:23]
    ds_read_b128 v[232:235], v3 offset:2048
    v_mfma_f32_16x16x32_bf16 v[24:27], v[244:247], v[144:147], v[24:27]
    ds_read_b128 v[236:239], v3 offset:3072
    s_waitcnt lgkmcnt(8)
    v_mfma_f32_16x16x32_bf16 v[28:31], v[248:251], v[144:147], v[28:31]
    ds_read_b128 v[240:243], v3 offset:4096
    v_mfma_f32_16x16x32_bf16 v[32:35], v[252:255], v[144:147], v[32:35]
    ds_read_b128 v[244:247], v3 offset:5120
    s_waitcnt lgkmcnt(8)
    v_mfma_f32_16x16x32_bf16 v[36:39], v[208:211], v[144:147], v[36:39]
    ds_read_b128 v[248:251], v3 offset:6144
    s_waitcnt vmcnt(3)
    v_mfma_f32_16x16x32_bf16 v[20:23], v[212:215], v[148:151], v[20:23]
    ds_read_b128 v[252:255], v3 offset:7168
    s_waitcnt lgkmcnt(8)
    v_mfma_f32_16x16x32_bf16 v[24:27], v[216:219], v[148:151], v[24:27]
    ds_read_b128 v[208:211], v3 offset:8192
    v_mfma_f32_16x16x32_bf16 v[28:31], v[220:223], v[148:151], v[28:31]
    ds_read_b128 v[212:215], v3 offset:9216
    s_waitcnt lgkmcnt(8)
    v_mfma_f32_16x16x32_bf16 v[32:35], v[224:227], v[148:151], v[32:35]
    ds_read_b128 v[216:219], v3 offset:10240
    v_mfma_f32_16x16x32_bf16 v[36:39], v[228:231], v[148:151], v[36:39]
    ds_read_b128 v[220:223], v3 offset:11264
    s_waitcnt vmcnt(2) lgkmcnt(8)
    v_mfma_f32_16x16x32_bf16 v[20:23], v[232:235], v[152:155], v[20:23]
    v_mfma_f32_16x16x32_bf16 v[24:27], v[236:239], v[152:155], v[24:27]
    s_waitcnt lgkmcnt(6)
    v_mfma_f32_16x16x32_bf16 v[28:31], v[240:243], v[152:155], v[28:31]
    v_mfma_f32_16x16x32_bf16 v[32:35], v[244:247], v[152:155], v[32:35]
    s_waitcnt lgkmcnt(4)
    v_mfma_f32_16x16x32_bf16 v[36:39], v[248:251], v[152:155], v[36:39]
    s_waitcnt vmcnt(1)
    v_mfma_f32_16x16x32_bf16 v[20:23], v[252:255], v[156:159], v[20:23]
    s_waitcnt lgkmcnt(2)
    v_mfma_f32_16x16x32_bf16 v[24:27], v[208:211], v[156:159], v[24:27]
    v_mfma_f32_16x16x32_bf16 v[28:31], v[212:215], v[156:159], v[28:31]
    s_waitcnt lgkmcnt(0)
    v_mfma_f32_16x16x32_bf16 v[32:35], v[216:219], v[156:159], v[32:35]
    v_mfma_f32_16x16x32_bf16 v[36:39], v[220:223], v[156:159], v[36:39]
    s_nop 1
    v_cvt_pk_bf16_f32 v60, v20, v21
    v_cvt_pk_bf16_f32 v61, v22, v23
    v_cvt_pk_bf16_f32 v62, v24, v25
    v_cvt_pk_bf16_f32 v63, v26, v27
    v_cvt_pk_bf16_f32 v64, v28, v29
    v_cvt_pk_bf16_f32 v65, v30, v31
    v_cvt_pk_bf16_f32 v66, v32, v33
    v_cvt_pk_bf16_f32 v67, v34, v35
    v_cvt_pk_bf16_f32 v68, v36, v37
    v_cvt_pk_bf16_f32 v69, v38, v39
    s_add_u32 s82, s52, 18874368
    s_add_u32 s83, s53, 18874368
    s_cmp_eq_u32 s50, 0
    s_cbranch_scc1 SLOW_24
    buffer_store_dwordx4 v[60:63], v1, s[8:11], s82 offen
    buffer_store_dwordx4 v[64:67], v1, s[8:11], s82 offen offset:1024
    buffer_store_dwordx2 v[68:69], v4, s[8:11], s83 offen
BACK_24:
    v_pk_add_f32 v[72:73], v[20:21], v[22:23]
    v_pk_mul_f32 v[74:75], v[20:21], v[20:21]
    v_pk_fma_f32 v[74:75], v[22:23], v[22:23], v[74:75]
    v_pk_add_f32 v[72:73], v[72:73], v[24:25]
    v_pk_fma_f32 v[74:75], v[24:25], v[24:25], v[74:75]
    v_pk_add_f32 v[72:73], v[72:73], v[26:27]
    v_pk_fma_f32 v[74:75], v[26:27], v[26:27], v[74:75]
    v_pk_add_f32 v[72:73], v[72:73], v[28:29]
    v_pk_fma_f32 v[74:75], v[28:29], v[28:29], v[74:75]
    v_pk_add_f32 v[72:73], v[72:73], v[30:31]
    v_pk_fma_f32 v[74:75], v[30:31], v[30:31], v[74:75]
    v_pk_add_f32 v[72:73], v[72:73], v[32:33]
    v_pk_fma_f32 v[74:75], v[32:33], v[32:33], v[74:75]
    v_pk_add_f32 v[72:73], v[72:73], v[34:35]
    v_pk_fma_f32 v[74:75], v[34:35], v[34:35], v[74:75]
    v_pk_add_f32 v[72:73], v[72:73], v[36:37]
    v_pk_fma_f32 v[74:75], v[36:37], v[36:37], v[74:75]
    v_pk_add_f32 v[72:73], v[72:73], v[38:39]
    v_pk_fma_f32 v[74:75], v[38:39], v[38:39], v[74:75]
    v_add_f32 v72, v72, v73
    v_add_f32 v74, v74, v75
    s_nop 1
    v_permlane32_swap_b32 v72, v74
    v_add_f32 v72, v72, v74
    v_mov_b32 v73, v72
    s_nop 1
    v_permlane16_swap_b32 v72, v73
    v_add_f32 v72, v72, v73
    v_and_or_b32 v72, v72, -4, 2
    s_add_u32 s82, s54, 18874368
    s_cmp_eq_u32 s50, 0
    s_cbranch_scc1 SLOW_25
    buffer_store_dword v72, v5, s[8:11], s82 offen
BACK_25:
    v_pk_add_f32 v[40:41], v[40:41], v[20:21]
    v_pk_add_f32 v[42:43], v[42:43], v[22:23]
    v_pk_add_f32 v[44:45], v[44:45], v[24:25]
    v_pk_add_f32 v[46:47], v[46:47], v[26:27]
    v_pk_add_f32 v[48:49], v[48:49], v[28:29]
    v_pk_add_f32 v[50:51], v[50:51], v[30:31]
    v_pk_add_f32 v[52:53], v[52:53], v[32:33]
    v_pk_add_f32 v[54:55], v[54:55], v[34:35]
    v_pk_add_f32 v[56:57], v[56:57], v[36:37]
    v_pk_add_f32 v[58:59], v[58:59], v[38:39]
    s_waitcnt vmcnt(1)
    v_mov_b32 v7, 11
    v_mov_b32 v18, 0
    s_mov_b64 exec, 1
    s_cmp_eq_u32 s50, 0
    s_cbranch_scc1 SLOW_26
    buffer_store_dword v7, v18, s[8:11], s76 offen
BACK_26:
    s_mov_b64 exec, -1
    v_accvgpr_read_b32 v92, a251
    s_nop 1
    v_mov_b32_dpp v80, v92 row_newbcast:0 row_mask:0xf bank_mask:0xf
    v_mov_b32_dpp v81, v92 row_newbcast:1 row_mask:0xf bank_mask:0xf
    v_mov_b32_dpp v82, v92 row_newbcast:2 row_mask:0xf bank_mask:0xf
    v_mov_b32_dpp v83, v92 row_newbcast:3 row_mask:0xf bank_mask:0xf
    v_mov_b32_dpp v84, v92 row_newbcast:4 row_mask:0xf bank_mask:0xf
    v_mov_b32_dpp v85, v92 row_newbcast:5 row_mask:0xf bank_mask:0xf
    v_mov_b32_dpp v86, v92 row_newbcast:6 row_mask:0xf bank_mask:0xf
    v_mov_b32_dpp v87, v92 row_newbcast:7 row_mask:0xf bank_mask:0xf
    v_mov_b32_dpp v88, v92 row_newbcast:8 row_mask:0xf bank_mask:0xf
    v_mov_b32_dpp v89, v92 row_newbcast:9 row_mask:0xf bank_mask:0xf
    v_mov_b32_dpp v90, v92 row_newbcast:10 row_mask:0xf bank_mask:0xf
    v_mov_b32_dpp v91, v92 row_newbcast:11 row_mask:0xf bank_mask:0xf
    s_barrier
    s_lshl_b32 s85, s48, 7
    s_add_u32 s85, s85, 13635584
    s_add_u32 s86, s75, s63
    s_mov_b32 s92, s67
POLL_47:
    buffer_load_dword v7, v6, s[8:11], s85 offen sc1
    s_waitcnt vmcnt(0)
    v_cmp_le_u32 vcc, 11, v7
    s_nop 0
    s_cmp_eq_u64 vcc, -1
    s_cbranch_scc1 PDONE_48
    s_sub_u32 s92, s92, 1
    s_cbranch_scc0 POLL_47
    s_mov_b32 s67, 0
PDONE_48:
    s_add_u32 m0, s63, 40960
    s_add_u32 s93, s86, 18874368
    buffer_load_dwordx4 v1, s[8:11], s93 offen offset:0 sc1 lds
    buffer_load_dwordx4 v1, s[8:11], s93 offen offset:1024 sc1 lds
    buffer_load_dwordx4 v1, s[8:11], s93 offen offset:2048 sc1 lds
    buffer_load_dwordx4 v1, s[8:11], s93 offen offset:3072 sc1 lds
    s_add_u32 m0, m0, 4096
    s_add_u32 s93, s93, 4096
    buffer_load_dwordx4 v1, s[8:11], s93 offen offset:0 sc1 lds
    s_add_u32 s84, s75, 18894848
    buffer_load_dwordx4 v[96:99], v1, s[8:11], s84 offen offset:0 sc1
    s_add_u32 s84, s75, 18916352
    buffer_load_dwordx4 v[100:103], v1, s[8:11], s84 offen offset:0 sc1
    s_add_u32 s84, s75, 18937856
    buffer_load_dwordx4 v[104:107], v1, s[8:11], s84 offen offset:0 sc1
    s_add_u32 s84, s75, 18959360
    buffer_load_dwordx4 v[108:111], v1, s[8:11], s84 offen offset:0 sc1
    s_waitcnt vmcnt(4)
    s_barrier
    ds_read_b128 v[208:211], v1 offset:40960
    ds_read_b128 v[212:215], v1 offset:41984
    ds_read_b128 v[216:219], v1 offset:43008
    ds_read_b128 v[220:223], v1 offset:44032
    ds_read_b128 v[224:227], v1 offset:45056
    ds_read_b128 v[228:231], v1 offset:46080
    s_waitcnt lgkmcnt(5)
    v_mfma_f32_16x16x32_bf16 v[128:131], a[0:3], v[208:211], 0
    ds_read_b128 v[232:235], v1 offset:47104
    s_waitcnt lgkmcnt(5)
    v_mfma_f32_16x16x32_bf16 v[132:135], a[80:83], v[208:211], 0
    s_add_u32 m0, s63, 102400
    v_mfma_f32_16x16x32_bf16 v[136:139], a[160:163], v[208:211], 0
    s_add_u32 s93, s86, 18895872
    v_mfma_f32_16x16x32_bf16 v[128:131], a[4:7], v[212:215], v[128:131]
    ds_read_b128 v[236:239], v1 offset:48128
    buffer_load_dwordx4 v1, s[8:11], s93 offen offset:0 sc1 lds
    s_waitcnt lgkmcnt(5)
    v_mfma_f32_16x16x32_bf16 v[132:135], a[84:87], v[212:215], v[132:135]
    v_mfma_f32_16x16x32_bf16 v[136:139], a[164:167], v[212:215], v[136:139]
    v_mfma_f32_16x16x32_bf16 v[128:131], a[8:11], v[216:219], v[128:131]
    ds_read_b128 v[208:211], v1 offset:49152
    buffer_load_dwordx4 v1, s[8:11], s93 offen offset:1024 sc1 lds
    s_waitcnt lgkmcnt(5)
    v_mfma_f32_16x16x32_bf16 v[132:135], a[88:91], v[216:219], v[132:135]
    s_waitcnt vmcnt(2)
    v_or3_b32 v112, v96, v97, v98
    v_or3_b32 v112, v112, v99, v100
    v_mfma_f32_16x16x32_bf16 v[136:139], a[168:171], v[216:219], v[136:139]
    v_or3_b32 v112, v112, v101, v102
    v_or3_b32 v112, v112, v103, v104
    v_mfma_f32_16x16x32_bf16 v[128:131], a[12:15], v[220:223], v[128:131]
    ds_read_b128 v[212:215], v1 offset:50176
    s_waitcnt lgkmcnt(5)
    v_or3_b32 v112, v112, v105, v106
    v_mfma_f32_16x16x32_bf16 v[132:135], a[92:95], v[220:223], v[132:135]
    v_or3_b32 v112, v112, v107, v108
    v_or3_b32 v112, v112, v109, v110
    v_mfma_f32_16x16x32_bf16 v[136:139], a[172:175], v[220:223], v[136:139]
    v_or_b32 v112, v112, v111
    v_and_b32 v112, 1, v112
    v_mfma_f32_16x16x32_bf16 v[128:131], a[16:19], v[224:227], v[128:131]
    ds_read_b128 v[216:219], v1 offset:51200
    buffer_load_dwordx4 v1, s[8:11], s93 offen offset:2048 sc1 lds
    s_waitcnt lgkmcnt(5)
    v_mfma_f32_16x16x32_bf16 v[132:135], a[96:99], v[224:227], v[132:135]
    v_cmp_ne_u32 vcc, 0, v112
    s_nop 0
    s_cmp_lg_u64 vcc, 0
    s_cbranch_scc1 STR_45
STB_46:
    v_mfma_f32_16x16x32_bf16 v[136:139], a[176:179], v[224:227], v[136:139]
    v_add_f32 v96, v96, v98
    v_add_f32 v100, v100, v102
    v_mfma_f32_16x16x32_bf16 v[128:131], a[20:23], v[228:231], v[128:131]
    ds_read_b128 v[220:223], v1 offset:52224
    buffer_load_dwordx4 v1, s[8:11], s93 offen offset:3072 sc1 lds
    s_waitcnt lgkmcnt(5)
    v_mfma_f32_16x16x32_bf16 v[132:135], a[100:103], v[228:231], v[132:135]
    s_add_u32 m0, m0, 4096
    v_add_f32 v104, v104, v106
    v_add_f32 v108, v108, v110
    v_mfma_f32_16x16x32_bf16 v[136:139], a[180:183], v[228:231], v[136:139]
    s_add_u32 s93, s93, 4096
    v_add_f32 v97, v97, v99
    v_add_f32 v101, v101, v103
    v_mfma_f32_16x16x32_bf16 v[128:131], a[24:27], v[232:235], v[128:131]
    ds_read_b128 v[224:227], v1 offset:53248
    buffer_load_dwordx4 v1, s[8:11], s93 offen offset:0 sc1 lds
    s_waitcnt lgkmcnt(5)
    v_mfma_f32_16x16x32_bf16 v[132:135], a[104:107], v[232:235], v[132:135]
    v_add_f32 v105, v105, v107
    v_add_f32 v109, v109, v111
    v_mfma_f32_16x16x32_bf16 v[136:139], a[184:187], v[232:235], v[136:139]
    v_permlane32_swap_b32 v96, v97
    v_permlane32_swap_b32 v100, v101
    v_mfma_f32_16x16x32_bf16 v[128:131], a[28:31], v[236:239], v[128:131]
    ds_read_b128 v[228:231], v1 offset:54272
    s_waitcnt lgkmcnt(5)
    v_permlane32_swap_b32 v104, v105
    v_mfma_f32_16x16x32_bf16 v[132:135], a[108:111], v[236:239], v[132:135]
    s_add_u32 m0, s63, 143360
    v_permlane32_swap_b32 v108, v109
    v_add_f32 v96, v96, v97
    v_mfma_f32_16x16x32_bf16 v[136:139], a[188:191], v[236:239], v[136:139]
    s_add_u32 s93, s86, 18917376
    v_add_f32 v100, v100, v101
    v_add_f32 v104, v104, v105
    v_mfma_f32_16x16x32_bf16 v[128:131], a[32:35], v[208:211], v[128:131]
    ds_read_b128 v[232:235], v1 offset:55296
    buffer_load_dwordx4 v1, s[8:11], s93 offen offset:0 sc1 lds
    s_waitcnt lgkmcnt(5)
    v_mfma_f32_16x16x32_bf16 v[132:135], a[112:115], v[208:211], v[132:135]
    v_add_f32 v108, v108, v109
    v_mov_b32 v97, v96
    v_mfma_f32_16x16x32_bf16 v[136:139], a[192:195], v[208:211], v[136:139]
    v_mov_b32 v101, v100
    v_mov_b32 v105, v104
    v_mfma_f32_16x16x32_bf16 v[128:131], a[36:39], v[212:215], v[128:131]
    ds_read_b128 v[236:239], v1 offset:56320
    buffer_load_dwordx4 v1, s[8:11], s93 offen offset:1024 sc1 lds
    s_waitcnt lgkmcnt(5)
    v_mfma_f32_16x16x32_bf16 v[132:135], a[116:119], v[212:215], v[132:135]
    v_mov_b32 v109, v108
    v_permlane16_swap_b32 v96, v97
    v_mfma_f32_16x16x32_bf16 v[136:139], a[196:199], v[212:215], v[136:139]
    v_permlane16_swap_b32 v100, v101
    v_permlane16_swap_b32 v104, v105
    v_mfma_f32_16x16x32_bf16 v[128:131], a[40:43], v[216:219], v[128:131]
    ds_read_b128 v[208:211], v1 offset:57344
    buffer_load_dwordx4 v1, s[8:11], s93 offen offset:2048 sc1 lds
    s_waitcnt lgkmcnt(5)
    v_mfma_f32_16x16x32_bf16 v[132:135], a[120:123], v[216:219], v[132:135]
    v_permlane16_swap_b32 v108, v109
    v_add_f32 v96, v96, v97
    v_mfma_f32_16x16x32_bf16 v[136:139], a[200:203], v[216:219], v[136:139]
    v_add_f32 v100, v100, v101
    v_add_f32 v104, v104, v105
    v_mfma_f32_16x16x32_bf16 v[128:131], a[44:47], v[220:223], v[128:131]
    ds_read_b128 v[212:215], v1 offset:58368
    buffer_load_dwordx4 v1, s[8:11], s93 offen offset:3072 sc1 lds
    s_waitcnt lgkmcnt(5)
    v_mfma_f32_16x16x32_bf16 v[132:135], a[124:127], v[220:223], v[132:135]
    v_add_f32 v108, v108, v109
    v_mov_b32 v97, v96
    v_mfma_f32_16x16x32_bf16 v[136:139], a[204:207], v[220:223], v[136:139]
    v_mov_b32 v101, v100
    v_mov_b32 v105, v104
    v_mfma_f32_16x16x32_bf16 v[128:131], a[48:51], v[224:227], v[128:131]
    ds_read_b128 v[216:219], v1 offset:59392
    s_waitcnt lgkmcnt(5)
    v_mov_b32 v109, v108
    v_mfma_f32_16x16x32_bf16 v[132:135], a[128:131], v[224:227], v[132:135]
    s_add_u32 m0, m0, 4096
    v_permlane32_swap_b32 v96, v97
    v_permlane32_swap_b32 v100, v101
    v_mfma_f32_16x16x32_bf16 v[136:139], a[208:211], v[224:227], v[136:139]
    s_add_u32 s93, s93, 4096
    v_permlane32_swap_b32 v104, v105
    v_permlane32_swap_b32 v108, v109
    v_mfma_f32_16x16x32_bf16 v[128:131], a[52:55], v[228:231], v[128:131]
    ds_read_b128 v[220:223], v1 offset:60416
    buffer_load_dwordx4 v1, s[8:11], s93 offen offset:0 sc1 lds
    s_waitcnt lgkmcnt(5)
    v_mfma_f32_16x16x32_bf16 v[132:135], a[132:135], v[228:231], v[132:135]
    s_add_u32 m0, s63, 0
    v_mul_f32 v112, 0xbacccccd, v96
    v_mul_f32 v116, 0xbacccccd, v100
    v_mfma_f32_16x16x32_bf16 v[136:139], a[212:215], v[228:231], v[136:139]
    s_add_u32 s93, s86, 18938880
    v_mul_f32 v120, 0xbacccccd, v104
    v_mul_f32 v124, 0xbacccccd, v108
    v_mfma_f32_16x16x32_bf16 v[128:131], a[56:59], v[232:235], v[128:131]
    s_waitcnt vmcnt(5)
    s_barrier
    ds_read_b128 v[224:227], v2 offset:36864
    buffer_load_dwordx4 v1, s[8:11], s93 offen offset:0 sc1 lds
    s_waitcnt lgkmcnt(5)
    v_mfma_f32_16x16x32_bf16 v[132:135], a[136:139], v[232:235], v[132:135]
    v_mul_f32 v97, 0x3acccccd, v97
    v_mul_f32 v101, 0x3acccccd, v101
    v_mfma_f32_16x16x32_bf16 v[136:139], a[216:219], v[232:235], v[136:139]
    v_mul_f32 v105, 0x3acccccd, v105
    v_mul_f32 v109, 0x3acccccd, v109
    v_mfma_f32_16x16x32_bf16 v[128:131], a[60:63], v[236:239], v[128:131]
    ds_read_b128 v[228:231], v2 offset:37888
    buffer_load_dwordx4 v1, s[8:11], s93 offen offset:1024 sc1 lds
    s_waitcnt lgkmcnt(5)
    v_mfma_f32_16x16x32_bf16 v[132:135], a[140:143], v[236:239], v[132:135]
    v_fma_f32 v97, -v112, v112, v97
    v_fma_f32 v101, -v116, v116, v101
    v_mfma_f32_16x16x32_bf16 v[136:139], a[220:223], v[236:239], v[136:139]
    v_fma_f32 v105, -v120, v120, v105
    v_fma_f32 v109, -v124, v124, v109
    v_mfma_f32_16x16x32_bf16 v[128:131], a[64:67], v[208:211], v[128:131]
    ds_read_b128 v[232:235], v2 offset:38912
    s_waitcnt lgkmcnt(5)
    v_max_f32 v97, 0, v97
    v_mfma_f32_16x16x32_bf16 v[132:135], a[144:147], v[208:211], v[132:135]
    v_max_f32 v101, 0, v101
    v_max_f32 v105, 0, v105
    v_mfma_f32_16x16x32_bf16 v[136:139], a[224:227], v[208:211], v[136:139]
    v_max_f32 v109, 0, v109
    v_add_f32 v98, 0x3727c5ac, v97
    v_mfma_f32_16x16x32_bf16 v[128:131], a[68:71], v[212:215], v[128:131]
    ds_read_b128 v[236:239], v2 offset:39936
    buffer_load_dwordx4 v1, s[8:11], s93 offen offset:2048 sc1 lds
    s_waitcnt lgkmcnt(5)
    v_mfma_f32_16x16x32_bf16 v[132:135], a[148:151], v[212:215], v[132:135]
    v_add_f32 v102, 0x3727c5ac, v101
    v_add_f32 v106, 0x3727c5ac, v105
    v_mfma_f32_16x16x32_bf16 v[136:139], a[228:231], v[212:215], v[136:139]
    v_add_f32 v110, 0x3727c5ac, v109
    v_mfma_f32_16x16x32_bf16 v[128:131], a[72:75], v[216:219], v[128:131]
    ds_read_b128 v[208:211], v2 offset:40960
    buffer_load_dwordx4 v1, s[8:11], s93 offen offset:3072 sc1 lds
    s_waitcnt lgkmcnt(5)
    v_mfma_f32_16x16x32_bf16 v[132:135], a[152:155], v[216:219], v[132:135]
    s_add_u32 m0, m0, 4096
    v_rsq_f32 v99, v98
    v_mfma_f32_16x16x32_bf16 v[136:139], a[232:235], v[216:219], v[136:139]
    s_add_u32 s93, s93, 4096
    v_rsq_f32 v103, v102
    v_mfma_f32_16x16x32_bf16 v[128:131], a[76:79], v[220:223], v[128:131]
    ds_read_b128 v[212:215], v2 offset:41984
    buffer_load_dwordx4 v1, s[8:11], s93 offen offset:0 sc1 lds
    s_waitcnt lgkmcnt(5)
    v_mfma_f32_16x16x32_bf16 v[132:135], a[156:159], v[220:223], v[132:135]
    v_rsq_f32 v107, v106
    v_mfma_f32_16x16x32_bf16 v[136:139], a[236:239], v[220:223], v[136:139]
    v_rsq_f32 v111, v110
    v_rcp_f32 v113, v99
    v_rcp_f32 v117, v103
    v_rcp_f32 v121, v107
    v_rcp_f32 v125, v111
    v_mul_f32 v115, 0xc0135761, v99
    v_mul_f32 v119, 0xc0135761, v103
    v_mul_f32 v123, 0xc0135761, v107
    v_mul_f32 v127, 0xc0135761, v111
    v_mul_f32 v114, v99, v99
    v_mul_f32 v118, v103, v103
    v_mul_f32 v122, v107, v107
    v_mul_f32 v126, v111, v111
    v_mul_f32 v114, v114, v115
    v_mul_f32 v118, v118, v119
    v_mul_f32 v122, v122, v123
    v_mul_f32 v126, v126, v127
    v_mul_f32 v114, 0x3d372713, v114
    v_mul_f32 v118, 0x3d372713, v118
    v_mul_f32 v122, 0x3d372713, v122
    v_mul_f32 v126, 0x3d372713, v126
    v_pk_fma_f32 v[128:129], v[80:81], v[112:113], v[128:129] op_sel_hi:[1,0,1]
    v_pk_fma_f32 v[130:131], v[82:83], v[112:113], v[130:131] op_sel_hi:[1,0,1]
    v_pk_fma_f32 v[132:133], v[84:85], v[112:113], v[132:133] op_sel_hi:[1,0,1]
    v_pk_fma_f32 v[134:135], v[86:87], v[112:113], v[134:135] op_sel_hi:[1,0,1]
    v_pk_fma_f32 v[136:137], v[88:89], v[112:113], v[136:137] op_sel_hi:[1,0,1]
    v_pk_fma_f32 v[138:139], v[90:91], v[112:113], v[138:139] op_sel_hi:[1,0,1]
    v_pk_mul_f32 v[176:177], v[128:129], v[128:129]
    v_pk_mul_f32 v[178:179], v[130:131], v[130:131]
    v_pk_mul_f32 v[180:181], v[132:133], v[132:133]
    v_pk_mul_f32 v[182:183], v[134:135], v[134:135]
    v_pk_mul_f32 v[184:185], v[136:137], v[136:137]
    v_pk_mul_f32 v[186:187], v[138:139], v[138:139]
    v_pk_fma_f32 v[176:177], v[176:177], v[114:115], v[114:115] op_sel:[0,0,1] op_sel_hi:[1,0,1]
    v_pk_fma_f32 v[178:179], v[178:179], v[114:115], v[114:115] op_sel:[0,0,1] op_sel_hi:[1,0,1]
    v_pk_fma_f32 v[180:181], v[180:181], v[114:115], v[114:115] op_sel:[0,0,1] op_sel_hi:[1,0,1]
    v_pk_fma_f32 v[182:183], v[182:183], v[114:115], v[114:115] op_sel:[0,0,1] op_sel_hi:[1,0,1]
    v_pk_fma_f32 v[184:185], v[184:185], v[114:115], v[114:115] op_sel:[0,0,1] op_sel_hi:[1,0,1]
    v_pk_fma_f32 v[186:187], v[186:187], v[114:115], v[114:115] op_sel:[0,0,1] op_sel_hi:[1,0,1]
    v_pk_mul_f32 v[176:177], v[176:177], v[128:129]
    v_pk_mul_f32 v[178:179], v[178:179], v[130:131]
    v_pk_mul_f32 v[180:181], v[180:181], v[132:133]
    v_pk_mul_f32 v[182:183], v[182:183], v[134:135]
    v_pk_mul_f32 v[184:185], v[184:185], v[136:137]
    v_pk_mul_f32 v[186:187], v[186:187], v[138:139]
    v_mfma_f32_16x16x32_bf16 v[140:143], a[0:3], v[224:227], 0
    ds_read_b128 v[216:219], v2 offset:43008
    s_waitcnt lgkmcnt(5)
    v_mfma_f32_16x16x32_bf16 v[144:147], a[80:83], v[224:227], 0
    s_getpc_b64 s[4:5]
PCL_49:
    s_lshl_b32 s6, s45, 2
    s_add_u32 s6, s6, s49
    s_and_b32 s6, s6, 31
    s_lshl_b32 s6, s6, 10
    v_add_u32 v19, s6, v1
    v_min_u32 v19, CODE_END-PCL_49-16, v19
    global_load_dword a253, v19, s[4:5]
    s_add_u32 m0, s63, 81920
    v_mfma_f32_16x16x32_bf16 v[148:151], a[160:163], v[224:227], 0
    s_add_u32 s93, s61, 8388608
    v_exp_f32 v176, v176
    v_mfma_f32_16x16x32_bf16 v[140:143], a[4:7], v[228:231], v[140:143]
    ds_read_b128 v[220:223], v2 offset:44032
    buffer_load_dwordx4 v1, s[8:11], s93 offen offset:0  lds
    s_waitcnt lgkmcnt(5)
    v_mfma_f32_16x16x32_bf16 v[144:147], a[84:87], v[228:231], v[144:147]
    v_exp_f32 v177, v177
    v_mfma_f32_16x16x32_bf16 v[148:151], a[164:167], v[228:231], v[148:151]
    v_exp_f32 v178, v178
    v_mfma_f32_16x16x32_bf16 v[140:143], a[8:11], v[232:235], v[140:143]
    ds_read_b128 v[224:227], v2 offset:45056
    s_waitcnt lgkmcnt(5)
    v_mfma_f32_16x16x32_bf16 v[144:147], a[88:91], v[232:235], v[144:147]
    v_exp_f32 v179, v179
    v_mfma_f32_16x16x32_bf16 v[148:151], a[168:171], v[232:235], v[148:151]
    v_exp_f32 v180, v180
    v_mfma_f32_16x16x32_bf16 v[140:143], a[12:15], v[236:239], v[140:143]
    ds_read_b128 v[228:231], v2 offset:46080
    buffer_load_dwordx4 v1, s[8:11], s93 offen offset:1024  lds
    s_waitcnt lgkmcnt(5)
    v_mfma_f32_16x16x32_bf16 v[144:147], a[92:95], v[236:239], v[144:147]
    v_exp_f32 v181, v181
    v_mfma_f32_16x16x32_bf16 v[148:151], a[172:175], v[236:239], v[148:151]
    v_exp_f32 v182, v182
    v_mfma_f32_16x16x32_bf16 v[140:143], a[16:19], v[208:211], v[140:143]
    ds_read_b128 v[232:235], v2 offset:47104
    buffer_load_dwordx4 v1, s[8:11], s93 offen offset:2048  lds
    s_waitcnt lgkmcnt(5)
    v_mfma_f32_16x16x32_bf16 v[144:147], a[96:99], v[208:211], v[144:147]
    v_exp_f32 v183, v183
    v_mfma_f32_16x16x32_bf16 v[148:151], a[176:179], v[208:211], v[148:151]
    v_exp_f32 v184, v184
    v_mfma_f32_16x16x32_bf16 v[140:143], a[20:23], v[212:215], v[140:143]
    ds_read_b128 v[236:239], v2 offset:48128
    s_waitcnt lgkmcnt(5)
    v_mfma_f32_16x16x32_bf16 v[144:147], a[100:103], v[212:215], v[144:147]
    v_exp_f32 v185, v185
    v_mfma_f32_16x16x32_bf16 v[148:151], a[180:183], v[212:215], v[148:151]
    v_exp_f32 v186, v186
    v_mfma_f32_16x16x32_bf16 v[140:143], a[24:27], v[216:219], v[140:143]
    ds_read_b128 v[208:211], v2 offset:49152
    buffer_load_dwordx4 v1, s[8:11], s93 offen offset:3072  lds
    s_waitcnt lgkmcnt(5)
    v_mfma_f32_16x16x32_bf16 v[144:147], a[104:107], v[216:219], v[144:147]
    v_exp_f32 v187, v187
    v_mfma_f32_16x16x32_bf16 v[148:151], a[184:187], v[216:219], v[148:151]
    v_fma_f32 v176, v176, v113, v113
    v_fma_f32 v177, v177, v113, v113
    v_mfma_f32_16x16x32_bf16 v[140:143], a[28:31], v[220:223], v[140:143]
    ds_read_b128 v[212:215], v2 offset:50176
    s_waitcnt lgkmcnt(5)
    v_fma_f32 v178, v178, v113, v113
    v_mfma_f32_16x16x32_bf16 v[144:147], a[108:111], v[220:223], v[144:147]
    s_add_u32 m0, m0, 4096
    v_fma_f32 v179, v179, v113, v113
    v_fma_f32 v180, v180, v113, v113
    v_mfma_f32_16x16x32_bf16 v[148:151], a[188:191], v[220:223], v[148:151]
    s_add_u32 s93, s93, 4096
    v_fma_f32 v181, v181, v113, v113
    v_fma_f32 v182, v182, v113, v113
    v_mfma_f32_16x16x32_bf16 v[140:143], a[32:35], v[224:227], v[140:143]
    ds_read_b128 v[216:219], v2 offset:51200
    buffer_load_dwordx4 v1, s[8:11], s93 offen offset:0  lds
    s_waitcnt lgkmcnt(5)
    v_mfma_f32_16x16x32_bf16 v[144:147], a[112:115], v[224:227], v[144:147]
    s_add_u32 m0, s63, 61440
    v_fma_f32 v183, v183, v113, v113
    v_fma_f32 v184, v184, v113, v113
    v_mfma_f32_16x16x32_bf16 v[148:151], a[192:195], v[224:227], v[148:151]
    s_add_u32 s93, s61, 8409088
    v_fma_f32 v185, v185, v113, v113
    v_fma_f32 v186, v186, v113, v113
    v_mfma_f32_16x16x32_bf16 v[140:143], a[36:39], v[228:231], v[140:143]
    ds_read_b128 v[220:223], v2 offset:52224
    buffer_load_dwordx4 v1, s[8:11], s93 offen offset:0  lds
    s_waitcnt lgkmcnt(5)
    v_mfma_f32_16x16x32_bf16 v[144:147], a[116:119], v[228:231], v[144:147]
    v_fma_f32 v187, v187, v113, v113
    v_mfma_f32_16x16x32_bf16 v[148:151], a[196:199], v[228:231], v[148:151]
    v_rcp_f32 v176, v176
    v_mfma_f32_16x16x32_bf16 v[140:143], a[40:43], v[232:235], v[140:143]
    ds_read_b128 v[224:227], v2 offset:53248
    s_waitcnt lgkmcnt(5)
    v_mfma_f32_16x16x32_bf16 v[144:147], a[120:123], v[232:235], v[144:147]
    v_rcp_f32 v177, v177
    v_mfma_f32_16x16x32_bf16 v[148:151], a[200:203], v[232:235], v[148:151]
    v_rcp_f32 v178, v178
    v_mfma_f32_16x16x32_bf16 v[140:143], a[44:47], v[236:239], v[140:143]
    ds_read_b128 v[228:231], v2 offset:54272
    buffer_load_dwordx4 v1, s[8:11], s93 offen offset:1024  lds
    s_waitcnt lgkmcnt(5)
    v_mfma_f32_16x16x32_bf16 v[144:147], a[124:127], v[236:239], v[144:147]
    v_rcp_f32 v179, v179
    v_mfma_f32_16x16x32_bf16 v[148:151], a[204:207], v[236:239], v[148:151]
    v_rcp_f32 v180, v180
    v_mfma_f32_16x16x32_bf16 v[140:143], a[48:51], v[208:211], v[140:143]
    ds_read_b128 v[232:235], v2 offset:55296
    buffer_load_dwordx4 v1, s[8:11], s93 offen offset:2048  lds
    s_waitcnt lgkmcnt(5)
    v_mfma_f32_16x16x32_bf16 v[144:147], a[128:131], v[208:211], v[144:147]
    v_rcp_f32 v181, v181
    v_mfma_f32_16x16x32_bf16 v[148:151], a[208:211], v[208:211], v[148:151]
    v_rcp_f32 v182, v182
    v_mfma_f32_16x16x32_bf16 v[140:143], a[52:55], v[212:215], v[140:143]
    ds_read_b128 v[236:239], v2 offset:56320
    s_waitcnt lgkmcnt(5)
    v_mfma_f32_16x16x32_bf16 v[144:147], a[132:135], v[212:215], v[144:147]
    v_rcp_f32 v183, v183
    v_mfma_f32_16x16x32_bf16 v[148:151], a[212:215], v[212:215], v[148:151]
    v_rcp_f32 v184, v184
    v_mfma_f32_16x16x32_bf16 v[140:143], a[56:59], v[216:219], v[140:143]
    s_waitcnt vmcnt(9)
    s_barrier
    ds_read_b128 v[208:211], v3 offset:12288
    buffer_load_dwordx4 v1, s[8:11], s93 offen offset:3072  lds
    s_waitcnt lgkmcnt(5)
    v_mfma_f32_16x16x32_bf16 v[144:147], a[136:139], v[216:219], v[144:147]
    v_rcp_f32 v185, v185
    v_mfma_f32_16x16x32_bf16 v[148:151], a[216:219], v[216:219], v[148:151]
    v_rcp_f32 v186, v186
    v_mfma_f32_16x16x32_bf16 v[140:143], a[60:63], v[220:223], v[140:143]
    ds_read_b128 v[212:215], v3 offset:13312
    s_waitcnt lgkmcnt(5)
    v_mfma_f32_16x16x32_bf16 v[144:147], a[140:143], v[220:223], v[144:147]
    s_add_u32 m0, m0, 4096
    v_rcp_f32 v187, v187
    v_mfma_f32_16x16x32_bf16 v[148:151], a[220:223], v[220:223], v[148:151]
    s_add_u32 s93, s93, 4096
    v_mul_f32 v128, v128, v176
    v_mul_f32 v129, v129, v177
    v_mfma_f32_16x16x32_bf16 v[140:143], a[64:67], v[224:227], v[140:143]
    ds_read_b128 v[216:219], v3 offset:14336
    buffer_load_dwordx4 v1, s[8:11], s93 offen offset:0  lds
    s_waitcnt lgkmcnt(5)
    v_mfma_f32_16x16x32_bf16 v[144:147], a[144:147], v[224:227], v[144:147]
    s_add_u32 m0, s63, 20480
    v_mul_f32 v130, v130, v178
    v_mul_f32 v131, v131, v179
    v_mfma_f32_16x16x32_bf16 v[148:151], a[224:227], v[224:227], v[148:151]
    s_add_u32 s93, s61, 8429568
    v_mul_f32 v132, v132, v180
    v_mul_f32 v133, v133, v181
    v_mfma_f32_16x16x32_bf16 v[140:143], a[68:71], v[228:231], v[140:143]
    ds_read_b128 v[220:223], v3 offset:15360
    buffer_load_dwordx4 v1, s[8:11], s93 offen offset:0  lds
    s_waitcnt lgkmcnt(5)
    v_mfma_f32_16x16x32_bf16 v[144:147], a[148:151], v[228:231], v[144:147]
    v_mul_f32 v134, v134, v182
    v_mul_f32 v135, v135, v183
    v_mfma_f32_16x16x32_bf16 v[148:151], a[228:231], v[228:231], v[148:151]
    v_mul_f32 v136, v136, v184
    v_mul_f32 v137, v137, v185
    v_mfma_f32_16x16x32_bf16 v[140:143], a[72:75], v[232:235], v[140:143]
    ds_read_b128 v[224:227], v3 offset:16384
    s_waitcnt lgkmcnt(5)
    v_mul_f32 v138, v138, v186
    v_mfma_f32_16x16x32_bf16 v[144:147], a[152:155], v[232:235], v[144:147]
    v_mul_f32 v139, v139, v187
    v_cvt_pk_bf16_f32 v128, v128, v129
    v_mfma_f32_16x16x32_bf16 v[148:151], a[232:235], v[232:235], v[148:151]
    v_cvt_pk_bf16_f32 v129, v130, v131
    v_cvt_pk_bf16_f32 v130, v132, v133
    v_mfma_f32_16x16x32_bf16 v[140:143], a[76:79], v[236:239], v[140:143]
    ds_read_b128 v[228:231], v3 offset:17408
    buffer_load_dwordx4 v1, s[8:11], s93 offen offset:1024  lds
    s_waitcnt lgkmcnt(5)
    v_mfma_f32_16x16x32_bf16 v[144:147], a[156:159], v[236:239], v[144:147]
    v_cvt_pk_bf16_f32 v131, v134, v135
    v_cvt_pk_bf16_f32 v132, v136, v137
    v_mfma_f32_16x16x32_bf16 v[148:151], a[236:239], v[236:239], v[148:151]
    v_cvt_pk_bf16_f32 v133, v138, v139
    s_add_u32 s82, s73, 37748736
    s_add_u32 s83, s74, 37748736
    buffer_store_dwordx4 v[128:131], v1, s[8:11], s82 offen sc1
    buffer_store_dwordx2 v[132:133], v4, s[8:11], s83 offen sc1
    v_pk_fma_f32 v[140:141], v[80:81], v[116:117], v[140:141] op_sel_hi:[1,0,1]
    v_pk_fma_f32 v[142:143], v[82:83], v[116:117], v[142:143] op_sel_hi:[1,0,1]
    v_pk_fma_f32 v[144:145], v[84:85], v[116:117], v[144:145] op_sel_hi:[1,0,1]
    v_pk_fma_f32 v[146:147], v[86:87], v[116:117], v[146:147] op_sel_hi:[1,0,1]
    v_pk_fma_f32 v[148:149], v[88:89], v[116:117], v[148:149] op_sel_hi:[1,0,1]
    v_pk_fma_f32 v[150:151], v[90:91], v[116:117], v[150:151] op_sel_hi:[1,0,1]
    v_pk_mul_f32 v[176:177], v[140:141], v[140:141]
    v_pk_mul_f32 v[178:179], v[142:143], v[142:143]
    v_pk_mul_f32 v[180:181], v[144:145], v[144:145]
    v_pk_mul_f32 v[182:183], v[146:147], v[146:147]
    v_pk_mul_f32 v[184:185], v[148:149], v[148:149]
    v_pk_mul_f32 v[186:187], v[150:151], v[150:151]
    v_pk_fma_f32 v[176:177], v[176:177], v[118:119], v[118:119] op_sel:[0,0,1] op_sel_hi:[1,0,1]
    v_pk_fma_f32 v[178:179], v[178:179], v[118:119], v[118:119] op_sel:[0,0,1] op_sel_hi:[1,0,1]
    v_pk_fma_f32 v[180:181], v[180:181], v[118:119], v[118:119] op_sel:[0,0,1] op_sel_hi:[1,0,1]
    v_pk_fma_f32 v[182:183], v[182:183], v[118:119], v[118:119] op_sel:[0,0,1] op_sel_hi:[1,0,1]
    v_pk_fma_f32 v[184:185], v[184:185], v[118:119], v[118:119] op_sel:[0,0,1] op_sel_hi:[1,0,1]
    v_pk_fma_f32 v[186:187], v[186:187], v[118:119], v[118:119] op_sel:[0,0,1] op_sel_hi:[1,0,1]
    v_pk_mul_f32 v[176:177], v[176:177], v[140:141]
    v_pk_mul_f32 v[178:179], v[178:179], v[142:143]
    v_pk_mul_f32 v[180:181], v[180:181], v[144:145]
    v_pk_mul_f32 v[182:183], v[182:183], v[146:147]
    v_pk_mul_f32 v[184:185], v[184:185], v[148:149]
    v_pk_mul_f32 v[186:187], v[186:187], v[150:151]
    v_mfma_f32_16x16x32_bf16 v[152:155], a[0:3], v[208:211], 0
    ds_read_b128 v[232:235], v3 offset:18432
    s_waitcnt lgkmcnt(5)
    v_mfma_f32_16x16x32_bf16 v[156:159], a[80:83], v[208:211], 0
    v_exp_f32 v176, v176
    v_mfma_f32_16x16x32_bf16 v[160:163], a[160:163], v[208:211], 0
    v_exp_f32 v177, v177
    v_mfma_f32_16x16x32_bf16 v[152:155], a[4:7], v[212:215], v[152:155]
    ds_read_b128 v[236:239], v3 offset:19456
    buffer_load_dwordx4 v1, s[8:11], s93 offen offset:2048  lds
    s_waitcnt lgkmcnt(5)
    v_mfma_f32_16x16x32_bf16 v[156:159], a[84:87], v[212:215], v[156:159]
    v_exp_f32 v178, v178
    v_mfma_f32_16x16x32_bf16 v[160:163], a[164:167], v[212:215], v[160:163]
    v_exp_f32 v179, v179
    v_mfma_f32_16x16x32_bf16 v[152:155], a[8:11], v[216:219], v[152:155]
    ds_read_b128 v[208:211], v3 offset:20480
    buffer_load_dwordx4 v1, s[8:11], s93 offen offset:3072  lds
    s_waitcnt lgkmcnt(5)
    v_mfma_f32_16x16x32_bf16 v[156:159], a[88:91], v[216:219], v[156:159]
    v_exp_f32 v180, v180
    v_mfma_f32_16x16x32_bf16 v[160:163], a[168:171], v[216:219], v[160:163]
    v_exp_f32 v181, v181
    v_mfma_f32_16x16x32_bf16 v[152:155], a[12:15], v[220:223], v[152:155]
    ds_read_b128 v[212:215], v3 offset:21504
    s_waitcnt lgkmcnt(5)
    v_mfma_f32_16x16x32_bf16 v[156:159], a[92:95], v[220:223], v[156:159]
    s_add_u32 m0, m0, 4096
    v_exp_f32 v182, v182
    v_mfma_f32_16x16x32_bf16 v[160:163], a[172:175], v[220:223], v[160:163]
    s_add_u32 s93, s93, 4096
    v_exp_f32 v183, v183
    v_mfma_f32_16x16x32_bf16 v[152:155], a[16:19], v[224:227], v[152:155]
    ds_read_b128 v[216:219], v3 offset:22528
    buffer_load_dwordx4 v1, s[8:11], s93 offen offset:0  lds
    s_waitcnt lgkmcnt(5)
    v_mfma_f32_16x16x32_bf16 v[156:159], a[96:99], v[224:227], v[156:159]
    v_exp_f32 v184, v184
    v_mfma_f32_16x16x32_bf16 v[160:163], a[176:179], v[224:227], v[160:163]
    v_exp_f32 v185, v185
    v_mfma_f32_16x16x32_bf16 v[152:155], a[20:23], v[228:231], v[152:155]
    ds_read_b128 v[220:223], v3 offset:23552
    s_waitcnt lgkmcnt(5)
    v_mfma_f32_16x16x32_bf16 v[156:159], a[100:103], v[228:231], v[156:159]
    s_add_u32 m0, s63, 122880
    v_exp_f32 v186, v186
    v_mfma_f32_16x16x32_bf16 v[160:163], a[180:183], v[228:231], v[160:163]
    s_add_u32 s93, s61, 8450048
    v_exp_f32 v187, v187
    v_mfma_f32_16x16x32_bf16 v[152:155], a[24:27], v[232:235], v[152:155]
    ds_read_b128 v[224:227], v3 offset:24576
    buffer_load_dwordx4 v1, s[8:11], s93 offen offset:0  lds
    s_waitcnt lgkmcnt(5)
    v_mfma_f32_16x16x32_bf16 v[156:159], a[104:107], v[232:235], v[156:159]
    v_fma_f32 v176, v176, v117, v117
    v_fma_f32 v177, v177, v117, v117
    v_mfma_f32_16x16x32_bf16 v[160:163], a[184:187], v[232:235], v[160:163]
    v_fma_f32 v178, v178, v117, v117
    v_fma_f32 v179, v179, v117, v117
    v_mfma_f32_16x16x32_bf16 v[152:155], a[28:31], v[236:239], v[152:155]
    ds_read_b128 v[228:231], v3 offset:25600
    buffer_load_dwordx4 v1, s[8:11], s93 offen offset:1024  lds
    s_waitcnt lgkmcnt(5)
    v_mfma_f32_16x16x32_bf16 v[156:159], a[108:111], v[236:239], v[156:159]
    v_fma_f32 v180, v180, v117, v117
    v_fma_f32 v181, v181, v117, v117
    v_mfma_f32_16x16x32_bf16 v[160:163], a[188:191], v[236:239], v[160:163]
    v_fma_f32 v182, v182, v117, v117
    v_fma_f32 v183, v183, v117, v117
    v_mfma_f32_16x16x32_bf16 v[152:155], a[32:35], v[208:211], v[152:155]
    ds_read_b128 v[232:235], v3 offset:26624
    s_waitcnt lgkmcnt(5)
    v_fma_f32 v184, v184, v117, v117
    v_mfma_f32_16x16x32_bf16 v[156:159], a[112:115], v[208:211], v[156:159]
    v_fma_f32 v185, v185, v117, v117
    v_fma_f32 v186, v186, v117, v117
    v_mfma_f32_16x16x32_bf16 v[160:163], a[192:195], v[208:211], v[160:163]
    v_fma_f32 v187, v187, v117, v117
    v_mfma_f32_16x16x32_bf16 v[152:155], a[36:39], v[212:215], v[152:155]
    ds_read_b128 v[236:239], v3 offset:27648
    buffer_load_dwordx4 v1, s[8:11], s93 offen offset:2048  lds
    s_waitcnt lgkmcnt(5)
    v_mfma_f32_16x16x32_bf16 v[156:159], a[116:119], v[212:215], v[156:159]
    v_rcp_f32 v176, v176
    v_mfma_f32_16x16x32_bf16 v[160:163], a[196:199], v[212:215], v[160:163]
    v_rcp_f32 v177, v177
    v_mfma_f32_16x16x32_bf16 v[152:155], a[40:43], v[216:219], v[152:155]
    ds_read_b128 v[208:211], v3 offset:28672
    buffer_load_dwordx4 v1, s[8:11], s93 offen offset:3072  lds
    s_waitcnt lgkmcnt(5)
    v_mfma_f32_16x16x32_bf16 v[156:159], a[120:123], v[216:219], v[156:159]
    v_rcp_f32 v178, v178
    v_mfma_f32_16x16x32_bf16 v[160:163], a[200:203], v[216:219], v[160:163]
    v_rcp_f32 v179, v179
    v_mfma_f32_16x16x32_bf16 v[152:155], a[44:47], v[220:223], v[152:155]
    ds_read_b128 v[212:215], v3 offset:29696
    s_waitcnt lgkmcnt(5)
    v_mfma_f32_16x16x32_bf16 v[156:159], a[124:127], v[220:223], v[156:159]
    s_add_u32 m0, m0, 4096
    v_rcp_f32 v180, v180
    v_mfma_f32_16x16x32_bf16 v[160:163], a[204:207], v[220:223], v[160:163]
    s_add_u32 s93, s93, 4096
    v_rcp_f32 v181, v181
    v_mfma_f32_16x16x32_bf16 v[152:155], a[48:51], v[224:227], v[152:155]
    ds_read_b128 v[216:219], v3 offset:30720
    buffer_load_dwordx4 v1, s[8:11], s93 offen offset:0  lds
    s_waitcnt lgkmcnt(5)
    v_mfma_f32_16x16x32_bf16 v[156:159], a[128:131], v[224:227], v[156:159]
    v_rcp_f32 v182, v182
    v_mfma_f32_16x16x32_bf16 v[160:163], a[208:211], v[224:227], v[160:163]
    v_rcp_f32 v183, v183
    v_mfma_f32_16x16x32_bf16 v[152:155], a[52:55], v[228:231], v[152:155]
    ds_read_b128 v[220:223], v3 offset:31744
    s_waitcnt lgkmcnt(5)
    v_mfma_f32_16x16x32_bf16 v[156:159], a[132:135], v[228:231], v[156:159]
    s_add_u32 m0, s63, 40960
    v_rcp_f32 v184, v184
    v_mfma_f32_16x16x32_bf16 v[160:163], a[212:215], v[228:231], v[160:163]
    s_add_u32 s93, s61, 8470528
    v_rcp_f32 v185, v185
    v_mfma_f32_16x16x32_bf16 v[152:155], a[56:59], v[232:235], v[152:155]
    s_barrier
    ds_read_b128 v[224:227], v1 offset:0
    buffer_load_dwordx4 v1, s[8:11], s93 offen offset:0  lds
    s_waitcnt lgkmcnt(5)
    v_mfma_f32_16x16x32_bf16 v[156:159], a[136:139], v[232:235], v[156:159]
    v_rcp_f32 v186, v186
    v_mfma_f32_16x16x32_bf16 v[160:163], a[216:219], v[232:235], v[160:163]
    v_rcp_f32 v187, v187
    v_mfma_f32_16x16x32_bf16 v[152:155], a[60:63], v[236:239], v[152:155]
    ds_read_b128 v[228:231], v1 offset:1024
    buffer_load_dwordx4 v1, s[8:11], s93 offen offset:1024  lds
    s_waitcnt lgkmcnt(5)
    v_mfma_f32_16x16x32_bf16 v[156:159], a[140:143], v[236:239], v[156:159]
    v_mul_f32 v140, v140, v176
    v_mul_f32 v141, v141, v177
    v_mfma_f32_16x16x32_bf16 v[160:163], a[220:223], v[236:239], v[160:163]
    v_mul_f32 v142, v142, v178
    v_mul_f32 v143, v143, v179
    v_mfma_f32_16x16x32_bf16 v[152:155], a[64:67], v[208:211], v[152:155]
    ds_read_b128 v[232:235], v1 offset:2048
    s_waitcnt lgkmcnt(5)
    v_mul_f32 v144, v144, v180
    v_mfma_f32_16x16x32_bf16 v[156:159], a[144:147], v[208:211], v[156:159]
    v_mul_f32 v145, v145, v181
    v_mul_f32 v146, v146, v182
    v_mfma_f32_16x16x32_bf16 v[160:163], a[224:227], v[208:211], v[160:163]
    v_mul_f32 v147, v147, v183
    v_mul_f32 v148, v148, v184
    v_mfma_f32_16x16x32_bf16 v[152:155], a[68:71], v[212:215], v[152:155]
    ds_read_b128 v[236:239], v1 offset:3072
    buffer_load_dwordx4 v1, s[8:11], s93 offen offset:2048  lds
    s_waitcnt lgkmcnt(5)
    v_mfma_f32_16x16x32_bf16 v[156:159], a[148:151], v[212:215], v[156:159]
    v_mul_f32 v149, v149, v185
    v_mul_f32 v150, v150, v186
    v_mfma_f32_16x16x32_bf16 v[160:163], a[228:231], v[212:215], v[160:163]
    v_mul_f32 v151, v151, v187
    v_cvt_pk_bf16_f32 v140, v140, v141
    v_mfma_f32_16x16x32_bf16 v[152:155], a[72:75], v[216:219], v[152:155]
    ds_read_b128 v[208:211], v1 offset:4096
    s_waitcnt lgkmcnt(5)
    v_cvt_pk_bf16_f32 v141, v142, v143
    v_mfma_f32_16x16x32_bf16 v[156:159], a[152:155], v[216:219], v[156:159]
    v_cvt_pk_bf16_f32 v142, v144, v145
    v_cvt_pk_bf16_f32 v143, v146, v147
    v_mfma_f32_16x16x32_bf16 v[160:163], a[232:235], v[216:219], v[160:163]
    v_cvt_pk_bf16_f32 v144, v148, v149
    v_cvt_pk_bf16_f32 v145, v150, v151
    v_mfma_f32_16x16x32_bf16 v[152:155], a[76:79], v[220:223], v[152:155]
    ds_read_b128 v[212:215], v1 offset:5120
    buffer_load_dwordx4 v1, s[8:11], s93 offen offset:3072  lds
    s_waitcnt lgkmcnt(5)
    v_mfma_f32_16x16x32_bf16 v[156:159], a[156:159], v[220:223], v[156:159]
    s_add_u32 m0, m0, 4096
    s_add_u32 s82, s73, 37797888
    s_add_u32 s83, s74, 37797888
    buffer_store_dwordx4 v[140:143], v1, s[8:11], s82 offen sc1
    buffer_store_dwordx2 v[144:145], v4, s[8:11], s83 offen sc1
    v_mfma_f32_16x16x32_bf16 v[160:163], a[236:239], v[220:223], v[160:163]
    s_add_u32 s93, s93, 4096
    v_pk_fma_f32 v[152:153], v[80:81], v[120:121], v[152:153] op_sel_hi:[1,0,1]
    v_pk_fma_f32 v[154:155], v[82:83], v[120:121], v[154:155] op_sel_hi:[1,0,1]
    v_pk_fma_f32 v[156:157], v[84:85], v[120:121], v[156:157] op_sel_hi:[1,0,1]
    v_pk_fma_f32 v[158:159], v[86:87], v[120:121], v[158:159] op_sel_hi:[1,0,1]
    s_nop 2
    v_pk_fma_f32 v[160:161], v[88:89], v[120:121], v[160:161] op_sel_hi:[1,0,1]
    v_pk_fma_f32 v[162:163], v[90:91], v[120:121], v[162:163] op_sel_hi:[1,0,1]
    v_pk_mul_f32 v[176:177], v[152:153], v[152:153]
    v_pk_mul_f32 v[178:179], v[154:155], v[154:155]
    v_pk_mul_f32 v[180:181], v[156:157], v[156:157]
    v_pk_mul_f32 v[182:183], v[158:159], v[158:159]
    v_pk_mul_f32 v[184:185], v[160:161], v[160:161]
    v_pk_mul_f32 v[186:187], v[162:163], v[162:163]
    v_pk_fma_f32 v[176:177], v[176:177], v[122:123], v[122:123] op_sel:[0,0,1] op_sel_hi:[1,0,1]
    v_pk_fma_f32 v[178:179], v[178:179], v[122:123], v[122:123] op_sel:[0,0,1] op_sel_hi:[1,0,1]
    v_pk_fma_f32 v[180:181], v[180:181], v[122:123], v[122:123] op_sel:[0,0,1] op_sel_hi:[1,0,1]
    v_pk_fma_f32 v[182:183], v[182:183], v[122:123], v[122:123] op_sel:[0,0,1] op_sel_hi:[1,0,1]
    v_pk_fma_f32 v[184:185], v[184:185], v[122:123], v[122:123] op_sel:[0,0,1] op_sel_hi:[1,0,1]
    v_pk_fma_f32 v[186:187], v[186:187], v[122:123], v[122:123] op_sel:[0,0,1] op_sel_hi:[1,0,1]
    v_pk_mul_f32 v[176:177], v[176:177], v[152:153]
    v_pk_mul_f32 v[178:179], v[178:179], v[154:155]
    v_pk_mul_f32 v[180:181], v[180:181], v[156:157]
    v_pk_mul_f32 v[182:183], v[182:183], v[158:159]
    v_pk_mul_f32 v[184:185], v[184:185], v[160:161]
    v_pk_mul_f32 v[186:187], v[186:187], v[162:163]
    v_mfma_f32_16x16x32_bf16 v[164:167], a[0:3], v[224:227], 0
    ds_read_b128 v[216:219], v1 offset:6144
    buffer_load_dwordx4 v1, s[8:11], s93 offen offset:0  lds
    s_waitcnt lgkmcnt(5)
    v_mfma_f32_16x16x32_bf16 v[168:171], a[80:83], v[224:227], 0
    v_exp_f32 v176, v176
    v_mfma_f32_16x16x32_bf16 v[172:175], a[160:163], v[224:227], 0
    v_exp_f32 v177, v177
    v_mfma_f32_16x16x32_bf16 v[164:167], a[4:7], v[228:231], v[164:167]
    ds_read_b128 v[220:223], v1 offset:7168
    s_waitcnt lgkmcnt(5)
    v_mfma_f32_16x16x32_bf16 v[168:171], a[84:87], v[228:231], v[168:171]
    s_add_u32 m0, s63, 102400
    v_exp_f32 v178, v178
    v_mfma_f32_16x16x32_bf16 v[172:175], a[164:167], v[228:231], v[172:175]
    s_add_u32 s93, s61, 8491008
    v_exp_f32 v179, v179
    v_mfma_f32_16x16x32_bf16 v[164:167], a[8:11], v[232:235], v[164:167]
    s_barrier
    ds_read_b128 v[224:227], v1 offset:8192
    buffer_load_dwordx4 v1, s[8:11], s93 offen offset:0  lds
    s_waitcnt lgkmcnt(5)
    v_mfma_f32_16x16x32_bf16 v[168:171], a[88:91], v[232:235], v[168:171]
    v_exp_f32 v180, v180
    v_mfma_f32_16x16x32_bf16 v[172:175], a[168:171], v[232:235], v[172:175]
    v_exp_f32 v181, v181
    v_mfma_f32_16x16x32_bf16 v[164:167], a[12:15], v[236:239], v[164:167]
    ds_read_b128 v[228:231], v1 offset:9216
    buffer_load_dwordx4 v1, s[8:11], s93 offen offset:1024  lds
    s_waitcnt lgkmcnt(5)
    v_mfma_f32_16x16x32_bf16 v[168:171], a[92:95], v[236:239], v[168:171]
    v_exp_f32 v182, v182
    v_mfma_f32_16x16x32_bf16 v[172:175], a[172:175], v[236:239], v[172:175]
    v_exp_f32 v183, v183
    v_mfma_f32_16x16x32_bf16 v[164:167], a[16:19], v[208:211], v[164:167]
    ds_read_b128 v[232:235], v1 offset:10240
    s_waitcnt lgkmcnt(5)
    v_mfma_f32_16x16x32_bf16 v[168:171], a[96:99], v[208:211], v[168:171]
    v_exp_f32 v184, v184
    v_mfma_f32_16x16x32_bf16 v[172:175], a[176:179], v[208:211], v[172:175]
    v_exp_f32 v185, v185
    v_mfma_f32_16x16x32_bf16 v[164:167], a[20:23], v[212:215], v[164:167]
    ds_read_b128 v[236:239], v1 offset:11264
    buffer_load_dwordx4 v1, s[8:11], s93 offen offset:2048  lds
    s_waitcnt lgkmcnt(5)
    v_mfma_f32_16x16x32_bf16 v[168:171], a[100:103], v[212:215], v[168:171]
    v_exp_f32 v186, v186
    v_mfma_f32_16x16x32_bf16 v[172:175], a[180:183], v[212:215], v[172:175]
    v_exp_f32 v187, v187
    v_mfma_f32_16x16x32_bf16 v[164:167], a[24:27], v[216:219], v[164:167]
    ds_read_b128 v[208:211], v1 offset:12288
    s_waitcnt lgkmcnt(5)
    v_fma_f32 v176, v176, v121, v121
    v_mfma_f32_16x16x32_bf16 v[168:171], a[104:107], v[216:219], v[168:171]
    v_fma_f32 v177, v177, v121, v121
    v_fma_f32 v178, v178, v121, v121
    v_mfma_f32_16x16x32_bf16 v[172:175], a[184:187], v[216:219], v[172:175]
    v_fma_f32 v179, v179, v121, v121
    v_fma_f32 v180, v180, v121, v121
    v_mfma_f32_16x16x32_bf16 v[164:167], a[28:31], v[220:223], v[164:167]
    ds_read_b128 v[212:215], v1 offset:13312
    buffer_load_dwordx4 v1, s[8:11], s93 offen offset:3072  lds
    s_waitcnt lgkmcnt(5)
    v_mfma_f32_16x16x32_bf16 v[168:171], a[108:111], v[220:223], v[168:171]
    s_add_u32 m0, m0, 4096
    v_fma_f32 v181, v181, v121, v121
    v_fma_f32 v182, v182, v121, v121
    v_mfma_f32_16x16x32_bf16 v[172:175], a[188:191], v[220:223], v[172:175]
    s_add_u32 s93, s93, 4096
    v_fma_f32 v183, v183, v121, v121
    v_fma_f32 v184, v184, v121, v121
    v_mfma_f32_16x16x32_bf16 v[164:167], a[32:35], v[224:227], v[164:167]
    ds_read_b128 v[216:219], v1 offset:14336
    buffer_load_dwordx4 v1, s[8:11], s93 offen offset:0  lds
    s_waitcnt lgkmcnt(5)
    v_mfma_f32_16x16x32_bf16 v[168:171], a[112:115], v[224:227], v[168:171]
    v_fma_f32 v185, v185, v121, v121
    v_fma_f32 v186, v186, v121, v121
    v_mfma_f32_16x16x32_bf16 v[172:175], a[192:195], v[224:227], v[172:175]
    v_fma_f32 v187, v187, v121, v121
    v_mfma_f32_16x16x32_bf16 v[164:167], a[36:39], v[228:231], v[164:167]
    ds_read_b128 v[220:223], v1 offset:15360
    s_waitcnt lgkmcnt(5)
    v_mfma_f32_16x16x32_bf16 v[168:171], a[116:119], v[228:231], v[168:171]
    s_add_u32 m0, s63, 143360
    v_rcp_f32 v176, v176
    v_mfma_f32_16x16x32_bf16 v[172:175], a[196:199], v[228:231], v[172:175]
    s_add_u32 s93, s61, 8511488
    v_rcp_f32 v177, v177
    v_mfma_f32_16x16x32_bf16 v[164:167], a[40:43], v[232:235], v[164:167]
    ds_read_b128 v[224:227], v1 offset:16384
    buffer_load_dwordx4 v1, s[8:11], s93 offen offset:0  lds
    s_waitcnt lgkmcnt(5)
    v_mfma_f32_16x16x32_bf16 v[168:171], a[120:123], v[232:235], v[168:171]
    v_rcp_f32 v178, v178
    v_mfma_f32_16x16x32_bf16 v[172:175], a[200:203], v[232:235], v[172:175]
    v_rcp_f32 v179, v179
    v_mfma_f32_16x16x32_bf16 v[164:167], a[44:47], v[236:239], v[164:167]
    ds_read_b128 v[228:231], v1 offset:17408
    s_waitcnt lgkmcnt(5)
    v_mfma_f32_16x16x32_bf16 v[168:171], a[124:127], v[236:239], v[168:171]
    v_rcp_f32 v180, v180
    v_mfma_f32_16x16x32_bf16 v[172:175], a[204:207], v[236:239], v[172:175]
    v_rcp_f32 v181, v181
    v_mfma_f32_16x16x32_bf16 v[164:167], a[48:51], v[208:211], v[164:167]
    ds_read_b128 v[232:235], v1 offset:18432
    buffer_load_dwordx4 v1, s[8:11], s93 offen offset:1024  lds
    s_waitcnt lgkmcnt(5)
    v_mfma_f32_16x16x32_bf16 v[168:171], a[128:131], v[208:211], v[168:171]
    v_rcp_f32 v182, v182
    v_mfma_f32_16x16x32_bf16 v[172:175], a[208:211], v[208:211], v[172:175]
    v_rcp_f32 v183, v183
    v_mfma_f32_16x16x32_bf16 v[164:167], a[52:55], v[212:215], v[164:167]
    ds_read_b128 v[236:239], v1 offset:19456
    buffer_load_dwordx4 v1, s[8:11], s93 offen offset:2048  lds
    s_waitcnt lgkmcnt(5)
    v_mfma_f32_16x16x32_bf16 v[168:171], a[132:135], v[212:215], v[168:171]
    v_rcp_f32 v184, v184
    v_mfma_f32_16x16x32_bf16 v[172:175], a[212:215], v[212:215], v[172:175]
    v_rcp_f32 v185, v185
    v_mfma_f32_16x16x32_bf16 v[164:167], a[56:59], v[216:219], v[164:167]
    s_waitcnt lgkmcnt(4)
    v_rcp_f32 v186, v186
    v_mfma_f32_16x16x32_bf16 v[168:171], a[136:139], v[216:219], v[168:171]
    v_rcp_f32 v187, v187
    v_mfma_f32_16x16x32_bf16 v[172:175], a[216:219], v[216:219], v[172:175]
    v_mul_f32 v152, v152, v176
    v_mul_f32 v153, v153, v177
    v_mfma_f32_16x16x32_bf16 v[164:167], a[60:63], v[220:223], v[164:167]
    buffer_load_dwordx4 v1, s[8:11], s93 offen offset:3072  lds
    s_waitcnt lgkmcnt(3)
    v_mfma_f32_16x16x32_bf16 v[168:171], a[140:143], v[220:223], v[168:171]
    v_mul_f32 v154, v154, v178
    v_mul_f32 v155, v155, v179
    v_mfma_f32_16x16x32_bf16 v[172:175], a[220:223], v[220:223], v[172:175]
    v_mul_f32 v156, v156, v180
    v_mul_f32 v157, v157, v181
    v_mfma_f32_16x16x32_bf16 v[164:167], a[64:67], v[224:227], v[164:167]
    s_waitcnt lgkmcnt(2)
    v_mul_f32 v158, v158, v182
    v_mul_f32 v159, v159, v183
    v_mfma_f32_16x16x32_bf16 v[168:171], a[144:147], v[224:227], v[168:171]
    s_add_u32 m0, m0, 4096
    v_mul_f32 v160, v160, v184
    v_mul_f32 v161, v161, v185
    v_mfma_f32_16x16x32_bf16 v[172:175], a[224:227], v[224:227], v[172:175]
    s_add_u32 s93, s93, 4096
    v_mul_f32 v162, v162, v186
    v_mul_f32 v163, v163, v187
    v_mfma_f32_16x16x32_bf16 v[164:167], a[68:71], v[228:231], v[164:167]
    buffer_load_dwordx4 v1, s[8:11], s93 offen offset:0  lds
    s_waitcnt lgkmcnt(1)
    v_mfma_f32_16x16x32_bf16 v[168:171], a[148:151], v[228:231], v[168:171]
    v_cvt_pk_bf16_f32 v152, v152, v153
    v_cvt_pk_bf16_f32 v153, v154, v155
    v_mfma_f32_16x16x32_bf16 v[172:175], a[228:231], v[228:231], v[172:175]
    v_cvt_pk_bf16_f32 v154, v156, v157
    v_cvt_pk_bf16_f32 v155, v158, v159
    v_mfma_f32_16x16x32_bf16 v[164:167], a[72:75], v[232:235], v[164:167]
    s_waitcnt lgkmcnt(0)
    v_cvt_pk_bf16_f32 v156, v160, v161
    v_cvt_pk_bf16_f32 v157, v162, v163
    v_mfma_f32_16x16x32_bf16 v[168:171], a[152:155], v[232:235], v[168:171]
    s_add_u32 s82, s73, 37847040
    s_add_u32 s83, s74, 37847040
    buffer_store_dwordx4 v[152:155], v1, s[8:11], s82 offen sc1
    buffer_store_dwordx2 v[156:157], v4, s[8:11], s83 offen sc1
    v_mfma_f32_16x16x32_bf16 v[172:175], a[232:235], v[232:235], v[172:175]
    v_mfma_f32_16x16x32_bf16 v[164:167], a[76:79], v[236:239], v[164:167]
    v_mfma_f32_16x16x32_bf16 v[168:171], a[156:159], v[236:239], v[168:171]
    v_mfma_f32_16x16x32_bf16 v[172:175], a[236:239], v[236:239], v[172:175]
    s_nop 5
    v_pk_fma_f32 v[164:165], v[80:81], v[124:125], v[164:165] op_sel_hi:[1,0,1]
    v_pk_fma_f32 v[166:167], v[82:83], v[124:125], v[166:167] op_sel_hi:[1,0,1]
    v_pk_fma_f32 v[168:169], v[84:85], v[124:125], v[168:169] op_sel_hi:[1,0,1]
    v_pk_fma_f32 v[170:171], v[86:87], v[124:125], v[170:171] op_sel_hi:[1,0,1]
    v_pk_fma_f32 v[172:173], v[88:89], v[124:125], v[172:173] op_sel_hi:[1,0,1]
    v_pk_fma_f32 v[174:175], v[90:91], v[124:125], v[174:175] op_sel_hi:[1,0,1]
    v_pk_mul_f32 v[176:177], v[164:165], v[164:165]
    v_pk_mul_f32 v[178:179], v[166:167], v[166:167]
    v_pk_mul_f32 v[180:181], v[168:169], v[168:169]
    v_pk_mul_f32 v[182:183], v[170:171], v[170:171]
    v_pk_mul_f32 v[184:185], v[172:173], v[172:173]
    v_pk_mul_f32 v[186:187], v[174:175], v[174:175]
    v_pk_fma_f32 v[176:177], v[176:177], v[126:127], v[126:127] op_sel:[0,0,1] op_sel_hi:[1,0,1]
    v_pk_fma_f32 v[178:179], v[178:179], v[126:127], v[126:127] op_sel:[0,0,1] op_sel_hi:[1,0,1]
    v_pk_fma_f32 v[180:181], v[180:181], v[126:127], v[126:127] op_sel:[0,0,1] op_sel_hi:[1,0,1]
    v_pk_fma_f32 v[182:183], v[182:183], v[126:127], v[126:127] op_sel:[0,0,1] op_sel_hi:[1,0,1]
    v_pk_fma_f32 v[184:185], v[184:185], v[126:127], v[126:127] op_sel:[0,0,1] op_sel_hi:[1,0,1]
    v_pk_fma_f32 v[186:187], v[186:187], v[126:127], v[126:127] op_sel:[0,0,1] op_sel_hi:[1,0,1]
    v_pk_mul_f32 v[176:177], v[176:177], v[164:165]
    v_pk_mul_f32 v[178:179], v[178:179], v[166:167]
    v_pk_mul_f32 v[180:181], v[180:181], v[168:169]
    v_pk_mul_f32 v[182:183], v[182:183], v[170:171]
    v_pk_mul_f32 v[184:185], v[184:185], v[172:173]
    v_pk_mul_f32 v[186:187], v[186:187], v[174:175]
    v_exp_f32 v176, v176
    v_exp_f32 v177, v177
    v_exp_f32 v178, v178
    v_exp_f32 v179, v179
    v_exp_f32 v180, v180
    v_exp_f32 v181, v181
    v_exp_f32 v182, v182
    v_exp_f32 v183, v183
    v_exp_f32 v184, v184
    v_exp_f32 v185, v185
    v_exp_f32 v186, v186
    v_exp_f32 v187, v187
    v_pk_fma_f32 v[176:177], v[176:177], v[124:125], v[124:125] op_sel:[0,1,1] op_sel_hi:[1,1,1]
    v_pk_fma_f32 v[178:179], v[178:179], v[124:125], v[124:125] op_sel:[0,1,1] op_sel_hi:[1,1,1]
    v_pk_fma_f32 v[180:181], v[180:181], v[124:125], v[124:125] op_sel:[0,1,1] op_sel_hi:[1,1,1]
    v_pk_fma_f32 v[182:183], v[182:183], v[124:125], v[124:125] op_sel:[0,1,1] op_sel_hi:[1,1,1]
    v_pk_fma_f32 v[184:185], v[184:185], v[124:125], v[124:125] op_sel:[0,1,1] op_sel_hi:[1,1,1]
    v_pk_fma_f32 v[186:187], v[186:187], v[124:125], v[124:125] op_sel:[0,1,1] op_sel_hi:[1,1,1]
    v_rcp_f32 v176, v176
    v_rcp_f32 v177, v177
    v_rcp_f32 v178, v178
    v_rcp_f32 v179, v179
    v_rcp_f32 v180, v180
    v_rcp_f32 v181, v181
    v_rcp_f32 v182, v182
    v_rcp_f32 v183, v183
    v_rcp_f32 v184, v184
    v_rcp_f32 v185, v185
    v_rcp_f32 v186, v186
    v_rcp_f32 v187, v187
    v_pk_mul_f32 v[164:165], v[164:165], v[176:177]
    v_pk_mul_f32 v[166:167], v[166:167], v[178:179]
    v_pk_mul_f32 v[168:169], v[168:169], v[180:181]
    v_pk_mul_f32 v[170:171], v[170:171], v[182:183]
    v_pk_mul_f32 v[172:173], v[172:173], v[184:185]
    v_pk_mul_f32 v[174:175], v[174:175], v[186:187]
    v_cvt_pk_bf16_f32 v164, v164, v165
    v_cvt_pk_bf16_f32 v165, v166, v167
    v_cvt_pk_bf16_f32 v166, v168, v169
    v_cvt_pk_bf16_f32 v167, v170, v171
    v_cvt_pk_bf16_f32 v168, v172, v173
    v_cvt_pk_bf16_f32 v169, v174, v175
    s_add_u32 s82, s73, 37896192
    s_add_u32 s83, s74, 37896192
    buffer_store_dwordx4 v[164:167], v1, s[8:11], s82 offen sc1
    buffer_store_dwordx2 v[168:169], v4, s[8:11], s83 offen sc1
    s_waitcnt vmcnt(0)
    v_mov_b32 v7, 12
    v_mov_b32 v18, 0
    s_mov_b64 exec, 1
    s_cmp_eq_u32 s50, 0
    s_cbranch_scc1 SLOW_27
    buffer_store_dword v7, v18, s[8:11], s76 offen
BACK_27:
    s_mov_b64 exec, -1
    s_barrier
    ds_read_b128 v[208:211], v2 offset:16384
    ds_read_b128 v[212:215], v2 offset:17408
    ds_read_b128 v[216:219], v2 offset:18432
    ds_read_b128 v[220:223], v2 offset:19456
    ds_read_b128 v[224:227], v2 offset:20480
    ds_read_b128 v[228:231], v2 offset:21504
    ds_read_b128 v[232:235], v2 offset:22528
    ds_read_b128 v[236:239], v2 offset:23552
    ds_read_b128 v[240:243], v2 offset:24576
    ds_read_b128 v[244:247], v2 offset:25600
    s_add_u32 m0, s63, 0
    s_add_u32 s93, s61, 8531968
    buffer_load_dwordx4 v1, s[8:11], s93 offen offset:0  lds
    buffer_load_dwordx4 v1, s[8:11], s93 offen offset:1024  lds
    buffer_load_dwordx4 v1, s[8:11], s93 offen offset:2048  lds
    buffer_load_dwordx4 v1, s[8:11], s93 offen offset:3072  lds
    s_add_u32 m0, m0, 4096
    s_add_u32 s93, s93, 4096
    buffer_load_dwordx4 v1, s[8:11], s93 offen offset:0  lds
    s_lshl_b32 s85, s48, 7
    s_add_u32 s85, s85, 13635584
    s_mov_b32 s92, s67
POLL_50:
    buffer_load_dword v7, v6, s[8:11], s85 offen sc1
    s_waitcnt vmcnt(0)
    v_cmp_le_u32 vcc, 12, v7
    s_nop 0
    s_cmp_eq_u64 vcc, -1
    s_cbranch_scc1 PDONE_51
    s_sub_u32 s92, s92, 1
    s_cbranch_scc0 POLL_50
    s_mov_b32 s67, 0
PDONE_51:
    s_add_u32 s84, s59, 37748736
    buffer_load_dwordx4 v[80:83], v1, s[8:11], s84 offen offset:0 sc1
    buffer_load_dwordx4 v[84:87], v1, s[8:11], s84 offen offset:1024 sc1
    buffer_load_dwordx4 v[88:91], v1, s[8:11], s84 offen offset:2048 sc1
    buffer_load_dwordx4 v[92:95], v1, s[8:11], s84 offen offset:3072 sc1
    s_add_u32 s84, s59, 37752832
    buffer_load_dwordx4 v[96:99], v1, s[8:11], s84 offen offset:0 sc1
    buffer_load_dwordx4 v[100:103], v1, s[8:11], s84 offen offset:1024 sc1
    buffer_load_dwordx4 v[104:107], v1, s[8:11], s84 offen offset:2048 sc1
    buffer_load_dwordx4 v[108:111], v1, s[8:11], s84 offen offset:3072 sc1
    s_add_u32 s84, s59, 37756928
    buffer_load_dwordx4 v[112:115], v1, s[8:11], s84 offen offset:0 sc1
    buffer_load_dwordx4 v[116:119], v1, s[8:11], s84 offen offset:1024 sc1
    s_waitcnt vmcnt(9) lgkmcnt(8)
    v_mfma_f32_16x16x32_bf16 v[40:43], v[208:211], v[80:83], v[40:43]
    ds_read_b128 v[248:251], v2 offset:26624
    v_mfma_f32_16x16x32_bf16 v[44:47], v[212:215], v[80:83], v[44:47]
    ds_read_b128 v[252:255], v2 offset:27648
    buffer_load_dwordx4 v[120:123], v1, s[8:11], s84 offen offset:2048 sc1
    s_waitcnt lgkmcnt(8)
    v_mfma_f32_16x16x32_bf16 v[48:51], v[216:219], v[80:83], v[48:51]
    ds_read_b128 v[208:211], v2 offset:28672
    v_mfma_f32_16x16x32_bf16 v[52:55], v[220:223], v[80:83], v[52:55]
    ds_read_b128 v[212:215], v2 offset:29696
    s_waitcnt lgkmcnt(8)
    v_mfma_f32_16x16x32_bf16 v[56:59], v[224:227], v[80:83], v[56:59]
    ds_read_b128 v[216:219], v2 offset:30720
    s_waitcnt vmcnt(9)
    v_mfma_f32_16x16x32_bf16 v[40:43], v[228:231], v[84:87], v[40:43]
    ds_read_b128 v[220:223], v2 offset:31744
    s_waitcnt lgkmcnt(8)
    v_mfma_f32_16x16x32_bf16 v[44:47], v[232:235], v[84:87], v[44:47]
    ds_read_b128 v[224:227], v2 offset:32768
    buffer_load_dwordx4 v[124:127], v1, s[8:11], s84 offen offset:3072 sc1
    v_mfma_f32_16x16x32_bf16 v[48:51], v[236:239], v[84:87], v[48:51]
    ds_read_b128 v[228:231], v2 offset:33792
    s_waitcnt lgkmcnt(8)
    v_mfma_f32_16x16x32_bf16 v[52:55], v[240:243], v[84:87], v[52:55]
    ds_read_b128 v[232:235], v2 offset:34816
    v_mfma_f32_16x16x32_bf16 v[56:59], v[244:247], v[84:87], v[56:59]
    ds_read_b128 v[236:239], v2 offset:35840
    s_waitcnt vmcnt(9) lgkmcnt(8)
    v_mfma_f32_16x16x32_bf16 v[40:43], v[248:251], v[88:91], v[40:43]
    ds_read_b128 v[240:243], v1 offset:61440
    v_mfma_f32_16x16x32_bf16 v[44:47], v[252:255], v[88:91], v[44:47]
    ds_read_b128 v[244:247], v1 offset:62464
    s_add_u32 s84, s59, 37761024
    buffer_load_dwordx4 v[128:131], v1, s[8:11], s84 offen offset:0 sc1
    s_waitcnt lgkmcnt(8)
    v_mfma_f32_16x16x32_bf16 v[48:51], v[208:211], v[88:91], v[48:51]
    ds_read_b128 v[248:251], v1 offset:63488
    v_mfma_f32_16x16x32_bf16 v[52:55], v[212:215], v[88:91], v[52:55]
    ds_read_b128 v[252:255], v1 offset:64512
    s_waitcnt lgkmcnt(8)
    v_mfma_f32_16x16x32_bf16 v[56:59], v[216:219], v[88:91], v[56:59]
    ds_read_b128 v[208:211], v2 offset:0
    s_waitcnt vmcnt(9)
    v_mfma_f32_16x16x32_bf16 v[40:43], v[220:223], v[92:95], v[40:43]
    ds_read_b128 v[212:215], v2 offset:1024
    s_waitcnt lgkmcnt(8)
    v_mfma_f32_16x16x32_bf16 v[44:47], v[224:227], v[92:95], v[44:47]
    ds_read_b128 v[216:219], v2 offset:2048
    buffer_load_dwordx4 v[132:135], v1, s[8:11], s84 offen offset:1024 sc1
    v_mfma_f32_16x16x32_bf16 v[48:51], v[228:231], v[92:95], v[48:51]
    ds_read_b128 v[220:223], v2 offset:3072
    s_waitcnt lgkmcnt(8)
    v_mfma_f32_16x16x32_bf16 v[52:55], v[232:235], v[92:95], v[52:55]
    ds_read_b128 v[224:227], v2 offset:4096
    v_mfma_f32_16x16x32_bf16 v[56:59], v[236:239], v[92:95], v[56:59]
    ds_read_b128 v[228:231], v2 offset:5120
    s_waitcnt vmcnt(9) lgkmcnt(8)
    v_mfma_f32_16x16x32_bf16 v[40:43], v[240:243], v[96:99], v[40:43]
    ds_read_b128 v[232:235], v2 offset:6144
    v_mfma_f32_16x16x32_bf16 v[44:47], v[244:247], v[96:99], v[44:47]
    ds_read_b128 v[236:239], v2 offset:7168
    buffer_load_dwordx4 v[136:139], v1, s[8:11], s84 offen offset:2048 sc1
    s_waitcnt lgkmcnt(8)
    v_mfma_f32_16x16x32_bf16 v[48:51], v[248:251], v[96:99], v[48:51]
    ds_read_b128 v[240:243], v2 offset:8192
    v_mfma_f32_16x16x32_bf16 v[52:55], v[252:255], v[96:99], v[52:55]
    ds_read_b128 v[244:247], v2 offset:9216
    s_waitcnt lgkmcnt(8)
    v_mfma_f32_16x16x32_bf16 v[56:59], v[208:211], v[96:99], v[56:59]
    ds_read_b128 v[248:251], v2 offset:10240
    s_waitcnt vmcnt(9)
    v_mfma_f32_16x16x32_bf16 v[40:43], v[212:215], v[100:103], v[40:43]
    ds_read_b128 v[252:255], v2 offset:11264
    s_waitcnt lgkmcnt(8)
    v_mfma_f32_16x16x32_bf16 v[44:47], v[216:219], v[100:103], v[44:47]
    ds_read_b128 v[208:211], v2 offset:12288
    buffer_load_dwordx4 v[140:143], v1, s[8:11], s84 offen offset:3072 sc1
    v_mfma_f32_16x16x32_bf16 v[48:51], v[220:223], v[100:103], v[48:51]
    ds_read_b128 v[212:215], v2 offset:13312
    s_waitcnt lgkmcnt(8)
    v_mfma_f32_16x16x32_bf16 v[52:55], v[224:227], v[100:103], v[52:55]
    ds_read_b128 v[216:219], v2 offset:14336
    v_mfma_f32_16x16x32_bf16 v[56:59], v[228:231], v[100:103], v[56:59]
    ds_read_b128 v[220:223], v2 offset:15360
    s_waitcnt vmcnt(9) lgkmcnt(8)
    v_mfma_f32_16x16x32_bf16 v[40:43], v[232:235], v[104:107], v[40:43]
    ds_read_b128 v[224:227], v1 offset:20480
    v_mfma_f32_16x16x32_bf16 v[44:47], v[236:239], v[104:107], v[44:47]
    ds_read_b128 v[228:231], v1 offset:21504
    s_add_u32 s84, s59, 37765120
    buffer_load_dwordx4 v[144:147], v1, s[8:11], s84 offen offset:0 sc1
    s_waitcnt lgkmcnt(8)
    v_mfma_f32_16x16x32_bf16 v[48:51], v[240:243], v[104:107], v[48:51]
    ds_read_b128 v[232:235], v1 offset:22528
    v_mfma_f32_16x16x32_bf16 v[52:55], v[244:247], v[104:107], v[52:55]
    ds_read_b128 v[236:239], v1 offset:23552
    s_waitcnt lgkmcnt(8)
    v_mfma_f32_16x16x32_bf16 v[56:59], v[248:251], v[104:107], v[56:59]
    ds_read_b128 v[240:243], v1 offset:24576
    s_waitcnt vmcnt(9)
    v_mfma_f32_16x16x32_bf16 v[40:43], v[252:255], v[108:111], v[40:43]
    ds_read_b128 v[244:247], v1 offset:25600
    s_waitcnt lgkmcnt(8)
    v_mfma_f32_16x16x32_bf16 v[44:47], v[208:211], v[108:111], v[44:47]
    ds_read_b128 v[248:251], v1 offset:26624
    buffer_load_dwordx4 v[148:151], v1, s[8:11], s84 offen offset:1024 sc1
    v_mfma_f32_16x16x32_bf16 v[48:51], v[212:215], v[108:111], v[48:51]
    ds_read_b128 v[252:255], v1 offset:27648
    s_waitcnt lgkmcnt(8)
    v_mfma_f32_16x16x32_bf16 v[52:55], v[216:219], v[108:111], v[52:55]
    ds_read_b128 v[208:211], v1 offset:28672
    v_mfma_f32_16x16x32_bf16 v[56:59], v[220:223], v[108:111], v[56:59]
    ds_read_b128 v[212:215], v1 offset:29696
    s_waitcnt vmcnt(9) lgkmcnt(8)
    v_mfma_f32_16x16x32_bf16 v[40:43], v[224:227], v[112:115], v[40:43]
    s_barrier
    ds_read_b128 v[216:219], v1 offset:30720
    v_mfma_f32_16x16x32_bf16 v[44:47], v[228:231], v[112:115], v[44:47]
    ds_read_b128 v[220:223], v1 offset:31744
    buffer_load_dwordx4 v[152:155], v1, s[8:11], s84 offen offset:2048 sc1
    s_waitcnt lgkmcnt(8)
    v_mfma_f32_16x16x32_bf16 v[48:51], v[232:235], v[112:115], v[48:51]
    ds_read_b128 v[224:227], v1 offset:32768
    v_mfma_f32_16x16x32_bf16 v[52:55], v[236:239], v[112:115], v[52:55]
    ds_read_b128 v[228:231], v1 offset:33792
    s_add_u32 m0, s63, 81920
    s_add_u32 s93, s61, 8552448
    buffer_load_dwordx4 v1, s[8:11], s93 offen offset:0  lds
    s_waitcnt lgkmcnt(8)
    v_mfma_f32_16x16x32_bf16 v[56:59], v[240:243], v[112:115], v[56:59]
    ds_read_b128 v[232:235], v1 offset:34816
    s_waitcnt vmcnt(10)
    v_mfma_f32_16x16x32_bf16 v[40:43], v[244:247], v[116:119], v[40:43]
    ds_read_b128 v[236:239], v1 offset:35840
    s_waitcnt lgkmcnt(8)
    v_mfma_f32_16x16x32_bf16 v[44:47], v[248:251], v[116:119], v[44:47]
    ds_read_b128 v[240:243], v1 offset:36864
    buffer_load_dwordx4 v[156:159], v1, s[8:11], s84 offen offset:3072 sc1
    v_mfma_f32_16x16x32_bf16 v[48:51], v[252:255], v[116:119], v[48:51]
    ds_read_b128 v[244:247], v1 offset:37888
    s_waitcnt lgkmcnt(8)
    v_mfma_f32_16x16x32_bf16 v[52:55], v[208:211], v[116:119], v[52:55]
    ds_read_b128 v[248:251], v1 offset:38912
    buffer_load_dwordx4 v1, s[8:11], s93 offen offset:1024  lds
    v_mfma_f32_16x16x32_bf16 v[56:59], v[212:215], v[116:119], v[56:59]
    ds_read_b128 v[252:255], v1 offset:39936
    s_waitcnt vmcnt(11) lgkmcnt(8)
    v_mfma_f32_16x16x32_bf16 v[40:43], v[216:219], v[120:123], v[40:43]
    ds_read_b128 v[208:211], v2 offset:57344
    v_mfma_f32_16x16x32_bf16 v[44:47], v[220:223], v[120:123], v[44:47]
    ds_read_b128 v[212:215], v2 offset:58368
    s_add_u32 s84, s59, 37769216
    buffer_load_dwordx4 v[160:163], v1, s[8:11], s84 offen offset:0 sc1
    s_waitcnt lgkmcnt(8)
    v_mfma_f32_16x16x32_bf16 v[48:51], v[224:227], v[120:123], v[48:51]
    ds_read_b128 v[216:219], v2 offset:59392
    v_mfma_f32_16x16x32_bf16 v[52:55], v[228:231], v[120:123], v[52:55]
    ds_read_b128 v[220:223], v2 offset:60416
    buffer_load_dwordx4 v1, s[8:11], s93 offen offset:2048  lds
    s_waitcnt lgkmcnt(8)
    v_mfma_f32_16x16x32_bf16 v[56:59], v[232:235], v[120:123], v[56:59]
    ds_read_b128 v[224:227], v2 offset:61440
    s_waitcnt vmcnt(12)
    v_mfma_f32_16x16x32_bf16 v[40:43], v[236:239], v[124:127], v[40:43]
    ds_read_b128 v[228:231], v2 offset:62464
    s_waitcnt lgkmcnt(8)
    v_mfma_f32_16x16x32_bf16 v[44:47], v[240:243], v[124:127], v[44:47]
    ds_read_b128 v[232:235], v2 offset:63488
    buffer_load_dwordx4 v[164:167], v1, s[8:11], s84 offen offset:1024 sc1
    v_mfma_f32_16x16x32_bf16 v[48:51], v[244:247], v[124:127], v[48:51]
    ds_read_b128 v[236:239], v2 offset:64512
    s_waitcnt lgkmcnt(8)
    v_mfma_f32_16x16x32_bf16 v[52:55], v[248:251], v[124:127], v[52:55]
    ds_read_b128 v[240:243], v3 offset:0
    buffer_load_dwordx4 v1, s[8:11], s93 offen offset:3072  lds
    v_mfma_f32_16x16x32_bf16 v[56:59], v[252:255], v[124:127], v[56:59]
    ds_read_b128 v[244:247], v3 offset:1024
    s_waitcnt vmcnt(13) lgkmcnt(8)
    v_mfma_f32_16x16x32_bf16 v[40:43], v[208:211], v[128:131], v[40:43]
    ds_read_b128 v[248:251], v3 offset:2048
    v_mfma_f32_16x16x32_bf16 v[44:47], v[212:215], v[128:131], v[44:47]
    ds_read_b128 v[252:255], v3 offset:3072
    buffer_load_dwordx4 v[168:171], v1, s[8:11], s84 offen offset:2048 sc1
    s_waitcnt lgkmcnt(8)
    v_mfma_f32_16x16x32_bf16 v[48:51], v[216:219], v[128:131], v[48:51]
    ds_read_b128 v[208:211], v3 offset:4096
    v_mfma_f32_16x16x32_bf16 v[52:55], v[220:223], v[128:131], v[52:55]
    ds_read_b128 v[212:215], v3 offset:5120
    s_add_u32 m0, m0, 4096
    s_add_u32 s93, s93, 4096
    buffer_load_dwordx4 v1, s[8:11], s93 offen offset:0  lds
    s_waitcnt lgkmcnt(8)
    v_mfma_f32_16x16x32_bf16 v[56:59], v[224:227], v[128:131], v[56:59]
    ds_read_b128 v[216:219], v3 offset:6144
    s_waitcnt vmcnt(14)
    v_mfma_f32_16x16x32_bf16 v[40:43], v[228:231], v[132:135], v[40:43]
    ds_read_b128 v[220:223], v3 offset:7168
    s_waitcnt lgkmcnt(8)
    v_mfma_f32_16x16x32_bf16 v[44:47], v[232:235], v[132:135], v[44:47]
    ds_read_b128 v[224:227], v3 offset:8192
    buffer_load_dwordx4 v[172:175], v1, s[8:11], s84 offen offset:3072 sc1
    v_mfma_f32_16x16x32_bf16 v[48:51], v[236:239], v[132:135], v[48:51]
    ds_read_b128 v[228:231], v3 offset:9216
    s_waitcnt lgkmcnt(8)
    v_mfma_f32_16x16x32_bf16 v[52:55], v[240:243], v[132:135], v[52:55]
    ds_read_b128 v[232:235], v3 offset:10240
    s_add_u32 m0, s63, 61440
    s_add_u32 s93, s61, 8572928
    buffer_load_dwordx4 v1, s[8:11], s93 offen offset:0  lds
    v_mfma_f32_16x16x32_bf16 v[56:59], v[244:247], v[132:135], v[56:59]
    ds_read_b128 v[236:239], v3 offset:11264
    s_waitcnt vmcnt(15) lgkmcnt(8)
    v_mfma_f32_16x16x32_bf16 v[40:43], v[248:251], v[136:139], v[40:43]
    ds_read_b128 v[240:243], v1 offset:40960
    v_mfma_f32_16x16x32_bf16 v[44:47], v[252:255], v[136:139], v[44:47]
    ds_read_b128 v[244:247], v1 offset:41984
    s_add_u32 s84, s59, 37773312
    buffer_load_dwordx4 v[176:179], v1, s[8:11], s84 offen offset:0 sc1
    s_waitcnt lgkmcnt(8)
    v_mfma_f32_16x16x32_bf16 v[48:51], v[208:211], v[136:139], v[48:51]
    ds_read_b128 v[248:251], v1 offset:43008
    v_mfma_f32_16x16x32_bf16 v[52:55], v[212:215], v[136:139], v[52:55]
    ds_read_b128 v[252:255], v1 offset:44032
    buffer_load_dwordx4 v1, s[8:11], s93 offen offset:1024  lds
    s_waitcnt lgkmcnt(8)
    v_mfma_f32_16x16x32_bf16 v[56:59], v[216:219], v[136:139], v[56:59]
    ds_read_b128 v[208:211], v1 offset:45056
    s_waitcnt vmcnt(16)
    v_mfma_f32_16x16x32_bf16 v[40:43], v[220:223], v[140:143], v[40:43]
    ds_read_b128 v[212:215], v1 offset:46080
    s_waitcnt lgkmcnt(8)
    v_mfma_f32_16x16x32_bf16 v[44:47], v[224:227], v[140:143], v[44:47]
    ds_read_b128 v[216:219], v1 offset:47104
    buffer_load_dwordx4 v[180:183], v1, s[8:11], s84 offen offset:1024 sc1
    v_mfma_f32_16x16x32_bf16 v[48:51], v[228:231], v[140:143], v[48:51]
    ds_read_b128 v[220:223], v1 offset:48128
    s_waitcnt lgkmcnt(8)
    v_mfma_f32_16x16x32_bf16 v[52:55], v[232:235], v[140:143], v[52:55]
    ds_read_b128 v[224:227], v1 offset:49152
    buffer_load_dwordx4 v1, s[8:11], s93 offen offset:2048  lds
    v_mfma_f32_16x16x32_bf16 v[56:59], v[236:239], v[140:143], v[56:59]
    ds_read_b128 v[228:231], v1 offset:50176
    s_waitcnt vmcnt(17) lgkmcnt(8)
    v_mfma_f32_16x16x32_bf16 v[40:43], v[240:243], v[144:147], v[40:43]
    ds_read_b128 v[232:235], v1 offset:51200
    v_mfma_f32_16x16x32_bf16 v[44:47], v[244:247], v[144:147], v[44:47]
    ds_read_b128 v[236:239], v1 offset:52224
    buffer_load_dwordx4 v[184:187], v1, s[8:11], s84 offen offset:2048 sc1
    s_waitcnt lgkmcnt(8)
    v_mfma_f32_16x16x32_bf16 v[48:51], v[248:251], v[144:147], v[48:51]
    ds_read_b128 v[240:243], v1 offset:53248
    v_mfma_f32_16x16x32_bf16 v[52:55], v[252:255], v[144:147], v[52:55]
    ds_read_b128 v[244:247], v1 offset:54272
    buffer_load_dwordx4 v1, s[8:11], s93 offen offset:3072  lds
    s_waitcnt lgkmcnt(8)
    v_mfma_f32_16x16x32_bf16 v[56:59], v[208:211], v[144:147], v[56:59]
    ds_read_b128 v[248:251], v1 offset:55296
    s_waitcnt vmcnt(18)
    v_mfma_f32_16x16x32_bf16 v[40:43], v[212:215], v[148:151], v[40:43]
    ds_read_b128 v[252:255], v1 offset:56320
    s_waitcnt lgkmcnt(8)
    v_mfma_f32_16x16x32_bf16 v[44:47], v[216:219], v[148:151], v[44:47]
    ds_read_b128 v[208:211], v1 offset:57344
    buffer_load_dwordx4 v[188:191], v1, s[8:11], s84 offen offset:3072 sc1
    v_mfma_f32_16x16x32_bf16 v[48:51], v[220:223], v[148:151], v[48:51]
    ds_read_b128 v[212:215], v1 offset:58368
    s_waitcnt lgkmcnt(8)
    v_mfma_f32_16x16x32_bf16 v[52:55], v[224:227], v[148:151], v[52:55]
    ds_read_b128 v[216:219], v1 offset:59392
    s_add_u32 m0, m0, 4096
    s_add_u32 s93, s93, 4096
    buffer_load_dwordx4 v1, s[8:11], s93 offen offset:0  lds
    v_mfma_f32_16x16x32_bf16 v[56:59], v[228:231], v[148:151], v[56:59]
    ds_read_b128 v[220:223], v1 offset:60416
    s_waitcnt vmcnt(19) lgkmcnt(8)
    v_mfma_f32_16x16x32_bf16 v[40:43], v[232:235], v[152:155], v[40:43]
    s_barrier
    ds_read_b128 v[224:227], v2 offset:36864
    v_mfma_f32_16x16x32_bf16 v[44:47], v[236:239], v[152:155], v[44:47]
    ds_read_b128 v[228:231], v2 offset:37888
    s_add_u32 s84, s59, 37777408
    buffer_load_dwordx4 v[192:195], v1, s[8:11], s84 offen offset:0 sc1
    s_waitcnt lgkmcnt(8)
    v_mfma_f32_16x16x32_bf16 v[48:51], v[240:243], v[152:155], v[48:51]
    ds_read_b128 v[232:235], v2 offset:38912
    v_mfma_f32_16x16x32_bf16 v[52:55], v[244:247], v[152:155], v[52:55]
    ds_read_b128 v[236:239], v2 offset:39936
    s_add_u32 m0, s63, 20480
    s_add_u32 s93, s61, 8593408
    buffer_load_dwordx4 v1, s[8:11], s93 offen offset:0  lds
    s_waitcnt lgkmcnt(8)
    v_mfma_f32_16x16x32_bf16 v[56:59], v[248:251], v[152:155], v[56:59]
    ds_read_b128 v[240:243], v2 offset:40960
    s_waitcnt vmcnt(19)
    v_mfma_f32_16x16x32_bf16 v[40:43], v[252:255], v[156:159], v[40:43]
    ds_read_b128 v[244:247], v2 offset:41984
    s_waitcnt lgkmcnt(8)
    v_mfma_f32_16x16x32_bf16 v[44:47], v[208:211], v[156:159], v[44:47]
    ds_read_b128 v[248:251], v2 offset:43008
    buffer_load_dwordx4 v[196:199], v1, s[8:11], s84 offen offset:1024 sc1
    v_mfma_f32_16x16x32_bf16 v[48:51], v[212:215], v[156:159], v[48:51]
    ds_read_b128 v[252:255], v2 offset:44032
    s_waitcnt lgkmcnt(8)
    v_mfma_f32_16x16x32_bf16 v[52:55], v[216:219], v[156:159], v[52:55]
    ds_read_b128 v[208:211], v2 offset:45056
    buffer_load_dwordx4 v1, s[8:11], s93 offen offset:1024  lds
    v_mfma_f32_16x16x32_bf16 v[56:59], v[220:223], v[156:159], v[56:59]
    ds_read_b128 v[212:215], v2 offset:46080
    s_waitcnt vmcnt(19) lgkmcnt(8)
    v_mfma_f32_16x16x32_bf16 v[40:43], v[224:227], v[160:163], v[40:43]
    ds_read_b128 v[216:219], v2 offset:47104
    v_mfma_f32_16x16x32_bf16 v[44:47], v[228:231], v[160:163], v[44:47]
    ds_read_b128 v[220:223], v2 offset:48128
    buffer_load_dwordx4 v[200:203], v1, s[8:11], s84 offen offset:2048 sc1
    s_waitcnt lgkmcnt(8)
    v_mfma_f32_16x16x32_bf16 v[48:51], v[232:235], v[160:163], v[48:51]
    ds_read_b128 v[224:227], v2 offset:49152
    v_mfma_f32_16x16x32_bf16 v[52:55], v[236:239], v[160:163], v[52:55]
    ds_read_b128 v[228:231], v2 offset:50176
    buffer_load_dwordx4 v1, s[8:11], s93 offen offset:2048  lds
    s_waitcnt lgkmcnt(8)
    v_mfma_f32_16x16x32_bf16 v[56:59], v[240:243], v[160:163], v[56:59]
    ds_read_b128 v[232:235], v2 offset:51200
    s_waitcnt vmcnt(19)
    v_mfma_f32_16x16x32_bf16 v[40:43], v[244:247], v[164:167], v[40:43]
    ds_read_b128 v[236:239], v2 offset:52224
    s_waitcnt lgkmcnt(8)
    v_mfma_f32_16x16x32_bf16 v[44:47], v[248:251], v[164:167], v[44:47]
    ds_read_b128 v[240:243], v2 offset:53248
    buffer_load_dwordx4 v[204:207], v1, s[8:11], s84 offen offset:3072 sc1
    v_mfma_f32_16x16x32_bf16 v[48:51], v[252:255], v[164:167], v[48:51]
    ds_read_b128 v[244:247], v2 offset:54272
    s_waitcnt lgkmcnt(8)
    v_mfma_f32_16x16x32_bf16 v[52:55], v[208:211], v[164:167], v[52:55]
    ds_read_b128 v[248:251], v2 offset:55296
    buffer_load_dwordx4 v1, s[8:11], s93 offen offset:3072  lds
    v_mfma_f32_16x16x32_bf16 v[56:59], v[212:215], v[164:167], v[56:59]
    ds_read_b128 v[252:255], v2 offset:56320
    s_waitcnt vmcnt(19) lgkmcnt(8)
    v_mfma_f32_16x16x32_bf16 v[40:43], v[216:219], v[168:171], v[40:43]
    ds_read_b128 v[208:211], v3 offset:12288
    v_mfma_f32_16x16x32_bf16 v[44:47], v[220:223], v[168:171], v[44:47]
    ds_read_b128 v[212:215], v3 offset:13312
    s_add_u32 s84, s59, 37781504
    buffer_load_dwordx4 v[80:83], v1, s[8:11], s84 offen offset:0 sc1
    s_waitcnt lgkmcnt(8)
    v_mfma_f32_16x16x32_bf16 v[48:51], v[224:227], v[168:171], v[48:51]
    ds_read_b128 v[216:219], v3 offset:14336
    v_mfma_f32_16x16x32_bf16 v[52:55], v[228:231], v[168:171], v[52:55]
    ds_read_b128 v[220:223], v3 offset:15360
    s_add_u32 m0, m0, 4096
    s_add_u32 s93, s93, 4096
    buffer_load_dwordx4 v1, s[8:11], s93 offen offset:0  lds
    s_waitcnt lgkmcnt(8)
    v_mfma_f32_16x16x32_bf16 v[56:59], v[232:235], v[168:171], v[56:59]
    ds_read_b128 v[224:227], v3 offset:16384
    s_waitcnt vmcnt(19)
    v_mfma_f32_16x16x32_bf16 v[40:43], v[236:239], v[172:175], v[40:43]
    ds_read_b128 v[228:231], v3 offset:17408
    s_waitcnt lgkmcnt(8)
    v_mfma_f32_16x16x32_bf16 v[44:47], v[240:243], v[172:175], v[44:47]
    ds_read_b128 v[232:235], v3 offset:18432
    buffer_load_dwordx4 v[84:87], v1, s[8:11], s84 offen offset:1024 sc1
    v_mfma_f32_16x16x32_bf16 v[48:51], v[244:247], v[172:175], v[48:51]
    ds_read_b128 v[236:239], v3 offset:19456
    s_waitcnt lgkmcnt(8)
    v_mfma_f32_16x16x32_bf16 v[52:55], v[248:251], v[172:175], v[52:55]
    ds_read_b128 v[240:243], v3 offset:20480
    s_add_u32 m0, s63, 122880
    s_add_u32 s93, s61, 8613888
    buffer_load_dwordx4 v1, s[8:11], s93 offen offset:0  lds
    v_mfma_f32_16x16x32_bf16 v[56:59], v[252:255], v[172:175], v[56:59]
    ds_read_b128 v[244:247], v3 offset:21504
    s_waitcnt vmcnt(19) lgkmcnt(8)
    v_mfma_f32_16x16x32_bf16 v[40:43], v[208:211], v[176:179], v[40:43]
    ds_read_b128 v[248:251], v3 offset:22528
    v_mfma_f32_16x16x32_bf16 v[44:47], v[212:215], v[176:179], v[44:47]
    ds_read_b128 v[252:255], v3 offset:23552
    buffer_load_dwordx4 v[88:91], v1, s[8:11], s84 offen offset:2048 sc1
    s_waitcnt lgkmcnt(8)
    v_mfma_f32_16x16x32_bf16 v[48:51], v[216:219], v[176:179], v[48:51]
    ds_read_b128 v[208:211], v3 offset:24576
    v_mfma_f32_16x16x32_bf16 v[52:55], v[220:223], v[176:179], v[52:55]
    ds_read_b128 v[212:215], v3 offset:25600
    buffer_load_dwordx4 v1, s[8:11], s93 offen offset:1024  lds
    s_waitcnt lgkmcnt(8)
    v_mfma_f32_16x16x32_bf16 v[56:59], v[224:227], v[176:179], v[56:59]
    ds_read_b128 v[216:219], v3 offset:26624
    s_waitcnt vmcnt(19)
    v_mfma_f32_16x16x32_bf16 v[40:43], v[228:231], v[180:183], v[40:43]
    ds_read_b128 v[220:223], v3 offset:27648
    s_waitcnt lgkmcnt(8)
    v_mfma_f32_16x16x32_bf16 v[44:47], v[232:235], v[180:183], v[44:47]
    ds_read_b128 v[224:227], v3 offset:28672
    buffer_load_dwordx4 v[92:95], v1, s[8:11], s84 offen offset:3072 sc1
    v_mfma_f32_16x16x32_bf16 v[48:51], v[236:239], v[180:183], v[48:51]
    ds_read_b128 v[228:231], v3 offset:29696
    s_waitcnt lgkmcnt(8)
    v_mfma_f32_16x16x32_bf16 v[52:55], v[240:243], v[180:183], v[52:55]
    ds_read_b128 v[232:235], v3 offset:30720
    buffer_load_dwordx4 v1, s[8:11], s93 offen offset:2048  lds
    v_mfma_f32_16x16x32_bf16 v[56:59], v[244:247], v[180:183], v[56:59]
    ds_read_b128 v[236:239], v3 offset:31744
    s_waitcnt vmcnt(19) lgkmcnt(8)
    v_mfma_f32_16x16x32_bf16 v[40:43], v[248:251], v[184:187], v[40:43]
    ds_read_b128 v[240:243], v1 offset:0
    v_mfma_f32_16x16x32_bf16 v[44:47], v[252:255], v[184:187], v[44:47]
    ds_read_b128 v[244:247], v1 offset:1024
    s_add_u32 s84, s59, 37785600
    buffer_load_dwordx4 v[96:99], v1, s[8:11], s84 offen offset:0 sc1
    s_waitcnt lgkmcnt(8)
    v_mfma_f32_16x16x32_bf16 v[48:51], v[208:211], v[184:187], v[48:51]
    ds_read_b128 v[248:251], v1 offset:2048
    v_mfma_f32_16x16x32_bf16 v[52:55], v[212:215], v[184:187], v[52:55]
    ds_read_b128 v[252:255], v1 offset:3072
    buffer_load_dwordx4 v1, s[8:11], s93 offen offset:3072  lds
    s_waitcnt lgkmcnt(8)
    v_mfma_f32_16x16x32_bf16 v[56:59], v[216:219], v[184:187], v[56:59]
    ds_read_b128 v[208:211], v1 offset:4096
    s_waitcnt vmcnt(19)
    v_mfma_f32_16x16x32_bf16 v[40:43], v[220:223], v[188:191], v[40:43]
    ds_read_b128 v[212:215], v1 offset:5120
    s_waitcnt lgkmcnt(8)
    v_mfma_f32_16x16x32_bf16 v[44:47], v[224:227], v[188:191], v[44:47]
    ds_read_b128 v[216:219], v1 offset:6144
    buffer_load_dwordx4 v[100:103], v1, s[8:11], s84 offen offset:1024 sc1
    v_mfma_f32_16x16x32_bf16 v[48:51], v[228:231], v[188:191], v[48:51]
    ds_read_b128 v[220:223], v1 offset:7168
    s_waitcnt lgkmcnt(8)
    v_mfma_f32_16x16x32_bf16 v[52:55], v[232:235], v[188:191], v[52:55]
    ds_read_b128 v[224:227], v1 offset:8192
    s_add_u32 m0, m0, 4096
    s_add_u32 s93, s93, 4096
    buffer_load_dwordx4 v1, s[8:11], s93 offen offset:0  lds
    v_mfma_f32_16x16x32_bf16 v[56:59], v[236:239], v[188:191], v[56:59]
    ds_read_b128 v[228:231], v1 offset:9216
    s_waitcnt vmcnt(19) lgkmcnt(8)
    v_mfma_f32_16x16x32_bf16 v[40:43], v[240:243], v[192:195], v[40:43]
    ds_read_b128 v[232:235], v1 offset:10240
    v_mfma_f32_16x16x32_bf16 v[44:47], v[244:247], v[192:195], v[44:47]
    ds_read_b128 v[236:239], v1 offset:11264
    buffer_load_dwordx4 v[104:107], v1, s[8:11], s84 offen offset:2048 sc1
    s_waitcnt lgkmcnt(8)
    v_mfma_f32_16x16x32_bf16 v[48:51], v[248:251], v[192:195], v[48:51]
    ds_read_b128 v[240:243], v1 offset:12288
    v_mfma_f32_16x16x32_bf16 v[52:55], v[252:255], v[192:195], v[52:55]
    ds_read_b128 v[244:247], v1 offset:13312
    s_waitcnt lgkmcnt(8)
    v_mfma_f32_16x16x32_bf16 v[56:59], v[208:211], v[192:195], v[56:59]
    ds_read_b128 v[248:251], v1 offset:14336
    s_waitcnt vmcnt(18)
    v_mfma_f32_16x16x32_bf16 v[40:43], v[212:215], v[196:199], v[40:43]
    ds_read_b128 v[252:255], v1 offset:15360
    s_waitcnt lgkmcnt(8)
    v_mfma_f32_16x16x32_bf16 v[44:47], v[216:219], v[196:199], v[44:47]
    ds_read_b128 v[208:211], v1 offset:16384
    buffer_load_dwordx4 v[108:111], v1, s[8:11], s84 offen offset:3072 sc1
    v_mfma_f32_16x16x32_bf16 v[48:51], v[220:223], v[196:199], v[48:51]
    ds_read_b128 v[212:215], v1 offset:17408
    s_waitcnt lgkmcnt(8)
    v_mfma_f32_16x16x32_bf16 v[52:55], v[224:227], v[196:199], v[52:55]
    ds_read_b128 v[216:219], v1 offset:18432
    v_mfma_f32_16x16x32_bf16 v[56:59], v[228:231], v[196:199], v[56:59]
    s_barrier
    ds_read_b128 v[220:223], v1 offset:19456
    s_waitcnt vmcnt(17) lgkmcnt(8)
    v_mfma_f32_16x16x32_bf16 v[40:43], v[232:235], v[200:203], v[40:43]
    ds_read_b128 v[224:227], v2 offset:16384
    v_mfma_f32_16x16x32_bf16 v[44:47], v[236:239], v[200:203], v[44:47]
    ds_read_b128 v[228:231], v2 offset:17408
    s_add_u32 s84, s59, 37789696
    buffer_load_dwordx4 v[112:115], v1, s[8:11], s84 offen offset:0 sc1
    s_waitcnt lgkmcnt(8)
    v_mfma_f32_16x16x32_bf16 v[48:51], v[240:243], v[200:203], v[48:51]
    ds_read_b128 v[232:235], v2 offset:18432
    v_mfma_f32_16x16x32_bf16 v[52:55], v[244:247], v[200:203], v[52:55]
    ds_read_b128 v[236:239], v2 offset:19456
    s_waitcnt lgkmcnt(8)
    v_mfma_f32_16x16x32_bf16 v[56:59], v[248:251], v[200:203], v[56:59]
    ds_read_b128 v[240:243], v2 offset:20480
    s_waitcnt vmcnt(16)
    v_mfma_f32_16x16x32_bf16 v[40:43], v[252:255], v[204:207], v[40:43]
    ds_read_b128 v[244:247], v2 offset:21504
    s_waitcnt lgkmcnt(8)
    v_mfma_f32_16x16x32_bf16 v[44:47], v[208:211], v[204:207], v[44:47]
    ds_read_b128 v[248:251], v2 offset:22528
    buffer_load_dwordx4 v[116:119], v1, s[8:11], s84 offen offset:1024 sc1
    v_mfma_f32_16x16x32_bf16 v[48:51], v[212:215], v[204:207], v[48:51]
    ds_read_b128 v[252:255], v2 offset:23552
    s_waitcnt lgkmcnt(8)
    v_mfma_f32_16x16x32_bf16 v[52:55], v[216:219], v[204:207], v[52:55]
    ds_read_b128 v[208:211], v2 offset:24576
    v_mfma_f32_16x16x32_bf16 v[56:59], v[220:223], v[204:207], v[56:59]
    ds_read_b128 v[212:215], v2 offset:25600
    s_waitcnt vmcnt(15) lgkmcnt(8)
    v_mfma_f32_16x16x32_bf16 v[40:43], v[224:227], v[80:83], v[40:43]
    ds_read_b128 v[216:219], v2 offset:26624
    v_mfma_f32_16x16x32_bf16 v[44:47], v[228:231], v[80:83], v[44:47]
    ds_read_b128 v[220:223], v2 offset:27648
    buffer_load_dwordx4 v[120:123], v1, s[8:11], s84 offen offset:2048 sc1
    s_waitcnt lgkmcnt(8)
    v_mfma_f32_16x16x32_bf16 v[48:51], v[232:235], v[80:83], v[48:51]
    ds_read_b128 v[224:227], v2 offset:28672
    v_mfma_f32_16x16x32_bf16 v[52:55], v[236:239], v[80:83], v[52:55]
    ds_read_b128 v[228:231], v2 offset:29696
    s_waitcnt lgkmcnt(8)
    v_mfma_f32_16x16x32_bf16 v[56:59], v[240:243], v[80:83], v[56:59]
    ds_read_b128 v[232:235], v2 offset:30720
    s_waitcnt vmcnt(14)
    v_mfma_f32_16x16x32_bf16 v[40:43], v[244:247], v[84:87], v[40:43]
    ds_read_b128 v[236:239], v2 offset:31744
    s_waitcnt lgkmcnt(8)
    v_mfma_f32_16x16x32_bf16 v[44:47], v[248:251], v[84:87], v[44:47]
    ds_read_b128 v[240:243], v2 offset:32768
    buffer_load_dwordx4 v[124:127], v1, s[8:11], s84 offen offset:3072 sc1
    v_mfma_f32_16x16x32_bf16 v[48:51], v[252:255], v[84:87], v[48:51]
    ds_read_b128 v[244:247], v2 offset:33792
    s_waitcnt lgkmcnt(8)
    v_mfma_f32_16x16x32_bf16 v[52:55], v[208:211], v[84:87], v[52:55]
    ds_read_b128 v[248:251], v2 offset:34816
    v_mfma_f32_16x16x32_bf16 v[56:59], v[212:215], v[84:87], v[56:59]
    ds_read_b128 v[252:255], v2 offset:35840
    s_waitcnt vmcnt(13) lgkmcnt(8)
    v_mfma_f32_16x16x32_bf16 v[40:43], v[216:219], v[88:91], v[40:43]
    ds_read_b128 v[208:211], v1 offset:61440
    v_mfma_f32_16x16x32_bf16 v[44:47], v[220:223], v[88:91], v[44:47]
    ds_read_b128 v[212:215], v1 offset:62464
    s_add_u32 s84, s59, 37793792
    buffer_load_dwordx4 v[128:131], v1, s[8:11], s84 offen offset:0 sc1
    s_waitcnt lgkmcnt(8)
    v_mfma_f32_16x16x32_bf16 v[48:51], v[224:227], v[88:91], v[48:51]
    ds_read_b128 v[216:219], v1 offset:63488
    v_mfma_f32_16x16x32_bf16 v[52:55], v[228:231], v[88:91], v[52:55]
    ds_read_b128 v[220:223], v1 offset:64512
    s_waitcnt lgkmcnt(8)
    v_mfma_f32_16x16x32_bf16 v[56:59], v[232:235], v[88:91], v[56:59]
    ds_read_b128 v[224:227], v2 offset:0
    s_waitcnt vmcnt(12)
    v_mfma_f32_16x16x32_bf16 v[40:43], v[236:239], v[92:95], v[40:43]
    ds_read_b128 v[228:231], v2 offset:1024
    s_waitcnt lgkmcnt(8)
    v_mfma_f32_16x16x32_bf16 v[44:47], v[240:243], v[92:95], v[44:47]
    ds_read_b128 v[232:235], v2 offset:2048
    buffer_load_dwordx4 v[132:135], v1, s[8:11], s84 offen offset:1024 sc1
    v_mfma_f32_16x16x32_bf16 v[48:51], v[244:247], v[92:95], v[48:51]
    ds_read_b128 v[236:239], v2 offset:3072
    s_waitcnt lgkmcnt(8)
    v_mfma_f32_16x16x32_bf16 v[52:55], v[248:251], v[92:95], v[52:55]
    ds_read_b128 v[240:243], v2 offset:4096
    v_mfma_f32_16x16x32_bf16 v[56:59], v[252:255], v[92:95], v[56:59]
    ds_read_b128 v[244:247], v2 offset:5120
    s_waitcnt vmcnt(11) lgkmcnt(8)
    v_mfma_f32_16x16x32_bf16 v[40:43], v[208:211], v[96:99], v[40:43]
    ds_read_b128 v[248:251], v2 offset:6144
    v_mfma_f32_16x16x32_bf16 v[44:47], v[212:215], v[96:99], v[44:47]
    ds_read_b128 v[252:255], v2 offset:7168
    buffer_load_dwordx4 v[136:139], v1, s[8:11], s84 offen offset:2048 sc1
    s_waitcnt lgkmcnt(8)
    v_mfma_f32_16x16x32_bf16 v[48:51], v[216:219], v[96:99], v[48:51]
    ds_read_b128 v[208:211], v2 offset:8192
    v_mfma_f32_16x16x32_bf16 v[52:55], v[220:223], v[96:99], v[52:55]
    ds_read_b128 v[212:215], v2 offset:9216
    s_waitcnt lgkmcnt(8)
    v_mfma_f32_16x16x32_bf16 v[56:59], v[224:227], v[96:99], v[56:59]
    ds_read_b128 v[216:219], v2 offset:10240
    s_waitcnt vmcnt(10)
    v_mfma_f32_16x16x32_bf16 v[40:43], v[228:231], v[100:103], v[40:43]
    ds_read_b128 v[220:223], v2 offset:11264
    s_waitcnt lgkmcnt(8)
    v_mfma_f32_16x16x32_bf16 v[44:47], v[232:235], v[100:103], v[44:47]
    ds_read_b128 v[224:227], v2 offset:12288
    buffer_load_dwordx4 v[140:143], v1, s[8:11], s84 offen offset:3072 sc1
    v_mfma_f32_16x16x32_bf16 v[48:51], v[236:239], v[100:103], v[48:51]
    ds_read_b128 v[228:231], v2 offset:13312
    s_waitcnt lgkmcnt(8)
    v_mfma_f32_16x16x32_bf16 v[52:55], v[240:243], v[100:103], v[52:55]
    ds_read_b128 v[232:235], v2 offset:14336
    v_mfma_f32_16x16x32_bf16 v[56:59], v[244:247], v[100:103], v[56:59]
    s_waitcnt vmcnt(10)
    s_barrier
    ds_read_b128 v[236:239], v2 offset:15360
    s_waitcnt vmcnt(9) lgkmcnt(8)
    v_mfma_f32_16x16x32_bf16 v[40:43], v[248:251], v[104:107], v[40:43]
    ds_read_b128 v[240:243], v1 offset:20480
    v_mfma_f32_16x16x32_bf16 v[44:47], v[252:255], v[104:107], v[44:47]
    ds_read_b128 v[244:247], v1 offset:21504
    s_waitcnt lgkmcnt(8)
    v_mfma_f32_16x16x32_bf16 v[48:51], v[208:211], v[104:107], v[48:51]
    ds_read_b128 v[248:251], v1 offset:22528
    v_mfma_f32_16x16x32_bf16 v[52:55], v[212:215], v[104:107], v[52:55]
    ds_read_b128 v[252:255], v1 offset:23552
    s_waitcnt lgkmcnt(8)
    v_mfma_f32_16x16x32_bf16 v[56:59], v[216:219], v[104:107], v[56:59]
    ds_read_b128 v[208:211], v1 offset:24576
    s_waitcnt vmcnt(8)
    v_mfma_f32_16x16x32_bf16 v[40:43], v[220:223], v[108:111], v[40:43]
    ds_read_b128 v[212:215], v1 offset:25600
    s_getpc_b64 s[4:5]
PCL_52:
    s_lshl_b32 s6, s45, 2
    s_add_u32 s6, s6, s49
    s_and_b32 s6, s6, 31
    s_lshl_b32 s6, s6, 10
    v_add_u32 v19, s6, v1
    v_min_u32 v19, CODE_END-PCL_52-16, v19
    global_load_dword a253, v19, s[4:5]
    s_waitcnt lgkmcnt(8)
    v_mfma_f32_16x16x32_bf16 v[44:47], v[224:227], v[108:111], v[44:47]
    ds_read_b128 v[216:219], v1 offset:26624
    v_mfma_f32_16x16x32_bf16 v[48:51], v[228:231], v[108:111], v[48:51]
    ds_read_b128 v[220:223], v1 offset:27648
    s_waitcnt lgkmcnt(8)
    v_mfma_f32_16x16x32_bf16 v[52:55], v[232:235], v[108:111], v[52:55]
    ds_read_b128 v[224:227], v1 offset:28672
    v_mfma_f32_16x16x32_bf16 v[56:59], v[236:239], v[108:111], v[56:59]
    ds_read_b128 v[228:231], v1 offset:29696
    s_waitcnt vmcnt(8) lgkmcnt(8)
    v_mfma_f32_16x16x32_bf16 v[40:43], v[240:243], v[112:115], v[40:43]
    ds_read_b128 v[232:235], v1 offset:30720
    v_mfma_f32_16x16x32_bf16 v[44:47], v[244:247], v[112:115], v[44:47]
    ds_read_b128 v[236:239], v1 offset:31744
    s_waitcnt lgkmcnt(8)
    v_mfma_f32_16x16x32_bf16 v[48:51], v[248:251], v[112:115], v[48:51]
    ds_read_b128 v[240:243], v1 offset:32768
    v_mfma_f32_16x16x32_bf16 v[52:55], v[252:255], v[112:115], v[52:55]
    ds_read_b128 v[244:247], v1 offset:33792
    s_waitcnt lgkmcnt(8)
    v_mfma_f32_16x16x32_bf16 v[56:59], v[208:211], v[112:115], v[56:59]
    ds_read_b128 v[248:251], v1 offset:34816
    s_waitcnt vmcnt(7)
    v_mfma_f32_16x16x32_bf16 v[40:43], v[212:215], v[116:119], v[40:43]
    ds_read_b128 v[252:255], v1 offset:35840
    s_waitcnt lgkmcnt(8)
    v_mfma_f32_16x16x32_bf16 v[44:47], v[216:219], v[116:119], v[44:47]
    ds_read_b128 v[208:211], v1 offset:36864
    v_mfma_f32_16x16x32_bf16 v[48:51], v[220:223], v[116:119], v[48:51]
    ds_read_b128 v[212:215], v1 offset:37888
    s_waitcnt lgkmcnt(8)
    v_mfma_f32_16x16x32_bf16 v[52:55], v[224:227], v[116:119], v[52:55]
    ds_read_b128 v[216:219], v1 offset:38912
    v_mfma_f32_16x16x32_bf16 v[56:59], v[228:231], v[116:119], v[56:59]
    ds_read_b128 v[220:223], v1 offset:39936
    s_waitcnt vmcnt(6) lgkmcnt(8)
    v_mfma_f32_16x16x32_bf16 v[40:43], v[232:235], v[120:123], v[40:43]
    ds_read_b128 v[224:227], v2 offset:57344
    v_mfma_f32_16x16x32_bf16 v[44:47], v[236:239], v[120:123], v[44:47]
    ds_read_b128 v[228:231], v2 offset:58368
    s_waitcnt lgkmcnt(8)
    v_mfma_f32_16x16x32_bf16 v[48:51], v[240:243], v[120:123], v[48:51]
    ds_read_b128 v[232:235], v2 offset:59392
    v_mfma_f32_16x16x32_bf16 v[52:55], v[244:247], v[120:123], v[52:55]
    ds_read_b128 v[236:239], v2 offset:60416
    s_waitcnt lgkmcnt(8)
    v_mfma_f32_16x16x32_bf16 v[56:59], v[248:251], v[120:123], v[56:59]
    ds_read_b128 v[240:243], v2 offset:61440
    s_waitcnt vmcnt(5)
    v_mfma_f32_16x16x32_bf16 v[40:43], v[252:255], v[124:127], v[40:43]
    ds_read_b128 v[244:247], v2 offset:62464
    s_waitcnt lgkmcnt(8)
    v_mfma_f32_16x16x32_bf16 v[44:47], v[208:211], v[124:127], v[44:47]
    ds_read_b128 v[248:251], v2 offset:63488
    v_mfma_f32_16x16x32_bf16 v[48:51], v[212:215], v[124:127], v[48:51]
    ds_read_b128 v[252:255], v2 offset:64512
    s_waitcnt lgkmcnt(8)
    v_mfma_f32_16x16x32_bf16 v[52:55], v[216:219], v[124:127], v[52:55]
    ds_read_b128 v[208:211], v3 offset:0
    v_mfma_f32_16x16x32_bf16 v[56:59], v[220:223], v[124:127], v[56:59]
    ds_read_b128 v[212:215], v3 offset:1024
    s_waitcnt vmcnt(4) lgkmcnt(8)
    v_mfma_f32_16x16x32_bf16 v[40:43], v[224:227], v[128:131], v[40:43]
    ds_read_b128 v[216:219], v3 offset:2048
    v_mfma_f32_16x16x32_bf16 v[44:47], v[228:231], v[128:131], v[44:47]
    ds_read_b128 v[220:223], v3 offset:3072
    s_waitcnt lgkmcnt(8)
    v_mfma_f32_16x16x32_bf16 v[48:51], v[232:235], v[128:131], v[48:51]
    ds_read_b128 v[224:227], v3 offset:4096
    v_mfma_f32_16x16x32_bf16 v[52:55], v[236:239], v[128:131], v[52:55]
    ds_read_b128 v[228:231], v3 offset:5120
    s_waitcnt lgkmcnt(8)
    v_mfma_f32_16x16x32_bf16 v[56:59], v[240:243], v[128:131], v[56:59]
    ds_read_b128 v[232:235], v3 offset:6144
    s_waitcnt vmcnt(3)
    v_mfma_f32_16x16x32_bf16 v[40:43], v[244:247], v[132:135], v[40:43]
    ds_read_b128 v[236:239], v3 offset:7168
    s_waitcnt lgkmcnt(8)
    v_mfma_f32_16x16x32_bf16 v[44:47], v[248:251], v[132:135], v[44:47]
    ds_read_b128 v[240:243], v3 offset:8192
    v_mfma_f32_16x16x32_bf16 v[48:51], v[252:255], v[132:135], v[48:51]
    ds_read_b128 v[244:247], v3 offset:9216
    s_waitcnt lgkmcnt(8)
    v_mfma_f32_16x16x32_bf16 v[52:55], v[208:211], v[132:135], v[52:55]
    ds_read_b128 v[248:251], v3 offset:10240
    v_mfma_f32_16x16x32_bf16 v[56:59], v[212:215], v[132:135], v[56:59]
    ds_read_b128 v[252:255], v3 offset:11264
    s_waitcnt vmcnt(2) lgkmcnt(8)
    v_mfma_f32_16x16x32_bf16 v[40:43], v[216:219], v[136:139], v[40:43]
    v_mfma_f32_16x16x32_bf16 v[44:47], v[220:223], v[136:139], v[44:47]
    s_waitcnt lgkmcnt(6)
    v_mfma_f32_16x16x32_bf16 v[48:51], v[224:227], v[136:139], v[48:51]
    v_mfma_f32_16x16x32_bf16 v[52:55], v[228:231], v[136:139], v[52:55]
    s_waitcnt lgkmcnt(4)
    v_mfma_f32_16x16x32_bf16 v[56:59], v[232:235], v[136:139], v[56:59]
    s_waitcnt vmcnt(1)
    v_mfma_f32_16x16x32_bf16 v[40:43], v[236:239], v[140:143], v[40:43]
    s_waitcnt lgkmcnt(2)
    v_mfma_f32_16x16x32_bf16 v[44:47], v[240:243], v[140:143], v[44:47]
    v_mfma_f32_16x16x32_bf16 v[48:51], v[244:247], v[140:143], v[48:51]
    s_waitcnt lgkmcnt(0)
    v_mfma_f32_16x16x32_bf16 v[52:55], v[248:251], v[140:143], v[52:55]
    v_mfma_f32_16x16x32_bf16 v[56:59], v[252:255], v[140:143], v[56:59]
    s_nop 1
    v_cvt_pk_bf16_f32 v60, v40, v41
    v_cvt_pk_bf16_f32 v61, v42, v43
    v_cvt_pk_bf16_f32 v62, v44, v45
    v_cvt_pk_bf16_f32 v63, v46, v47
    v_cvt_pk_bf16_f32 v64, v48, v49
    v_cvt_pk_bf16_f32 v65, v50, v51
    v_cvt_pk_bf16_f32 v66, v52, v53
    v_cvt_pk_bf16_f32 v67, v54, v55
    v_cvt_pk_bf16_f32 v68, v56, v57
    v_cvt_pk_bf16_f32 v69, v58, v59
    v_and_b32 v20, 15, v0
    v_lshrrev_b32 v21, 4, v0
    v_mul_u32_u24 v26, 1280, v20
    v_lshl_add_u32 v27, v21, 4, v26
    v_lshl_add_u32 v28, v21, 3, v26
    buffer_store_dwordx4 v[60:63], v27, s[16:19], s64 offen
    buffer_store_dwordx4 v[64:67], v27, s[16:19], s64 offen offset:64
    buffer_store_dwordx2 v[68:69], v28, s[16:19], s65 offen
    s_waitcnt vmcnt(0) lgkmcnt(0)
KEND:
    s_endpgm
KVPOLL_3:
    s_sub_u32 s92, s92, 1
    s_cbranch_scc0 KVPOLL_3_go
    s_mov_b32 s67, 0
    s_branch KVDONE_4
KVPOLL_3_go:
    v_max_u32 v24, v64, v65
    s_add_u32 s85, s72, 0
    v_cmp_eq_u32 vcc, -1, v24
    s_nop 0
    s_mov_b64 exec, vcc
    s_cbranch_execz KVPOLL_3_s0
    buffer_load_dwordx2 v[64:65], v57, s[8:11], s85 offen sc1
KVPOLL_3_s0:
    s_mov_b64 exec, -1
    v_max_u32 v24, v66, v67
    s_add_u32 s85, s72, 8192
    v_cmp_eq_u32 vcc, -1, v24
    s_nop 0
    s_mov_b64 exec, vcc
    s_cbranch_execz KVPOLL_3_s1
    buffer_load_dwordx2 v[66:67], v57, s[8:11], s85 offen sc1
KVPOLL_3_s1:
    s_mov_b64 exec, -1
    v_max_u32 v24, v68, v69
    s_add_u32 s85, s72, 16384
    v_cmp_eq_u32 vcc, -1, v24
    s_nop 0
    s_mov_b64 exec, vcc
    s_cbranch_execz KVPOLL_3_s2
    buffer_load_dwordx2 v[68:69], v57, s[8:11], s85 offen sc1
KVPOLL_3_s2:
    s_mov_b64 exec, -1
    v_max_u32 v24, v70, v71
    s_add_u32 s85, s72, 24576
    v_cmp_eq_u32 vcc, -1, v24
    s_nop 0
    s_mov_b64 exec, vcc
    s_cbranch_execz KVPOLL_3_s3
    buffer_load_dwordx2 v[70:71], v57, s[8:11], s85 offen sc1
KVPOLL_3_s3:
    s_mov_b64 exec, -1
    v_max_u32 v24, v72, v73
    s_add_u32 s85, s72, 32768
    v_cmp_eq_u32 vcc, -1, v24
    s_nop 0
    s_mov_b64 exec, vcc
    s_cbranch_execz KVPOLL_3_s4
    buffer_load_dwordx2 v[72:73], v57, s[8:11], s85 offen sc1
KVPOLL_3_s4:
    s_mov_b64 exec, -1
    v_max_u32 v24, v74, v75
    s_add_u32 s85, s72, 40960
    v_cmp_eq_u32 vcc, -1, v24
    s_nop 0
    s_mov_b64 exec, vcc
    s_cbranch_execz KVPOLL_3_s5
    buffer_load_dwordx2 v[74:75], v57, s[8:11], s85 offen sc1
KVPOLL_3_s5:
    s_mov_b64 exec, -1
    v_max_u32 v24, v76, v77
    s_add_u32 s85, s72, 49152
    v_cmp_eq_u32 vcc, -1, v24
    s_nop 0
    s_mov_b64 exec, vcc
    s_cbranch_execz KVPOLL_3_s6
    buffer_load_dwordx2 v[76:77], v57, s[8:11], s85 offen sc1
KVPOLL_3_s6:
    s_mov_b64 exec, -1
    v_max_u32 v24, v78, v79
    s_add_u32 s85, s72, 57344
    v_cmp_eq_u32 vcc, -1, v24
    s_nop 0
    s_mov_b64 exec, vcc
    s_cbranch_execz KVPOLL_3_s7
    buffer_load_dwordx2 v[78:79], v57, s[8:11], s85 offen sc1
KVPOLL_3_s7:
    s_mov_b64 exec, -1
    s_waitcnt vmcnt(0)
    s_branch KVCHK_5
POLL_6:
    s_mov_b32 s92, s67
POLL_6_l:
    buffer_load_dword v7, v6, s[8:11], s85 offen sc1
    s_waitcnt vmcnt(0)
    v_cmp_le_u32 vcc, 1, v7
    s_nop 0
    s_cmp_eq_u64 vcc, -1
    s_cbranch_scc1 PDONE_7
    s_sub_u32 s92, s92, 1
    s_cbranch_scc0 POLL_6_l
    s_mov_b32 s67, 0
    s_branch PDONE_7
POLL_11:
    s_mov_b32 s92, s67
POLL_11_l:
    buffer_load_dword v7, v168, s[8:11], s85 offen sc1
    s_waitcnt vmcnt(0)
    v_cmp_le_u32 vcc, 1, v7
    s_nop 0
    s_cmp_eq_u64 vcc, -1
    s_cbranch_scc1 PDONE_12
    s_sub_u32 s92, s92, 1
    s_cbranch_scc0 POLL_11_l
    s_mov_b32 s67, 0
    s_branch PDONE_12
STR_13:
    s_mov_b32 s92, s67
STR_13_l:
    s_nop 7
    s_nop 7
    s_add_u32 s7, s55, 18894848
    buffer_load_dwordx4 v[172:175], v1, s[8:11], s7 offen sc1
    s_waitcnt vmcnt(0)
    v_or3_b32 v76, v172, v173, v174
    v_or_b32 v76, v76, v175
    v_and_b32 v76, 1, v76
    v_cmp_ne_u32 vcc, 0, v76
    s_nop 0
    s_cmp_eq_u64 vcc, 0
    s_cbranch_scc1 STB_14
    s_sub_u32 s92, s92, 1
    s_cbranch_scc0 STR_13_l
    s_mov_b32 s67, 0
    s_branch STB_14
STR_19:
    s_mov_b32 s92, s67
STR_19_l:
    s_nop 7
    s_nop 7
    s_add_u32 s7, s75, 18894848
    buffer_load_dwordx4 v[60:63], v1, s[8:11], s7 offen sc1
    s_add_u32 s7, s75, 18916352
    buffer_load_dwordx4 v[64:67], v1, s[8:11], s7 offen sc1
    s_add_u32 s7, s75, 18937856
    buffer_load_dwordx4 v[68:71], v1, s[8:11], s7 offen sc1
    s_add_u32 s7, s75, 18959360
    buffer_load_dwordx4 v[72:75], v1, s[8:11], s7 offen sc1
    s_waitcnt vmcnt(0)
    v_or3_b32 v160, v60, v61, v62
    v_or3_b32 v160, v160, v63, v64
    v_or3_b32 v160, v160, v65, v66
    v_or3_b32 v160, v160, v67, v68
    v_or3_b32 v160, v160, v69, v70
    v_or3_b32 v160, v160, v71, v72
    v_or3_b32 v160, v160, v73, v74
    v_or_b32 v160, v160, v75
    v_and_b32 v160, 2, v160
    v_cmp_ne_u32 vcc, 0, v160
    s_nop 0
    s_cmp_eq_u64 vcc, 0
    s_cbranch_scc1 STB_20
    s_sub_u32 s92, s92, 1
    s_cbranch_scc0 STR_19_l
    s_mov_b32 s67, 0
    s_branch STB_20
STR_28:
    s_mov_b32 s92, s67
STR_28_l:
    s_nop 7
    s_nop 7
    s_add_u32 s7, s68, 18894848
    buffer_load_dwordx4 v[128:131], v1, s[8:11], s7 offen sc1
    s_add_u32 s7, s68, 18894848
    buffer_load_dwordx4 v[132:135], v44, s[8:11], s7 offen sc1
    s_add_u32 s7, s68, 18894848
    buffer_load_dwordx4 v[136:139], v45, s[8:11], s7 offen sc1
    s_add_u32 s7, s68, 18894848
    buffer_load_dwordx4 v[140:143], v46, s[8:11], s7 offen sc1
    s_waitcnt vmcnt(0)
    v_or3_b32 v36, v128, v129, v130
    v_or3_b32 v36, v36, v131, v132
    v_or3_b32 v36, v36, v133, v134
    v_or3_b32 v36, v36, v135, v136
    v_or3_b32 v36, v36, v137, v138
    v_or3_b32 v36, v36, v139, v140
    v_or3_b32 v36, v36, v141, v142
    v_or_b32 v36, v36, v143
    v_and_b32 v36, 1, v36
    v_cmp_ne_u32 vcc, 0, v36
    s_nop 0
    s_cmp_eq_u64 vcc, 0
    s_cbranch_scc1 STB_29
    s_sub_u32 s92, s92, 1
    s_cbranch_scc0 STR_28_l
    s_mov_b32 s67, 0
    s_branch STB_29
KVPOLL_31:
    s_sub_u32 s92, s92, 1
    s_cbranch_scc0 KVPOLL_31_go
    s_mov_b32 s67, 0
    s_branch KVDONE_32
KVPOLL_31_go:
    v_max_u32 v24, v64, v65
    s_add_u32 s85, s72, 2097152
    v_cmp_eq_u32 vcc, -1, v24
    s_nop 0
    s_mov_b64 exec, vcc
    s_cbranch_execz KVPOLL_31_s0
    buffer_load_dwordx2 v[64:65], v57, s[8:11], s85 offen sc1
KVPOLL_31_s0:
    s_mov_b64 exec, -1
    v_max_u32 v24, v66, v67
    s_add_u32 s85, s72, 2105344
    v_cmp_eq_u32 vcc, -1, v24
    s_nop 0
    s_mov_b64 exec, vcc
    s_cbranch_execz KVPOLL_31_s1
    buffer_load_dwordx2 v[66:67], v57, s[8:11], s85 offen sc1
KVPOLL_31_s1:
    s_mov_b64 exec, -1
    v_max_u32 v24, v68, v69
    s_add_u32 s85, s72, 2113536
    v_cmp_eq_u32 vcc, -1, v24
    s_nop 0
    s_mov_b64 exec, vcc
    s_cbranch_execz KVPOLL_31_s2
    buffer_load_dwordx2 v[68:69], v57, s[8:11], s85 offen sc1
KVPOLL_31_s2:
    s_mov_b64 exec, -1
    v_max_u32 v24, v70, v71
    s_add_u32 s85, s72, 2121728
    v_cmp_eq_u32 vcc, -1, v24
    s_nop 0
    s_mov_b64 exec, vcc
    s_cbranch_execz KVPOLL_31_s3
    buffer_load_dwordx2 v[70:71], v57, s[8:11], s85 offen sc1
KVPOLL_31_s3:
    s_mov_b64 exec, -1
    v_max_u32 v24, v72, v73
    s_add_u32 s85, s72, 2129920
    v_cmp_eq_u32 vcc, -1, v24
    s_nop 0
    s_mov_b64 exec, vcc
    s_cbranch_execz KVPOLL_31_s4
    buffer_load_dwordx2 v[72:73], v57, s[8:11], s85 offen sc1
KVPOLL_31_s4:
    s_mov_b64 exec, -1
    v_max_u32 v24, v74, v75
    s_add_u32 s85, s72, 2138112
    v_cmp_eq_u32 vcc, -1, v24
    s_nop 0
    s_mov_b64 exec, vcc
    s_cbranch_execz KVPOLL_31_s5
    buffer_load_dwordx2 v[74:75], v57, s[8:11], s85 offen sc1
KVPOLL_31_s5:
    s_mov_b64 exec, -1
    v_max_u32 v24, v76, v77
    s_add_u32 s85, s72, 2146304
    v_cmp_eq_u32 vcc, -1, v24
    s_nop 0
    s_mov_b64 exec, vcc
    s_cbranch_execz KVPOLL_31_s6
    buffer_load_dwordx2 v[76:77], v57, s[8:11], s85 offen sc1
KVPOLL_31_s6:
    s_mov_b64 exec, -1
    v_max_u32 v24, v78, v79
    s_add_u32 s85, s72, 2154496
    v_cmp_eq_u32 vcc, -1, v24
    s_nop 0
    s_mov_b64 exec, vcc
    s_cbranch_execz KVPOLL_31_s7
    buffer_load_dwordx2 v[78:79], v57, s[8:11], s85 offen sc1
KVPOLL_31_s7:
    s_mov_b64 exec, -1
    s_waitcnt vmcnt(0)
    s_branch KVCHK_33
POLL_34:
    s_mov_b32 s92, s67
POLL_34_l:
    buffer_load_dword v7, v6, s[8:11], s85 offen sc1
    s_waitcnt vmcnt(0)
    v_cmp_le_u32 vcc, 2, v7
    s_nop 0
    s_cmp_eq_u64 vcc, -1
    s_cbranch_scc1 PDONE_35
    s_sub_u32 s92, s92, 1
    s_cbranch_scc0 POLL_34_l
    s_mov_b32 s67, 0
    s_branch PDONE_35
POLL_37:
    s_mov_b32 s92, s67
POLL_37_l:
    buffer_load_dword v7, v168, s[8:11], s85 offen sc1
    s_waitcnt vmcnt(0)
    v_cmp_le_u32 vcc, 9, v7
    s_nop 0
    s_cmp_eq_u64 vcc, -1
    s_cbranch_scc1 PDONE_38
    s_sub_u32 s92, s92, 1
    s_cbranch_scc0 POLL_37_l
    s_mov_b32 s67, 0
    s_branch PDONE_38
STR_39:
    s_mov_b32 s92, s67
STR_39_l:
    s_nop 7
    s_nop 7
    s_add_u32 s7, s55, 18894848
    buffer_load_dwordx4 v[172:175], v1, s[8:11], s7 offen sc1
    s_waitcnt vmcnt(0)
    v_or3_b32 v76, v172, v173, v174
    v_or_b32 v76, v76, v175
    v_and_b32 v76, 2, v76
    v_cmp_ne_u32 vcc, 0, v76
    s_nop 0
    s_cmp_eq_u64 vcc, 0
    s_cbranch_scc1 STB_40
    s_sub_u32 s92, s92, 1
    s_cbranch_scc0 STR_39_l
    s_mov_b32 s67, 0
    s_branch STB_40
STR_45:
    s_mov_b32 s92, s67
STR_45_l:
    s_nop 7
    s_nop 7
    s_add_u32 s7, s75, 18894848
    buffer_load_dwordx4 v[96:99], v1, s[8:11], s7 offen sc1
    s_add_u32 s7, s75, 18916352
    buffer_load_dwordx4 v[100:103], v1, s[8:11], s7 offen sc1
    s_add_u32 s7, s75, 18937856
    buffer_load_dwordx4 v[104:107], v1, s[8:11], s7 offen sc1
    s_add_u32 s7, s75, 18959360
    buffer_load_dwordx4 v[108:111], v1, s[8:11], s7 offen sc1
    s_waitcnt vmcnt(0)
    v_or3_b32 v112, v96, v97, v98
    v_or3_b32 v112, v112, v99, v100
    v_or3_b32 v112, v112, v101, v102
    v_or3_b32 v112, v112, v103, v104
    v_or3_b32 v112, v112, v105, v106
    v_or3_b32 v112, v112, v107, v108
    v_or3_b32 v112, v112, v109, v110
    v_or_b32 v112, v112, v111
    v_and_b32 v112, 1, v112
    v_cmp_ne_u32 vcc, 0, v112
    s_nop 0
    s_cmp_eq_u64 vcc, 0
    s_cbranch_scc1 STB_46
    s_sub_u32 s92, s92, 1
    s_cbranch_scc0 STR_45_l
    s_mov_b32 s67, 0
    s_branch STB_46
SLOW_1:
    buffer_store_dwordx4 v[64:67], v60, s[8:11], s86 offen sc1
    buffer_store_dword v68, v61, s[8:11], s87 offen sc1
    s_branch BACK_1
SLOW_2:
    buffer_store_dwordx4 v[80:83], v60, s[8:11], s88 offen sc1
    buffer_store_dword v84, v61, s[8:11], s89 offen sc1
    s_branch BACK_2
SLOW_3:
    buffer_store_dword v7, v18, s[8:11], s77 offen sc1
    s_branch BACK_3
SLOW_4:
    buffer_store_dwordx4 v[60:63], v1, s[8:11], s82 offen sc1
    buffer_store_dwordx4 v[64:67], v1, s[8:11], s82 offen offset:1024 sc1
    buffer_store_dwordx2 v[68:69], v4, s[8:11], s83 offen sc1
    s_branch BACK_4
SLOW_5:
    buffer_store_dword v72, v5, s[8:11], s82 offen sc1
    s_branch BACK_5
SLOW_6:
    buffer_store_dword v7, v18, s[8:11], s76 offen sc1
    s_branch BACK_6
SLOW_7:
    buffer_store_dwordx4 v[60:63], v1, s[8:11], s82 offen sc1
    buffer_store_dwordx4 v[64:67], v1, s[8:11], s82 offen offset:1024 sc1
    buffer_store_dwordx2 v[68:69], v4, s[8:11], s83 offen sc1
    s_branch BACK_7
SLOW_8:
    buffer_store_dword v7, v18, s[8:11], s76 offen sc1
    s_branch BACK_8
SLOW_9:
    buffer_store_dwordx4 v[60:63], v1, s[8:11], s82 offen sc1
    buffer_store_dwordx4 v[64:67], v1, s[8:11], s82 offen offset:1024 sc1
    buffer_store_dwordx2 v[68:69], v4, s[8:11], s83 offen sc1
    s_branch BACK_9
SLOW_10:
    buffer_store_dword v72, v5, s[8:11], s82 offen sc1
    s_branch BACK_10
SLOW_11:
    buffer_store_dword v7, v18, s[8:11], s76 offen sc1
    s_branch BACK_11
SLOW_12:
    buffer_store_dword v7, v18, s[8:11], s76 offen sc1
    s_branch BACK_12
SLOW_13:
    buffer_store_dwordx4 v[8:11], v1, s[8:11], s82 offen sc1
    buffer_store_dwordx4 v[12:15], v1, s[8:11], s82 offen offset:1024 sc1
    buffer_store_dwordx2 v[16:17], v4, s[8:11], s83 offen sc1
    s_branch BACK_13
SLOW_14:
    buffer_store_dword v72, v5, s[8:11], s82 offen sc1
    s_branch BACK_14
SLOW_15:
    buffer_store_dword v7, v18, s[8:11], s76 offen sc1
    s_branch BACK_15
SLOW_16:
    buffer_store_dwordx4 v[64:67], v60, s[8:11], s86 offen sc1
    buffer_store_dword v68, v61, s[8:11], s87 offen sc1
    s_branch BACK_16
SLOW_17:
    buffer_store_dwordx4 v[80:83], v60, s[8:11], s88 offen sc1
    buffer_store_dword v84, v61, s[8:11], s89 offen sc1
    s_branch BACK_17
SLOW_18:
    buffer_store_dword v7, v18, s[8:11], s77 offen sc1
    s_branch BACK_18
SLOW_19:
    buffer_store_dwordx4 v[60:63], v1, s[8:11], s82 offen sc1
    buffer_store_dwordx4 v[64:67], v1, s[8:11], s82 offen offset:1024 sc1
    buffer_store_dwordx2 v[68:69], v4, s[8:11], s83 offen sc1
    s_branch BACK_19
SLOW_20:
    buffer_store_dword v72, v5, s[8:11], s82 offen sc1
    s_branch BACK_20
SLOW_21:
    buffer_store_dword v7, v18, s[8:11], s76 offen sc1
    s_branch BACK_21
SLOW_22:
    buffer_store_dwordx4 v[60:63], v1, s[8:11], s82 offen sc1
    buffer_store_dwordx4 v[64:67], v1, s[8:11], s82 offen offset:1024 sc1
    buffer_store_dwordx2 v[68:69], v4, s[8:11], s83 offen sc1
    s_branch BACK_22
SLOW_23:
    buffer_store_dword v7, v18, s[8:11], s76 offen sc1
    s_branch BACK_23
SLOW_24:
    buffer_store_dwordx4 v[60:63], v1, s[8:11], s82 offen sc1
    buffer_store_dwordx4 v[64:67], v1, s[8:11], s82 offen offset:1024 sc1
    buffer_store_dwordx2 v[68:69], v4, s[8:11], s83 offen sc1
    s_branch BACK_24
SLOW_25:
    buffer_store_dword v72, v5, s[8:11], s82 offen sc1
    s_branch BACK_25
SLOW_26:
    buffer_store_dword v7, v18, s[8:11], s76 offen sc1
    s_branch BACK_26
SLOW_27:
    buffer_store_dword v7, v18, s[8:11], s76 offen sc1
    s_branch BACK_27
CODE_END:
.section .rodata,"a"
.p2align 6
.amdhsa_kernel interleave_layers__linear_kernel_hedgehog__mixer_s_mlp__prompt_kernel
  .amdhsa_next_free_vgpr 512
  .amdhsa_next_free_sgpr 102
  .amdhsa_accum_offset 256
  .amdhsa_group_segment_fixed_size 0
  .amdhsa_kernarg_size 96
  .amdhsa_user_sgpr_count 2
  .amdhsa_user_sgpr_kernarg_segment_ptr 1
  .amdhsa_system_sgpr_workgroup_id_x 1
.end_amdhsa_kernel
```
